```python
import torch

def _softmax(x, axis=-1):
    return torch.softmax(x, dim=axis)
def _gelu(x):
    return torch.nn.functional.gelu(x, approximate="tanh")
def _silu(x):
    return torch.nn.functional.silu(x)
def _sigmoid(x):
    return torch.sigmoid(x)
def _layernorm(x, axis=-1, eps=1e-5):
    m = x.mean(dim=axis, keepdim=True)
    v = x.var(dim=axis, keepdim=True, unbiased=False)
    return (x - m) / torch.sqrt(v + eps)
def _scatter_add(tgt, idx, src, axis=0):
    return tgt.clone().index_add_(axis, idx, src)
def _segment_sum(src, seg, n):
    out = torch.zeros((n,) + src.shape[1:], dtype=src.dtype)
    return out.index_add_(0, seg, src)
def _pad(x, pw):
    flat = tuple(v for pair in reversed(pw) for v in pair)
    return torch.nn.functional.pad(x, flat)

kernel_name = 'parallel_sum__ssm_conv_s5__swiglu_ffn__prompt'

def setup_inputs():

    _w = (lambda a: (lambda t: t.to(torch.bfloat16) if t.is_floating_point() else t)(torch.as_tensor(a)))
    def _A_setup():
        B, S, D = 1, 2048, 576
        P = D
        Lambda_re = -0.5 * (lambda _x: torch.exp(torch.as_tensor(_x)))((lambda *s: torch.randn(*s, dtype=torch.bfloat16) * 0.8)(P))
        Lambda_im = (lambda *s: torch.randn(*s, dtype=torch.bfloat16) * 0.8)(P) * 1.0
        B_re = (lambda *s: torch.randn(*s, dtype=torch.bfloat16) * 0.8)(P, D) * (D ** -0.5)
        B_im = (lambda *s: torch.randn(*s, dtype=torch.bfloat16) * 0.8)(P, D) * (D ** -0.5)
        C_re = (lambda *s: torch.randn(*s, dtype=torch.bfloat16) * 0.8)(D, P) * (P ** -0.5)
        C_im = (lambda *s: torch.randn(*s, dtype=torch.bfloat16) * 0.8)(D, P) * (P ** -0.5)
        log_dt = (lambda *s: torch.randn(*s, dtype=torch.bfloat16) * 0.8)(P) * 0.3 - 2.0
        Dskip = (lambda *s: torch.randn(*s, dtype=torch.bfloat16) * 0.8)(D)
        return {
            "x": _w((lambda *s: torch.randn(*s, dtype=torch.bfloat16) * 0.05)(B, S, D)),
            "Lambda_re": _w(Lambda_re),
            "Lambda_im": _w(Lambda_im),
            "B_re": _w(B_re),
            "B_im": _w(B_im),
            "C_re": _w(C_re),
            "C_im": _w(C_im),
            "log_dt": _w(log_dt),
            "Dskip": _w(Dskip),
        }
    _A_in = _A_setup()

    def _B_setup():
        B, S, D, F = 1, 2048, 576, 4608
        return {
            "x": _w((lambda *s: torch.randn(*s, dtype=torch.bfloat16) * 0.05)(B, S, D)),
            "w_gate": _w((lambda *s: torch.randn(*s, dtype=torch.bfloat16) * 0.05)(D, F)),
            "w_up": _w((lambda *s: torch.randn(*s, dtype=torch.bfloat16) * 0.05)(D, F)),
            "w_down": _w((lambda *s: torch.randn(*s, dtype=torch.bfloat16) * 0.05)(F, D)),
        }
    _B_in = _B_setup()

    return {
        "A_x": _A_in["x"],
        "A_Lambda_re": _A_in["Lambda_re"],
        "A_Lambda_im": _A_in["Lambda_im"],
        "A_B_re": _A_in["B_re"],
        "A_B_im": _A_in["B_im"],
        "A_C_re": _A_in["C_re"],
        "A_C_im": _A_in["C_im"],
        "A_log_dt": _A_in["log_dt"],
        "A_Dskip": _A_in["Dskip"],
        "B_x": _B_in["x"],
        "B_w_gate": _B_in["w_gate"],
        "B_w_up": _B_in["w_up"],
        "B_w_down": _B_in["w_down"],
    }

def reference(A_x, A_Lambda_re, A_Lambda_im, A_B_re, A_B_im, A_C_re, A_C_im, A_log_dt, A_Dskip, B_x, B_w_gate, B_w_up, B_w_down):
    def _A_ref(x, Lambda_re, Lambda_im, B_re, B_im, C_re, C_im, log_dt, Dskip):
        Bsz, L, H = x.shape
        Lam = Lambda_re + 1j * Lambda_im
        Bmat = B_re + 1j * B_im
        Cmat = C_re + 1j * C_im
        dt = torch.exp(log_dt)
        Lam_bar = torch.exp(dt * Lam)
        B_bar = ((Lam_bar - 1.0) / Lam)[:, None] * Bmat
        Bu = torch.einsum("bld,pd->blp", x + 0j, B_bar)
        h = torch.zeros_like(Bu[:, 0, :])
        hs = []
        for t in range(L):
            h = Lam_bar[None, :] * h + Bu[:, t, :]
            hs.append(h)
        hseq = torch.stack(hs, 1)
        y = 2.0 * torch.einsum("blp,dp->bld", hseq, Cmat).real + x * Dskip[None, None, :]
        return y

    def _B_ref(x, w_gate, w_up, w_down):
        g = _silu(x @ w_gate)
        u = x @ w_up
        return (g * u) @ w_down

    x = A_x
    xn = _layernorm(x, axis=-1)
    return x + _A_ref(xn, A_Lambda_re, A_Lambda_im, A_B_re, A_B_im, A_C_re, A_C_im, A_log_dt, A_Dskip) + _B_ref(xn, B_w_gate, B_w_up, B_w_down)
```

```asm
; @launch grid=(256,1,1) block=(512,1,1) lds=138240
.amdgcn_target "amdgcn-amd-amdhsa--gfx950"
.text
.globl parallel_sum__ssm_conv_s5__swiglu_ffn__prompt_kernel
.p2align 8
.type parallel_sum__ssm_conv_s5__swiglu_ffn__prompt_kernel,@function
parallel_sum__ssm_conv_s5__swiglu_ffn__prompt_kernel:

    s_cmp_ge_u32 s2, 256
    s_cbranch_scc1 K1_done
    s_load_dwordx4 s[4:7], s[0:1], 80
    s_load_dwordx2 s[8:9], s[0:1], 120
    s_load_dwordx4 s[36:39], s[0:1], 24
    s_load_dwordx2 s[10:11], s[0:1], 96
    s_load_dwordx4 s[68:71], s[0:1], 0
    s_load_dwordx2 s[72:73], s[0:1], 16
    s_load_dwordx2 s[74:75], s[0:1], 56
    s_load_dwordx4 s[76:79], s[0:1], 40
    s_load_dwordx2 s[80:81], s[0:1], 112
    v_lshrrev_b32 v15, 6, v0
    v_and_b32 v0, 63, v0
    v_readfirstlane_b32 s20, v15
    v_lshlrev_b32 v1, 4, v0
    s_and_b32 s21, s2, 7
    s_lshr_b32 s22, s2, 3
    s_and_b32 s23, s22, 3
    s_lshl_b32 s21, s21, 2
    s_add_u32 s21, s21, s23
    s_lshr_b32 s22, s22, 2
    s_waitcnt lgkmcnt(0)
    s_cmp_gt_u32 s20, 1
    s_cbranch_scc1 KM_noxl
    s_mov_b32 s48, s68
    s_and_b32 s49, s69, 0xffff
    s_mov_b32 s50, 2359296
    s_mov_b32 s51, 0x00020000
    v_lshrrev_b32 v48, 4, v0
    v_and_b32 v49, 15, v0
    v_mul_u32_u24 v50, 1152, v48
    v_lshl_add_u32 v50, v49, 3, v50
    s_lshl_b32 s52, s22, 8
    s_lshl_b32 s53, s21, 3
    s_add_u32 s52, s52, s53
    s_lshl_b32 s53, s20, 2
    s_add_u32 s52, s52, s53
    s_mul_i32 s53, s52, 1152
    buffer_load_dwordx2 v[16:17], v50, s[48:51], s53 offen offset:0
    buffer_load_dwordx2 v[18:19], v50, s[48:51], s53 offen offset:128
    buffer_load_dwordx2 v[20:21], v50, s[48:51], s53 offen offset:256
    buffer_load_dwordx2 v[22:23], v50, s[48:51], s53 offen offset:384
    buffer_load_dwordx2 v[24:25], v50, s[48:51], s53 offen offset:512
    buffer_load_dwordx2 v[26:27], v50, s[48:51], s53 offen offset:640
    buffer_load_dwordx2 v[28:29], v50, s[48:51], s53 offen offset:768
    buffer_load_dwordx2 v[30:31], v50, s[48:51], s53 offen offset:896
    buffer_load_dwordx2 v[32:33], v50, s[48:51], s53 offen offset:1024
KM_noxl:
    s_and_b32 s23, s20, 3
    s_lshl_b32 s23, s23, 4
    s_mul_i32 s24, s21, 288
    s_movk_i32 s25, 3641
    s_movk_i32 s26, 9216
    s_mul_i32 s27, s20, 4608
    s_add_u32 s27, s27, 13824
    s_mul_i32 s29, s20, 576
    s_lshl_b32 s28, s22, 3
    s_add_u32 s28, s28, s20
    s_mul_i32 s28, s28, 36864
    v_mov_b32 v184, v0
    v_mul_lo_u32 v185, v184, s25
    v_lshrrev_b32 v185, 16, v185
    v_mul_u32_u24 v186, 18, v185
    v_sub_u32 v186, v184, v186
    v_add_u32 v185, s23, v185
    v_and_b32 v187, 0x23, v185
    v_bfe_u32 v188, v185, 2, 2
    v_lshl_add_u32 v187, v188, 3, v187
    v_bfe_u32 v188, v185, 4, 1
    v_lshl_add_u32 v187, v188, 2, v187
    v_mul_lo_u32 v187, v187, s26
    v_lshl_add_u32 v187, v186, 4, v187
    v_add_u32 v2, s24, v187
    v_add_u32 v184, 64, v0
    v_mul_lo_u32 v185, v184, s25
    v_lshrrev_b32 v185, 16, v185
    v_mul_u32_u24 v186, 18, v185
    v_sub_u32 v186, v184, v186
    v_add_u32 v185, s23, v185
    v_and_b32 v187, 0x23, v185
    v_bfe_u32 v188, v185, 2, 2
    v_lshl_add_u32 v187, v188, 3, v187
    v_bfe_u32 v188, v185, 4, 1
    v_lshl_add_u32 v187, v188, 2, v187
    v_mul_lo_u32 v187, v187, s26
    v_lshl_add_u32 v187, v186, 4, v187
    v_add_u32 v3, s24, v187
    v_add_u32 v184, 128, v0
    v_mul_lo_u32 v185, v184, s25
    v_lshrrev_b32 v185, 16, v185
    v_mul_u32_u24 v186, 18, v185
    v_sub_u32 v186, v184, v186
    v_add_u32 v185, s23, v185
    v_and_b32 v187, 0x23, v185
    v_bfe_u32 v188, v185, 2, 2
    v_lshl_add_u32 v187, v188, 3, v187
    v_bfe_u32 v188, v185, 4, 1
    v_lshl_add_u32 v187, v188, 2, v187
    v_mul_lo_u32 v187, v187, s26
    v_lshl_add_u32 v187, v186, 4, v187
    v_add_u32 v4, s24, v187
    v_add_u32 v184, 192, v0
    v_mul_lo_u32 v185, v184, s25
    v_lshrrev_b32 v185, 16, v185
    v_mul_u32_u24 v186, 18, v185
    v_sub_u32 v186, v184, v186
    v_add_u32 v185, s23, v185
    v_and_b32 v187, 0x23, v185
    v_bfe_u32 v188, v185, 2, 2
    v_lshl_add_u32 v187, v188, 3, v187
    v_bfe_u32 v188, v185, 4, 1
    v_lshl_add_u32 v187, v188, 2, v187
    v_mul_lo_u32 v187, v187, s26
    v_lshl_add_u32 v187, v186, 4, v187
    v_add_u32 v5, s24, v187
    v_add_u32 v184, 256, v0
    v_mul_lo_u32 v185, v184, s25
    v_lshrrev_b32 v185, 16, v185
    v_mul_u32_u24 v186, 18, v185
    v_sub_u32 v186, v184, v186
    v_add_u32 v185, s23, v185
    v_and_b32 v187, 0x23, v185
    v_bfe_u32 v188, v185, 2, 2
    v_lshl_add_u32 v187, v188, 3, v187
    v_bfe_u32 v188, v185, 4, 1
    v_lshl_add_u32 v187, v188, 2, v187
    v_mul_lo_u32 v187, v187, s26
    v_lshl_add_u32 v187, v186, 4, v187
    v_add_u32 v6, s24, v187
    s_mul_i32 s23, s20, 36
    v_add_u32 v184, s23, v0
    v_lshrrev_b32 v185, 3, v184
    v_xor_b32 v186, v184, v185
    v_and_b32 v186, 7, v186
    s_mul_i32 s23, s21, 18
    s_cmp_lt_u32 s20, 4
    s_cselect_b32 s24, 0, 18
    s_sub_u32 s23, s23, s24
    v_add_u32 v185, s23, v185
    v_mul_u32_u24 v185, 1152, v185
    v_lshl_add_u32 v7, v186, 4, v185
    s_waitcnt lgkmcnt(0)
    s_cmp_lt_u32 s20, 4
    s_cselect_b32 s12, s4, s6
    s_cselect_b32 s13, s5, s7
    s_cselect_b32 s40, s36, s38
    s_cselect_b32 s41, s37, s39
    s_and_b32 s13, s13, 0xffff
    s_mov_b32 s14, 5308416
    s_mov_b32 s15, 0x00020000
    s_and_b32 s41, s41, 0xffff
    s_mov_b32 s42, 663552
    s_mov_b32 s43, 0x00020000
    s_mov_b32 s16, s8
    s_and_b32 s17, s9, 0xffff
    s_mov_b32 s18, 268435456
    s_mov_b32 s19, 0x00020000
    s_mov_b32 s44, s10
    s_and_b32 s45, s11, 0xffff
    s_mov_b32 s46, 5308416
    s_mov_b32 s47, 0x00020000
    s_mov_b32 s64, s80
    s_and_b32 s65, s81, 0xffff
    s_mov_b32 s66, 256
    s_mov_b32 s67, 0x00020000
    s_lshl_b32 s101, s2, 8
    s_add_u32 s101, s101, 49283072
    s_bitcmp1_b32 0x63, s20
    s_cbranch_scc1 KM_nodma
    s_add_u32 m0, s27, 0
    s_mov_b32 s30, 0
    buffer_load_dwordx4 v2, s[12:15], s30 offen lds
    s_add_u32 m0, s27, 1024
    s_mov_b32 s30, 0
    buffer_load_dwordx4 v3, s[12:15], s30 offen lds
    s_add_u32 m0, s27, 2048
    s_mov_b32 s30, 0
    buffer_load_dwordx4 v4, s[12:15], s30 offen lds
    s_add_u32 m0, s27, 3072
    s_mov_b32 s30, 0
    buffer_load_dwordx4 v5, s[12:15], s30 offen lds
    s_add_u32 m0, s27, 4096
    s_mov_b32 s30, 0
    s_mov_b32 exec_hi, 0
    buffer_load_dwordx4 v6, s[12:15], s30 offen lds
    s_mov_b32 exec_hi, -1
    s_add_u32 m0, s29, 0
    s_movk_i32 s30, 0
    s_mov_b32 exec_hi, 0xf
    buffer_load_dwordx4 v7, s[40:43], s30 offen lds
    s_mov_b32 exec_hi, -1
    s_add_u32 m0, s27, 36864
    s_mov_b32 s30, 589824
    buffer_load_dwordx4 v2, s[12:15], s30 offen lds
    s_add_u32 m0, s27, 37888
    s_mov_b32 s30, 589824
    buffer_load_dwordx4 v3, s[12:15], s30 offen lds
    s_add_u32 m0, s27, 38912
    s_mov_b32 s30, 589824
    buffer_load_dwordx4 v4, s[12:15], s30 offen lds
    s_add_u32 m0, s27, 39936
    s_mov_b32 s30, 589824
    buffer_load_dwordx4 v5, s[12:15], s30 offen lds
    s_add_u32 m0, s27, 40960
    s_mov_b32 s30, 589824
    s_mov_b32 exec_hi, 0
    buffer_load_dwordx4 v6, s[12:15], s30 offen lds
    s_mov_b32 exec_hi, -1
    s_add_u32 m0, s29, 4608
    s_movk_i32 s30, 128
    s_mov_b32 exec_hi, 0xf
    buffer_load_dwordx4 v7, s[40:43], s30 offen lds
    s_mov_b32 exec_hi, -1
KM_nodma:
    v_lshrrev_b32 v184, 2, v0
    v_mul_u32_u24 v184, 288, v184
    v_and_b32 v185, 3, v0
    v_lshl_add_u32 v11, v185, 3, v184
    v_add_u32 v11, 13824, v11
    v_add_u32 v12, 36864, v11
    v_add_u32 v13, 73728, v11
    v_and_b32 v184, 15, v0
    v_lshrrev_b32 v185, 4, v0
    v_xor_b32 v186, v184, v185
    v_and_b32 v186, 7, v186
    v_lshlrev_b32 v8, 7, v184
    v_lshl_add_u32 v8, v186, 4, v8
    v_xor_b32 v9, 64, v8
    v_and_b32 v187, 3, v0
    v_xor_b32 v186, v187, v185
    v_lshlrev_b32 v196, 7, v187
    v_lshl_add_u32 v196, v186, 4, v196
    v_add_u32 v196, 4096, v196
    v_xor_b32 v197, 64, v196
    s_and_b32 s23, s20, 3
    s_mul_i32 s23, s23, 36
    v_add_u32 v184, s23, v0
    v_mul_u32_u24 v185, 3641, v184
    v_lshrrev_b32 v185, 16, v185
    v_mul_u32_u24 v186, 18, v185
    v_sub_u32 v186, v184, v186
    s_lshl_b32 s23, s22, 3
    v_add_u32 v185, s23, v185
    v_mul_lo_u32 v185, v185, s26
    v_lshl_add_u32 v185, v186, 4, v185
    s_mul_i32 s24, s21, 288
    v_add_u32 v14, s24, v185
    s_bitcmp1_b32 0x63, s20
    s_cbranch_scc1 KM_nopf0
    s_mov_b32 s49, 1179648
    s_mov_b32 exec_hi, 0xf
    buffer_load_dwordx4 v[188:191], v14, s[12:15], s49 offen
    s_mov_b32 exec_hi, -1
    s_mov_b32 s49, 1769472
    s_mov_b32 exec_hi, 0xf
    buffer_load_dwordx4 v[188:191], v14, s[12:15], s49 offen
    s_mov_b32 exec_hi, -1
KM_nopf0:
    s_mul_i32 s49, s21, 18
    v_add_u32 v193, s49, v0
    v_lshlrev_b32 v193, 4, v193
    v_lshl_add_u32 v10, s20, 10, v1
    s_mul_i32 s48, s2, 20736
    s_add_u32 s46, s48, 20736
    s_cmp_gt_u32 s20, 1
    s_cbranch_scc1 KM_r1
    s_lshl_b32 s52, s22, 8
    s_lshl_b32 s53, s21, 3
    s_add_u32 s52, s52, s53
    s_lshl_b32 s53, s20, 2
    s_add_u32 s52, s52, s53
    v_add_u32 v36, s52, v48
    v_lshrrev_b32 v37, 5, v36
    v_mul_u32_u24 v37, 36864, v37
    v_bfe_u32 v38, v36, 4, 1
    v_lshl_add_u32 v37, v38, 10, v37
    v_and_b32 v38, 15, v36
    v_lshl_add_u32 v37, v38, 4, v37
    v_lshrrev_b32 v38, 3, v49
    v_lshl_add_u32 v37, v38, 11, v37
    v_bfe_u32 v38, v49, 1, 2
    v_lshl_add_u32 v37, v38, 8, v37
    v_and_b32 v38, 1, v49
    v_lshl_add_u32 v37, v38, 3, v37
    v_mov_b32 v38, 0x3f803f80
    v_mov_b32 v34, 0
    v_mov_b32 v35, 0
    s_waitcnt vmcnt(0)
    v_dot2_f32_bf16 v34, v16, v38, v34
    v_dot2_f32_bf16 v35, v17, v38, v35
    v_dot2_f32_bf16 v34, v18, v38, v34
    v_dot2_f32_bf16 v35, v19, v38, v35
    v_dot2_f32_bf16 v34, v20, v38, v34
    v_dot2_f32_bf16 v35, v21, v38, v35
    v_dot2_f32_bf16 v34, v22, v38, v34
    v_dot2_f32_bf16 v35, v23, v38, v35
    v_dot2_f32_bf16 v34, v24, v38, v34
    v_dot2_f32_bf16 v35, v25, v38, v35
    v_dot2_f32_bf16 v34, v26, v38, v34
    v_dot2_f32_bf16 v35, v27, v38, v35
    v_dot2_f32_bf16 v34, v28, v38, v34
    v_dot2_f32_bf16 v35, v29, v38, v35
    v_dot2_f32_bf16 v34, v30, v38, v34
    v_dot2_f32_bf16 v35, v31, v38, v35
    v_dot2_f32_bf16 v34, v32, v38, v34
    v_dot2_f32_bf16 v35, v33, v38, v35
    s_nop 2
    v_add_f32 v34, v34, v35
    s_nop 1
    v_add_f32_dpp v34, v34, v34 row_ror:8 row_mask:0xf bank_mask:0xf
    s_nop 1
    v_add_f32_dpp v34, v34, v34 row_ror:4 row_mask:0xf bank_mask:0xf
    s_nop 1
    v_add_f32_dpp v34, v34, v34 row_ror:2 row_mask:0xf bank_mask:0xf
    s_nop 1
    v_add_f32_dpp v34, v34, v34 row_ror:1 row_mask:0xf bank_mask:0xf
    v_mul_f32 v34, 0x3ae38e39, v34
    v_mov_b32 v35, 0
    v_mov_b32 v36, 0
    v_lshlrev_b32 v40, 16, v16
    v_and_b32 v41, 0xffff0000, v16
    v_sub_f32 v40, v40, v34
    v_sub_f32 v41, v41, v34
    v_fmac_f32 v35, v40, v40
    v_fmac_f32 v36, v41, v41
    v_lshlrev_b32 v42, 16, v17
    v_and_b32 v43, 0xffff0000, v17
    v_sub_f32 v42, v42, v34
    v_sub_f32 v43, v43, v34
    v_fmac_f32 v35, v42, v42
    v_fmac_f32 v36, v43, v43
    v_lshlrev_b32 v44, 16, v18
    v_and_b32 v45, 0xffff0000, v18
    v_sub_f32 v44, v44, v34
    v_sub_f32 v45, v45, v34
    v_fmac_f32 v35, v44, v44
    v_fmac_f32 v36, v45, v45
    v_lshlrev_b32 v46, 16, v19
    v_and_b32 v47, 0xffff0000, v19
    v_sub_f32 v46, v46, v34
    v_sub_f32 v47, v47, v34
    v_fmac_f32 v35, v46, v46
    v_fmac_f32 v36, v47, v47
    v_lshlrev_b32 v40, 16, v20
    v_and_b32 v41, 0xffff0000, v20
    v_sub_f32 v40, v40, v34
    v_sub_f32 v41, v41, v34
    v_fmac_f32 v35, v40, v40
    v_fmac_f32 v36, v41, v41
    v_lshlrev_b32 v42, 16, v21
    v_and_b32 v43, 0xffff0000, v21
    v_sub_f32 v42, v42, v34
    v_sub_f32 v43, v43, v34
    v_fmac_f32 v35, v42, v42
    v_fmac_f32 v36, v43, v43
    v_lshlrev_b32 v44, 16, v22
    v_and_b32 v45, 0xffff0000, v22
    v_sub_f32 v44, v44, v34
    v_sub_f32 v45, v45, v34
    v_fmac_f32 v35, v44, v44
    v_fmac_f32 v36, v45, v45
    v_lshlrev_b32 v46, 16, v23
    v_and_b32 v47, 0xffff0000, v23
    v_sub_f32 v46, v46, v34
    v_sub_f32 v47, v47, v34
    v_fmac_f32 v35, v46, v46
    v_fmac_f32 v36, v47, v47
    v_lshlrev_b32 v40, 16, v24
    v_and_b32 v41, 0xffff0000, v24
    v_sub_f32 v40, v40, v34
    v_sub_f32 v41, v41, v34
    v_fmac_f32 v35, v40, v40
    v_fmac_f32 v36, v41, v41
    v_lshlrev_b32 v42, 16, v25
    v_and_b32 v43, 0xffff0000, v25
    v_sub_f32 v42, v42, v34
    v_sub_f32 v43, v43, v34
    v_fmac_f32 v35, v42, v42
    v_fmac_f32 v36, v43, v43
    v_lshlrev_b32 v44, 16, v26
    v_and_b32 v45, 0xffff0000, v26
    v_sub_f32 v44, v44, v34
    v_sub_f32 v45, v45, v34
    v_fmac_f32 v35, v44, v44
    v_fmac_f32 v36, v45, v45
    v_lshlrev_b32 v46, 16, v27
    v_and_b32 v47, 0xffff0000, v27
    v_sub_f32 v46, v46, v34
    v_sub_f32 v47, v47, v34
    v_fmac_f32 v35, v46, v46
    v_fmac_f32 v36, v47, v47
    v_lshlrev_b32 v40, 16, v28
    v_and_b32 v41, 0xffff0000, v28
    v_sub_f32 v40, v40, v34
    v_sub_f32 v41, v41, v34
    v_fmac_f32 v35, v40, v40
    v_fmac_f32 v36, v41, v41
    v_lshlrev_b32 v42, 16, v29
    v_and_b32 v43, 0xffff0000, v29
    v_sub_f32 v42, v42, v34
    v_sub_f32 v43, v43, v34
    v_fmac_f32 v35, v42, v42
    v_fmac_f32 v36, v43, v43
    v_lshlrev_b32 v44, 16, v30
    v_and_b32 v45, 0xffff0000, v30
    v_sub_f32 v44, v44, v34
    v_sub_f32 v45, v45, v34
    v_fmac_f32 v35, v44, v44
    v_fmac_f32 v36, v45, v45
    v_lshlrev_b32 v46, 16, v31
    v_and_b32 v47, 0xffff0000, v31
    v_sub_f32 v46, v46, v34
    v_sub_f32 v47, v47, v34
    v_fmac_f32 v35, v46, v46
    v_fmac_f32 v36, v47, v47
    v_lshlrev_b32 v40, 16, v32
    v_and_b32 v41, 0xffff0000, v32
    v_sub_f32 v40, v40, v34
    v_sub_f32 v41, v41, v34
    v_fmac_f32 v35, v40, v40
    v_fmac_f32 v36, v41, v41
    v_lshlrev_b32 v42, 16, v33
    v_and_b32 v43, 0xffff0000, v33
    v_sub_f32 v42, v42, v34
    v_sub_f32 v43, v43, v34
    v_fmac_f32 v35, v42, v42
    v_fmac_f32 v36, v43, v43
    v_add_f32 v35, v35, v36
    s_nop 1
    v_add_f32_dpp v35, v35, v35 row_ror:8 row_mask:0xf bank_mask:0xf
    s_nop 1
    v_add_f32_dpp v35, v35, v35 row_ror:4 row_mask:0xf bank_mask:0xf
    s_nop 1
    v_add_f32_dpp v35, v35, v35 row_ror:2 row_mask:0xf bank_mask:0xf
    s_nop 1
    v_add_f32_dpp v35, v35, v35 row_ror:1 row_mask:0xf bank_mask:0xf
    v_mul_f32 v35, 0x3ae38e39, v35
    v_cvt_pk_bf16_f32 v34, 0, v34
    v_cvt_pk_bf16_f32 v35, 0, v35
    v_add_f32 v35, 0x3727c5ac, v35
    v_cvt_pk_bf16_f32 v35, 0, v35
    v_sqrt_f32 v35, v35
    s_nop 0
    v_cvt_pk_bf16_f32 v35, 0, v35
    v_rcp_f32 v35, v35
    s_nop 0
    v_lshlrev_b32 v40, 16, v16
    v_and_b32 v41, 0xffff0000, v16
    v_sub_f32 v40, v40, v34
    v_sub_f32 v41, v41, v34
    v_cvt_pk_bf16_f32 v40, 0, v40
    v_cvt_pk_bf16_f32 v41, 0, v41
    v_mul_f32 v40, v40, v35
    v_mul_f32 v41, v41, v35
    v_cvt_pk_bf16_f32 v16, v40, v41
    v_lshlrev_b32 v42, 16, v17
    v_and_b32 v43, 0xffff0000, v17
    v_sub_f32 v42, v42, v34
    v_sub_f32 v43, v43, v34
    v_cvt_pk_bf16_f32 v42, 0, v42
    v_cvt_pk_bf16_f32 v43, 0, v43
    v_mul_f32 v42, v42, v35
    v_mul_f32 v43, v43, v35
    v_cvt_pk_bf16_f32 v17, v42, v43
    s_mov_b32 s53, 0
    buffer_store_dwordx2 v[16:17], v37, s[16:19], s53 offen sc1
    v_lshlrev_b32 v44, 16, v18
    v_and_b32 v45, 0xffff0000, v18
    v_sub_f32 v44, v44, v34
    v_sub_f32 v45, v45, v34
    v_cvt_pk_bf16_f32 v44, 0, v44
    v_cvt_pk_bf16_f32 v45, 0, v45
    v_mul_f32 v44, v44, v35
    v_mul_f32 v45, v45, v35
    v_cvt_pk_bf16_f32 v18, v44, v45
    v_lshlrev_b32 v46, 16, v19
    v_and_b32 v47, 0xffff0000, v19
    v_sub_f32 v46, v46, v34
    v_sub_f32 v47, v47, v34
    v_cvt_pk_bf16_f32 v46, 0, v46
    v_cvt_pk_bf16_f32 v47, 0, v47
    v_mul_f32 v46, v46, v35
    v_mul_f32 v47, v47, v35
    v_cvt_pk_bf16_f32 v19, v46, v47
    s_mov_b32 s53, 4096
    buffer_store_dwordx2 v[18:19], v37, s[16:19], s53 offen sc1
    v_lshlrev_b32 v40, 16, v20
    v_and_b32 v41, 0xffff0000, v20
    v_sub_f32 v40, v40, v34
    v_sub_f32 v41, v41, v34
    v_cvt_pk_bf16_f32 v40, 0, v40
    v_cvt_pk_bf16_f32 v41, 0, v41
    v_mul_f32 v40, v40, v35
    v_mul_f32 v41, v41, v35
    v_cvt_pk_bf16_f32 v20, v40, v41
    v_lshlrev_b32 v42, 16, v21
    v_and_b32 v43, 0xffff0000, v21
    v_sub_f32 v42, v42, v34
    v_sub_f32 v43, v43, v34
    v_cvt_pk_bf16_f32 v42, 0, v42
    v_cvt_pk_bf16_f32 v43, 0, v43
    v_mul_f32 v42, v42, v35
    v_mul_f32 v43, v43, v35
    v_cvt_pk_bf16_f32 v21, v42, v43
    s_mov_b32 s53, 8192
    buffer_store_dwordx2 v[20:21], v37, s[16:19], s53 offen sc1
    v_lshlrev_b32 v44, 16, v22
    v_and_b32 v45, 0xffff0000, v22
    v_sub_f32 v44, v44, v34
    v_sub_f32 v45, v45, v34
    v_cvt_pk_bf16_f32 v44, 0, v44
    v_cvt_pk_bf16_f32 v45, 0, v45
    v_mul_f32 v44, v44, v35
    v_mul_f32 v45, v45, v35
    v_cvt_pk_bf16_f32 v22, v44, v45
    v_lshlrev_b32 v46, 16, v23
    v_and_b32 v47, 0xffff0000, v23
    v_sub_f32 v46, v46, v34
    v_sub_f32 v47, v47, v34
    v_cvt_pk_bf16_f32 v46, 0, v46
    v_cvt_pk_bf16_f32 v47, 0, v47
    v_mul_f32 v46, v46, v35
    v_mul_f32 v47, v47, v35
    v_cvt_pk_bf16_f32 v23, v46, v47
    s_mov_b32 s53, 12288
    buffer_store_dwordx2 v[22:23], v37, s[16:19], s53 offen sc1
    v_lshlrev_b32 v40, 16, v24
    v_and_b32 v41, 0xffff0000, v24
    v_sub_f32 v40, v40, v34
    v_sub_f32 v41, v41, v34
    v_cvt_pk_bf16_f32 v40, 0, v40
    v_cvt_pk_bf16_f32 v41, 0, v41
    v_mul_f32 v40, v40, v35
    v_mul_f32 v41, v41, v35
    v_cvt_pk_bf16_f32 v24, v40, v41
    v_lshlrev_b32 v42, 16, v25
    v_and_b32 v43, 0xffff0000, v25
    v_sub_f32 v42, v42, v34
    v_sub_f32 v43, v43, v34
    v_cvt_pk_bf16_f32 v42, 0, v42
    v_cvt_pk_bf16_f32 v43, 0, v43
    v_mul_f32 v42, v42, v35
    v_mul_f32 v43, v43, v35
    v_cvt_pk_bf16_f32 v25, v42, v43
    s_mov_b32 s53, 16384
    buffer_store_dwordx2 v[24:25], v37, s[16:19], s53 offen sc1
    v_lshlrev_b32 v44, 16, v26
    v_and_b32 v45, 0xffff0000, v26
    v_sub_f32 v44, v44, v34
    v_sub_f32 v45, v45, v34
    v_cvt_pk_bf16_f32 v44, 0, v44
    v_cvt_pk_bf16_f32 v45, 0, v45
    v_mul_f32 v44, v44, v35
    v_mul_f32 v45, v45, v35
    v_cvt_pk_bf16_f32 v26, v44, v45
    v_lshlrev_b32 v46, 16, v27
    v_and_b32 v47, 0xffff0000, v27
    v_sub_f32 v46, v46, v34
    v_sub_f32 v47, v47, v34
    v_cvt_pk_bf16_f32 v46, 0, v46
    v_cvt_pk_bf16_f32 v47, 0, v47
    v_mul_f32 v46, v46, v35
    v_mul_f32 v47, v47, v35
    v_cvt_pk_bf16_f32 v27, v46, v47
    s_mov_b32 s53, 20480
    buffer_store_dwordx2 v[26:27], v37, s[16:19], s53 offen sc1
    v_lshlrev_b32 v40, 16, v28
    v_and_b32 v41, 0xffff0000, v28
    v_sub_f32 v40, v40, v34
    v_sub_f32 v41, v41, v34
    v_cvt_pk_bf16_f32 v40, 0, v40
    v_cvt_pk_bf16_f32 v41, 0, v41
    v_mul_f32 v40, v40, v35
    v_mul_f32 v41, v41, v35
    v_cvt_pk_bf16_f32 v28, v40, v41
    v_lshlrev_b32 v42, 16, v29
    v_and_b32 v43, 0xffff0000, v29
    v_sub_f32 v42, v42, v34
    v_sub_f32 v43, v43, v34
    v_cvt_pk_bf16_f32 v42, 0, v42
    v_cvt_pk_bf16_f32 v43, 0, v43
    v_mul_f32 v42, v42, v35
    v_mul_f32 v43, v43, v35
    v_cvt_pk_bf16_f32 v29, v42, v43
    s_mov_b32 s53, 24576
    buffer_store_dwordx2 v[28:29], v37, s[16:19], s53 offen sc1
    v_lshlrev_b32 v44, 16, v30
    v_and_b32 v45, 0xffff0000, v30
    v_sub_f32 v44, v44, v34
    v_sub_f32 v45, v45, v34
    v_cvt_pk_bf16_f32 v44, 0, v44
    v_cvt_pk_bf16_f32 v45, 0, v45
    v_mul_f32 v44, v44, v35
    v_mul_f32 v45, v45, v35
    v_cvt_pk_bf16_f32 v30, v44, v45
    v_lshlrev_b32 v46, 16, v31
    v_and_b32 v47, 0xffff0000, v31
    v_sub_f32 v46, v46, v34
    v_sub_f32 v47, v47, v34
    v_cvt_pk_bf16_f32 v46, 0, v46
    v_cvt_pk_bf16_f32 v47, 0, v47
    v_mul_f32 v46, v46, v35
    v_mul_f32 v47, v47, v35
    v_cvt_pk_bf16_f32 v31, v46, v47
    s_mov_b32 s53, 28672
    buffer_store_dwordx2 v[30:31], v37, s[16:19], s53 offen sc1
    v_lshlrev_b32 v40, 16, v32
    v_and_b32 v41, 0xffff0000, v32
    v_sub_f32 v40, v40, v34
    v_sub_f32 v41, v41, v34
    v_cvt_pk_bf16_f32 v40, 0, v40
    v_cvt_pk_bf16_f32 v41, 0, v41
    v_mul_f32 v40, v40, v35
    v_mul_f32 v41, v41, v35
    v_cvt_pk_bf16_f32 v32, v40, v41
    v_lshlrev_b32 v42, 16, v33
    v_and_b32 v43, 0xffff0000, v33
    v_sub_f32 v42, v42, v34
    v_sub_f32 v43, v43, v34
    v_cvt_pk_bf16_f32 v42, 0, v42
    v_cvt_pk_bf16_f32 v43, 0, v43
    v_mul_f32 v42, v42, v35
    v_mul_f32 v43, v43, v35
    v_cvt_pk_bf16_f32 v33, v42, v43
    s_mov_b32 s53, 32768
    buffer_store_dwordx2 v[32:33], v37, s[16:19], s53 offen sc1
    s_waitcnt vmcnt(0)
    s_branch KM_r_end
KM_r1:
    s_cmp_gt_u32 s20, 4
    s_cbranch_scc1 KM_r2
    s_sub_u32 s52, s20, 2
    s_lshl_b32 s52, s52, 6
    v_add_u32 v40, s52, v0
    s_mov_b32 s57, 33554432
    s_mov_b32 s58, 7456541
    s_mul_i32 s59, s2, 324
    v_add_u32 v41, 0, v40
    v_min_u32 v41, 323, v41
    v_add_u32 v41, s59, v41
    v_mul_hi_u32 v42, v41, s58
    v_mul_u32_u24 v43, 576, v42
    v_sub_u32 v43, v41, v43
    v_cmp_le_u32 vcc, 72, v42
    v_subrev_u32 v44, 72, v42
    v_mov_b32 v46, s76
    v_mov_b32 v47, s77
    v_mov_b32 v48, s78
    v_mov_b32 v49, s79
    v_cndmask_b32 v44, v42, v44, vcc
    v_cndmask_b32 v46, v46, v48, vcc
    v_cndmask_b32 v47, v47, v49, vcc
    v_mov_b32 v25, 0x80008000
    v_cndmask_b32 v25, 0, v25, vcc
    v_mul_u32_u24 v45, 9216, v44
    v_lshl_add_u32 v45, v43, 1, v45
    v_lshlrev_b32 v50, 1, v43
    v_add_u32 v51, 1, v50
    v_cndmask_b32 v50, v50, v51, vcc
    v_and_b32 v51, 0xffffffe3, v50
    v_bfe_u32 v60, v50, 2, 1
    v_lshl_add_u32 v51, v60, 4, v51
    v_bfe_u32 v60, v50, 3, 2
    v_lshl_add_u32 v50, v60, 2, v51
    v_mul_u32_u24 v50, 1152, v50
    v_lshl_add_u32 v24, v44, 4, v50
    v_add_co_u32 v46, vcc, v46, v45
    s_nop 1
    v_addc_co_u32 v47, vcc, 0, v47, vcc
    v_add_co_u32 v48, vcc, 4608, v46
    s_nop 1
    v_addc_co_u32 v49, vcc, 0, v47, vcc
    global_load_ushort v16, v[46:47], off offset:0
    global_load_ushort v17, v[46:47], off offset:1152
    global_load_ushort v18, v[46:47], off offset:2304
    global_load_ushort v19, v[46:47], off offset:3456
    global_load_ushort v20, v[48:49], off offset:0
    global_load_ushort v21, v[48:49], off offset:1152
    global_load_ushort v22, v[48:49], off offset:2304
    global_load_ushort v23, v[48:49], off offset:3456
    v_add_u32 v41, 192, v40
    v_min_u32 v41, 323, v41
    v_add_u32 v41, s59, v41
    v_mul_hi_u32 v42, v41, s58
    v_mul_u32_u24 v43, 576, v42
    v_sub_u32 v43, v41, v43
    v_cmp_le_u32 vcc, 72, v42
    v_subrev_u32 v44, 72, v42
    v_mov_b32 v46, s76
    v_mov_b32 v47, s77
    v_mov_b32 v48, s78
    v_mov_b32 v49, s79
    v_cndmask_b32 v44, v42, v44, vcc
    v_cndmask_b32 v46, v46, v48, vcc
    v_cndmask_b32 v47, v47, v49, vcc
    v_mov_b32 v37, 0x80008000
    v_cndmask_b32 v37, 0, v37, vcc
    v_mul_u32_u24 v45, 9216, v44
    v_lshl_add_u32 v45, v43, 1, v45
    v_lshlrev_b32 v50, 1, v43
    v_add_u32 v51, 1, v50
    v_cndmask_b32 v50, v50, v51, vcc
    v_and_b32 v51, 0xffffffe3, v50
    v_bfe_u32 v60, v50, 2, 1
    v_lshl_add_u32 v51, v60, 4, v51
    v_bfe_u32 v60, v50, 3, 2
    v_lshl_add_u32 v50, v60, 2, v51
    v_mul_u32_u24 v50, 1152, v50
    v_lshl_add_u32 v36, v44, 4, v50
    v_add_co_u32 v46, vcc, v46, v45
    s_nop 1
    v_addc_co_u32 v47, vcc, 0, v47, vcc
    v_add_co_u32 v48, vcc, 4608, v46
    s_nop 1
    v_addc_co_u32 v49, vcc, 0, v47, vcc
    global_load_ushort v28, v[46:47], off offset:0
    global_load_ushort v29, v[46:47], off offset:1152
    global_load_ushort v30, v[46:47], off offset:2304
    global_load_ushort v31, v[46:47], off offset:3456
    global_load_ushort v32, v[48:49], off offset:0
    global_load_ushort v33, v[48:49], off offset:1152
    global_load_ushort v34, v[48:49], off offset:2304
    global_load_ushort v35, v[48:49], off offset:3456
    s_waitcnt vmcnt(0)
    v_lshl_or_b32 v52, v17, 16, v16
    v_xor_b32 v52, v25, v52
    v_lshl_or_b32 v53, v19, 16, v18
    v_xor_b32 v53, v25, v53
    v_lshl_or_b32 v54, v21, 16, v20
    v_xor_b32 v54, v25, v54
    v_lshl_or_b32 v55, v23, 16, v22
    v_xor_b32 v55, v25, v55
    buffer_store_dwordx4 v[52:55], v24, s[16:19], s57 offen sc1
    v_lshl_or_b32 v56, v29, 16, v28
    v_xor_b32 v56, v37, v56
    v_lshl_or_b32 v57, v31, 16, v30
    v_xor_b32 v57, v37, v57
    v_lshl_or_b32 v58, v33, 16, v32
    v_xor_b32 v58, v37, v58
    v_lshl_or_b32 v59, v35, 16, v34
    v_xor_b32 v59, v37, v59
    buffer_store_dwordx4 v[56:59], v36, s[16:19], s57 offen sc1
    s_branch KM_r_end
KM_r2:
    s_cmp_lg_u32 s20, 6
    s_cbranch_scc1 KM_r3
    s_memrealtime s[52:53]
    s_waitcnt lgkmcnt(0)
    s_lshl_b32 s52, s52, 3
    s_or_b32 s52, s52, 8
    s_mov_b64 exec, 1
    v_mov_b32 v16, s52
    v_mov_b32 v17, 0
    v_mov_b32 v18, 0
    v_mov_b32 v19, s52
    buffer_atomic_cmpswap v[16:17], v18, s[64:67], 0 offen sc0
    s_waitcnt vmcnt(0)
    v_cmp_eq_u32 vcc, 0, v16
    s_nop 1
    v_cndmask_b32 v16, v16, v19, vcc
    v_mov_b32 v18, 127296
    ds_write_b32 v18, v16
    s_mov_b64 exec, -1
    s_branch KM_r_end
KM_r3:
    s_cmp_lg_u32 s20, 5
    s_cbranch_scc1 KM_r_end
    s_mul_i32 s52, s21, 18
    v_min_u32 v16, 17, v0
    v_add_u32 v17, s52, v16
    v_lshlrev_b32 v17, 1, v17
    global_load_ushort v18, v17, s[70:71]
    global_load_ushort v19, v17, s[72:73]
    global_load_ushort v20, v17, s[74:75]
    s_waitcnt vmcnt(0)
    v_lshlrev_b32 v18, 16, v18
    v_lshlrev_b32 v19, 16, v19
    v_lshlrev_b32 v20, 16, v20
    v_mul_f32 v20, 1069066811, v20
    v_exp_f32 v20, v20
    s_nop 0
    v_cvt_pk_bf16_f32 v20, 0, v20
    v_mul_f32 v21, v20, v18
    v_mul_f32 v22, v20, v19
    v_mul_f32 v21, 1069066811, v21
    v_mul_f32 v22, 1042479491, v22
    v_exp_f32 v21, v21
    v_fract_f32 v22, v22
    s_nop 0
    v_cos_f32 v23, v22
    v_sin_f32 v24, v22
    s_nop 0
    v_mul_f32 v64, v21, v23
    v_mul_f32 v65, v21, v24
    v_add_f32 v25, -1.0, v64
    v_mul_f32 v26, v18, v18
    v_fmac_f32 v26, v19, v19
    v_rcp_f32 v27, v26
    v_mul_f32 v66, v25, v18
    v_fmac_f32 v66, v65, v19
    v_mul_f32 v67, v65, v18
    v_fma_f32 v67, -v25, v19, v67
    v_fma_f32 v28, -v26, v27, 1.0
    v_fmac_f32 v27, v28, v27
    v_add_f32 v27, v27, v27
    v_mul_f32 v66, v66, v27
    v_mul_f32 v67, v67, v27
    v_mov_b32 v72, v64
    v_mov_b32 v73, v65
    v_mul_f32 v74, v64, v72
    v_mul_f32 v75, v64, v73
    v_fma_f32 v74, -v65, v73, v74
    v_fmac_f32 v75, v65, v72
    v_mul_f32 v76, v64, v74
    v_mul_f32 v77, v64, v75
    v_fma_f32 v76, -v65, v75, v76
    v_fmac_f32 v77, v65, v74
    v_mul_f32 v78, v64, v76
    v_mul_f32 v79, v64, v77
    v_fma_f32 v78, -v65, v77, v78
    v_fmac_f32 v79, v65, v76
    v_mul_f32 v80, v64, v78
    v_mul_f32 v81, v64, v79
    v_fma_f32 v80, -v65, v79, v80
    v_fmac_f32 v81, v65, v78
    v_mul_f32 v82, v64, v80
    v_mul_f32 v83, v64, v81
    v_fma_f32 v82, -v65, v81, v82
    v_fmac_f32 v83, v65, v80
    v_mul_f32 v84, v64, v82
    v_mul_f32 v85, v64, v83
    v_fma_f32 v84, -v65, v83, v84
    v_fmac_f32 v85, v65, v82
    v_mul_f32 v86, v64, v84
    v_mul_f32 v87, v64, v85
    v_fma_f32 v86, -v65, v85, v86
    v_fmac_f32 v87, v65, v84
    v_mul_f32 v88, v64, v86
    v_mul_f32 v89, v64, v87
    v_fma_f32 v88, -v65, v87, v88
    v_fmac_f32 v89, v65, v86
    v_mul_f32 v90, v64, v88
    v_mul_f32 v91, v64, v89
    v_fma_f32 v90, -v65, v89, v90
    v_fmac_f32 v91, v65, v88
    v_mul_f32 v92, v64, v90
    v_mul_f32 v93, v64, v91
    v_fma_f32 v92, -v65, v91, v92
    v_fmac_f32 v93, v65, v90
    v_mul_f32 v94, v64, v92
    v_mul_f32 v95, v64, v93
    v_fma_f32 v94, -v65, v93, v94
    v_fmac_f32 v95, v65, v92
    v_mul_f32 v96, v64, v94
    v_mul_f32 v97, v64, v95
    v_fma_f32 v96, -v65, v95, v96
    v_fmac_f32 v97, v65, v94
    v_mul_f32 v98, v64, v96
    v_mul_f32 v99, v64, v97
    v_fma_f32 v98, -v65, v97, v98
    v_fmac_f32 v99, v65, v96
    v_mul_f32 v100, v64, v98
    v_mul_f32 v101, v64, v99
    v_fma_f32 v100, -v65, v99, v100
    v_fmac_f32 v101, v65, v98
    v_mul_f32 v102, v64, v100
    v_mul_f32 v103, v64, v101
    v_fma_f32 v102, -v65, v101, v102
    v_fmac_f32 v103, v65, v100
    v_mov_b32 v68, v102
    v_mov_b32 v69, v103
    v_mul_f32 v30, v68, v68
    v_mul_f32 v31, v68, v69
    v_fma_f32 v30, -v69, v69, v30
    v_fmac_f32 v31, v69, v68
    v_mul_f32 v32, v30, v30
    v_mul_f32 v33, v30, v31
    v_fma_f32 v32, -v31, v31, v32
    v_fmac_f32 v33, v31, v30
    v_mul_f32 v30, v32, v32
    v_mul_f32 v31, v32, v33
    v_fma_f32 v30, -v33, v33, v30
    v_fmac_f32 v31, v33, v32
    v_mul_f32 v70, v30, v30
    v_mul_f32 v71, v30, v31
    v_fma_f32 v70, -v31, v31, v70
    v_fmac_f32 v71, v31, v30
    v_mul_u32_u24 v17, 160, v16
    v_add_u32 v17, 124416, v17
    v_cmp_gt_u32 vcc, 18, v0
    s_and_saveexec_b64 s[60:61], vcc
    ds_write_b128 v17, v[64:67] offset:0
    ds_write_b128 v17, v[68:71] offset:16
    ds_write_b128 v17, v[72:75] offset:32
    ds_write_b128 v17, v[76:79] offset:48
    ds_write_b128 v17, v[80:83] offset:64
    ds_write_b128 v17, v[84:87] offset:80
    ds_write_b128 v17, v[88:91] offset:96
    ds_write_b128 v17, v[92:95] offset:112
    ds_write_b128 v17, v[96:99] offset:128
    ds_write_b128 v17, v[100:103] offset:144
    s_mov_b64 exec, s[60:61]
KM_r_end:
    s_waitcnt lgkmcnt(0)
    s_barrier
    v_mov_b32 v184, 127296
    ds_read_b32 v185, v184
    s_waitcnt lgkmcnt(0)
    v_readfirstlane_b32 s3, v185
    s_nop 3
    s_cmp_lg_u32 s20, 7
    s_cbranch_scc1 KM_p0wait
    s_mov_b64 exec, 1
    s_add_u32 s100, s3, 1
    v_mov_b32 v194, s100
    v_mov_b32 v195, 0
    buffer_store_dword v194, v195, s[16:19], s101 offen sc1
    s_mov_b64 exec, -1
    s_mov_b32 exec_hi, 0
    v_lshlrev_b32 v184, 8, v0
    s_lshl_b32 s49, s22, 13
    s_add_u32 s49, s49, 49283072
KM_poll0:
    buffer_load_dword v185, v184, s[16:19], s49 offen sc1
    s_add_u32 s100, s3, 1
    s_waitcnt vmcnt(0)
    v_subrev_u32 v185, s100, v185
    v_cmp_le_u32 vcc, 7, v185
    s_nop 4
    s_cbranch_vccz KM_poll0_ok
    s_sleep 2
    s_branch KM_poll0
KM_poll0_ok:
    s_mov_b64 exec, -1
KM_p0wait:
    s_bitcmp0_b32 0x63, s20
    s_cbranch_scc1 KM_p0b
    s_add_u32 m0, s27, 0
    s_mov_b32 s30, 0
    buffer_load_dwordx4 v2, s[12:15], s30 offen lds
    s_add_u32 m0, s27, 1024
    s_mov_b32 s30, 0
    buffer_load_dwordx4 v3, s[12:15], s30 offen lds
    s_add_u32 m0, s27, 2048
    s_mov_b32 s30, 0
    buffer_load_dwordx4 v4, s[12:15], s30 offen lds
    s_add_u32 m0, s27, 3072
    s_mov_b32 s30, 0
    buffer_load_dwordx4 v5, s[12:15], s30 offen lds
    s_add_u32 m0, s27, 4096
    s_mov_b32 s30, 0
    s_mov_b32 exec_hi, 0
    buffer_load_dwordx4 v6, s[12:15], s30 offen lds
    s_mov_b32 exec_hi, -1
    s_add_u32 m0, s29, 0
    s_movk_i32 s30, 0
    s_mov_b32 exec_hi, 0xf
    buffer_load_dwordx4 v7, s[40:43], s30 offen lds
    s_mov_b32 exec_hi, -1
    s_add_u32 m0, s27, 36864
    s_mov_b32 s30, 589824
    buffer_load_dwordx4 v2, s[12:15], s30 offen lds
    s_add_u32 m0, s27, 37888
    s_mov_b32 s30, 589824
    buffer_load_dwordx4 v3, s[12:15], s30 offen lds
    s_add_u32 m0, s27, 38912
    s_mov_b32 s30, 589824
    buffer_load_dwordx4 v4, s[12:15], s30 offen lds
    s_add_u32 m0, s27, 39936
    s_mov_b32 s30, 589824
    buffer_load_dwordx4 v5, s[12:15], s30 offen lds
    s_add_u32 m0, s27, 40960
    s_mov_b32 s30, 589824
    s_mov_b32 exec_hi, 0
    buffer_load_dwordx4 v6, s[12:15], s30 offen lds
    s_mov_b32 exec_hi, -1
    s_add_u32 m0, s29, 4608
    s_movk_i32 s30, 128
    s_mov_b32 exec_hi, 0xf
    buffer_load_dwordx4 v7, s[40:43], s30 offen lds
    s_mov_b32 exec_hi, -1
    s_mov_b32 s49, 1179648
    s_mov_b32 exec_hi, 0xf
    buffer_load_dwordx4 v[188:191], v14, s[12:15], s49 offen
    s_mov_b32 exec_hi, -1
    s_mov_b32 s49, 1769472
    s_mov_b32 exec_hi, 0xf
    buffer_load_dwordx4 v[188:191], v14, s[12:15], s49 offen
    s_mov_b32 exec_hi, -1
    s_branch KM_p0c
KM_p0b:
KM_p0c:
    s_mul_i32 s48, s2, 20736
    s_waitcnt vmcnt(0) lgkmcnt(0)
    s_barrier
    s_add_u32 s31, s28, 0
    buffer_load_dwordx4 a[0:3], v1, s[16:19], s31 offen offset:0 sc1
    buffer_load_dwordx4 a[4:7], v1, s[16:19], s31 offen offset:1024 sc1
    s_add_u32 s31, s28, 2048
    buffer_load_dwordx4 a[8:11], v1, s[16:19], s31 offen offset:0 sc1
    buffer_load_dwordx4 a[12:15], v1, s[16:19], s31 offen offset:1024 sc1
    ds_read_b64_tr_b16 a[24:25], v11 offset:0
    ds_read_b64_tr_b16 a[26:27], v11 offset:4608
    ds_read_b64_tr_b16 a[28:29], v11 offset:18432
    ds_read_b64_tr_b16 a[30:31], v11 offset:23040
    ds_read_b64_tr_b16 a[32:33], v11 offset:32
    ds_read_b64_tr_b16 a[34:35], v11 offset:4640
    ds_read_b64_tr_b16 a[36:37], v11 offset:18464
    ds_read_b64_tr_b16 a[38:39], v11 offset:23072
    ds_read_b64_tr_b16 a[40:41], v11 offset:64
    ds_read_b64_tr_b16 a[42:43], v11 offset:4672
    s_waitcnt vmcnt(2) lgkmcnt(8)
    v_mfma_f32_16x16x32_bf16 v[16:19], a[24:27], a[0:3], 0
    ds_read_b64_tr_b16 a[44:45], v11 offset:18496
    ds_read_b64_tr_b16 a[46:47], v11 offset:23104
    v_mfma_f32_16x16x32_bf16 v[24:27], a[24:27], a[4:7], 0
    s_add_u32 s31, s28, 4096
    buffer_load_dwordx4 a[16:19], v1, s[16:19], s31 offen offset:0 sc1
    buffer_load_dwordx4 a[20:23], v1, s[16:19], s31 offen offset:1024 sc1
    s_waitcnt lgkmcnt(8)
    v_mfma_f32_16x16x32_bf16 v[20:23], a[28:31], a[0:3], 0
    ds_read_b64_tr_b16 a[48:49], v11 offset:96
    ds_read_b64_tr_b16 a[50:51], v11 offset:4704
    v_mfma_f32_16x16x32_bf16 v[28:31], a[28:31], a[4:7], 0
    s_waitcnt lgkmcnt(8)
    v_mfma_f32_16x16x32_bf16 v[32:35], a[32:35], a[0:3], 0
    ds_read_b64_tr_b16 a[52:53], v11 offset:18528
    ds_read_b64_tr_b16 a[54:55], v11 offset:23136
    v_mfma_f32_16x16x32_bf16 v[40:43], a[32:35], a[4:7], 0
    s_waitcnt lgkmcnt(8)
    v_mfma_f32_16x16x32_bf16 v[36:39], a[36:39], a[0:3], 0
    ds_read_b64_tr_b16 a[24:25], v11 offset:128
    ds_read_b64_tr_b16 a[26:27], v11 offset:4736
    v_mfma_f32_16x16x32_bf16 v[44:47], a[36:39], a[4:7], 0
    s_waitcnt lgkmcnt(8)
    v_mfma_f32_16x16x32_bf16 v[48:51], a[40:43], a[0:3], 0
    ds_read_b64_tr_b16 a[28:29], v11 offset:18560
    ds_read_b64_tr_b16 a[30:31], v11 offset:23168
    v_mfma_f32_16x16x32_bf16 v[56:59], a[40:43], a[4:7], 0
    s_waitcnt lgkmcnt(8)
    v_mfma_f32_16x16x32_bf16 v[52:55], a[44:47], a[0:3], 0
    ds_read_b64_tr_b16 a[32:33], v11 offset:160
    ds_read_b64_tr_b16 a[34:35], v11 offset:4768
    v_mfma_f32_16x16x32_bf16 v[60:63], a[44:47], a[4:7], 0
    s_waitcnt lgkmcnt(8)
    v_mfma_f32_16x16x32_bf16 v[64:67], a[48:51], a[0:3], 0
    ds_read_b64_tr_b16 a[36:37], v11 offset:18592
    ds_read_b64_tr_b16 a[38:39], v11 offset:23200
    v_mfma_f32_16x16x32_bf16 v[72:75], a[48:51], a[4:7], 0
    s_waitcnt lgkmcnt(8)
    v_mfma_f32_16x16x32_bf16 v[68:71], a[52:55], a[0:3], 0
    ds_read_b64_tr_b16 a[40:41], v11 offset:192
    ds_read_b64_tr_b16 a[42:43], v11 offset:4800
    v_mfma_f32_16x16x32_bf16 v[76:79], a[52:55], a[4:7], 0
    s_waitcnt lgkmcnt(8)
    v_mfma_f32_16x16x32_bf16 v[80:83], a[24:27], a[0:3], 0
    ds_read_b64_tr_b16 a[44:45], v11 offset:18624
    ds_read_b64_tr_b16 a[46:47], v11 offset:23232
    v_mfma_f32_16x16x32_bf16 v[88:91], a[24:27], a[4:7], 0
    s_waitcnt lgkmcnt(8)
    v_mfma_f32_16x16x32_bf16 v[84:87], a[28:31], a[0:3], 0
    ds_read_b64_tr_b16 a[48:49], v11 offset:224
    ds_read_b64_tr_b16 a[50:51], v11 offset:4832
    v_mfma_f32_16x16x32_bf16 v[92:95], a[28:31], a[4:7], 0
    s_waitcnt lgkmcnt(8)
    v_mfma_f32_16x16x32_bf16 v[96:99], a[32:35], a[0:3], 0
    ds_read_b64_tr_b16 a[52:53], v11 offset:18656
    ds_read_b64_tr_b16 a[54:55], v11 offset:23264
    v_mfma_f32_16x16x32_bf16 v[104:107], a[32:35], a[4:7], 0
    s_waitcnt lgkmcnt(8)
    v_mfma_f32_16x16x32_bf16 v[100:103], a[36:39], a[0:3], 0
    ds_read_b64_tr_b16 a[24:25], v11 offset:256
    ds_read_b64_tr_b16 a[26:27], v11 offset:4864
    v_mfma_f32_16x16x32_bf16 v[108:111], a[36:39], a[4:7], 0
    s_waitcnt lgkmcnt(8)
    v_mfma_f32_16x16x32_bf16 v[112:115], a[40:43], a[0:3], 0
    ds_read_b64_tr_b16 a[28:29], v11 offset:18688
    ds_read_b64_tr_b16 a[30:31], v11 offset:23296
    v_mfma_f32_16x16x32_bf16 v[120:123], a[40:43], a[4:7], 0
    s_waitcnt lgkmcnt(8)
    v_mfma_f32_16x16x32_bf16 v[116:119], a[44:47], a[0:3], 0
    ds_read_b128 a[32:35], v8 offset:0
    v_mfma_f32_16x16x32_bf16 v[124:127], a[44:47], a[4:7], 0
    s_waitcnt lgkmcnt(7)
    v_mfma_f32_16x16x32_bf16 v[128:131], a[48:51], a[0:3], 0
    ds_read_b128 a[36:39], v8 offset:2048
    v_mfma_f32_16x16x32_bf16 v[136:139], a[48:51], a[4:7], 0
    s_mov_b32 s49, 2359296
    s_mov_b32 exec_hi, 0xf
    buffer_load_dwordx4 v[188:191], v14, s[12:15], s49 offen
    s_mov_b32 exec_hi, -1
    s_waitcnt lgkmcnt(6)
    v_mfma_f32_16x16x32_bf16 v[132:135], a[52:55], a[0:3], 0
    ds_read_b128 a[40:43], v196 offset:0
    v_mfma_f32_16x16x32_bf16 v[140:143], a[52:55], a[4:7], 0
    s_waitcnt lgkmcnt(5)
    v_mfma_f32_16x16x32_bf16 v[144:147], a[24:27], a[0:3], 0
    ds_read_b64_tr_b16 a[44:45], v11 offset:9216
    ds_read_b64_tr_b16 a[46:47], v11 offset:13824
    v_mfma_f32_16x16x32_bf16 v[152:155], a[24:27], a[4:7], 0
    s_waitcnt lgkmcnt(5)
    v_mfma_f32_16x16x32_bf16 v[148:151], a[28:31], a[0:3], 0
    ds_read_b64_tr_b16 a[48:49], v11 offset:27648
    ds_read_b64_tr_b16 a[50:51], v11 offset:32256
    v_mfma_f32_16x16x32_bf16 v[156:159], a[28:31], a[4:7], 0
    s_waitcnt lgkmcnt(6)
    v_mfma_f32_16x16x32_bf16 v[160:163], a[32:35], a[0:3], 0
    ds_read_b64_tr_b16 a[52:53], v11 offset:9248
    ds_read_b64_tr_b16 a[54:55], v11 offset:13856
    v_mfma_f32_16x16x32_bf16 v[164:167], a[32:35], a[4:7], 0
    s_waitcnt lgkmcnt(7)
    v_mfma_f32_16x16x32_bf16 v[168:171], a[36:39], a[0:3], 0
    ds_read_b64_tr_b16 a[24:25], v11 offset:27680
    ds_read_b64_tr_b16 a[26:27], v11 offset:32288
    v_mfma_f32_16x16x32_bf16 v[172:175], a[36:39], a[4:7], 0
    s_waitcnt lgkmcnt(8)
    v_mfma_f32_16x16x32_bf16 v[176:179], a[40:43], a[0:3], 0
    ds_read_b64_tr_b16 a[28:29], v11 offset:9280
    ds_read_b64_tr_b16 a[30:31], v11 offset:13888
    v_mfma_f32_16x16x32_bf16 v[180:183], a[40:43], a[4:7], 0
    s_waitcnt vmcnt(3) lgkmcnt(8)
    v_mfma_f32_16x16x32_bf16 v[16:19], a[44:47], a[8:11], v[16:19]
    ds_read_b64_tr_b16 a[32:33], v11 offset:27712
    ds_read_b64_tr_b16 a[34:35], v11 offset:32320
    v_mfma_f32_16x16x32_bf16 v[24:27], a[44:47], a[12:15], v[24:27]
    s_add_u32 s31, s28, 6144
    buffer_load_dwordx4 a[0:3], v1, s[16:19], s31 offen offset:0 sc1
    buffer_load_dwordx4 a[4:7], v1, s[16:19], s31 offen offset:1024 sc1
    s_waitcnt lgkmcnt(8)
    v_mfma_f32_16x16x32_bf16 v[20:23], a[48:51], a[8:11], v[20:23]
    ds_read_b64_tr_b16 a[36:37], v11 offset:9312
    ds_read_b64_tr_b16 a[38:39], v11 offset:13920
    v_mfma_f32_16x16x32_bf16 v[28:31], a[48:51], a[12:15], v[28:31]
    s_waitcnt lgkmcnt(8)
    v_mfma_f32_16x16x32_bf16 v[32:35], a[52:55], a[8:11], v[32:35]
    ds_read_b64_tr_b16 a[40:41], v11 offset:27744
    ds_read_b64_tr_b16 a[42:43], v11 offset:32352
    v_mfma_f32_16x16x32_bf16 v[40:43], a[52:55], a[12:15], v[40:43]
    s_waitcnt lgkmcnt(8)
    v_mfma_f32_16x16x32_bf16 v[36:39], a[24:27], a[8:11], v[36:39]
    ds_read_b64_tr_b16 a[44:45], v11 offset:9344
    ds_read_b64_tr_b16 a[46:47], v11 offset:13952
    v_mfma_f32_16x16x32_bf16 v[44:47], a[24:27], a[12:15], v[44:47]
    s_waitcnt lgkmcnt(8)
    v_mfma_f32_16x16x32_bf16 v[48:51], a[28:31], a[8:11], v[48:51]
    ds_read_b64_tr_b16 a[48:49], v11 offset:27776
    ds_read_b64_tr_b16 a[50:51], v11 offset:32384
    v_mfma_f32_16x16x32_bf16 v[56:59], a[28:31], a[12:15], v[56:59]
    s_waitcnt lgkmcnt(8)
    v_mfma_f32_16x16x32_bf16 v[52:55], a[32:35], a[8:11], v[52:55]
    ds_read_b64_tr_b16 a[52:53], v11 offset:9376
    ds_read_b64_tr_b16 a[54:55], v11 offset:13984
    v_mfma_f32_16x16x32_bf16 v[60:63], a[32:35], a[12:15], v[60:63]
    s_waitcnt lgkmcnt(8)
    v_mfma_f32_16x16x32_bf16 v[64:67], a[36:39], a[8:11], v[64:67]
    ds_read_b64_tr_b16 a[24:25], v11 offset:27808
    ds_read_b64_tr_b16 a[26:27], v11 offset:32416
    v_mfma_f32_16x16x32_bf16 v[72:75], a[36:39], a[12:15], v[72:75]
    s_waitcnt lgkmcnt(8)
    v_mfma_f32_16x16x32_bf16 v[68:71], a[40:43], a[8:11], v[68:71]
    ds_read_b64_tr_b16 a[28:29], v11 offset:9408
    ds_read_b64_tr_b16 a[30:31], v11 offset:14016
    v_mfma_f32_16x16x32_bf16 v[76:79], a[40:43], a[12:15], v[76:79]
    s_waitcnt lgkmcnt(8)
    v_mfma_f32_16x16x32_bf16 v[80:83], a[44:47], a[8:11], v[80:83]
    ds_read_b64_tr_b16 a[32:33], v11 offset:27840
    ds_read_b64_tr_b16 a[34:35], v11 offset:32448
    v_mfma_f32_16x16x32_bf16 v[88:91], a[44:47], a[12:15], v[88:91]
    s_waitcnt lgkmcnt(8)
    v_mfma_f32_16x16x32_bf16 v[84:87], a[48:51], a[8:11], v[84:87]
    ds_read_b64_tr_b16 a[36:37], v11 offset:9440
    ds_read_b64_tr_b16 a[38:39], v11 offset:14048
    v_mfma_f32_16x16x32_bf16 v[92:95], a[48:51], a[12:15], v[92:95]
    s_waitcnt lgkmcnt(8)
    v_mfma_f32_16x16x32_bf16 v[96:99], a[52:55], a[8:11], v[96:99]
    ds_read_b64_tr_b16 a[40:41], v11 offset:27872
    ds_read_b64_tr_b16 a[42:43], v11 offset:32480
    v_mfma_f32_16x16x32_bf16 v[104:107], a[52:55], a[12:15], v[104:107]
    s_waitcnt lgkmcnt(8)
    v_mfma_f32_16x16x32_bf16 v[100:103], a[24:27], a[8:11], v[100:103]
    ds_read_b64_tr_b16 a[44:45], v11 offset:9472
    ds_read_b64_tr_b16 a[46:47], v11 offset:14080
    v_mfma_f32_16x16x32_bf16 v[108:111], a[24:27], a[12:15], v[108:111]
    s_waitcnt lgkmcnt(8)
    v_mfma_f32_16x16x32_bf16 v[112:115], a[28:31], a[8:11], v[112:115]
    ds_read_b64_tr_b16 a[48:49], v11 offset:27904
    ds_read_b64_tr_b16 a[50:51], v11 offset:32512
    v_mfma_f32_16x16x32_bf16 v[120:123], a[28:31], a[12:15], v[120:123]
    s_waitcnt lgkmcnt(8)
    v_mfma_f32_16x16x32_bf16 v[116:119], a[32:35], a[8:11], v[116:119]
    ds_read_b128 a[52:55], v9 offset:0
    v_mfma_f32_16x16x32_bf16 v[124:127], a[32:35], a[12:15], v[124:127]
    s_waitcnt lgkmcnt(7)
    v_mfma_f32_16x16x32_bf16 v[128:131], a[36:39], a[8:11], v[128:131]
    ds_read_b128 a[24:27], v9 offset:2048
    v_mfma_f32_16x16x32_bf16 v[136:139], a[36:39], a[12:15], v[136:139]
    s_waitcnt lgkmcnt(6)
    v_mfma_f32_16x16x32_bf16 v[132:135], a[40:43], a[8:11], v[132:135]
    ds_read_b128 a[28:31], v197 offset:0
    v_mfma_f32_16x16x32_bf16 v[140:143], a[40:43], a[12:15], v[140:143]
    s_barrier
    s_waitcnt lgkmcnt(5)
    v_mfma_f32_16x16x32_bf16 v[144:147], a[44:47], a[8:11], v[144:147]
    ds_read_b64_tr_b16 a[32:33], v12 offset:0
    ds_read_b64_tr_b16 a[34:35], v12 offset:4608
    v_mfma_f32_16x16x32_bf16 v[152:155], a[44:47], a[12:15], v[152:155]
    s_waitcnt lgkmcnt(5)
    v_mfma_f32_16x16x32_bf16 v[148:151], a[48:51], a[8:11], v[148:151]
    ds_read_b64_tr_b16 a[36:37], v12 offset:18432
    ds_read_b64_tr_b16 a[38:39], v12 offset:23040
    v_mfma_f32_16x16x32_bf16 v[156:159], a[48:51], a[12:15], v[156:159]
    s_add_u32 m0, s27, 73728
    s_mov_b32 s30, 1179648
    buffer_load_dwordx4 v2, s[12:15], s30 offen lds
    s_waitcnt lgkmcnt(6)
    v_mfma_f32_16x16x32_bf16 v[160:163], a[52:55], a[8:11], v[160:163]
    ds_read_b64_tr_b16 a[40:41], v12 offset:32
    ds_read_b64_tr_b16 a[42:43], v12 offset:4640
    v_mfma_f32_16x16x32_bf16 v[164:167], a[52:55], a[12:15], v[164:167]
    s_waitcnt lgkmcnt(7)
    v_mfma_f32_16x16x32_bf16 v[168:171], a[24:27], a[8:11], v[168:171]
    ds_read_b64_tr_b16 a[44:45], v12 offset:18464
    ds_read_b64_tr_b16 a[46:47], v12 offset:23072
    v_mfma_f32_16x16x32_bf16 v[172:175], a[24:27], a[12:15], v[172:175]
    s_add_u32 m0, s27, 74752
    s_mov_b32 s30, 1179648
    buffer_load_dwordx4 v3, s[12:15], s30 offen lds
    s_waitcnt lgkmcnt(8)
    v_mfma_f32_16x16x32_bf16 v[176:179], a[28:31], a[8:11], v[176:179]
    ds_read_b64_tr_b16 a[48:49], v12 offset:64
    ds_read_b64_tr_b16 a[50:51], v12 offset:4672
    v_mfma_f32_16x16x32_bf16 v[180:183], a[28:31], a[12:15], v[180:183]
    s_waitcnt vmcnt(5) lgkmcnt(8)
    v_mfma_f32_16x16x32_bf16 v[16:19], a[32:35], a[16:19], v[16:19]
    ds_read_b64_tr_b16 a[52:53], v12 offset:18496
    ds_read_b64_tr_b16 a[54:55], v12 offset:23104
    v_mfma_f32_16x16x32_bf16 v[24:27], a[32:35], a[20:23], v[24:27]
    s_add_u32 s31, s28, 8192
    buffer_load_dwordx4 a[8:11], v1, s[16:19], s31 offen offset:0 sc1
    buffer_load_dwordx4 a[12:15], v1, s[16:19], s31 offen offset:1024 sc1
    s_waitcnt lgkmcnt(8)
    v_mfma_f32_16x16x32_bf16 v[20:23], a[36:39], a[16:19], v[20:23]
    ds_read_b64_tr_b16 a[24:25], v12 offset:96
    ds_read_b64_tr_b16 a[26:27], v12 offset:4704
    v_mfma_f32_16x16x32_bf16 v[28:31], a[36:39], a[20:23], v[28:31]
    s_add_u32 m0, s27, 75776
    s_mov_b32 s30, 1179648
    buffer_load_dwordx4 v4, s[12:15], s30 offen lds
    s_waitcnt lgkmcnt(8)
    v_mfma_f32_16x16x32_bf16 v[32:35], a[40:43], a[16:19], v[32:35]
    ds_read_b64_tr_b16 a[28:29], v12 offset:18528
    ds_read_b64_tr_b16 a[30:31], v12 offset:23136
    v_mfma_f32_16x16x32_bf16 v[40:43], a[40:43], a[20:23], v[40:43]
    s_waitcnt lgkmcnt(8)
    v_mfma_f32_16x16x32_bf16 v[36:39], a[44:47], a[16:19], v[36:39]
    ds_read_b64_tr_b16 a[32:33], v12 offset:128
    ds_read_b64_tr_b16 a[34:35], v12 offset:4736
    v_mfma_f32_16x16x32_bf16 v[44:47], a[44:47], a[20:23], v[44:47]
    s_add_u32 m0, s27, 76800
    s_mov_b32 s30, 1179648
    buffer_load_dwordx4 v5, s[12:15], s30 offen lds
    s_waitcnt lgkmcnt(8)
    v_mfma_f32_16x16x32_bf16 v[48:51], a[48:51], a[16:19], v[48:51]
    ds_read_b64_tr_b16 a[36:37], v12 offset:18560
    ds_read_b64_tr_b16 a[38:39], v12 offset:23168
    v_mfma_f32_16x16x32_bf16 v[56:59], a[48:51], a[20:23], v[56:59]
    s_waitcnt lgkmcnt(8)
    v_mfma_f32_16x16x32_bf16 v[52:55], a[52:55], a[16:19], v[52:55]
    ds_read_b64_tr_b16 a[40:41], v12 offset:160
    ds_read_b64_tr_b16 a[42:43], v12 offset:4768
    v_mfma_f32_16x16x32_bf16 v[60:63], a[52:55], a[20:23], v[60:63]
    s_add_u32 m0, s27, 77824
    s_mov_b32 s30, 1179648
    s_mov_b32 exec_hi, 0
    buffer_load_dwordx4 v6, s[12:15], s30 offen lds
    s_mov_b32 exec_hi, -1
    s_waitcnt lgkmcnt(8)
    v_mfma_f32_16x16x32_bf16 v[64:67], a[24:27], a[16:19], v[64:67]
    ds_read_b64_tr_b16 a[44:45], v12 offset:18592
    ds_read_b64_tr_b16 a[46:47], v12 offset:23200
    v_mfma_f32_16x16x32_bf16 v[72:75], a[24:27], a[20:23], v[72:75]
    s_waitcnt lgkmcnt(8)
    v_mfma_f32_16x16x32_bf16 v[68:71], a[28:31], a[16:19], v[68:71]
    ds_read_b64_tr_b16 a[48:49], v12 offset:192
    ds_read_b64_tr_b16 a[50:51], v12 offset:4800
    v_mfma_f32_16x16x32_bf16 v[76:79], a[28:31], a[20:23], v[76:79]
    s_add_u32 m0, s29, 9216
    s_movk_i32 s30, 256
    s_mov_b32 exec_hi, 0xf
    buffer_load_dwordx4 v7, s[40:43], s30 offen lds
    s_mov_b32 exec_hi, -1
    s_waitcnt lgkmcnt(8)
    v_mfma_f32_16x16x32_bf16 v[80:83], a[32:35], a[16:19], v[80:83]
    ds_read_b64_tr_b16 a[52:53], v12 offset:18624
    ds_read_b64_tr_b16 a[54:55], v12 offset:23232
    v_mfma_f32_16x16x32_bf16 v[88:91], a[32:35], a[20:23], v[88:91]
    s_waitcnt lgkmcnt(8)
    v_mfma_f32_16x16x32_bf16 v[84:87], a[36:39], a[16:19], v[84:87]
    ds_read_b64_tr_b16 a[24:25], v12 offset:224
    ds_read_b64_tr_b16 a[26:27], v12 offset:4832
    v_mfma_f32_16x16x32_bf16 v[92:95], a[36:39], a[20:23], v[92:95]
    s_waitcnt lgkmcnt(8)
    v_mfma_f32_16x16x32_bf16 v[96:99], a[40:43], a[16:19], v[96:99]
    ds_read_b64_tr_b16 a[28:29], v12 offset:18656
    ds_read_b64_tr_b16 a[30:31], v12 offset:23264
    v_mfma_f32_16x16x32_bf16 v[104:107], a[40:43], a[20:23], v[104:107]
    s_waitcnt lgkmcnt(8)
    v_mfma_f32_16x16x32_bf16 v[100:103], a[44:47], a[16:19], v[100:103]
    ds_read_b64_tr_b16 a[32:33], v12 offset:256
    ds_read_b64_tr_b16 a[34:35], v12 offset:4864
    v_mfma_f32_16x16x32_bf16 v[108:111], a[44:47], a[20:23], v[108:111]
    s_waitcnt lgkmcnt(8)
    v_mfma_f32_16x16x32_bf16 v[112:115], a[48:51], a[16:19], v[112:115]
    ds_read_b64_tr_b16 a[36:37], v12 offset:18688
    ds_read_b64_tr_b16 a[38:39], v12 offset:23296
    v_mfma_f32_16x16x32_bf16 v[120:123], a[48:51], a[20:23], v[120:123]
    s_waitcnt lgkmcnt(8)
    v_mfma_f32_16x16x32_bf16 v[116:119], a[52:55], a[16:19], v[116:119]
    ds_read_b128 a[40:43], v8 offset:4608
    v_mfma_f32_16x16x32_bf16 v[124:127], a[52:55], a[20:23], v[124:127]
    s_waitcnt lgkmcnt(7)
    v_mfma_f32_16x16x32_bf16 v[128:131], a[24:27], a[16:19], v[128:131]
    ds_read_b128 a[44:47], v8 offset:6656
    v_mfma_f32_16x16x32_bf16 v[136:139], a[24:27], a[20:23], v[136:139]
    s_mov_b32 s49, 2949120
    s_mov_b32 exec_hi, 0xf
    buffer_load_dwordx4 v[188:191], v14, s[12:15], s49 offen
    s_mov_b32 exec_hi, -1
    s_waitcnt lgkmcnt(6)
    v_mfma_f32_16x16x32_bf16 v[132:135], a[28:31], a[16:19], v[132:135]
    ds_read_b128 a[48:51], v196 offset:4608
    v_mfma_f32_16x16x32_bf16 v[140:143], a[28:31], a[20:23], v[140:143]
    s_waitcnt lgkmcnt(5)
    v_mfma_f32_16x16x32_bf16 v[144:147], a[32:35], a[16:19], v[144:147]
    ds_read_b64_tr_b16 a[52:53], v12 offset:9216
    ds_read_b64_tr_b16 a[54:55], v12 offset:13824
    v_mfma_f32_16x16x32_bf16 v[152:155], a[32:35], a[20:23], v[152:155]
    s_waitcnt lgkmcnt(5)
    v_mfma_f32_16x16x32_bf16 v[148:151], a[36:39], a[16:19], v[148:151]
    ds_read_b64_tr_b16 a[24:25], v12 offset:27648
    ds_read_b64_tr_b16 a[26:27], v12 offset:32256
    v_mfma_f32_16x16x32_bf16 v[156:159], a[36:39], a[20:23], v[156:159]
    s_waitcnt lgkmcnt(6)
    v_mfma_f32_16x16x32_bf16 v[160:163], a[40:43], a[16:19], v[160:163]
    ds_read_b64_tr_b16 a[28:29], v12 offset:9248
    ds_read_b64_tr_b16 a[30:31], v12 offset:13856
    v_mfma_f32_16x16x32_bf16 v[164:167], a[40:43], a[20:23], v[164:167]
    s_waitcnt lgkmcnt(7)
    v_mfma_f32_16x16x32_bf16 v[168:171], a[44:47], a[16:19], v[168:171]
    ds_read_b64_tr_b16 a[32:33], v12 offset:27680
    ds_read_b64_tr_b16 a[34:35], v12 offset:32288
    v_mfma_f32_16x16x32_bf16 v[172:175], a[44:47], a[20:23], v[172:175]
    s_waitcnt lgkmcnt(8)
    v_mfma_f32_16x16x32_bf16 v[176:179], a[48:51], a[16:19], v[176:179]
    ds_read_b64_tr_b16 a[36:37], v12 offset:9280
    ds_read_b64_tr_b16 a[38:39], v12 offset:13888
    v_mfma_f32_16x16x32_bf16 v[180:183], a[48:51], a[20:23], v[180:183]
    s_waitcnt vmcnt(9) lgkmcnt(8)
    v_mfma_f32_16x16x32_bf16 v[16:19], a[52:55], a[0:3], v[16:19]
    ds_read_b64_tr_b16 a[40:41], v12 offset:27712
    ds_read_b64_tr_b16 a[42:43], v12 offset:32320
    v_mfma_f32_16x16x32_bf16 v[24:27], a[52:55], a[4:7], v[24:27]
    s_add_u32 s31, s28, 10240
    buffer_load_dwordx4 a[16:19], v1, s[16:19], s31 offen offset:0 sc1
    buffer_load_dwordx4 a[20:23], v1, s[16:19], s31 offen offset:1024 sc1
    s_waitcnt lgkmcnt(8)
    v_mfma_f32_16x16x32_bf16 v[20:23], a[24:27], a[0:3], v[20:23]
    ds_read_b64_tr_b16 a[44:45], v12 offset:9312
    ds_read_b64_tr_b16 a[46:47], v12 offset:13920
    v_mfma_f32_16x16x32_bf16 v[28:31], a[24:27], a[4:7], v[28:31]
    s_waitcnt lgkmcnt(8)
    v_mfma_f32_16x16x32_bf16 v[32:35], a[28:31], a[0:3], v[32:35]
    ds_read_b64_tr_b16 a[48:49], v12 offset:27744
    ds_read_b64_tr_b16 a[50:51], v12 offset:32352
    v_mfma_f32_16x16x32_bf16 v[40:43], a[28:31], a[4:7], v[40:43]
    s_waitcnt lgkmcnt(8)
    v_mfma_f32_16x16x32_bf16 v[36:39], a[32:35], a[0:3], v[36:39]
    ds_read_b64_tr_b16 a[52:53], v12 offset:9344
    ds_read_b64_tr_b16 a[54:55], v12 offset:13952
    v_mfma_f32_16x16x32_bf16 v[44:47], a[32:35], a[4:7], v[44:47]
    s_waitcnt lgkmcnt(8)
    v_mfma_f32_16x16x32_bf16 v[48:51], a[36:39], a[0:3], v[48:51]
    ds_read_b64_tr_b16 a[24:25], v12 offset:27776
    ds_read_b64_tr_b16 a[26:27], v12 offset:32384
    v_mfma_f32_16x16x32_bf16 v[56:59], a[36:39], a[4:7], v[56:59]
    s_waitcnt lgkmcnt(8)
    v_mfma_f32_16x16x32_bf16 v[52:55], a[40:43], a[0:3], v[52:55]
    ds_read_b64_tr_b16 a[28:29], v12 offset:9376
    ds_read_b64_tr_b16 a[30:31], v12 offset:13984
    v_mfma_f32_16x16x32_bf16 v[60:63], a[40:43], a[4:7], v[60:63]
    s_waitcnt lgkmcnt(8)
    v_mfma_f32_16x16x32_bf16 v[64:67], a[44:47], a[0:3], v[64:67]
    ds_read_b64_tr_b16 a[32:33], v12 offset:27808
    ds_read_b64_tr_b16 a[34:35], v12 offset:32416
    v_mfma_f32_16x16x32_bf16 v[72:75], a[44:47], a[4:7], v[72:75]
    s_waitcnt lgkmcnt(8)
    v_mfma_f32_16x16x32_bf16 v[68:71], a[48:51], a[0:3], v[68:71]
    ds_read_b64_tr_b16 a[36:37], v12 offset:9408
    ds_read_b64_tr_b16 a[38:39], v12 offset:14016
    v_mfma_f32_16x16x32_bf16 v[76:79], a[48:51], a[4:7], v[76:79]
    s_waitcnt lgkmcnt(8)
    v_mfma_f32_16x16x32_bf16 v[80:83], a[52:55], a[0:3], v[80:83]
    ds_read_b64_tr_b16 a[40:41], v12 offset:27840
    ds_read_b64_tr_b16 a[42:43], v12 offset:32448
    v_mfma_f32_16x16x32_bf16 v[88:91], a[52:55], a[4:7], v[88:91]
    s_waitcnt lgkmcnt(8)
    v_mfma_f32_16x16x32_bf16 v[84:87], a[24:27], a[0:3], v[84:87]
    ds_read_b64_tr_b16 a[44:45], v12 offset:9440
    ds_read_b64_tr_b16 a[46:47], v12 offset:14048
    v_mfma_f32_16x16x32_bf16 v[92:95], a[24:27], a[4:7], v[92:95]
    s_waitcnt lgkmcnt(8)
    v_mfma_f32_16x16x32_bf16 v[96:99], a[28:31], a[0:3], v[96:99]
    ds_read_b64_tr_b16 a[48:49], v12 offset:27872
    ds_read_b64_tr_b16 a[50:51], v12 offset:32480
    v_mfma_f32_16x16x32_bf16 v[104:107], a[28:31], a[4:7], v[104:107]
    s_waitcnt lgkmcnt(8)
    v_mfma_f32_16x16x32_bf16 v[100:103], a[32:35], a[0:3], v[100:103]
    ds_read_b64_tr_b16 a[52:53], v12 offset:9472
    ds_read_b64_tr_b16 a[54:55], v12 offset:14080
    v_mfma_f32_16x16x32_bf16 v[108:111], a[32:35], a[4:7], v[108:111]
    s_waitcnt lgkmcnt(8)
    v_mfma_f32_16x16x32_bf16 v[112:115], a[36:39], a[0:3], v[112:115]
    ds_read_b64_tr_b16 a[24:25], v12 offset:27904
    ds_read_b64_tr_b16 a[26:27], v12 offset:32512
    v_mfma_f32_16x16x32_bf16 v[120:123], a[36:39], a[4:7], v[120:123]
    s_waitcnt lgkmcnt(8)
    v_mfma_f32_16x16x32_bf16 v[116:119], a[40:43], a[0:3], v[116:119]
    ds_read_b128 a[28:31], v9 offset:4608
    v_mfma_f32_16x16x32_bf16 v[124:127], a[40:43], a[4:7], v[124:127]
    s_waitcnt lgkmcnt(7)
    v_mfma_f32_16x16x32_bf16 v[128:131], a[44:47], a[0:3], v[128:131]
    ds_read_b128 a[32:35], v9 offset:6656
    v_mfma_f32_16x16x32_bf16 v[136:139], a[44:47], a[4:7], v[136:139]
    s_waitcnt lgkmcnt(6)
    v_mfma_f32_16x16x32_bf16 v[132:135], a[48:51], a[0:3], v[132:135]
    ds_read_b128 a[36:39], v197 offset:4608
    v_mfma_f32_16x16x32_bf16 v[140:143], a[48:51], a[4:7], v[140:143]
    s_waitcnt vmcnt(3)
    s_barrier
    s_waitcnt lgkmcnt(5)
    v_mfma_f32_16x16x32_bf16 v[144:147], a[52:55], a[0:3], v[144:147]
    ds_read_b64_tr_b16 a[40:41], v13 offset:0
    ds_read_b64_tr_b16 a[42:43], v13 offset:4608
    v_mfma_f32_16x16x32_bf16 v[152:155], a[52:55], a[4:7], v[152:155]
    s_waitcnt lgkmcnt(5)
    v_mfma_f32_16x16x32_bf16 v[148:151], a[24:27], a[0:3], v[148:151]
    ds_read_b64_tr_b16 a[44:45], v13 offset:18432
    ds_read_b64_tr_b16 a[46:47], v13 offset:23040
    v_mfma_f32_16x16x32_bf16 v[156:159], a[24:27], a[4:7], v[156:159]
    s_add_u32 m0, s27, 0
    s_mov_b32 s30, 1769472
    buffer_load_dwordx4 v2, s[12:15], s30 offen lds
    s_waitcnt lgkmcnt(6)
    v_mfma_f32_16x16x32_bf16 v[160:163], a[28:31], a[0:3], v[160:163]
    ds_read_b64_tr_b16 a[48:49], v13 offset:32
    ds_read_b64_tr_b16 a[50:51], v13 offset:4640
    v_mfma_f32_16x16x32_bf16 v[164:167], a[28:31], a[4:7], v[164:167]
    s_waitcnt lgkmcnt(7)
    v_mfma_f32_16x16x32_bf16 v[168:171], a[32:35], a[0:3], v[168:171]
    ds_read_b64_tr_b16 a[52:53], v13 offset:18464
    ds_read_b64_tr_b16 a[54:55], v13 offset:23072
    v_mfma_f32_16x16x32_bf16 v[172:175], a[32:35], a[4:7], v[172:175]
    s_add_u32 m0, s27, 1024
    s_mov_b32 s30, 1769472
    buffer_load_dwordx4 v3, s[12:15], s30 offen lds
    s_waitcnt lgkmcnt(8)
    v_mfma_f32_16x16x32_bf16 v[176:179], a[36:39], a[0:3], v[176:179]
    ds_read_b64_tr_b16 a[24:25], v13 offset:64
    ds_read_b64_tr_b16 a[26:27], v13 offset:4672
    v_mfma_f32_16x16x32_bf16 v[180:183], a[36:39], a[4:7], v[180:183]
    s_waitcnt lgkmcnt(8)
    v_mfma_f32_16x16x32_bf16 v[16:19], a[40:43], a[8:11], v[16:19]
    ds_read_b64_tr_b16 a[28:29], v13 offset:18496
    ds_read_b64_tr_b16 a[30:31], v13 offset:23104
    v_mfma_f32_16x16x32_bf16 v[24:27], a[40:43], a[12:15], v[24:27]
    s_add_u32 s31, s28, 12288
    buffer_load_dwordx4 a[0:3], v1, s[16:19], s31 offen offset:0 sc1
    buffer_load_dwordx4 a[4:7], v1, s[16:19], s31 offen offset:1024 sc1
    s_waitcnt lgkmcnt(8)
    v_mfma_f32_16x16x32_bf16 v[20:23], a[44:47], a[8:11], v[20:23]
    ds_read_b64_tr_b16 a[32:33], v13 offset:96
    ds_read_b64_tr_b16 a[34:35], v13 offset:4704
    v_mfma_f32_16x16x32_bf16 v[28:31], a[44:47], a[12:15], v[28:31]
    s_add_u32 m0, s27, 2048
    s_mov_b32 s30, 1769472
    buffer_load_dwordx4 v4, s[12:15], s30 offen lds
    s_waitcnt lgkmcnt(8)
    v_mfma_f32_16x16x32_bf16 v[32:35], a[48:51], a[8:11], v[32:35]
    ds_read_b64_tr_b16 a[36:37], v13 offset:18528
    ds_read_b64_tr_b16 a[38:39], v13 offset:23136
    v_mfma_f32_16x16x32_bf16 v[40:43], a[48:51], a[12:15], v[40:43]
    s_waitcnt lgkmcnt(8)
    v_mfma_f32_16x16x32_bf16 v[36:39], a[52:55], a[8:11], v[36:39]
    ds_read_b64_tr_b16 a[40:41], v13 offset:128
    ds_read_b64_tr_b16 a[42:43], v13 offset:4736
    v_mfma_f32_16x16x32_bf16 v[44:47], a[52:55], a[12:15], v[44:47]
    s_add_u32 m0, s27, 3072
    s_mov_b32 s30, 1769472
    buffer_load_dwordx4 v5, s[12:15], s30 offen lds
    s_waitcnt lgkmcnt(8)
    v_mfma_f32_16x16x32_bf16 v[48:51], a[24:27], a[8:11], v[48:51]
    ds_read_b64_tr_b16 a[44:45], v13 offset:18560
    ds_read_b64_tr_b16 a[46:47], v13 offset:23168
    v_mfma_f32_16x16x32_bf16 v[56:59], a[24:27], a[12:15], v[56:59]
    s_waitcnt lgkmcnt(8)
    v_mfma_f32_16x16x32_bf16 v[52:55], a[28:31], a[8:11], v[52:55]
    ds_read_b64_tr_b16 a[48:49], v13 offset:160
    ds_read_b64_tr_b16 a[50:51], v13 offset:4768
    v_mfma_f32_16x16x32_bf16 v[60:63], a[28:31], a[12:15], v[60:63]
    s_add_u32 m0, s27, 4096
    s_mov_b32 s30, 1769472
    s_mov_b32 exec_hi, 0
    buffer_load_dwordx4 v6, s[12:15], s30 offen lds
    s_mov_b32 exec_hi, -1
    s_waitcnt lgkmcnt(8)
    v_mfma_f32_16x16x32_bf16 v[64:67], a[32:35], a[8:11], v[64:67]
    ds_read_b64_tr_b16 a[52:53], v13 offset:18592
    ds_read_b64_tr_b16 a[54:55], v13 offset:23200
    v_mfma_f32_16x16x32_bf16 v[72:75], a[32:35], a[12:15], v[72:75]
    s_waitcnt lgkmcnt(8)
    v_mfma_f32_16x16x32_bf16 v[68:71], a[36:39], a[8:11], v[68:71]
    ds_read_b64_tr_b16 a[24:25], v13 offset:192
    ds_read_b64_tr_b16 a[26:27], v13 offset:4800
    v_mfma_f32_16x16x32_bf16 v[76:79], a[36:39], a[12:15], v[76:79]
    s_add_u32 m0, s29, 0
    s_movk_i32 s30, 384
    s_mov_b32 exec_hi, 0xf
    buffer_load_dwordx4 v7, s[40:43], s30 offen lds
    s_mov_b32 exec_hi, -1
    s_waitcnt lgkmcnt(8)
    v_mfma_f32_16x16x32_bf16 v[80:83], a[40:43], a[8:11], v[80:83]
    ds_read_b64_tr_b16 a[28:29], v13 offset:18624
    ds_read_b64_tr_b16 a[30:31], v13 offset:23232
    v_mfma_f32_16x16x32_bf16 v[88:91], a[40:43], a[12:15], v[88:91]
    s_waitcnt lgkmcnt(8)
    v_mfma_f32_16x16x32_bf16 v[84:87], a[44:47], a[8:11], v[84:87]
    ds_read_b64_tr_b16 a[32:33], v13 offset:224
    ds_read_b64_tr_b16 a[34:35], v13 offset:4832
    v_mfma_f32_16x16x32_bf16 v[92:95], a[44:47], a[12:15], v[92:95]
    s_waitcnt lgkmcnt(8)
    v_mfma_f32_16x16x32_bf16 v[96:99], a[48:51], a[8:11], v[96:99]
    ds_read_b64_tr_b16 a[36:37], v13 offset:18656
    ds_read_b64_tr_b16 a[38:39], v13 offset:23264
    v_mfma_f32_16x16x32_bf16 v[104:107], a[48:51], a[12:15], v[104:107]
    s_add_u32 s49, s48, 0
    buffer_load_dwordx4 v[188:191], v10, s[44:47], s49 offen
    s_waitcnt lgkmcnt(8)
    v_mfma_f32_16x16x32_bf16 v[100:103], a[52:55], a[8:11], v[100:103]
    ds_read_b64_tr_b16 a[40:41], v13 offset:256
    ds_read_b64_tr_b16 a[42:43], v13 offset:4864
    v_mfma_f32_16x16x32_bf16 v[108:111], a[52:55], a[12:15], v[108:111]
    s_waitcnt lgkmcnt(8)
    v_mfma_f32_16x16x32_bf16 v[112:115], a[24:27], a[8:11], v[112:115]
    ds_read_b64_tr_b16 a[44:45], v13 offset:18688
    ds_read_b64_tr_b16 a[46:47], v13 offset:23296
    v_mfma_f32_16x16x32_bf16 v[120:123], a[24:27], a[12:15], v[120:123]
    s_waitcnt lgkmcnt(8)
    v_mfma_f32_16x16x32_bf16 v[116:119], a[28:31], a[8:11], v[116:119]
    ds_read_b128 a[48:51], v8 offset:9216
    v_mfma_f32_16x16x32_bf16 v[124:127], a[28:31], a[12:15], v[124:127]
    s_waitcnt lgkmcnt(7)
    v_mfma_f32_16x16x32_bf16 v[128:131], a[32:35], a[8:11], v[128:131]
    ds_read_b128 a[52:55], v8 offset:11264
    v_mfma_f32_16x16x32_bf16 v[136:139], a[32:35], a[12:15], v[136:139]
    s_mov_b32 s49, 3538944
    s_mov_b32 exec_hi, 0xf
    buffer_load_dwordx4 v[188:191], v14, s[12:15], s49 offen
    s_mov_b32 exec_hi, -1
    s_waitcnt lgkmcnt(6)
    v_mfma_f32_16x16x32_bf16 v[132:135], a[36:39], a[8:11], v[132:135]
    ds_read_b128 a[24:27], v196 offset:9216
    v_mfma_f32_16x16x32_bf16 v[140:143], a[36:39], a[12:15], v[140:143]
    s_waitcnt lgkmcnt(5)
    v_mfma_f32_16x16x32_bf16 v[144:147], a[40:43], a[8:11], v[144:147]
    ds_read_b64_tr_b16 a[28:29], v13 offset:9216
    ds_read_b64_tr_b16 a[30:31], v13 offset:13824
    v_mfma_f32_16x16x32_bf16 v[152:155], a[40:43], a[12:15], v[152:155]
    s_waitcnt lgkmcnt(5)
    v_mfma_f32_16x16x32_bf16 v[148:151], a[44:47], a[8:11], v[148:151]
    ds_read_b64_tr_b16 a[32:33], v13 offset:27648
    ds_read_b64_tr_b16 a[34:35], v13 offset:32256
    v_mfma_f32_16x16x32_bf16 v[156:159], a[44:47], a[12:15], v[156:159]
    s_waitcnt lgkmcnt(6)
    v_mfma_f32_16x16x32_bf16 v[160:163], a[48:51], a[8:11], v[160:163]
    ds_read_b64_tr_b16 a[36:37], v13 offset:9248
    ds_read_b64_tr_b16 a[38:39], v13 offset:13856
    v_mfma_f32_16x16x32_bf16 v[164:167], a[48:51], a[12:15], v[164:167]
    s_waitcnt lgkmcnt(7)
    v_mfma_f32_16x16x32_bf16 v[168:171], a[52:55], a[8:11], v[168:171]
    ds_read_b64_tr_b16 a[40:41], v13 offset:27680
    ds_read_b64_tr_b16 a[42:43], v13 offset:32288
    v_mfma_f32_16x16x32_bf16 v[172:175], a[52:55], a[12:15], v[172:175]
    s_waitcnt lgkmcnt(8)
    v_mfma_f32_16x16x32_bf16 v[176:179], a[24:27], a[8:11], v[176:179]
    ds_read_b64_tr_b16 a[44:45], v13 offset:9280
    ds_read_b64_tr_b16 a[46:47], v13 offset:13888
    v_mfma_f32_16x16x32_bf16 v[180:183], a[24:27], a[12:15], v[180:183]
    s_waitcnt vmcnt(10) lgkmcnt(8)
    v_mfma_f32_16x16x32_bf16 v[16:19], a[28:31], a[16:19], v[16:19]
    ds_read_b64_tr_b16 a[48:49], v13 offset:27712
    ds_read_b64_tr_b16 a[50:51], v13 offset:32320
    v_mfma_f32_16x16x32_bf16 v[24:27], a[28:31], a[20:23], v[24:27]
    s_add_u32 s31, s28, 14336
    buffer_load_dwordx4 a[8:11], v1, s[16:19], s31 offen offset:0 sc1
    buffer_load_dwordx4 a[12:15], v1, s[16:19], s31 offen offset:1024 sc1
    s_waitcnt lgkmcnt(8)
    v_mfma_f32_16x16x32_bf16 v[20:23], a[32:35], a[16:19], v[20:23]
    ds_read_b64_tr_b16 a[52:53], v13 offset:9312
    ds_read_b64_tr_b16 a[54:55], v13 offset:13920
    v_mfma_f32_16x16x32_bf16 v[28:31], a[32:35], a[20:23], v[28:31]
    s_waitcnt lgkmcnt(8)
    v_mfma_f32_16x16x32_bf16 v[32:35], a[36:39], a[16:19], v[32:35]
    ds_read_b64_tr_b16 a[24:25], v13 offset:27744
    ds_read_b64_tr_b16 a[26:27], v13 offset:32352
    v_mfma_f32_16x16x32_bf16 v[40:43], a[36:39], a[20:23], v[40:43]
    s_waitcnt lgkmcnt(8)
    v_mfma_f32_16x16x32_bf16 v[36:39], a[40:43], a[16:19], v[36:39]
    ds_read_b64_tr_b16 a[28:29], v13 offset:9344
    ds_read_b64_tr_b16 a[30:31], v13 offset:13952
    v_mfma_f32_16x16x32_bf16 v[44:47], a[40:43], a[20:23], v[44:47]
    s_waitcnt lgkmcnt(8)
    v_mfma_f32_16x16x32_bf16 v[48:51], a[44:47], a[16:19], v[48:51]
    ds_read_b64_tr_b16 a[32:33], v13 offset:27776
    ds_read_b64_tr_b16 a[34:35], v13 offset:32384
    v_mfma_f32_16x16x32_bf16 v[56:59], a[44:47], a[20:23], v[56:59]
    s_waitcnt lgkmcnt(8)
    v_mfma_f32_16x16x32_bf16 v[52:55], a[48:51], a[16:19], v[52:55]
    ds_read_b64_tr_b16 a[36:37], v13 offset:9376
    ds_read_b64_tr_b16 a[38:39], v13 offset:13984
    v_mfma_f32_16x16x32_bf16 v[60:63], a[48:51], a[20:23], v[60:63]
    s_waitcnt lgkmcnt(8)
    v_mfma_f32_16x16x32_bf16 v[64:67], a[52:55], a[16:19], v[64:67]
    ds_read_b64_tr_b16 a[40:41], v13 offset:27808
    ds_read_b64_tr_b16 a[42:43], v13 offset:32416
    v_mfma_f32_16x16x32_bf16 v[72:75], a[52:55], a[20:23], v[72:75]
    s_waitcnt lgkmcnt(8)
    v_mfma_f32_16x16x32_bf16 v[68:71], a[24:27], a[16:19], v[68:71]
    ds_read_b64_tr_b16 a[44:45], v13 offset:9408
    ds_read_b64_tr_b16 a[46:47], v13 offset:14016
    v_mfma_f32_16x16x32_bf16 v[76:79], a[24:27], a[20:23], v[76:79]
    s_waitcnt lgkmcnt(8)
    v_mfma_f32_16x16x32_bf16 v[80:83], a[28:31], a[16:19], v[80:83]
    ds_read_b64_tr_b16 a[48:49], v13 offset:27840
    ds_read_b64_tr_b16 a[50:51], v13 offset:32448
    v_mfma_f32_16x16x32_bf16 v[88:91], a[28:31], a[20:23], v[88:91]
    s_waitcnt lgkmcnt(8)
    v_mfma_f32_16x16x32_bf16 v[84:87], a[32:35], a[16:19], v[84:87]
    ds_read_b64_tr_b16 a[52:53], v13 offset:9440
    ds_read_b64_tr_b16 a[54:55], v13 offset:14048
    v_mfma_f32_16x16x32_bf16 v[92:95], a[32:35], a[20:23], v[92:95]
    s_waitcnt lgkmcnt(8)
    v_mfma_f32_16x16x32_bf16 v[96:99], a[36:39], a[16:19], v[96:99]
    ds_read_b64_tr_b16 a[24:25], v13 offset:27872
    ds_read_b64_tr_b16 a[26:27], v13 offset:32480
    v_mfma_f32_16x16x32_bf16 v[104:107], a[36:39], a[20:23], v[104:107]
    s_add_u32 s49, s48, 8192
    buffer_load_dwordx4 v[188:191], v10, s[44:47], s49 offen
    s_waitcnt lgkmcnt(8)
    v_mfma_f32_16x16x32_bf16 v[100:103], a[40:43], a[16:19], v[100:103]
    ds_read_b64_tr_b16 a[28:29], v13 offset:9472
    ds_read_b64_tr_b16 a[30:31], v13 offset:14080
    v_mfma_f32_16x16x32_bf16 v[108:111], a[40:43], a[20:23], v[108:111]
    s_waitcnt lgkmcnt(8)
    v_mfma_f32_16x16x32_bf16 v[112:115], a[44:47], a[16:19], v[112:115]
    ds_read_b64_tr_b16 a[32:33], v13 offset:27904
    ds_read_b64_tr_b16 a[34:35], v13 offset:32512
    v_mfma_f32_16x16x32_bf16 v[120:123], a[44:47], a[20:23], v[120:123]
    s_waitcnt lgkmcnt(8)
    v_mfma_f32_16x16x32_bf16 v[116:119], a[48:51], a[16:19], v[116:119]
    ds_read_b128 a[36:39], v9 offset:9216
    v_mfma_f32_16x16x32_bf16 v[124:127], a[48:51], a[20:23], v[124:127]
    s_waitcnt lgkmcnt(7)
    v_mfma_f32_16x16x32_bf16 v[128:131], a[52:55], a[16:19], v[128:131]
    ds_read_b128 a[40:43], v9 offset:11264
    v_mfma_f32_16x16x32_bf16 v[136:139], a[52:55], a[20:23], v[136:139]
    s_waitcnt lgkmcnt(6)
    v_mfma_f32_16x16x32_bf16 v[132:135], a[24:27], a[16:19], v[132:135]
    ds_read_b128 a[44:47], v197 offset:9216
    v_mfma_f32_16x16x32_bf16 v[140:143], a[24:27], a[20:23], v[140:143]
    s_waitcnt vmcnt(5)
    s_barrier
    s_waitcnt lgkmcnt(5)
    v_mfma_f32_16x16x32_bf16 v[144:147], a[28:31], a[16:19], v[144:147]
    ds_read_b64_tr_b16 a[48:49], v11 offset:0
    ds_read_b64_tr_b16 a[50:51], v11 offset:4608
    v_mfma_f32_16x16x32_bf16 v[152:155], a[28:31], a[20:23], v[152:155]
    s_waitcnt lgkmcnt(5)
    v_mfma_f32_16x16x32_bf16 v[148:151], a[32:35], a[16:19], v[148:151]
    ds_read_b64_tr_b16 a[52:53], v11 offset:18432
    ds_read_b64_tr_b16 a[54:55], v11 offset:23040
    v_mfma_f32_16x16x32_bf16 v[156:159], a[32:35], a[20:23], v[156:159]
    s_add_u32 m0, s27, 36864
    s_mov_b32 s30, 2359296
    buffer_load_dwordx4 v2, s[12:15], s30 offen lds
    s_waitcnt lgkmcnt(6)
    v_mfma_f32_16x16x32_bf16 v[160:163], a[36:39], a[16:19], v[160:163]
    ds_read_b64_tr_b16 a[24:25], v11 offset:32
    ds_read_b64_tr_b16 a[26:27], v11 offset:4640
    v_mfma_f32_16x16x32_bf16 v[164:167], a[36:39], a[20:23], v[164:167]
    s_waitcnt lgkmcnt(7)
    v_mfma_f32_16x16x32_bf16 v[168:171], a[40:43], a[16:19], v[168:171]
    ds_read_b64_tr_b16 a[28:29], v11 offset:18464
    ds_read_b64_tr_b16 a[30:31], v11 offset:23072
    v_mfma_f32_16x16x32_bf16 v[172:175], a[40:43], a[20:23], v[172:175]
    s_add_u32 m0, s27, 37888
    s_mov_b32 s30, 2359296
    buffer_load_dwordx4 v3, s[12:15], s30 offen lds
    s_waitcnt lgkmcnt(8)
    v_mfma_f32_16x16x32_bf16 v[176:179], a[44:47], a[16:19], v[176:179]
    ds_read_b64_tr_b16 a[32:33], v11 offset:64
    ds_read_b64_tr_b16 a[34:35], v11 offset:4672
    v_mfma_f32_16x16x32_bf16 v[180:183], a[44:47], a[20:23], v[180:183]
    s_waitcnt lgkmcnt(8)
    v_mfma_f32_16x16x32_bf16 v[16:19], a[48:51], a[0:3], v[16:19]
    ds_read_b64_tr_b16 a[36:37], v11 offset:18496
    ds_read_b64_tr_b16 a[38:39], v11 offset:23104
    v_mfma_f32_16x16x32_bf16 v[24:27], a[48:51], a[4:7], v[24:27]
    s_add_u32 s31, s28, 16384
    buffer_load_dwordx4 a[16:19], v1, s[16:19], s31 offen offset:0 sc1
    buffer_load_dwordx4 a[20:23], v1, s[16:19], s31 offen offset:1024 sc1
    s_waitcnt lgkmcnt(8)
    v_mfma_f32_16x16x32_bf16 v[20:23], a[52:55], a[0:3], v[20:23]
    ds_read_b64_tr_b16 a[40:41], v11 offset:96
    ds_read_b64_tr_b16 a[42:43], v11 offset:4704
    v_mfma_f32_16x16x32_bf16 v[28:31], a[52:55], a[4:7], v[28:31]
    s_add_u32 m0, s27, 38912
    s_mov_b32 s30, 2359296
    buffer_load_dwordx4 v4, s[12:15], s30 offen lds
    s_waitcnt lgkmcnt(8)
    v_mfma_f32_16x16x32_bf16 v[32:35], a[24:27], a[0:3], v[32:35]
    ds_read_b64_tr_b16 a[44:45], v11 offset:18528
    ds_read_b64_tr_b16 a[46:47], v11 offset:23136
    v_mfma_f32_16x16x32_bf16 v[40:43], a[24:27], a[4:7], v[40:43]
    s_waitcnt lgkmcnt(8)
    v_mfma_f32_16x16x32_bf16 v[36:39], a[28:31], a[0:3], v[36:39]
    ds_read_b64_tr_b16 a[48:49], v11 offset:128
    ds_read_b64_tr_b16 a[50:51], v11 offset:4736
    v_mfma_f32_16x16x32_bf16 v[44:47], a[28:31], a[4:7], v[44:47]
    s_add_u32 m0, s27, 39936
    s_mov_b32 s30, 2359296
    buffer_load_dwordx4 v5, s[12:15], s30 offen lds
    s_waitcnt lgkmcnt(8)
    v_mfma_f32_16x16x32_bf16 v[48:51], a[32:35], a[0:3], v[48:51]
    ds_read_b64_tr_b16 a[52:53], v11 offset:18560
    ds_read_b64_tr_b16 a[54:55], v11 offset:23168
    v_mfma_f32_16x16x32_bf16 v[56:59], a[32:35], a[4:7], v[56:59]
    s_waitcnt lgkmcnt(8)
    v_mfma_f32_16x16x32_bf16 v[52:55], a[36:39], a[0:3], v[52:55]
    ds_read_b64_tr_b16 a[24:25], v11 offset:160
    ds_read_b64_tr_b16 a[26:27], v11 offset:4768
    v_mfma_f32_16x16x32_bf16 v[60:63], a[36:39], a[4:7], v[60:63]
    s_add_u32 m0, s27, 40960
    s_mov_b32 s30, 2359296
    s_mov_b32 exec_hi, 0
    buffer_load_dwordx4 v6, s[12:15], s30 offen lds
    s_mov_b32 exec_hi, -1
    s_waitcnt lgkmcnt(8)
    v_mfma_f32_16x16x32_bf16 v[64:67], a[40:43], a[0:3], v[64:67]
    ds_read_b64_tr_b16 a[28:29], v11 offset:18592
    ds_read_b64_tr_b16 a[30:31], v11 offset:23200
    v_mfma_f32_16x16x32_bf16 v[72:75], a[40:43], a[4:7], v[72:75]
    s_waitcnt lgkmcnt(8)
    v_mfma_f32_16x16x32_bf16 v[68:71], a[44:47], a[0:3], v[68:71]
    ds_read_b64_tr_b16 a[32:33], v11 offset:192
    ds_read_b64_tr_b16 a[34:35], v11 offset:4800
    v_mfma_f32_16x16x32_bf16 v[76:79], a[44:47], a[4:7], v[76:79]
    s_add_u32 m0, s29, 4608
    s_movk_i32 s30, 512
    s_mov_b32 exec_hi, 0xf
    buffer_load_dwordx4 v7, s[40:43], s30 offen lds
    s_mov_b32 exec_hi, -1
    s_waitcnt lgkmcnt(8)
    v_mfma_f32_16x16x32_bf16 v[80:83], a[48:51], a[0:3], v[80:83]
    ds_read_b64_tr_b16 a[36:37], v11 offset:18624
    ds_read_b64_tr_b16 a[38:39], v11 offset:23232
    v_mfma_f32_16x16x32_bf16 v[88:91], a[48:51], a[4:7], v[88:91]
    s_waitcnt lgkmcnt(8)
    v_mfma_f32_16x16x32_bf16 v[84:87], a[52:55], a[0:3], v[84:87]
    ds_read_b64_tr_b16 a[40:41], v11 offset:224
    ds_read_b64_tr_b16 a[42:43], v11 offset:4832
    v_mfma_f32_16x16x32_bf16 v[92:95], a[52:55], a[4:7], v[92:95]
    s_waitcnt lgkmcnt(8)
    v_mfma_f32_16x16x32_bf16 v[96:99], a[24:27], a[0:3], v[96:99]
    ds_read_b64_tr_b16 a[44:45], v11 offset:18656
    ds_read_b64_tr_b16 a[46:47], v11 offset:23264
    v_mfma_f32_16x16x32_bf16 v[104:107], a[24:27], a[4:7], v[104:107]
    s_add_u32 s49, s48, 16384
    buffer_load_dwordx4 v[188:191], v10, s[44:47], s49 offen
    s_waitcnt lgkmcnt(8)
    v_mfma_f32_16x16x32_bf16 v[100:103], a[28:31], a[0:3], v[100:103]
    ds_read_b64_tr_b16 a[48:49], v11 offset:256
    ds_read_b64_tr_b16 a[50:51], v11 offset:4864
    v_mfma_f32_16x16x32_bf16 v[108:111], a[28:31], a[4:7], v[108:111]
    s_waitcnt lgkmcnt(8)
    v_mfma_f32_16x16x32_bf16 v[112:115], a[32:35], a[0:3], v[112:115]
    ds_read_b64_tr_b16 a[52:53], v11 offset:18688
    ds_read_b64_tr_b16 a[54:55], v11 offset:23296
    v_mfma_f32_16x16x32_bf16 v[120:123], a[32:35], a[4:7], v[120:123]
    s_waitcnt lgkmcnt(8)
    v_mfma_f32_16x16x32_bf16 v[116:119], a[36:39], a[0:3], v[116:119]
    ds_read_b128 a[24:27], v8 offset:0
    v_mfma_f32_16x16x32_bf16 v[124:127], a[36:39], a[4:7], v[124:127]
    s_waitcnt lgkmcnt(7)
    v_mfma_f32_16x16x32_bf16 v[128:131], a[40:43], a[0:3], v[128:131]
    ds_read_b128 a[28:31], v8 offset:2048
    v_mfma_f32_16x16x32_bf16 v[136:139], a[40:43], a[4:7], v[136:139]
    s_mov_b32 s49, 4128768
    s_mov_b32 exec_hi, 0xf
    buffer_load_dwordx4 v[188:191], v14, s[12:15], s49 offen
    s_mov_b32 exec_hi, -1
    s_waitcnt lgkmcnt(6)
    v_mfma_f32_16x16x32_bf16 v[132:135], a[44:47], a[0:3], v[132:135]
    ds_read_b128 a[32:35], v196 offset:0
    v_mfma_f32_16x16x32_bf16 v[140:143], a[44:47], a[4:7], v[140:143]
    s_waitcnt lgkmcnt(5)
    v_mfma_f32_16x16x32_bf16 v[144:147], a[48:51], a[0:3], v[144:147]
    ds_read_b64_tr_b16 a[36:37], v11 offset:9216
    ds_read_b64_tr_b16 a[38:39], v11 offset:13824
    v_mfma_f32_16x16x32_bf16 v[152:155], a[48:51], a[4:7], v[152:155]
    s_waitcnt lgkmcnt(5)
    v_mfma_f32_16x16x32_bf16 v[148:151], a[52:55], a[0:3], v[148:151]
    ds_read_b64_tr_b16 a[40:41], v11 offset:27648
    ds_read_b64_tr_b16 a[42:43], v11 offset:32256
    v_mfma_f32_16x16x32_bf16 v[156:159], a[52:55], a[4:7], v[156:159]
    s_waitcnt lgkmcnt(6)
    v_mfma_f32_16x16x32_bf16 v[160:163], a[24:27], a[0:3], v[160:163]
    ds_read_b64_tr_b16 a[44:45], v11 offset:9248
    ds_read_b64_tr_b16 a[46:47], v11 offset:13856
    v_mfma_f32_16x16x32_bf16 v[164:167], a[24:27], a[4:7], v[164:167]
    s_waitcnt lgkmcnt(7)
    v_mfma_f32_16x16x32_bf16 v[168:171], a[28:31], a[0:3], v[168:171]
    ds_read_b64_tr_b16 a[48:49], v11 offset:27680
    ds_read_b64_tr_b16 a[50:51], v11 offset:32288
    v_mfma_f32_16x16x32_bf16 v[172:175], a[28:31], a[4:7], v[172:175]
    s_waitcnt lgkmcnt(8)
    v_mfma_f32_16x16x32_bf16 v[176:179], a[32:35], a[0:3], v[176:179]
    ds_read_b64_tr_b16 a[52:53], v11 offset:9280
    ds_read_b64_tr_b16 a[54:55], v11 offset:13888
    v_mfma_f32_16x16x32_bf16 v[180:183], a[32:35], a[4:7], v[180:183]
    s_waitcnt vmcnt(11) lgkmcnt(8)
    v_mfma_f32_16x16x32_bf16 v[16:19], a[36:39], a[8:11], v[16:19]
    ds_read_b64_tr_b16 a[24:25], v11 offset:27712
    ds_read_b64_tr_b16 a[26:27], v11 offset:32320
    v_mfma_f32_16x16x32_bf16 v[24:27], a[36:39], a[12:15], v[24:27]
    s_add_u32 s31, s28, 18432
    buffer_load_dwordx4 a[0:3], v1, s[16:19], s31 offen offset:0 sc1
    buffer_load_dwordx4 a[4:7], v1, s[16:19], s31 offen offset:1024 sc1
    s_waitcnt lgkmcnt(8)
    v_mfma_f32_16x16x32_bf16 v[20:23], a[40:43], a[8:11], v[20:23]
    ds_read_b64_tr_b16 a[28:29], v11 offset:9312
    ds_read_b64_tr_b16 a[30:31], v11 offset:13920
    v_mfma_f32_16x16x32_bf16 v[28:31], a[40:43], a[12:15], v[28:31]
    s_waitcnt lgkmcnt(8)
    v_mfma_f32_16x16x32_bf16 v[32:35], a[44:47], a[8:11], v[32:35]
    ds_read_b64_tr_b16 a[32:33], v11 offset:27744
    ds_read_b64_tr_b16 a[34:35], v11 offset:32352
    v_mfma_f32_16x16x32_bf16 v[40:43], a[44:47], a[12:15], v[40:43]
    s_waitcnt lgkmcnt(8)
    v_mfma_f32_16x16x32_bf16 v[36:39], a[48:51], a[8:11], v[36:39]
    ds_read_b64_tr_b16 a[36:37], v11 offset:9344
    ds_read_b64_tr_b16 a[38:39], v11 offset:13952
    v_mfma_f32_16x16x32_bf16 v[44:47], a[48:51], a[12:15], v[44:47]
    s_waitcnt lgkmcnt(8)
    v_mfma_f32_16x16x32_bf16 v[48:51], a[52:55], a[8:11], v[48:51]
    ds_read_b64_tr_b16 a[40:41], v11 offset:27776
    ds_read_b64_tr_b16 a[42:43], v11 offset:32384
    v_mfma_f32_16x16x32_bf16 v[56:59], a[52:55], a[12:15], v[56:59]
    s_waitcnt lgkmcnt(8)
    v_mfma_f32_16x16x32_bf16 v[52:55], a[24:27], a[8:11], v[52:55]
    ds_read_b64_tr_b16 a[44:45], v11 offset:9376
    ds_read_b64_tr_b16 a[46:47], v11 offset:13984
    v_mfma_f32_16x16x32_bf16 v[60:63], a[24:27], a[12:15], v[60:63]
    s_waitcnt lgkmcnt(8)
    v_mfma_f32_16x16x32_bf16 v[64:67], a[28:31], a[8:11], v[64:67]
    ds_read_b64_tr_b16 a[48:49], v11 offset:27808
    ds_read_b64_tr_b16 a[50:51], v11 offset:32416
    v_mfma_f32_16x16x32_bf16 v[72:75], a[28:31], a[12:15], v[72:75]
    s_waitcnt lgkmcnt(8)
    v_mfma_f32_16x16x32_bf16 v[68:71], a[32:35], a[8:11], v[68:71]
    ds_read_b64_tr_b16 a[52:53], v11 offset:9408
    ds_read_b64_tr_b16 a[54:55], v11 offset:14016
    v_mfma_f32_16x16x32_bf16 v[76:79], a[32:35], a[12:15], v[76:79]
    s_waitcnt lgkmcnt(8)
    v_mfma_f32_16x16x32_bf16 v[80:83], a[36:39], a[8:11], v[80:83]
    ds_read_b64_tr_b16 a[24:25], v11 offset:27840
    ds_read_b64_tr_b16 a[26:27], v11 offset:32448
    v_mfma_f32_16x16x32_bf16 v[88:91], a[36:39], a[12:15], v[88:91]
    s_waitcnt lgkmcnt(8)
    v_mfma_f32_16x16x32_bf16 v[84:87], a[40:43], a[8:11], v[84:87]
    ds_read_b64_tr_b16 a[28:29], v11 offset:9440
    ds_read_b64_tr_b16 a[30:31], v11 offset:14048
    v_mfma_f32_16x16x32_bf16 v[92:95], a[40:43], a[12:15], v[92:95]
    s_waitcnt lgkmcnt(8)
    v_mfma_f32_16x16x32_bf16 v[96:99], a[44:47], a[8:11], v[96:99]
    ds_read_b64_tr_b16 a[32:33], v11 offset:27872
    ds_read_b64_tr_b16 a[34:35], v11 offset:32480
    v_mfma_f32_16x16x32_bf16 v[104:107], a[44:47], a[12:15], v[104:107]
    s_waitcnt lgkmcnt(8)
    v_mfma_f32_16x16x32_bf16 v[100:103], a[48:51], a[8:11], v[100:103]
    ds_read_b64_tr_b16 a[36:37], v11 offset:9472
    ds_read_b64_tr_b16 a[38:39], v11 offset:14080
    v_mfma_f32_16x16x32_bf16 v[108:111], a[48:51], a[12:15], v[108:111]
    s_waitcnt lgkmcnt(8)
    v_mfma_f32_16x16x32_bf16 v[112:115], a[52:55], a[8:11], v[112:115]
    ds_read_b64_tr_b16 a[40:41], v11 offset:27904
    ds_read_b64_tr_b16 a[42:43], v11 offset:32512
    v_mfma_f32_16x16x32_bf16 v[120:123], a[52:55], a[12:15], v[120:123]
    s_waitcnt lgkmcnt(8)
    v_mfma_f32_16x16x32_bf16 v[116:119], a[24:27], a[8:11], v[116:119]
    ds_read_b128 a[44:47], v9 offset:0
    v_mfma_f32_16x16x32_bf16 v[124:127], a[24:27], a[12:15], v[124:127]
    s_waitcnt lgkmcnt(7)
    v_mfma_f32_16x16x32_bf16 v[128:131], a[28:31], a[8:11], v[128:131]
    ds_read_b128 a[48:51], v9 offset:2048
    v_mfma_f32_16x16x32_bf16 v[136:139], a[28:31], a[12:15], v[136:139]
    s_waitcnt lgkmcnt(6)
    v_mfma_f32_16x16x32_bf16 v[132:135], a[32:35], a[8:11], v[132:135]
    ds_read_b128 a[52:55], v197 offset:0
    v_mfma_f32_16x16x32_bf16 v[140:143], a[32:35], a[12:15], v[140:143]
    s_waitcnt vmcnt(4)
    s_barrier
    s_waitcnt lgkmcnt(5)
    v_mfma_f32_16x16x32_bf16 v[144:147], a[36:39], a[8:11], v[144:147]
    ds_read_b64_tr_b16 a[24:25], v12 offset:0
    ds_read_b64_tr_b16 a[26:27], v12 offset:4608
    v_mfma_f32_16x16x32_bf16 v[152:155], a[36:39], a[12:15], v[152:155]
    s_waitcnt lgkmcnt(5)
    v_mfma_f32_16x16x32_bf16 v[148:151], a[40:43], a[8:11], v[148:151]
    ds_read_b64_tr_b16 a[28:29], v12 offset:18432
    ds_read_b64_tr_b16 a[30:31], v12 offset:23040
    v_mfma_f32_16x16x32_bf16 v[156:159], a[40:43], a[12:15], v[156:159]
    s_add_u32 m0, s27, 73728
    s_mov_b32 s30, 2949120
    buffer_load_dwordx4 v2, s[12:15], s30 offen lds
    s_waitcnt lgkmcnt(6)
    v_mfma_f32_16x16x32_bf16 v[160:163], a[44:47], a[8:11], v[160:163]
    ds_read_b64_tr_b16 a[32:33], v12 offset:32
    ds_read_b64_tr_b16 a[34:35], v12 offset:4640
    v_mfma_f32_16x16x32_bf16 v[164:167], a[44:47], a[12:15], v[164:167]
    s_waitcnt lgkmcnt(7)
    v_mfma_f32_16x16x32_bf16 v[168:171], a[48:51], a[8:11], v[168:171]
    ds_read_b64_tr_b16 a[36:37], v12 offset:18464
    ds_read_b64_tr_b16 a[38:39], v12 offset:23072
    v_mfma_f32_16x16x32_bf16 v[172:175], a[48:51], a[12:15], v[172:175]
    s_add_u32 m0, s27, 74752
    s_mov_b32 s30, 2949120
    buffer_load_dwordx4 v3, s[12:15], s30 offen lds
    s_waitcnt lgkmcnt(8)
    v_mfma_f32_16x16x32_bf16 v[176:179], a[52:55], a[8:11], v[176:179]
    ds_read_b64_tr_b16 a[40:41], v12 offset:64
    ds_read_b64_tr_b16 a[42:43], v12 offset:4672
    v_mfma_f32_16x16x32_bf16 v[180:183], a[52:55], a[12:15], v[180:183]
    s_waitcnt lgkmcnt(8)
    v_mfma_f32_16x16x32_bf16 v[16:19], a[24:27], a[16:19], v[16:19]
    ds_read_b64_tr_b16 a[44:45], v12 offset:18496
    ds_read_b64_tr_b16 a[46:47], v12 offset:23104
    v_mfma_f32_16x16x32_bf16 v[24:27], a[24:27], a[20:23], v[24:27]
    s_add_u32 s31, s28, 20480
    buffer_load_dwordx4 a[8:11], v1, s[16:19], s31 offen offset:0 sc1
    buffer_load_dwordx4 a[12:15], v1, s[16:19], s31 offen offset:1024 sc1
    s_waitcnt lgkmcnt(8)
    v_mfma_f32_16x16x32_bf16 v[20:23], a[28:31], a[16:19], v[20:23]
    ds_read_b64_tr_b16 a[48:49], v12 offset:96
    ds_read_b64_tr_b16 a[50:51], v12 offset:4704
    v_mfma_f32_16x16x32_bf16 v[28:31], a[28:31], a[20:23], v[28:31]
    s_add_u32 m0, s27, 75776
    s_mov_b32 s30, 2949120
    buffer_load_dwordx4 v4, s[12:15], s30 offen lds
    s_waitcnt lgkmcnt(8)
    v_mfma_f32_16x16x32_bf16 v[32:35], a[32:35], a[16:19], v[32:35]
    ds_read_b64_tr_b16 a[52:53], v12 offset:18528
    ds_read_b64_tr_b16 a[54:55], v12 offset:23136
    v_mfma_f32_16x16x32_bf16 v[40:43], a[32:35], a[20:23], v[40:43]
    s_waitcnt lgkmcnt(8)
    v_mfma_f32_16x16x32_bf16 v[36:39], a[36:39], a[16:19], v[36:39]
    ds_read_b64_tr_b16 a[24:25], v12 offset:128
    ds_read_b64_tr_b16 a[26:27], v12 offset:4736
    v_mfma_f32_16x16x32_bf16 v[44:47], a[36:39], a[20:23], v[44:47]
    s_add_u32 m0, s27, 76800
    s_mov_b32 s30, 2949120
    buffer_load_dwordx4 v5, s[12:15], s30 offen lds
    s_waitcnt lgkmcnt(8)
    v_mfma_f32_16x16x32_bf16 v[48:51], a[40:43], a[16:19], v[48:51]
    ds_read_b64_tr_b16 a[28:29], v12 offset:18560
    ds_read_b64_tr_b16 a[30:31], v12 offset:23168
    v_mfma_f32_16x16x32_bf16 v[56:59], a[40:43], a[20:23], v[56:59]
    s_waitcnt lgkmcnt(8)
    v_mfma_f32_16x16x32_bf16 v[52:55], a[44:47], a[16:19], v[52:55]
    ds_read_b64_tr_b16 a[32:33], v12 offset:160
    ds_read_b64_tr_b16 a[34:35], v12 offset:4768
    v_mfma_f32_16x16x32_bf16 v[60:63], a[44:47], a[20:23], v[60:63]
    s_add_u32 m0, s27, 77824
    s_mov_b32 s30, 2949120
    s_mov_b32 exec_hi, 0
    buffer_load_dwordx4 v6, s[12:15], s30 offen lds
    s_mov_b32 exec_hi, -1
    s_waitcnt lgkmcnt(8)
    v_mfma_f32_16x16x32_bf16 v[64:67], a[48:51], a[16:19], v[64:67]
    ds_read_b64_tr_b16 a[36:37], v12 offset:18592
    ds_read_b64_tr_b16 a[38:39], v12 offset:23200
    v_mfma_f32_16x16x32_bf16 v[72:75], a[48:51], a[20:23], v[72:75]
    s_waitcnt lgkmcnt(8)
    v_mfma_f32_16x16x32_bf16 v[68:71], a[52:55], a[16:19], v[68:71]
    ds_read_b64_tr_b16 a[40:41], v12 offset:192
    ds_read_b64_tr_b16 a[42:43], v12 offset:4800
    v_mfma_f32_16x16x32_bf16 v[76:79], a[52:55], a[20:23], v[76:79]
    s_add_u32 m0, s29, 9216
    s_movk_i32 s30, 640
    s_mov_b32 exec_hi, 0xf
    buffer_load_dwordx4 v7, s[40:43], s30 offen lds
    s_mov_b32 exec_hi, -1
    s_waitcnt lgkmcnt(8)
    v_mfma_f32_16x16x32_bf16 v[80:83], a[24:27], a[16:19], v[80:83]
    ds_read_b64_tr_b16 a[44:45], v12 offset:18624
    ds_read_b64_tr_b16 a[46:47], v12 offset:23232
    v_mfma_f32_16x16x32_bf16 v[88:91], a[24:27], a[20:23], v[88:91]
    s_waitcnt lgkmcnt(8)
    v_mfma_f32_16x16x32_bf16 v[84:87], a[28:31], a[16:19], v[84:87]
    ds_read_b64_tr_b16 a[48:49], v12 offset:224
    ds_read_b64_tr_b16 a[50:51], v12 offset:4832
    v_mfma_f32_16x16x32_bf16 v[92:95], a[28:31], a[20:23], v[92:95]
    s_waitcnt lgkmcnt(8)
    v_mfma_f32_16x16x32_bf16 v[96:99], a[32:35], a[16:19], v[96:99]
    ds_read_b64_tr_b16 a[52:53], v12 offset:18656
    ds_read_b64_tr_b16 a[54:55], v12 offset:23264
    v_mfma_f32_16x16x32_bf16 v[104:107], a[32:35], a[20:23], v[104:107]
    s_waitcnt lgkmcnt(8)
    v_mfma_f32_16x16x32_bf16 v[100:103], a[36:39], a[16:19], v[100:103]
    ds_read_b64_tr_b16 a[24:25], v12 offset:256
    ds_read_b64_tr_b16 a[26:27], v12 offset:4864
    v_mfma_f32_16x16x32_bf16 v[108:111], a[36:39], a[20:23], v[108:111]
    s_waitcnt lgkmcnt(8)
    v_mfma_f32_16x16x32_bf16 v[112:115], a[40:43], a[16:19], v[112:115]
    ds_read_b64_tr_b16 a[28:29], v12 offset:18688
    ds_read_b64_tr_b16 a[30:31], v12 offset:23296
    v_mfma_f32_16x16x32_bf16 v[120:123], a[40:43], a[20:23], v[120:123]
    s_waitcnt lgkmcnt(8)
    v_mfma_f32_16x16x32_bf16 v[116:119], a[44:47], a[16:19], v[116:119]
    ds_read_b128 a[32:35], v8 offset:4608
    v_mfma_f32_16x16x32_bf16 v[124:127], a[44:47], a[20:23], v[124:127]
    s_waitcnt lgkmcnt(7)
    v_mfma_f32_16x16x32_bf16 v[128:131], a[48:51], a[16:19], v[128:131]
    ds_read_b128 a[36:39], v8 offset:6656
    v_mfma_f32_16x16x32_bf16 v[136:139], a[48:51], a[20:23], v[136:139]
    s_mov_b32 s49, 4718592
    s_mov_b32 exec_hi, 0xf
    buffer_load_dwordx4 v[188:191], v14, s[12:15], s49 offen
    s_mov_b32 exec_hi, -1
    s_waitcnt lgkmcnt(6)
    v_mfma_f32_16x16x32_bf16 v[132:135], a[52:55], a[16:19], v[132:135]
    ds_read_b128 a[40:43], v196 offset:4608
    v_mfma_f32_16x16x32_bf16 v[140:143], a[52:55], a[20:23], v[140:143]
    s_waitcnt lgkmcnt(5)
    v_mfma_f32_16x16x32_bf16 v[144:147], a[24:27], a[16:19], v[144:147]
    ds_read_b64_tr_b16 a[44:45], v12 offset:9216
    ds_read_b64_tr_b16 a[46:47], v12 offset:13824
    v_mfma_f32_16x16x32_bf16 v[152:155], a[24:27], a[20:23], v[152:155]
    s_waitcnt lgkmcnt(5)
    v_mfma_f32_16x16x32_bf16 v[148:151], a[28:31], a[16:19], v[148:151]
    ds_read_b64_tr_b16 a[48:49], v12 offset:27648
    ds_read_b64_tr_b16 a[50:51], v12 offset:32256
    v_mfma_f32_16x16x32_bf16 v[156:159], a[28:31], a[20:23], v[156:159]
    s_waitcnt lgkmcnt(6)
    v_mfma_f32_16x16x32_bf16 v[160:163], a[32:35], a[16:19], v[160:163]
    ds_read_b64_tr_b16 a[52:53], v12 offset:9248
    ds_read_b64_tr_b16 a[54:55], v12 offset:13856
    v_mfma_f32_16x16x32_bf16 v[164:167], a[32:35], a[20:23], v[164:167]
    s_waitcnt lgkmcnt(7)
    v_mfma_f32_16x16x32_bf16 v[168:171], a[36:39], a[16:19], v[168:171]
    ds_read_b64_tr_b16 a[24:25], v12 offset:27680
    ds_read_b64_tr_b16 a[26:27], v12 offset:32288
    v_mfma_f32_16x16x32_bf16 v[172:175], a[36:39], a[20:23], v[172:175]
    s_waitcnt lgkmcnt(8)
    v_mfma_f32_16x16x32_bf16 v[176:179], a[40:43], a[16:19], v[176:179]
    ds_read_b64_tr_b16 a[28:29], v12 offset:9280
    ds_read_b64_tr_b16 a[30:31], v12 offset:13888
    v_mfma_f32_16x16x32_bf16 v[180:183], a[40:43], a[20:23], v[180:183]
    s_waitcnt vmcnt(9) lgkmcnt(8)
    v_mfma_f32_16x16x32_bf16 v[16:19], a[44:47], a[0:3], v[16:19]
    ds_read_b64_tr_b16 a[32:33], v12 offset:27712
    ds_read_b64_tr_b16 a[34:35], v12 offset:32320
    v_mfma_f32_16x16x32_bf16 v[24:27], a[44:47], a[4:7], v[24:27]
    s_add_u32 s31, s28, 22528
    buffer_load_dwordx4 a[16:19], v1, s[16:19], s31 offen offset:0 sc1
    buffer_load_dwordx4 a[20:23], v1, s[16:19], s31 offen offset:1024 sc1
    s_waitcnt lgkmcnt(8)
    v_mfma_f32_16x16x32_bf16 v[20:23], a[48:51], a[0:3], v[20:23]
    ds_read_b64_tr_b16 a[36:37], v12 offset:9312
    ds_read_b64_tr_b16 a[38:39], v12 offset:13920
    v_mfma_f32_16x16x32_bf16 v[28:31], a[48:51], a[4:7], v[28:31]
    s_waitcnt lgkmcnt(8)
    v_mfma_f32_16x16x32_bf16 v[32:35], a[52:55], a[0:3], v[32:35]
    ds_read_b64_tr_b16 a[40:41], v12 offset:27744
    ds_read_b64_tr_b16 a[42:43], v12 offset:32352
    v_mfma_f32_16x16x32_bf16 v[40:43], a[52:55], a[4:7], v[40:43]
    s_waitcnt lgkmcnt(8)
    v_mfma_f32_16x16x32_bf16 v[36:39], a[24:27], a[0:3], v[36:39]
    ds_read_b64_tr_b16 a[44:45], v12 offset:9344
    ds_read_b64_tr_b16 a[46:47], v12 offset:13952
    v_mfma_f32_16x16x32_bf16 v[44:47], a[24:27], a[4:7], v[44:47]
    s_waitcnt lgkmcnt(8)
    v_mfma_f32_16x16x32_bf16 v[48:51], a[28:31], a[0:3], v[48:51]
    ds_read_b64_tr_b16 a[48:49], v12 offset:27776
    ds_read_b64_tr_b16 a[50:51], v12 offset:32384
    v_mfma_f32_16x16x32_bf16 v[56:59], a[28:31], a[4:7], v[56:59]
    s_waitcnt lgkmcnt(8)
    v_mfma_f32_16x16x32_bf16 v[52:55], a[32:35], a[0:3], v[52:55]
    ds_read_b64_tr_b16 a[52:53], v12 offset:9376
    ds_read_b64_tr_b16 a[54:55], v12 offset:13984
    v_mfma_f32_16x16x32_bf16 v[60:63], a[32:35], a[4:7], v[60:63]
    s_waitcnt lgkmcnt(8)
    v_mfma_f32_16x16x32_bf16 v[64:67], a[36:39], a[0:3], v[64:67]
    ds_read_b64_tr_b16 a[24:25], v12 offset:27808
    ds_read_b64_tr_b16 a[26:27], v12 offset:32416
    v_mfma_f32_16x16x32_bf16 v[72:75], a[36:39], a[4:7], v[72:75]
    s_waitcnt lgkmcnt(8)
    v_mfma_f32_16x16x32_bf16 v[68:71], a[40:43], a[0:3], v[68:71]
    ds_read_b64_tr_b16 a[28:29], v12 offset:9408
    ds_read_b64_tr_b16 a[30:31], v12 offset:14016
    v_mfma_f32_16x16x32_bf16 v[76:79], a[40:43], a[4:7], v[76:79]
    s_waitcnt lgkmcnt(8)
    v_mfma_f32_16x16x32_bf16 v[80:83], a[44:47], a[0:3], v[80:83]
    ds_read_b64_tr_b16 a[32:33], v12 offset:27840
    ds_read_b64_tr_b16 a[34:35], v12 offset:32448
    v_mfma_f32_16x16x32_bf16 v[88:91], a[44:47], a[4:7], v[88:91]
    s_waitcnt lgkmcnt(8)
    v_mfma_f32_16x16x32_bf16 v[84:87], a[48:51], a[0:3], v[84:87]
    ds_read_b64_tr_b16 a[36:37], v12 offset:9440
    ds_read_b64_tr_b16 a[38:39], v12 offset:14048
    v_mfma_f32_16x16x32_bf16 v[92:95], a[48:51], a[4:7], v[92:95]
    s_waitcnt lgkmcnt(8)
    v_mfma_f32_16x16x32_bf16 v[96:99], a[52:55], a[0:3], v[96:99]
    ds_read_b64_tr_b16 a[40:41], v12 offset:27872
    ds_read_b64_tr_b16 a[42:43], v12 offset:32480
    v_mfma_f32_16x16x32_bf16 v[104:107], a[52:55], a[4:7], v[104:107]
    s_waitcnt lgkmcnt(8)
    v_mfma_f32_16x16x32_bf16 v[100:103], a[24:27], a[0:3], v[100:103]
    ds_read_b64_tr_b16 a[44:45], v12 offset:9472
    ds_read_b64_tr_b16 a[46:47], v12 offset:14080
    v_mfma_f32_16x16x32_bf16 v[108:111], a[24:27], a[4:7], v[108:111]
    s_waitcnt lgkmcnt(8)
    v_mfma_f32_16x16x32_bf16 v[112:115], a[28:31], a[0:3], v[112:115]
    ds_read_b64_tr_b16 a[48:49], v12 offset:27904
    ds_read_b64_tr_b16 a[50:51], v12 offset:32512
    v_mfma_f32_16x16x32_bf16 v[120:123], a[28:31], a[4:7], v[120:123]
    s_waitcnt lgkmcnt(8)
    v_mfma_f32_16x16x32_bf16 v[116:119], a[32:35], a[0:3], v[116:119]
    ds_read_b128 a[52:55], v9 offset:4608
    v_mfma_f32_16x16x32_bf16 v[124:127], a[32:35], a[4:7], v[124:127]
    s_waitcnt lgkmcnt(7)
    v_mfma_f32_16x16x32_bf16 v[128:131], a[36:39], a[0:3], v[128:131]
    ds_read_b128 a[24:27], v9 offset:6656
    v_mfma_f32_16x16x32_bf16 v[136:139], a[36:39], a[4:7], v[136:139]
    s_waitcnt lgkmcnt(6)
    v_mfma_f32_16x16x32_bf16 v[132:135], a[40:43], a[0:3], v[132:135]
    ds_read_b128 a[28:31], v197 offset:4608
    v_mfma_f32_16x16x32_bf16 v[140:143], a[40:43], a[4:7], v[140:143]
    s_waitcnt vmcnt(3)
    s_barrier
    s_waitcnt lgkmcnt(5)
    v_mfma_f32_16x16x32_bf16 v[144:147], a[44:47], a[0:3], v[144:147]
    ds_read_b64_tr_b16 a[32:33], v13 offset:0
    ds_read_b64_tr_b16 a[34:35], v13 offset:4608
    v_mfma_f32_16x16x32_bf16 v[152:155], a[44:47], a[4:7], v[152:155]
    s_waitcnt lgkmcnt(5)
    v_mfma_f32_16x16x32_bf16 v[148:151], a[48:51], a[0:3], v[148:151]
    ds_read_b64_tr_b16 a[36:37], v13 offset:18432
    ds_read_b64_tr_b16 a[38:39], v13 offset:23040
    v_mfma_f32_16x16x32_bf16 v[156:159], a[48:51], a[4:7], v[156:159]
    s_add_u32 m0, s27, 0
    s_mov_b32 s30, 3538944
    buffer_load_dwordx4 v2, s[12:15], s30 offen lds
    s_waitcnt lgkmcnt(6)
    v_mfma_f32_16x16x32_bf16 v[160:163], a[52:55], a[0:3], v[160:163]
    ds_read_b64_tr_b16 a[40:41], v13 offset:32
    ds_read_b64_tr_b16 a[42:43], v13 offset:4640
    v_mfma_f32_16x16x32_bf16 v[164:167], a[52:55], a[4:7], v[164:167]
    s_waitcnt lgkmcnt(7)
    v_mfma_f32_16x16x32_bf16 v[168:171], a[24:27], a[0:3], v[168:171]
    ds_read_b64_tr_b16 a[44:45], v13 offset:18464
    ds_read_b64_tr_b16 a[46:47], v13 offset:23072
    v_mfma_f32_16x16x32_bf16 v[172:175], a[24:27], a[4:7], v[172:175]
    s_add_u32 m0, s27, 1024
    s_mov_b32 s30, 3538944
    buffer_load_dwordx4 v3, s[12:15], s30 offen lds
    s_waitcnt lgkmcnt(8)
    v_mfma_f32_16x16x32_bf16 v[176:179], a[28:31], a[0:3], v[176:179]
    ds_read_b64_tr_b16 a[48:49], v13 offset:64
    ds_read_b64_tr_b16 a[50:51], v13 offset:4672
    v_mfma_f32_16x16x32_bf16 v[180:183], a[28:31], a[4:7], v[180:183]
    s_waitcnt lgkmcnt(8)
    v_mfma_f32_16x16x32_bf16 v[16:19], a[32:35], a[8:11], v[16:19]
    ds_read_b64_tr_b16 a[52:53], v13 offset:18496
    ds_read_b64_tr_b16 a[54:55], v13 offset:23104
    v_mfma_f32_16x16x32_bf16 v[24:27], a[32:35], a[12:15], v[24:27]
    s_add_u32 s31, s28, 24576
    buffer_load_dwordx4 a[0:3], v1, s[16:19], s31 offen offset:0 sc1
    buffer_load_dwordx4 a[4:7], v1, s[16:19], s31 offen offset:1024 sc1
    s_waitcnt lgkmcnt(8)
    v_mfma_f32_16x16x32_bf16 v[20:23], a[36:39], a[8:11], v[20:23]
    ds_read_b64_tr_b16 a[24:25], v13 offset:96
    ds_read_b64_tr_b16 a[26:27], v13 offset:4704
    v_mfma_f32_16x16x32_bf16 v[28:31], a[36:39], a[12:15], v[28:31]
    s_add_u32 m0, s27, 2048
    s_mov_b32 s30, 3538944
    buffer_load_dwordx4 v4, s[12:15], s30 offen lds
    s_waitcnt lgkmcnt(8)
    v_mfma_f32_16x16x32_bf16 v[32:35], a[40:43], a[8:11], v[32:35]
    ds_read_b64_tr_b16 a[28:29], v13 offset:18528
    ds_read_b64_tr_b16 a[30:31], v13 offset:23136
    v_mfma_f32_16x16x32_bf16 v[40:43], a[40:43], a[12:15], v[40:43]
    s_waitcnt lgkmcnt(8)
    v_mfma_f32_16x16x32_bf16 v[36:39], a[44:47], a[8:11], v[36:39]
    ds_read_b64_tr_b16 a[32:33], v13 offset:128
    ds_read_b64_tr_b16 a[34:35], v13 offset:4736
    v_mfma_f32_16x16x32_bf16 v[44:47], a[44:47], a[12:15], v[44:47]
    s_add_u32 m0, s27, 3072
    s_mov_b32 s30, 3538944
    buffer_load_dwordx4 v5, s[12:15], s30 offen lds
    s_waitcnt lgkmcnt(8)
    v_mfma_f32_16x16x32_bf16 v[48:51], a[48:51], a[8:11], v[48:51]
    ds_read_b64_tr_b16 a[36:37], v13 offset:18560
    ds_read_b64_tr_b16 a[38:39], v13 offset:23168
    v_mfma_f32_16x16x32_bf16 v[56:59], a[48:51], a[12:15], v[56:59]
    s_waitcnt lgkmcnt(8)
    v_mfma_f32_16x16x32_bf16 v[52:55], a[52:55], a[8:11], v[52:55]
    ds_read_b64_tr_b16 a[40:41], v13 offset:160
    ds_read_b64_tr_b16 a[42:43], v13 offset:4768
    v_mfma_f32_16x16x32_bf16 v[60:63], a[52:55], a[12:15], v[60:63]
    s_add_u32 m0, s27, 4096
    s_mov_b32 s30, 3538944
    s_mov_b32 exec_hi, 0
    buffer_load_dwordx4 v6, s[12:15], s30 offen lds
    s_mov_b32 exec_hi, -1
    s_waitcnt lgkmcnt(8)
    v_mfma_f32_16x16x32_bf16 v[64:67], a[24:27], a[8:11], v[64:67]
    ds_read_b64_tr_b16 a[44:45], v13 offset:18592
    ds_read_b64_tr_b16 a[46:47], v13 offset:23200
    v_mfma_f32_16x16x32_bf16 v[72:75], a[24:27], a[12:15], v[72:75]
    s_waitcnt lgkmcnt(8)
    v_mfma_f32_16x16x32_bf16 v[68:71], a[28:31], a[8:11], v[68:71]
    ds_read_b64_tr_b16 a[48:49], v13 offset:192
    ds_read_b64_tr_b16 a[50:51], v13 offset:4800
    v_mfma_f32_16x16x32_bf16 v[76:79], a[28:31], a[12:15], v[76:79]
    s_add_u32 m0, s29, 0
    s_movk_i32 s30, 768
    s_mov_b32 exec_hi, 0xf
    buffer_load_dwordx4 v7, s[40:43], s30 offen lds
    s_mov_b32 exec_hi, -1
    s_waitcnt lgkmcnt(8)
    v_mfma_f32_16x16x32_bf16 v[80:83], a[32:35], a[8:11], v[80:83]
    ds_read_b64_tr_b16 a[52:53], v13 offset:18624
    ds_read_b64_tr_b16 a[54:55], v13 offset:23232
    v_mfma_f32_16x16x32_bf16 v[88:91], a[32:35], a[12:15], v[88:91]
    s_waitcnt lgkmcnt(8)
    v_mfma_f32_16x16x32_bf16 v[84:87], a[36:39], a[8:11], v[84:87]
    ds_read_b64_tr_b16 a[24:25], v13 offset:224
    ds_read_b64_tr_b16 a[26:27], v13 offset:4832
    v_mfma_f32_16x16x32_bf16 v[92:95], a[36:39], a[12:15], v[92:95]
    s_waitcnt lgkmcnt(8)
    v_mfma_f32_16x16x32_bf16 v[96:99], a[40:43], a[8:11], v[96:99]
    ds_read_b64_tr_b16 a[28:29], v13 offset:18656
    ds_read_b64_tr_b16 a[30:31], v13 offset:23264
    v_mfma_f32_16x16x32_bf16 v[104:107], a[40:43], a[12:15], v[104:107]
    s_waitcnt lgkmcnt(8)
    v_mfma_f32_16x16x32_bf16 v[100:103], a[44:47], a[8:11], v[100:103]
    ds_read_b64_tr_b16 a[32:33], v13 offset:256
    ds_read_b64_tr_b16 a[34:35], v13 offset:4864
    v_mfma_f32_16x16x32_bf16 v[108:111], a[44:47], a[12:15], v[108:111]
    s_waitcnt lgkmcnt(8)
    v_mfma_f32_16x16x32_bf16 v[112:115], a[48:51], a[8:11], v[112:115]
    ds_read_b64_tr_b16 a[36:37], v13 offset:18688
    ds_read_b64_tr_b16 a[38:39], v13 offset:23296
    v_mfma_f32_16x16x32_bf16 v[120:123], a[48:51], a[12:15], v[120:123]
    s_waitcnt lgkmcnt(8)
    v_mfma_f32_16x16x32_bf16 v[116:119], a[52:55], a[8:11], v[116:119]
    ds_read_b128 a[40:43], v8 offset:9216
    v_mfma_f32_16x16x32_bf16 v[124:127], a[52:55], a[12:15], v[124:127]
    s_waitcnt lgkmcnt(7)
    v_mfma_f32_16x16x32_bf16 v[128:131], a[24:27], a[8:11], v[128:131]
    ds_read_b128 a[44:47], v8 offset:11264
    v_mfma_f32_16x16x32_bf16 v[136:139], a[24:27], a[12:15], v[136:139]
    s_waitcnt lgkmcnt(6)
    v_mfma_f32_16x16x32_bf16 v[132:135], a[28:31], a[8:11], v[132:135]
    ds_read_b128 a[48:51], v196 offset:9216
    v_mfma_f32_16x16x32_bf16 v[140:143], a[28:31], a[12:15], v[140:143]
    s_waitcnt lgkmcnt(5)
    v_mfma_f32_16x16x32_bf16 v[144:147], a[32:35], a[8:11], v[144:147]
    ds_read_b64_tr_b16 a[52:53], v13 offset:9216
    ds_read_b64_tr_b16 a[54:55], v13 offset:13824
    v_mfma_f32_16x16x32_bf16 v[152:155], a[32:35], a[12:15], v[152:155]
    s_waitcnt lgkmcnt(5)
    v_mfma_f32_16x16x32_bf16 v[148:151], a[36:39], a[8:11], v[148:151]
    ds_read_b64_tr_b16 a[24:25], v13 offset:27648
    ds_read_b64_tr_b16 a[26:27], v13 offset:32256
    v_mfma_f32_16x16x32_bf16 v[156:159], a[36:39], a[12:15], v[156:159]
    s_waitcnt lgkmcnt(6)
    v_mfma_f32_16x16x32_bf16 v[160:163], a[40:43], a[8:11], v[160:163]
    ds_read_b64_tr_b16 a[28:29], v13 offset:9248
    ds_read_b64_tr_b16 a[30:31], v13 offset:13856
    v_mfma_f32_16x16x32_bf16 v[164:167], a[40:43], a[12:15], v[164:167]
    s_waitcnt lgkmcnt(7)
    v_mfma_f32_16x16x32_bf16 v[168:171], a[44:47], a[8:11], v[168:171]
    ds_read_b64_tr_b16 a[32:33], v13 offset:27680
    ds_read_b64_tr_b16 a[34:35], v13 offset:32288
    v_mfma_f32_16x16x32_bf16 v[172:175], a[44:47], a[12:15], v[172:175]
    s_waitcnt lgkmcnt(8)
    v_mfma_f32_16x16x32_bf16 v[176:179], a[48:51], a[8:11], v[176:179]
    ds_read_b64_tr_b16 a[36:37], v13 offset:9280
    ds_read_b64_tr_b16 a[38:39], v13 offset:13888
    v_mfma_f32_16x16x32_bf16 v[180:183], a[48:51], a[12:15], v[180:183]
    s_waitcnt vmcnt(8) lgkmcnt(8)
    v_mfma_f32_16x16x32_bf16 v[16:19], a[52:55], a[16:19], v[16:19]
    ds_read_b64_tr_b16 a[40:41], v13 offset:27712
    ds_read_b64_tr_b16 a[42:43], v13 offset:32320
    v_mfma_f32_16x16x32_bf16 v[24:27], a[52:55], a[20:23], v[24:27]
    s_add_u32 s31, s28, 26624
    buffer_load_dwordx4 a[8:11], v1, s[16:19], s31 offen offset:0 sc1
    buffer_load_dwordx4 a[12:15], v1, s[16:19], s31 offen offset:1024 sc1
    s_waitcnt lgkmcnt(8)
    v_mfma_f32_16x16x32_bf16 v[20:23], a[24:27], a[16:19], v[20:23]
    ds_read_b64_tr_b16 a[44:45], v13 offset:9312
    ds_read_b64_tr_b16 a[46:47], v13 offset:13920
    v_mfma_f32_16x16x32_bf16 v[28:31], a[24:27], a[20:23], v[28:31]
    s_waitcnt lgkmcnt(8)
    v_mfma_f32_16x16x32_bf16 v[32:35], a[28:31], a[16:19], v[32:35]
    ds_read_b64_tr_b16 a[48:49], v13 offset:27744
    ds_read_b64_tr_b16 a[50:51], v13 offset:32352
    v_mfma_f32_16x16x32_bf16 v[40:43], a[28:31], a[20:23], v[40:43]
    s_waitcnt lgkmcnt(8)
    v_mfma_f32_16x16x32_bf16 v[36:39], a[32:35], a[16:19], v[36:39]
    ds_read_b64_tr_b16 a[52:53], v13 offset:9344
    ds_read_b64_tr_b16 a[54:55], v13 offset:13952
    v_mfma_f32_16x16x32_bf16 v[44:47], a[32:35], a[20:23], v[44:47]
    s_waitcnt lgkmcnt(8)
    v_mfma_f32_16x16x32_bf16 v[48:51], a[36:39], a[16:19], v[48:51]
    ds_read_b64_tr_b16 a[24:25], v13 offset:27776
    ds_read_b64_tr_b16 a[26:27], v13 offset:32384
    v_mfma_f32_16x16x32_bf16 v[56:59], a[36:39], a[20:23], v[56:59]
    s_waitcnt lgkmcnt(8)
    v_mfma_f32_16x16x32_bf16 v[52:55], a[40:43], a[16:19], v[52:55]
    ds_read_b64_tr_b16 a[28:29], v13 offset:9376
    ds_read_b64_tr_b16 a[30:31], v13 offset:13984
    v_mfma_f32_16x16x32_bf16 v[60:63], a[40:43], a[20:23], v[60:63]
    s_waitcnt lgkmcnt(8)
    v_mfma_f32_16x16x32_bf16 v[64:67], a[44:47], a[16:19], v[64:67]
    ds_read_b64_tr_b16 a[32:33], v13 offset:27808
    ds_read_b64_tr_b16 a[34:35], v13 offset:32416
    v_mfma_f32_16x16x32_bf16 v[72:75], a[44:47], a[20:23], v[72:75]
    s_waitcnt lgkmcnt(8)
    v_mfma_f32_16x16x32_bf16 v[68:71], a[48:51], a[16:19], v[68:71]
    ds_read_b64_tr_b16 a[36:37], v13 offset:9408
    ds_read_b64_tr_b16 a[38:39], v13 offset:14016
    v_mfma_f32_16x16x32_bf16 v[76:79], a[48:51], a[20:23], v[76:79]
    s_waitcnt lgkmcnt(8)
    v_mfma_f32_16x16x32_bf16 v[80:83], a[52:55], a[16:19], v[80:83]
    ds_read_b64_tr_b16 a[40:41], v13 offset:27840
    ds_read_b64_tr_b16 a[42:43], v13 offset:32448
    v_mfma_f32_16x16x32_bf16 v[88:91], a[52:55], a[20:23], v[88:91]
    s_waitcnt lgkmcnt(8)
    v_mfma_f32_16x16x32_bf16 v[84:87], a[24:27], a[16:19], v[84:87]
    ds_read_b64_tr_b16 a[44:45], v13 offset:9440
    ds_read_b64_tr_b16 a[46:47], v13 offset:14048
    v_mfma_f32_16x16x32_bf16 v[92:95], a[24:27], a[20:23], v[92:95]
    s_waitcnt lgkmcnt(8)
    v_mfma_f32_16x16x32_bf16 v[96:99], a[28:31], a[16:19], v[96:99]
    ds_read_b64_tr_b16 a[48:49], v13 offset:27872
    ds_read_b64_tr_b16 a[50:51], v13 offset:32480
    v_mfma_f32_16x16x32_bf16 v[104:107], a[28:31], a[20:23], v[104:107]
    s_waitcnt lgkmcnt(8)
    v_mfma_f32_16x16x32_bf16 v[100:103], a[32:35], a[16:19], v[100:103]
    ds_read_b64_tr_b16 a[52:53], v13 offset:9472
    ds_read_b64_tr_b16 a[54:55], v13 offset:14080
    v_mfma_f32_16x16x32_bf16 v[108:111], a[32:35], a[20:23], v[108:111]
    s_waitcnt lgkmcnt(8)
    v_mfma_f32_16x16x32_bf16 v[112:115], a[36:39], a[16:19], v[112:115]
    ds_read_b64_tr_b16 a[24:25], v13 offset:27904
    ds_read_b64_tr_b16 a[26:27], v13 offset:32512
    v_mfma_f32_16x16x32_bf16 v[120:123], a[36:39], a[20:23], v[120:123]
    s_waitcnt lgkmcnt(8)
    v_mfma_f32_16x16x32_bf16 v[116:119], a[40:43], a[16:19], v[116:119]
    ds_read_b128 a[28:31], v9 offset:9216
    v_mfma_f32_16x16x32_bf16 v[124:127], a[40:43], a[20:23], v[124:127]
    s_waitcnt lgkmcnt(7)
    v_mfma_f32_16x16x32_bf16 v[128:131], a[44:47], a[16:19], v[128:131]
    ds_read_b128 a[32:35], v9 offset:11264
    v_mfma_f32_16x16x32_bf16 v[136:139], a[44:47], a[20:23], v[136:139]
    s_waitcnt lgkmcnt(6)
    v_mfma_f32_16x16x32_bf16 v[132:135], a[48:51], a[16:19], v[132:135]
    ds_read_b128 a[36:39], v197 offset:9216
    v_mfma_f32_16x16x32_bf16 v[140:143], a[48:51], a[20:23], v[140:143]
    s_waitcnt vmcnt(2)
    s_barrier
    s_waitcnt lgkmcnt(5)
    v_mfma_f32_16x16x32_bf16 v[144:147], a[52:55], a[16:19], v[144:147]
    ds_read_b64_tr_b16 a[40:41], v11 offset:0
    ds_read_b64_tr_b16 a[42:43], v11 offset:4608
    v_mfma_f32_16x16x32_bf16 v[152:155], a[52:55], a[20:23], v[152:155]
    s_waitcnt lgkmcnt(5)
    v_mfma_f32_16x16x32_bf16 v[148:151], a[24:27], a[16:19], v[148:151]
    ds_read_b64_tr_b16 a[44:45], v11 offset:18432
    ds_read_b64_tr_b16 a[46:47], v11 offset:23040
    v_mfma_f32_16x16x32_bf16 v[156:159], a[24:27], a[20:23], v[156:159]
    s_add_u32 m0, s27, 36864
    s_mov_b32 s30, 4128768
    buffer_load_dwordx4 v2, s[12:15], s30 offen lds
    s_waitcnt lgkmcnt(6)
    v_mfma_f32_16x16x32_bf16 v[160:163], a[28:31], a[16:19], v[160:163]
    ds_read_b64_tr_b16 a[48:49], v11 offset:32
    ds_read_b64_tr_b16 a[50:51], v11 offset:4640
    v_mfma_f32_16x16x32_bf16 v[164:167], a[28:31], a[20:23], v[164:167]
    s_waitcnt lgkmcnt(7)
    v_mfma_f32_16x16x32_bf16 v[168:171], a[32:35], a[16:19], v[168:171]
    ds_read_b64_tr_b16 a[52:53], v11 offset:18464
    ds_read_b64_tr_b16 a[54:55], v11 offset:23072
    v_mfma_f32_16x16x32_bf16 v[172:175], a[32:35], a[20:23], v[172:175]
    s_add_u32 m0, s27, 37888
    s_mov_b32 s30, 4128768
    buffer_load_dwordx4 v3, s[12:15], s30 offen lds
    s_waitcnt lgkmcnt(8)
    v_mfma_f32_16x16x32_bf16 v[176:179], a[36:39], a[16:19], v[176:179]
    ds_read_b64_tr_b16 a[24:25], v11 offset:64
    ds_read_b64_tr_b16 a[26:27], v11 offset:4672
    v_mfma_f32_16x16x32_bf16 v[180:183], a[36:39], a[20:23], v[180:183]
    s_waitcnt lgkmcnt(8)
    v_mfma_f32_16x16x32_bf16 v[16:19], a[40:43], a[0:3], v[16:19]
    ds_read_b64_tr_b16 a[28:29], v11 offset:18496
    ds_read_b64_tr_b16 a[30:31], v11 offset:23104
    v_mfma_f32_16x16x32_bf16 v[24:27], a[40:43], a[4:7], v[24:27]
    s_add_u32 s31, s28, 28672
    buffer_load_dwordx4 a[16:19], v1, s[16:19], s31 offen offset:0 sc1
    buffer_load_dwordx4 a[20:23], v1, s[16:19], s31 offen offset:1024 sc1
    s_waitcnt lgkmcnt(8)
    v_mfma_f32_16x16x32_bf16 v[20:23], a[44:47], a[0:3], v[20:23]
    ds_read_b64_tr_b16 a[32:33], v11 offset:96
    ds_read_b64_tr_b16 a[34:35], v11 offset:4704
    v_mfma_f32_16x16x32_bf16 v[28:31], a[44:47], a[4:7], v[28:31]
    s_add_u32 m0, s27, 38912
    s_mov_b32 s30, 4128768
    buffer_load_dwordx4 v4, s[12:15], s30 offen lds
    s_waitcnt lgkmcnt(8)
    v_mfma_f32_16x16x32_bf16 v[32:35], a[48:51], a[0:3], v[32:35]
    ds_read_b64_tr_b16 a[36:37], v11 offset:18528
    ds_read_b64_tr_b16 a[38:39], v11 offset:23136
    v_mfma_f32_16x16x32_bf16 v[40:43], a[48:51], a[4:7], v[40:43]
    s_waitcnt lgkmcnt(8)
    v_mfma_f32_16x16x32_bf16 v[36:39], a[52:55], a[0:3], v[36:39]
    ds_read_b64_tr_b16 a[40:41], v11 offset:128
    ds_read_b64_tr_b16 a[42:43], v11 offset:4736
    v_mfma_f32_16x16x32_bf16 v[44:47], a[52:55], a[4:7], v[44:47]
    s_add_u32 m0, s27, 39936
    s_mov_b32 s30, 4128768
    buffer_load_dwordx4 v5, s[12:15], s30 offen lds
    s_waitcnt lgkmcnt(8)
    v_mfma_f32_16x16x32_bf16 v[48:51], a[24:27], a[0:3], v[48:51]
    ds_read_b64_tr_b16 a[44:45], v11 offset:18560
    ds_read_b64_tr_b16 a[46:47], v11 offset:23168
    v_mfma_f32_16x16x32_bf16 v[56:59], a[24:27], a[4:7], v[56:59]
    s_waitcnt lgkmcnt(8)
    v_mfma_f32_16x16x32_bf16 v[52:55], a[28:31], a[0:3], v[52:55]
    ds_read_b64_tr_b16 a[48:49], v11 offset:160
    ds_read_b64_tr_b16 a[50:51], v11 offset:4768
    v_mfma_f32_16x16x32_bf16 v[60:63], a[28:31], a[4:7], v[60:63]
    s_add_u32 m0, s27, 40960
    s_mov_b32 s30, 4128768
    s_mov_b32 exec_hi, 0
    buffer_load_dwordx4 v6, s[12:15], s30 offen lds
    s_mov_b32 exec_hi, -1
    s_waitcnt lgkmcnt(8)
    v_mfma_f32_16x16x32_bf16 v[64:67], a[32:35], a[0:3], v[64:67]
    ds_read_b64_tr_b16 a[52:53], v11 offset:18592
    ds_read_b64_tr_b16 a[54:55], v11 offset:23200
    v_mfma_f32_16x16x32_bf16 v[72:75], a[32:35], a[4:7], v[72:75]
    s_waitcnt lgkmcnt(8)
    v_mfma_f32_16x16x32_bf16 v[68:71], a[36:39], a[0:3], v[68:71]
    ds_read_b64_tr_b16 a[24:25], v11 offset:192
    ds_read_b64_tr_b16 a[26:27], v11 offset:4800
    v_mfma_f32_16x16x32_bf16 v[76:79], a[36:39], a[4:7], v[76:79]
    s_add_u32 m0, s29, 4608
    s_movk_i32 s30, 896
    s_mov_b32 exec_hi, 0xf
    buffer_load_dwordx4 v7, s[40:43], s30 offen lds
    s_mov_b32 exec_hi, -1
    s_waitcnt lgkmcnt(8)
    v_mfma_f32_16x16x32_bf16 v[80:83], a[40:43], a[0:3], v[80:83]
    ds_read_b64_tr_b16 a[28:29], v11 offset:18624
    ds_read_b64_tr_b16 a[30:31], v11 offset:23232
    v_mfma_f32_16x16x32_bf16 v[88:91], a[40:43], a[4:7], v[88:91]
    s_waitcnt lgkmcnt(8)
    v_mfma_f32_16x16x32_bf16 v[84:87], a[44:47], a[0:3], v[84:87]
    ds_read_b64_tr_b16 a[32:33], v11 offset:224
    ds_read_b64_tr_b16 a[34:35], v11 offset:4832
    v_mfma_f32_16x16x32_bf16 v[92:95], a[44:47], a[4:7], v[92:95]
    s_waitcnt lgkmcnt(8)
    v_mfma_f32_16x16x32_bf16 v[96:99], a[48:51], a[0:3], v[96:99]
    ds_read_b64_tr_b16 a[36:37], v11 offset:18656
    ds_read_b64_tr_b16 a[38:39], v11 offset:23264
    v_mfma_f32_16x16x32_bf16 v[104:107], a[48:51], a[4:7], v[104:107]
    s_waitcnt lgkmcnt(8)
    v_mfma_f32_16x16x32_bf16 v[100:103], a[52:55], a[0:3], v[100:103]
    ds_read_b64_tr_b16 a[40:41], v11 offset:256
    ds_read_b64_tr_b16 a[42:43], v11 offset:4864
    v_mfma_f32_16x16x32_bf16 v[108:111], a[52:55], a[4:7], v[108:111]
    s_waitcnt lgkmcnt(8)
    v_mfma_f32_16x16x32_bf16 v[112:115], a[24:27], a[0:3], v[112:115]
    ds_read_b64_tr_b16 a[44:45], v11 offset:18688
    ds_read_b64_tr_b16 a[46:47], v11 offset:23296
    v_mfma_f32_16x16x32_bf16 v[120:123], a[24:27], a[4:7], v[120:123]
    s_waitcnt lgkmcnt(8)
    v_mfma_f32_16x16x32_bf16 v[116:119], a[28:31], a[0:3], v[116:119]
    ds_read_b128 a[48:51], v8 offset:0
    v_mfma_f32_16x16x32_bf16 v[124:127], a[28:31], a[4:7], v[124:127]
    s_waitcnt lgkmcnt(7)
    v_mfma_f32_16x16x32_bf16 v[128:131], a[32:35], a[0:3], v[128:131]
    ds_read_b128 a[52:55], v8 offset:2048
    v_mfma_f32_16x16x32_bf16 v[136:139], a[32:35], a[4:7], v[136:139]
    s_waitcnt lgkmcnt(6)
    v_mfma_f32_16x16x32_bf16 v[132:135], a[36:39], a[0:3], v[132:135]
    ds_read_b128 a[24:27], v196 offset:0
    v_mfma_f32_16x16x32_bf16 v[140:143], a[36:39], a[4:7], v[140:143]
    s_waitcnt lgkmcnt(5)
    v_mfma_f32_16x16x32_bf16 v[144:147], a[40:43], a[0:3], v[144:147]
    ds_read_b64_tr_b16 a[28:29], v11 offset:9216
    ds_read_b64_tr_b16 a[30:31], v11 offset:13824
    v_mfma_f32_16x16x32_bf16 v[152:155], a[40:43], a[4:7], v[152:155]
    s_waitcnt lgkmcnt(5)
    v_mfma_f32_16x16x32_bf16 v[148:151], a[44:47], a[0:3], v[148:151]
    ds_read_b64_tr_b16 a[32:33], v11 offset:27648
    ds_read_b64_tr_b16 a[34:35], v11 offset:32256
    v_mfma_f32_16x16x32_bf16 v[156:159], a[44:47], a[4:7], v[156:159]
    s_waitcnt lgkmcnt(6)
    v_mfma_f32_16x16x32_bf16 v[160:163], a[48:51], a[0:3], v[160:163]
    ds_read_b64_tr_b16 a[36:37], v11 offset:9248
    ds_read_b64_tr_b16 a[38:39], v11 offset:13856
    v_mfma_f32_16x16x32_bf16 v[164:167], a[48:51], a[4:7], v[164:167]
    s_waitcnt lgkmcnt(7)
    v_mfma_f32_16x16x32_bf16 v[168:171], a[52:55], a[0:3], v[168:171]
    ds_read_b64_tr_b16 a[40:41], v11 offset:27680
    ds_read_b64_tr_b16 a[42:43], v11 offset:32288
    v_mfma_f32_16x16x32_bf16 v[172:175], a[52:55], a[4:7], v[172:175]
    s_waitcnt lgkmcnt(8)
    v_mfma_f32_16x16x32_bf16 v[176:179], a[24:27], a[0:3], v[176:179]
    ds_read_b64_tr_b16 a[44:45], v11 offset:9280
    ds_read_b64_tr_b16 a[46:47], v11 offset:13888
    v_mfma_f32_16x16x32_bf16 v[180:183], a[24:27], a[4:7], v[180:183]
    s_waitcnt vmcnt(8) lgkmcnt(8)
    v_mfma_f32_16x16x32_bf16 v[16:19], a[28:31], a[8:11], v[16:19]
    ds_read_b64_tr_b16 a[48:49], v11 offset:27712
    ds_read_b64_tr_b16 a[50:51], v11 offset:32320
    v_mfma_f32_16x16x32_bf16 v[24:27], a[28:31], a[12:15], v[24:27]
    s_add_u32 s31, s28, 30720
    buffer_load_dwordx4 a[0:3], v1, s[16:19], s31 offen offset:0 sc1
    buffer_load_dwordx4 a[4:7], v1, s[16:19], s31 offen offset:1024 sc1
    s_waitcnt lgkmcnt(8)
    v_mfma_f32_16x16x32_bf16 v[20:23], a[32:35], a[8:11], v[20:23]
    ds_read_b64_tr_b16 a[52:53], v11 offset:9312
    ds_read_b64_tr_b16 a[54:55], v11 offset:13920
    v_mfma_f32_16x16x32_bf16 v[28:31], a[32:35], a[12:15], v[28:31]
    s_waitcnt lgkmcnt(8)
    v_mfma_f32_16x16x32_bf16 v[32:35], a[36:39], a[8:11], v[32:35]
    ds_read_b64_tr_b16 a[24:25], v11 offset:27744
    ds_read_b64_tr_b16 a[26:27], v11 offset:32352
    v_mfma_f32_16x16x32_bf16 v[40:43], a[36:39], a[12:15], v[40:43]
    s_waitcnt lgkmcnt(8)
    v_mfma_f32_16x16x32_bf16 v[36:39], a[40:43], a[8:11], v[36:39]
    ds_read_b64_tr_b16 a[28:29], v11 offset:9344
    ds_read_b64_tr_b16 a[30:31], v11 offset:13952
    v_mfma_f32_16x16x32_bf16 v[44:47], a[40:43], a[12:15], v[44:47]
    s_waitcnt lgkmcnt(8)
    v_mfma_f32_16x16x32_bf16 v[48:51], a[44:47], a[8:11], v[48:51]
    ds_read_b64_tr_b16 a[32:33], v11 offset:27776
    ds_read_b64_tr_b16 a[34:35], v11 offset:32384
    v_mfma_f32_16x16x32_bf16 v[56:59], a[44:47], a[12:15], v[56:59]
    s_waitcnt lgkmcnt(8)
    v_mfma_f32_16x16x32_bf16 v[52:55], a[48:51], a[8:11], v[52:55]
    ds_read_b64_tr_b16 a[36:37], v11 offset:9376
    ds_read_b64_tr_b16 a[38:39], v11 offset:13984
    v_mfma_f32_16x16x32_bf16 v[60:63], a[48:51], a[12:15], v[60:63]
    s_waitcnt lgkmcnt(8)
    v_mfma_f32_16x16x32_bf16 v[64:67], a[52:55], a[8:11], v[64:67]
    ds_read_b64_tr_b16 a[40:41], v11 offset:27808
    ds_read_b64_tr_b16 a[42:43], v11 offset:32416
    v_mfma_f32_16x16x32_bf16 v[72:75], a[52:55], a[12:15], v[72:75]
    s_waitcnt lgkmcnt(8)
    v_mfma_f32_16x16x32_bf16 v[68:71], a[24:27], a[8:11], v[68:71]
    ds_read_b64_tr_b16 a[44:45], v11 offset:9408
    ds_read_b64_tr_b16 a[46:47], v11 offset:14016
    v_mfma_f32_16x16x32_bf16 v[76:79], a[24:27], a[12:15], v[76:79]
    s_waitcnt lgkmcnt(8)
    v_mfma_f32_16x16x32_bf16 v[80:83], a[28:31], a[8:11], v[80:83]
    ds_read_b64_tr_b16 a[48:49], v11 offset:27840
    ds_read_b64_tr_b16 a[50:51], v11 offset:32448
    v_mfma_f32_16x16x32_bf16 v[88:91], a[28:31], a[12:15], v[88:91]
    s_waitcnt lgkmcnt(8)
    v_mfma_f32_16x16x32_bf16 v[84:87], a[32:35], a[8:11], v[84:87]
    ds_read_b64_tr_b16 a[52:53], v11 offset:9440
    ds_read_b64_tr_b16 a[54:55], v11 offset:14048
    v_mfma_f32_16x16x32_bf16 v[92:95], a[32:35], a[12:15], v[92:95]
    s_waitcnt lgkmcnt(8)
    v_mfma_f32_16x16x32_bf16 v[96:99], a[36:39], a[8:11], v[96:99]
    ds_read_b64_tr_b16 a[24:25], v11 offset:27872
    ds_read_b64_tr_b16 a[26:27], v11 offset:32480
    v_mfma_f32_16x16x32_bf16 v[104:107], a[36:39], a[12:15], v[104:107]
    s_waitcnt lgkmcnt(8)
    v_mfma_f32_16x16x32_bf16 v[100:103], a[40:43], a[8:11], v[100:103]
    ds_read_b64_tr_b16 a[28:29], v11 offset:9472
    ds_read_b64_tr_b16 a[30:31], v11 offset:14080
    v_mfma_f32_16x16x32_bf16 v[108:111], a[40:43], a[12:15], v[108:111]
    s_waitcnt lgkmcnt(8)
    v_mfma_f32_16x16x32_bf16 v[112:115], a[44:47], a[8:11], v[112:115]
    ds_read_b64_tr_b16 a[32:33], v11 offset:27904
    ds_read_b64_tr_b16 a[34:35], v11 offset:32512
    v_mfma_f32_16x16x32_bf16 v[120:123], a[44:47], a[12:15], v[120:123]
    s_waitcnt lgkmcnt(8)
    v_mfma_f32_16x16x32_bf16 v[116:119], a[48:51], a[8:11], v[116:119]
    ds_read_b128 a[36:39], v9 offset:0
    v_mfma_f32_16x16x32_bf16 v[124:127], a[48:51], a[12:15], v[124:127]
    s_waitcnt lgkmcnt(7)
    v_mfma_f32_16x16x32_bf16 v[128:131], a[52:55], a[8:11], v[128:131]
    ds_read_b128 a[40:43], v9 offset:2048
    v_mfma_f32_16x16x32_bf16 v[136:139], a[52:55], a[12:15], v[136:139]
    s_waitcnt lgkmcnt(6)
    v_mfma_f32_16x16x32_bf16 v[132:135], a[24:27], a[8:11], v[132:135]
    ds_read_b128 a[44:47], v197 offset:0
    v_mfma_f32_16x16x32_bf16 v[140:143], a[24:27], a[12:15], v[140:143]
    s_waitcnt vmcnt(2)
    s_barrier
    s_waitcnt lgkmcnt(5)
    v_mfma_f32_16x16x32_bf16 v[144:147], a[28:31], a[8:11], v[144:147]
    ds_read_b64_tr_b16 a[48:49], v12 offset:0
    ds_read_b64_tr_b16 a[50:51], v12 offset:4608
    v_mfma_f32_16x16x32_bf16 v[152:155], a[28:31], a[12:15], v[152:155]
    s_waitcnt lgkmcnt(5)
    v_mfma_f32_16x16x32_bf16 v[148:151], a[32:35], a[8:11], v[148:151]
    ds_read_b64_tr_b16 a[52:53], v12 offset:18432
    ds_read_b64_tr_b16 a[54:55], v12 offset:23040
    v_mfma_f32_16x16x32_bf16 v[156:159], a[32:35], a[12:15], v[156:159]
    s_add_u32 m0, s27, 73728
    s_mov_b32 s30, 4718592
    buffer_load_dwordx4 v2, s[12:15], s30 offen lds
    s_waitcnt lgkmcnt(6)
    v_mfma_f32_16x16x32_bf16 v[160:163], a[36:39], a[8:11], v[160:163]
    ds_read_b64_tr_b16 a[24:25], v12 offset:32
    ds_read_b64_tr_b16 a[26:27], v12 offset:4640
    v_mfma_f32_16x16x32_bf16 v[164:167], a[36:39], a[12:15], v[164:167]
    s_waitcnt lgkmcnt(7)
    v_mfma_f32_16x16x32_bf16 v[168:171], a[40:43], a[8:11], v[168:171]
    ds_read_b64_tr_b16 a[28:29], v12 offset:18464
    ds_read_b64_tr_b16 a[30:31], v12 offset:23072
    v_mfma_f32_16x16x32_bf16 v[172:175], a[40:43], a[12:15], v[172:175]
    s_add_u32 m0, s27, 74752
    s_mov_b32 s30, 4718592
    buffer_load_dwordx4 v3, s[12:15], s30 offen lds
    s_waitcnt lgkmcnt(8)
    v_mfma_f32_16x16x32_bf16 v[176:179], a[44:47], a[8:11], v[176:179]
    ds_read_b64_tr_b16 a[32:33], v12 offset:64
    ds_read_b64_tr_b16 a[34:35], v12 offset:4672
    v_mfma_f32_16x16x32_bf16 v[180:183], a[44:47], a[12:15], v[180:183]
    s_waitcnt lgkmcnt(8)
    v_mfma_f32_16x16x32_bf16 v[16:19], a[48:51], a[16:19], v[16:19]
    ds_read_b64_tr_b16 a[36:37], v12 offset:18496
    ds_read_b64_tr_b16 a[38:39], v12 offset:23104
    v_mfma_f32_16x16x32_bf16 v[24:27], a[48:51], a[20:23], v[24:27]
    s_add_u32 s31, s28, 32768
    buffer_load_dwordx4 a[8:11], v1, s[16:19], s31 offen offset:0 sc1
    buffer_load_dwordx4 a[12:15], v1, s[16:19], s31 offen offset:1024 sc1
    s_waitcnt lgkmcnt(8)
    v_mfma_f32_16x16x32_bf16 v[20:23], a[52:55], a[16:19], v[20:23]
    ds_read_b64_tr_b16 a[40:41], v12 offset:96
    ds_read_b64_tr_b16 a[42:43], v12 offset:4704
    v_mfma_f32_16x16x32_bf16 v[28:31], a[52:55], a[20:23], v[28:31]
    s_add_u32 m0, s27, 75776
    s_mov_b32 s30, 4718592
    buffer_load_dwordx4 v4, s[12:15], s30 offen lds
    s_waitcnt lgkmcnt(8)
    v_mfma_f32_16x16x32_bf16 v[32:35], a[24:27], a[16:19], v[32:35]
    ds_read_b64_tr_b16 a[44:45], v12 offset:18528
    ds_read_b64_tr_b16 a[46:47], v12 offset:23136
    v_mfma_f32_16x16x32_bf16 v[40:43], a[24:27], a[20:23], v[40:43]
    s_waitcnt lgkmcnt(8)
    v_mfma_f32_16x16x32_bf16 v[36:39], a[28:31], a[16:19], v[36:39]
    ds_read_b64_tr_b16 a[48:49], v12 offset:128
    ds_read_b64_tr_b16 a[50:51], v12 offset:4736
    v_mfma_f32_16x16x32_bf16 v[44:47], a[28:31], a[20:23], v[44:47]
    s_add_u32 m0, s27, 76800
    s_mov_b32 s30, 4718592
    buffer_load_dwordx4 v5, s[12:15], s30 offen lds
    s_waitcnt lgkmcnt(8)
    v_mfma_f32_16x16x32_bf16 v[48:51], a[32:35], a[16:19], v[48:51]
    ds_read_b64_tr_b16 a[52:53], v12 offset:18560
    ds_read_b64_tr_b16 a[54:55], v12 offset:23168
    v_mfma_f32_16x16x32_bf16 v[56:59], a[32:35], a[20:23], v[56:59]
    s_waitcnt lgkmcnt(8)
    v_mfma_f32_16x16x32_bf16 v[52:55], a[36:39], a[16:19], v[52:55]
    ds_read_b64_tr_b16 a[24:25], v12 offset:160
    ds_read_b64_tr_b16 a[26:27], v12 offset:4768
    v_mfma_f32_16x16x32_bf16 v[60:63], a[36:39], a[20:23], v[60:63]
    s_add_u32 m0, s27, 77824
    s_mov_b32 s30, 4718592
    s_mov_b32 exec_hi, 0
    buffer_load_dwordx4 v6, s[12:15], s30 offen lds
    s_mov_b32 exec_hi, -1
    s_waitcnt lgkmcnt(8)
    v_mfma_f32_16x16x32_bf16 v[64:67], a[40:43], a[16:19], v[64:67]
    ds_read_b64_tr_b16 a[28:29], v12 offset:18592
    ds_read_b64_tr_b16 a[30:31], v12 offset:23200
    v_mfma_f32_16x16x32_bf16 v[72:75], a[40:43], a[20:23], v[72:75]
    s_waitcnt lgkmcnt(8)
    v_mfma_f32_16x16x32_bf16 v[68:71], a[44:47], a[16:19], v[68:71]
    ds_read_b64_tr_b16 a[32:33], v12 offset:192
    ds_read_b64_tr_b16 a[34:35], v12 offset:4800
    v_mfma_f32_16x16x32_bf16 v[76:79], a[44:47], a[20:23], v[76:79]
    s_add_u32 m0, s29, 9216
    s_movk_i32 s30, 1024
    s_mov_b32 exec_hi, 0xf
    buffer_load_dwordx4 v7, s[40:43], s30 offen lds
    s_mov_b32 exec_hi, -1
    s_waitcnt lgkmcnt(8)
    v_mfma_f32_16x16x32_bf16 v[80:83], a[48:51], a[16:19], v[80:83]
    ds_read_b64_tr_b16 a[36:37], v12 offset:18624
    ds_read_b64_tr_b16 a[38:39], v12 offset:23232
    v_mfma_f32_16x16x32_bf16 v[88:91], a[48:51], a[20:23], v[88:91]
    s_waitcnt lgkmcnt(8)
    v_mfma_f32_16x16x32_bf16 v[84:87], a[52:55], a[16:19], v[84:87]
    ds_read_b64_tr_b16 a[40:41], v12 offset:224
    ds_read_b64_tr_b16 a[42:43], v12 offset:4832
    v_mfma_f32_16x16x32_bf16 v[92:95], a[52:55], a[20:23], v[92:95]
    s_waitcnt lgkmcnt(8)
    v_mfma_f32_16x16x32_bf16 v[96:99], a[24:27], a[16:19], v[96:99]
    ds_read_b64_tr_b16 a[44:45], v12 offset:18656
    ds_read_b64_tr_b16 a[46:47], v12 offset:23264
    v_mfma_f32_16x16x32_bf16 v[104:107], a[24:27], a[20:23], v[104:107]
    s_waitcnt lgkmcnt(8)
    v_mfma_f32_16x16x32_bf16 v[100:103], a[28:31], a[16:19], v[100:103]
    ds_read_b64_tr_b16 a[48:49], v12 offset:256
    ds_read_b64_tr_b16 a[50:51], v12 offset:4864
    v_mfma_f32_16x16x32_bf16 v[108:111], a[28:31], a[20:23], v[108:111]
    s_waitcnt lgkmcnt(8)
    v_mfma_f32_16x16x32_bf16 v[112:115], a[32:35], a[16:19], v[112:115]
    ds_read_b64_tr_b16 a[52:53], v12 offset:18688
    ds_read_b64_tr_b16 a[54:55], v12 offset:23296
    v_mfma_f32_16x16x32_bf16 v[120:123], a[32:35], a[20:23], v[120:123]
    s_waitcnt lgkmcnt(8)
    v_mfma_f32_16x16x32_bf16 v[116:119], a[36:39], a[16:19], v[116:119]
    ds_read_b128 a[24:27], v8 offset:4608
    v_mfma_f32_16x16x32_bf16 v[124:127], a[36:39], a[20:23], v[124:127]
    s_waitcnt lgkmcnt(7)
    v_mfma_f32_16x16x32_bf16 v[128:131], a[40:43], a[16:19], v[128:131]
    ds_read_b128 a[28:31], v8 offset:6656
    v_mfma_f32_16x16x32_bf16 v[136:139], a[40:43], a[20:23], v[136:139]
    s_waitcnt lgkmcnt(6)
    v_mfma_f32_16x16x32_bf16 v[132:135], a[44:47], a[16:19], v[132:135]
    ds_read_b128 a[32:35], v196 offset:4608
    v_mfma_f32_16x16x32_bf16 v[140:143], a[44:47], a[20:23], v[140:143]
    s_waitcnt lgkmcnt(5)
    v_mfma_f32_16x16x32_bf16 v[144:147], a[48:51], a[16:19], v[144:147]
    ds_read_b64_tr_b16 a[36:37], v12 offset:9216
    ds_read_b64_tr_b16 a[38:39], v12 offset:13824
    v_mfma_f32_16x16x32_bf16 v[152:155], a[48:51], a[20:23], v[152:155]
    s_waitcnt lgkmcnt(5)
    v_mfma_f32_16x16x32_bf16 v[148:151], a[52:55], a[16:19], v[148:151]
    ds_read_b64_tr_b16 a[40:41], v12 offset:27648
    ds_read_b64_tr_b16 a[42:43], v12 offset:32256
    v_mfma_f32_16x16x32_bf16 v[156:159], a[52:55], a[20:23], v[156:159]
    s_waitcnt lgkmcnt(6)
    v_mfma_f32_16x16x32_bf16 v[160:163], a[24:27], a[16:19], v[160:163]
    ds_read_b64_tr_b16 a[44:45], v12 offset:9248
    ds_read_b64_tr_b16 a[46:47], v12 offset:13856
    v_mfma_f32_16x16x32_bf16 v[164:167], a[24:27], a[20:23], v[164:167]
    s_waitcnt lgkmcnt(7)
    v_mfma_f32_16x16x32_bf16 v[168:171], a[28:31], a[16:19], v[168:171]
    ds_read_b64_tr_b16 a[48:49], v12 offset:27680
    ds_read_b64_tr_b16 a[50:51], v12 offset:32288
    v_mfma_f32_16x16x32_bf16 v[172:175], a[28:31], a[20:23], v[172:175]
    s_waitcnt lgkmcnt(8)
    v_mfma_f32_16x16x32_bf16 v[176:179], a[32:35], a[16:19], v[176:179]
    ds_read_b64_tr_b16 a[52:53], v12 offset:9280
    ds_read_b64_tr_b16 a[54:55], v12 offset:13888
    v_mfma_f32_16x16x32_bf16 v[180:183], a[32:35], a[20:23], v[180:183]
    s_waitcnt vmcnt(8) lgkmcnt(8)
    v_mfma_f32_16x16x32_bf16 v[16:19], a[36:39], a[0:3], v[16:19]
    ds_read_b64_tr_b16 a[24:25], v12 offset:27712
    ds_read_b64_tr_b16 a[26:27], v12 offset:32320
    v_mfma_f32_16x16x32_bf16 v[24:27], a[36:39], a[4:7], v[24:27]
    s_add_u32 s31, s28, 34816
    buffer_load_dwordx4 a[16:19], v1, s[16:19], s31 offen offset:0 sc1
    buffer_load_dwordx4 a[20:23], v1, s[16:19], s31 offen offset:1024 sc1
    s_waitcnt lgkmcnt(8)
    v_mfma_f32_16x16x32_bf16 v[20:23], a[40:43], a[0:3], v[20:23]
    ds_read_b64_tr_b16 a[28:29], v12 offset:9312
    ds_read_b64_tr_b16 a[30:31], v12 offset:13920
    v_mfma_f32_16x16x32_bf16 v[28:31], a[40:43], a[4:7], v[28:31]
    s_waitcnt lgkmcnt(8)
    v_mfma_f32_16x16x32_bf16 v[32:35], a[44:47], a[0:3], v[32:35]
    ds_read_b64_tr_b16 a[32:33], v12 offset:27744
    ds_read_b64_tr_b16 a[34:35], v12 offset:32352
    v_mfma_f32_16x16x32_bf16 v[40:43], a[44:47], a[4:7], v[40:43]
    s_waitcnt lgkmcnt(8)
    v_mfma_f32_16x16x32_bf16 v[36:39], a[48:51], a[0:3], v[36:39]
    ds_read_b64_tr_b16 a[36:37], v12 offset:9344
    ds_read_b64_tr_b16 a[38:39], v12 offset:13952
    v_mfma_f32_16x16x32_bf16 v[44:47], a[48:51], a[4:7], v[44:47]
    s_waitcnt lgkmcnt(8)
    v_mfma_f32_16x16x32_bf16 v[48:51], a[52:55], a[0:3], v[48:51]
    ds_read_b64_tr_b16 a[40:41], v12 offset:27776
    ds_read_b64_tr_b16 a[42:43], v12 offset:32384
    v_mfma_f32_16x16x32_bf16 v[56:59], a[52:55], a[4:7], v[56:59]
    s_waitcnt lgkmcnt(8)
    v_mfma_f32_16x16x32_bf16 v[52:55], a[24:27], a[0:3], v[52:55]
    ds_read_b64_tr_b16 a[44:45], v12 offset:9376
    ds_read_b64_tr_b16 a[46:47], v12 offset:13984
    v_mfma_f32_16x16x32_bf16 v[60:63], a[24:27], a[4:7], v[60:63]
    s_waitcnt lgkmcnt(8)
    v_mfma_f32_16x16x32_bf16 v[64:67], a[28:31], a[0:3], v[64:67]
    ds_read_b64_tr_b16 a[48:49], v12 offset:27808
    ds_read_b64_tr_b16 a[50:51], v12 offset:32416
    v_mfma_f32_16x16x32_bf16 v[72:75], a[28:31], a[4:7], v[72:75]
    s_waitcnt lgkmcnt(8)
    v_mfma_f32_16x16x32_bf16 v[68:71], a[32:35], a[0:3], v[68:71]
    ds_read_b64_tr_b16 a[52:53], v12 offset:9408
    ds_read_b64_tr_b16 a[54:55], v12 offset:14016
    v_mfma_f32_16x16x32_bf16 v[76:79], a[32:35], a[4:7], v[76:79]
    s_waitcnt lgkmcnt(8)
    v_mfma_f32_16x16x32_bf16 v[80:83], a[36:39], a[0:3], v[80:83]
    ds_read_b64_tr_b16 a[24:25], v12 offset:27840
    ds_read_b64_tr_b16 a[26:27], v12 offset:32448
    v_mfma_f32_16x16x32_bf16 v[88:91], a[36:39], a[4:7], v[88:91]
    s_waitcnt lgkmcnt(8)
    v_mfma_f32_16x16x32_bf16 v[84:87], a[40:43], a[0:3], v[84:87]
    ds_read_b64_tr_b16 a[28:29], v12 offset:9440
    ds_read_b64_tr_b16 a[30:31], v12 offset:14048
    v_mfma_f32_16x16x32_bf16 v[92:95], a[40:43], a[4:7], v[92:95]
    s_waitcnt lgkmcnt(8)
    v_mfma_f32_16x16x32_bf16 v[96:99], a[44:47], a[0:3], v[96:99]
    ds_read_b64_tr_b16 a[32:33], v12 offset:27872
    ds_read_b64_tr_b16 a[34:35], v12 offset:32480
    v_mfma_f32_16x16x32_bf16 v[104:107], a[44:47], a[4:7], v[104:107]
    s_waitcnt lgkmcnt(8)
    v_mfma_f32_16x16x32_bf16 v[100:103], a[48:51], a[0:3], v[100:103]
    ds_read_b64_tr_b16 a[36:37], v12 offset:9472
    ds_read_b64_tr_b16 a[38:39], v12 offset:14080
    v_mfma_f32_16x16x32_bf16 v[108:111], a[48:51], a[4:7], v[108:111]
    s_waitcnt lgkmcnt(8)
    v_mfma_f32_16x16x32_bf16 v[112:115], a[52:55], a[0:3], v[112:115]
    ds_read_b64_tr_b16 a[40:41], v12 offset:27904
    ds_read_b64_tr_b16 a[42:43], v12 offset:32512
    v_mfma_f32_16x16x32_bf16 v[120:123], a[52:55], a[4:7], v[120:123]
    s_waitcnt lgkmcnt(8)
    v_mfma_f32_16x16x32_bf16 v[116:119], a[24:27], a[0:3], v[116:119]
    ds_read_b128 a[44:47], v9 offset:4608
    v_mfma_f32_16x16x32_bf16 v[124:127], a[24:27], a[4:7], v[124:127]
    s_waitcnt lgkmcnt(7)
    v_mfma_f32_16x16x32_bf16 v[128:131], a[28:31], a[0:3], v[128:131]
    ds_read_b128 a[48:51], v9 offset:6656
    v_mfma_f32_16x16x32_bf16 v[136:139], a[28:31], a[4:7], v[136:139]
    s_waitcnt lgkmcnt(6)
    v_mfma_f32_16x16x32_bf16 v[132:135], a[32:35], a[0:3], v[132:135]
    ds_read_b128 a[52:55], v197 offset:4608
    v_mfma_f32_16x16x32_bf16 v[140:143], a[32:35], a[4:7], v[140:143]
    s_waitcnt vmcnt(2)
    s_barrier
    s_waitcnt lgkmcnt(5)
    v_mfma_f32_16x16x32_bf16 v[144:147], a[36:39], a[0:3], v[144:147]
    ds_read_b64_tr_b16 a[24:25], v13 offset:0
    ds_read_b64_tr_b16 a[26:27], v13 offset:4608
    v_mfma_f32_16x16x32_bf16 v[152:155], a[36:39], a[4:7], v[152:155]
    s_waitcnt lgkmcnt(5)
    v_mfma_f32_16x16x32_bf16 v[148:151], a[40:43], a[0:3], v[148:151]
    ds_read_b64_tr_b16 a[28:29], v13 offset:18432
    ds_read_b64_tr_b16 a[30:31], v13 offset:23040
    v_mfma_f32_16x16x32_bf16 v[156:159], a[40:43], a[4:7], v[156:159]
    s_waitcnt lgkmcnt(6)
    v_mfma_f32_16x16x32_bf16 v[160:163], a[44:47], a[0:3], v[160:163]
    ds_read_b64_tr_b16 a[32:33], v13 offset:32
    ds_read_b64_tr_b16 a[34:35], v13 offset:4640
    v_mfma_f32_16x16x32_bf16 v[164:167], a[44:47], a[4:7], v[164:167]
    s_waitcnt lgkmcnt(7)
    v_mfma_f32_16x16x32_bf16 v[168:171], a[48:51], a[0:3], v[168:171]
    ds_read_b64_tr_b16 a[36:37], v13 offset:18464
    ds_read_b64_tr_b16 a[38:39], v13 offset:23072
    v_mfma_f32_16x16x32_bf16 v[172:175], a[48:51], a[4:7], v[172:175]
    s_waitcnt lgkmcnt(8)
    v_mfma_f32_16x16x32_bf16 v[176:179], a[52:55], a[0:3], v[176:179]
    ds_read_b64_tr_b16 a[40:41], v13 offset:64
    ds_read_b64_tr_b16 a[42:43], v13 offset:4672
    v_mfma_f32_16x16x32_bf16 v[180:183], a[52:55], a[4:7], v[180:183]
    s_waitcnt lgkmcnt(8)
    v_mfma_f32_16x16x32_bf16 v[16:19], a[24:27], a[8:11], v[16:19]
    ds_read_b64_tr_b16 a[44:45], v13 offset:18496
    ds_read_b64_tr_b16 a[46:47], v13 offset:23104
    v_mfma_f32_16x16x32_bf16 v[24:27], a[24:27], a[12:15], v[24:27]
    s_waitcnt lgkmcnt(8)
    v_mfma_f32_16x16x32_bf16 v[20:23], a[28:31], a[8:11], v[20:23]
    ds_read_b64_tr_b16 a[48:49], v13 offset:96
    ds_read_b64_tr_b16 a[50:51], v13 offset:4704
    v_mfma_f32_16x16x32_bf16 v[28:31], a[28:31], a[12:15], v[28:31]
    s_waitcnt lgkmcnt(8)
    v_mfma_f32_16x16x32_bf16 v[32:35], a[32:35], a[8:11], v[32:35]
    ds_read_b64_tr_b16 a[52:53], v13 offset:18528
    ds_read_b64_tr_b16 a[54:55], v13 offset:23136
    v_mfma_f32_16x16x32_bf16 v[40:43], a[32:35], a[12:15], v[40:43]
    s_waitcnt lgkmcnt(8)
    v_mfma_f32_16x16x32_bf16 v[36:39], a[36:39], a[8:11], v[36:39]
    ds_read_b64_tr_b16 a[24:25], v13 offset:128
    ds_read_b64_tr_b16 a[26:27], v13 offset:4736
    v_mfma_f32_16x16x32_bf16 v[44:47], a[36:39], a[12:15], v[44:47]
    s_waitcnt lgkmcnt(8)
    v_mfma_f32_16x16x32_bf16 v[48:51], a[40:43], a[8:11], v[48:51]
    ds_read_b64_tr_b16 a[28:29], v13 offset:18560
    ds_read_b64_tr_b16 a[30:31], v13 offset:23168
    v_mfma_f32_16x16x32_bf16 v[56:59], a[40:43], a[12:15], v[56:59]
    s_waitcnt lgkmcnt(8)
    v_mfma_f32_16x16x32_bf16 v[52:55], a[44:47], a[8:11], v[52:55]
    ds_read_b64_tr_b16 a[32:33], v13 offset:160
    ds_read_b64_tr_b16 a[34:35], v13 offset:4768
    v_mfma_f32_16x16x32_bf16 v[60:63], a[44:47], a[12:15], v[60:63]
    s_waitcnt lgkmcnt(8)
    v_mfma_f32_16x16x32_bf16 v[64:67], a[48:51], a[8:11], v[64:67]
    ds_read_b64_tr_b16 a[36:37], v13 offset:18592
    ds_read_b64_tr_b16 a[38:39], v13 offset:23200
    v_mfma_f32_16x16x32_bf16 v[72:75], a[48:51], a[12:15], v[72:75]
    s_waitcnt lgkmcnt(8)
    v_mfma_f32_16x16x32_bf16 v[68:71], a[52:55], a[8:11], v[68:71]
    ds_read_b64_tr_b16 a[40:41], v13 offset:192
    ds_read_b64_tr_b16 a[42:43], v13 offset:4800
    v_mfma_f32_16x16x32_bf16 v[76:79], a[52:55], a[12:15], v[76:79]
    s_waitcnt lgkmcnt(8)
    v_mfma_f32_16x16x32_bf16 v[80:83], a[24:27], a[8:11], v[80:83]
    ds_read_b64_tr_b16 a[44:45], v13 offset:18624
    ds_read_b64_tr_b16 a[46:47], v13 offset:23232
    v_mfma_f32_16x16x32_bf16 v[88:91], a[24:27], a[12:15], v[88:91]
    s_waitcnt lgkmcnt(8)
    v_mfma_f32_16x16x32_bf16 v[84:87], a[28:31], a[8:11], v[84:87]
    ds_read_b64_tr_b16 a[48:49], v13 offset:224
    ds_read_b64_tr_b16 a[50:51], v13 offset:4832
    v_mfma_f32_16x16x32_bf16 v[92:95], a[28:31], a[12:15], v[92:95]
    s_waitcnt lgkmcnt(8)
    v_mfma_f32_16x16x32_bf16 v[96:99], a[32:35], a[8:11], v[96:99]
    ds_read_b64_tr_b16 a[52:53], v13 offset:18656
    ds_read_b64_tr_b16 a[54:55], v13 offset:23264
    v_mfma_f32_16x16x32_bf16 v[104:107], a[32:35], a[12:15], v[104:107]
    s_waitcnt lgkmcnt(8)
    v_mfma_f32_16x16x32_bf16 v[100:103], a[36:39], a[8:11], v[100:103]
    ds_read_b64_tr_b16 a[24:25], v13 offset:256
    ds_read_b64_tr_b16 a[26:27], v13 offset:4864
    v_mfma_f32_16x16x32_bf16 v[108:111], a[36:39], a[12:15], v[108:111]
    s_waitcnt lgkmcnt(8)
    v_mfma_f32_16x16x32_bf16 v[112:115], a[40:43], a[8:11], v[112:115]
    ds_read_b64_tr_b16 a[28:29], v13 offset:18688
    ds_read_b64_tr_b16 a[30:31], v13 offset:23296
    v_mfma_f32_16x16x32_bf16 v[120:123], a[40:43], a[12:15], v[120:123]
    s_waitcnt lgkmcnt(8)
    v_mfma_f32_16x16x32_bf16 v[116:119], a[44:47], a[8:11], v[116:119]
    ds_read_b128 a[32:35], v8 offset:9216
    v_mfma_f32_16x16x32_bf16 v[124:127], a[44:47], a[12:15], v[124:127]
    s_waitcnt lgkmcnt(7)
    v_mfma_f32_16x16x32_bf16 v[128:131], a[48:51], a[8:11], v[128:131]
    ds_read_b128 a[36:39], v8 offset:11264
    v_mfma_f32_16x16x32_bf16 v[136:139], a[48:51], a[12:15], v[136:139]
    s_waitcnt lgkmcnt(6)
    v_mfma_f32_16x16x32_bf16 v[132:135], a[52:55], a[8:11], v[132:135]
    ds_read_b128 a[40:43], v196 offset:9216
    v_mfma_f32_16x16x32_bf16 v[140:143], a[52:55], a[12:15], v[140:143]
    s_waitcnt lgkmcnt(5)
    v_mfma_f32_16x16x32_bf16 v[144:147], a[24:27], a[8:11], v[144:147]
    ds_read_b64_tr_b16 a[44:45], v13 offset:9216
    ds_read_b64_tr_b16 a[46:47], v13 offset:13824
    v_mfma_f32_16x16x32_bf16 v[152:155], a[24:27], a[12:15], v[152:155]
    s_waitcnt lgkmcnt(5)
    v_mfma_f32_16x16x32_bf16 v[148:151], a[28:31], a[8:11], v[148:151]
    ds_read_b64_tr_b16 a[48:49], v13 offset:27648
    ds_read_b64_tr_b16 a[50:51], v13 offset:32256
    v_mfma_f32_16x16x32_bf16 v[156:159], a[28:31], a[12:15], v[156:159]
    s_waitcnt lgkmcnt(6)
    v_mfma_f32_16x16x32_bf16 v[160:163], a[32:35], a[8:11], v[160:163]
    ds_read_b64_tr_b16 a[52:53], v13 offset:9248
    ds_read_b64_tr_b16 a[54:55], v13 offset:13856
    v_mfma_f32_16x16x32_bf16 v[164:167], a[32:35], a[12:15], v[164:167]
    s_waitcnt lgkmcnt(7)
    v_mfma_f32_16x16x32_bf16 v[168:171], a[36:39], a[8:11], v[168:171]
    ds_read_b64_tr_b16 a[24:25], v13 offset:27680
    ds_read_b64_tr_b16 a[26:27], v13 offset:32288
    v_mfma_f32_16x16x32_bf16 v[172:175], a[36:39], a[12:15], v[172:175]
    s_waitcnt lgkmcnt(8)
    v_mfma_f32_16x16x32_bf16 v[176:179], a[40:43], a[8:11], v[176:179]
    ds_read_b64_tr_b16 a[28:29], v13 offset:9280
    ds_read_b64_tr_b16 a[30:31], v13 offset:13888
    v_mfma_f32_16x16x32_bf16 v[180:183], a[40:43], a[12:15], v[180:183]
    s_waitcnt vmcnt(0) lgkmcnt(8)
    v_mfma_f32_16x16x32_bf16 v[16:19], a[44:47], a[16:19], v[16:19]
    ds_read_b64_tr_b16 a[32:33], v13 offset:27712
    ds_read_b64_tr_b16 a[34:35], v13 offset:32320
    v_mfma_f32_16x16x32_bf16 v[24:27], a[44:47], a[20:23], v[24:27]
    s_waitcnt lgkmcnt(8)
    v_mfma_f32_16x16x32_bf16 v[20:23], a[48:51], a[16:19], v[20:23]
    ds_read_b64_tr_b16 a[36:37], v13 offset:9312
    ds_read_b64_tr_b16 a[38:39], v13 offset:13920
    v_mfma_f32_16x16x32_bf16 v[28:31], a[48:51], a[20:23], v[28:31]
    s_waitcnt lgkmcnt(8)
    v_mfma_f32_16x16x32_bf16 v[32:35], a[52:55], a[16:19], v[32:35]
    ds_read_b64_tr_b16 a[40:41], v13 offset:27744
    ds_read_b64_tr_b16 a[42:43], v13 offset:32352
    v_mfma_f32_16x16x32_bf16 v[40:43], a[52:55], a[20:23], v[40:43]
    s_waitcnt lgkmcnt(8)
    v_mfma_f32_16x16x32_bf16 v[36:39], a[24:27], a[16:19], v[36:39]
    ds_read_b64_tr_b16 a[44:45], v13 offset:9344
    ds_read_b64_tr_b16 a[46:47], v13 offset:13952
    v_mfma_f32_16x16x32_bf16 v[44:47], a[24:27], a[20:23], v[44:47]
    s_waitcnt lgkmcnt(8)
    v_mfma_f32_16x16x32_bf16 v[48:51], a[28:31], a[16:19], v[48:51]
    ds_read_b64_tr_b16 a[48:49], v13 offset:27776
    ds_read_b64_tr_b16 a[50:51], v13 offset:32384
    v_mfma_f32_16x16x32_bf16 v[56:59], a[28:31], a[20:23], v[56:59]
    s_waitcnt lgkmcnt(8)
    v_mfma_f32_16x16x32_bf16 v[52:55], a[32:35], a[16:19], v[52:55]
    ds_read_b64_tr_b16 a[52:53], v13 offset:9376
    ds_read_b64_tr_b16 a[54:55], v13 offset:13984
    v_mfma_f32_16x16x32_bf16 v[60:63], a[32:35], a[20:23], v[60:63]
    s_waitcnt lgkmcnt(8)
    v_mfma_f32_16x16x32_bf16 v[64:67], a[36:39], a[16:19], v[64:67]
    ds_read_b64_tr_b16 a[24:25], v13 offset:27808
    ds_read_b64_tr_b16 a[26:27], v13 offset:32416
    v_mfma_f32_16x16x32_bf16 v[72:75], a[36:39], a[20:23], v[72:75]
    s_waitcnt lgkmcnt(8)
    v_mfma_f32_16x16x32_bf16 v[68:71], a[40:43], a[16:19], v[68:71]
    ds_read_b64_tr_b16 a[28:29], v13 offset:9408
    ds_read_b64_tr_b16 a[30:31], v13 offset:14016
    v_mfma_f32_16x16x32_bf16 v[76:79], a[40:43], a[20:23], v[76:79]
    s_waitcnt lgkmcnt(8)
    v_mfma_f32_16x16x32_bf16 v[80:83], a[44:47], a[16:19], v[80:83]
    ds_read_b64_tr_b16 a[32:33], v13 offset:27840
    ds_read_b64_tr_b16 a[34:35], v13 offset:32448
    v_mfma_f32_16x16x32_bf16 v[88:91], a[44:47], a[20:23], v[88:91]
    s_waitcnt lgkmcnt(8)
    v_mfma_f32_16x16x32_bf16 v[84:87], a[48:51], a[16:19], v[84:87]
    ds_read_b64_tr_b16 a[36:37], v13 offset:9440
    ds_read_b64_tr_b16 a[38:39], v13 offset:14048
    v_mfma_f32_16x16x32_bf16 v[92:95], a[48:51], a[20:23], v[92:95]
    s_waitcnt lgkmcnt(8)
    v_mfma_f32_16x16x32_bf16 v[96:99], a[52:55], a[16:19], v[96:99]
    ds_read_b64_tr_b16 a[40:41], v13 offset:27872
    ds_read_b64_tr_b16 a[42:43], v13 offset:32480
    v_mfma_f32_16x16x32_bf16 v[104:107], a[52:55], a[20:23], v[104:107]
    s_waitcnt lgkmcnt(8)
    v_mfma_f32_16x16x32_bf16 v[100:103], a[24:27], a[16:19], v[100:103]
    ds_read_b64_tr_b16 a[44:45], v13 offset:9472
    ds_read_b64_tr_b16 a[46:47], v13 offset:14080
    v_mfma_f32_16x16x32_bf16 v[108:111], a[24:27], a[20:23], v[108:111]
    s_waitcnt lgkmcnt(8)
    v_mfma_f32_16x16x32_bf16 v[112:115], a[28:31], a[16:19], v[112:115]
    ds_read_b64_tr_b16 a[48:49], v13 offset:27904
    ds_read_b64_tr_b16 a[50:51], v13 offset:32512
    v_mfma_f32_16x16x32_bf16 v[120:123], a[28:31], a[20:23], v[120:123]
    s_waitcnt lgkmcnt(8)
    v_mfma_f32_16x16x32_bf16 v[116:119], a[32:35], a[16:19], v[116:119]
    ds_read_b128 a[52:55], v9 offset:9216
    v_mfma_f32_16x16x32_bf16 v[124:127], a[32:35], a[20:23], v[124:127]
    s_waitcnt lgkmcnt(7)
    v_mfma_f32_16x16x32_bf16 v[128:131], a[36:39], a[16:19], v[128:131]
    ds_read_b128 a[24:27], v9 offset:11264
    v_mfma_f32_16x16x32_bf16 v[136:139], a[36:39], a[20:23], v[136:139]
    s_waitcnt lgkmcnt(6)
    v_mfma_f32_16x16x32_bf16 v[132:135], a[40:43], a[16:19], v[132:135]
    ds_read_b128 a[28:31], v197 offset:9216
    v_mfma_f32_16x16x32_bf16 v[140:143], a[40:43], a[20:23], v[140:143]
    s_waitcnt lgkmcnt(5)
    v_mfma_f32_16x16x32_bf16 v[144:147], a[44:47], a[16:19], v[144:147]
    v_mfma_f32_16x16x32_bf16 v[152:155], a[44:47], a[20:23], v[152:155]
    s_waitcnt lgkmcnt(3)
    v_mfma_f32_16x16x32_bf16 v[148:151], a[48:51], a[16:19], v[148:151]
    v_mfma_f32_16x16x32_bf16 v[156:159], a[48:51], a[20:23], v[156:159]
    s_waitcnt lgkmcnt(2)
    v_mfma_f32_16x16x32_bf16 v[160:163], a[52:55], a[16:19], v[160:163]
    v_mfma_f32_16x16x32_bf16 v[164:167], a[52:55], a[20:23], v[164:167]
    s_waitcnt lgkmcnt(1)
    v_mfma_f32_16x16x32_bf16 v[168:171], a[24:27], a[16:19], v[168:171]
    v_mfma_f32_16x16x32_bf16 v[172:175], a[24:27], a[20:23], v[172:175]
    s_waitcnt lgkmcnt(0)
    v_mfma_f32_16x16x32_bf16 v[176:179], a[28:31], a[16:19], v[176:179]
    v_mfma_f32_16x16x32_bf16 v[180:183], a[28:31], a[20:23], v[180:183]
    s_barrier
    v_and_b32 v185, 15, v0
    v_lshrrev_b32 v186, 4, v0
    v_mul_u32_u24 v185, 208, v185
    v_lshl_add_u32 v185, v186, 4, v185
    s_mul_i32 s49, s20, 6656
    s_add_u32 s49, s49, 16384
    v_add_u32 v185, s49, v185
    ds_write_b128 v185, v[160:163] offset:0
    ds_write_b128 v185, v[168:171] offset:64
    ds_write_b128 v185, v[176:179] offset:128
    ds_write_b128 v185, v[164:167] offset:3328
    ds_write_b128 v185, v[172:175] offset:3392
    ds_write_b128 v185, v[180:183] offset:3456
    s_waitcnt lgkmcnt(0)
    s_barrier
    s_lshl_b32 s32, s22, 3
    s_add_u32 s32, s32, s20
    s_mul_i32 s32, s32, 180
    s_mul_i32 s33, s21, 9
    s_lshr_b32 s33, s33, 1
    s_add_u32 s32, s32, s33
    s_lshl_b32 s32, s32, 11
    s_add_u32 s32, s32, 4194304
    s_mov_b32 s60, 0xbfb8aa3b
    s_mov_b32 s61, 0xbfb8aa3b
    s_mov_b32 s62, 1.0
    s_mov_b32 s63, 1.0
    s_and_b32 s33, s21, 1
    s_cmp_gt_u32 s20, 4
    s_cbranch_scc1 K1_noscan
    v_lshl_add_u32 v184, s20, 6, v0
    v_cmp_gt_u32 vcc, 288, v184
    s_and_saveexec_b64 s[50:51], vcc
    v_mul_u32_u24 v185, 3641, v184
    v_lshrrev_b32 v185, 16, v185
    v_mul_u32_u24 v186, 18, v185
    v_sub_u32 v186, v184, v186
    v_mul_u32_u24 v187, 160, v186
    v_add_u32 v187, 124416, v187
    ds_read_b64 v[188:189], v187
    v_mul_u32_u24 v190, 3328, v185
    v_lshl_add_u32 v190, v186, 2, v190
    v_add_u32 v190, 16384, v190
    v_mov_b32 v176, 0
    v_mov_b32 v177, 0
    ds_read_b32 v160, v190 offset:0
    ds_read_b32 v161, v190 offset:72
    ds_read_b32 v162, v190 offset:208
    ds_read_b32 v163, v190 offset:280
    ds_read_b32 v164, v190 offset:416
    ds_read_b32 v165, v190 offset:488
    ds_read_b32 v166, v190 offset:624
    ds_read_b32 v167, v190 offset:696
    ds_read_b32 v168, v190 offset:832
    ds_read_b32 v169, v190 offset:904
    ds_read_b32 v170, v190 offset:1040
    ds_read_b32 v171, v190 offset:1112
    ds_read_b32 v172, v190 offset:1248
    s_waitcnt lgkmcnt(8)
    ds_read_b32 v173, v190 offset:1320
    ds_read_b32 v174, v190 offset:1456
    ds_read_b32 v175, v190 offset:1528
    s_waitcnt lgkmcnt(0)
    v_fma_f32 v162, -v189, v161, v162
    v_fmac_f32 v163, v189, v160
    v_fmac_f32 v162, v188, v160
    v_fmac_f32 v163, v188, v161
    v_fma_f32 v164, -v189, v163, v164
    v_fmac_f32 v165, v189, v162
    v_fmac_f32 v164, v188, v162
    v_fmac_f32 v165, v188, v163
    v_fma_f32 v166, -v189, v165, v166
    v_fmac_f32 v167, v189, v164
    v_fmac_f32 v166, v188, v164
    v_fmac_f32 v167, v188, v165
    v_fma_f32 v168, -v189, v167, v168
    v_fmac_f32 v169, v189, v166
    v_fmac_f32 v168, v188, v166
    v_fmac_f32 v169, v188, v167
    v_fma_f32 v170, -v189, v169, v170
    v_fmac_f32 v171, v189, v168
    v_fmac_f32 v170, v188, v168
    v_fmac_f32 v171, v188, v169
    v_fma_f32 v172, -v189, v171, v172
    v_fmac_f32 v173, v189, v170
    v_fmac_f32 v172, v188, v170
    v_fmac_f32 v173, v188, v171
    v_fma_f32 v174, -v189, v173, v174
    v_fmac_f32 v175, v189, v172
    v_fmac_f32 v174, v188, v172
    v_fmac_f32 v175, v188, v173
    ds_write_b32 v190, v162 offset:208
    ds_write_b32 v190, v163 offset:280
    ds_write_b32 v190, v164 offset:416
    ds_write_b32 v190, v165 offset:488
    ds_write_b32 v190, v166 offset:624
    ds_write_b32 v190, v167 offset:696
    ds_write_b32 v190, v168 offset:832
    ds_write_b32 v190, v169 offset:904
    ds_write_b32 v190, v170 offset:1040
    ds_write_b32 v190, v171 offset:1112
    ds_write_b32 v190, v172 offset:1248
    ds_write_b32 v190, v173 offset:1320
    ds_write_b32 v190, v174 offset:1456
    ds_write_b32 v190, v175 offset:1528
    v_mov_b32 v176, v174
    v_mov_b32 v177, v175
    s_waitcnt lgkmcnt(0)
    ds_read_b32 v160, v190 offset:1664
    ds_read_b32 v161, v190 offset:1736
    ds_read_b32 v162, v190 offset:1872
    ds_read_b32 v163, v190 offset:1944
    ds_read_b32 v164, v190 offset:2080
    ds_read_b32 v165, v190 offset:2152
    ds_read_b32 v166, v190 offset:2288
    ds_read_b32 v167, v190 offset:2360
    ds_read_b32 v168, v190 offset:2496
    ds_read_b32 v169, v190 offset:2568
    ds_read_b32 v170, v190 offset:2704
    ds_read_b32 v171, v190 offset:2776
    ds_read_b32 v172, v190 offset:2912
    s_waitcnt lgkmcnt(8)
    ds_read_b32 v173, v190 offset:2984
    ds_read_b32 v174, v190 offset:3120
    ds_read_b32 v175, v190 offset:3192
    s_waitcnt lgkmcnt(0)
    v_fma_f32 v160, -v189, v177, v160
    v_fmac_f32 v161, v189, v176
    v_fmac_f32 v160, v188, v176
    v_fmac_f32 v161, v188, v177
    v_fma_f32 v162, -v189, v161, v162
    v_fmac_f32 v163, v189, v160
    v_fmac_f32 v162, v188, v160
    v_fmac_f32 v163, v188, v161
    v_fma_f32 v164, -v189, v163, v164
    v_fmac_f32 v165, v189, v162
    v_fmac_f32 v164, v188, v162
    v_fmac_f32 v165, v188, v163
    v_fma_f32 v166, -v189, v165, v166
    v_fmac_f32 v167, v189, v164
    v_fmac_f32 v166, v188, v164
    v_fmac_f32 v167, v188, v165
    v_fma_f32 v168, -v189, v167, v168
    v_fmac_f32 v169, v189, v166
    v_fmac_f32 v168, v188, v166
    v_fmac_f32 v169, v188, v167
    v_fma_f32 v170, -v189, v169, v170
    v_fmac_f32 v171, v189, v168
    v_fmac_f32 v170, v188, v168
    v_fmac_f32 v171, v188, v169
    v_fma_f32 v172, -v189, v171, v172
    v_fmac_f32 v173, v189, v170
    v_fmac_f32 v172, v188, v170
    v_fmac_f32 v173, v188, v171
    v_fma_f32 v174, -v189, v173, v174
    v_fmac_f32 v175, v189, v172
    v_fmac_f32 v174, v188, v172
    v_fmac_f32 v175, v188, v173
    ds_write_b32 v190, v160 offset:1664
    ds_write_b32 v190, v161 offset:1736
    ds_write_b32 v190, v162 offset:1872
    ds_write_b32 v190, v163 offset:1944
    ds_write_b32 v190, v164 offset:2080
    ds_write_b32 v190, v165 offset:2152
    ds_write_b32 v190, v166 offset:2288
    ds_write_b32 v190, v167 offset:2360
    ds_write_b32 v190, v168 offset:2496
    ds_write_b32 v190, v169 offset:2568
    ds_write_b32 v190, v170 offset:2704
    ds_write_b32 v190, v171 offset:2776
    ds_write_b32 v190, v172 offset:2912
    ds_write_b32 v190, v173 offset:2984
    ds_write_b32 v190, v174 offset:3120
    ds_write_b32 v190, v175 offset:3192
    v_lshlrev_b32 v191, 3, v184
    v_add_u32 v191, 69632, v191
    ds_write_b64 v191, v[174:175]
    s_mov_b64 exec, s[50:51]
K1_noscan:
    s_cmp_eq_u32 s20, 0
    s_cbranch_scc1 KM_skipg0
    s_add_u32 s35, s32, 0
    s_cmp_eq_u32 s33, 1
    s_cbranch_scc1 K1_g_odd_1
    v_cvt_pk_bf16_f32 v16, 0, v16
    v_cvt_pk_bf16_f32 v17, 0, v17
    v_cvt_pk_bf16_f32 v18, 0, v18
    v_cvt_pk_bf16_f32 v19, 0, v19
    v_pk_mul_f32 v[184:185], v[16:17], s[60:61]
    v_pk_mul_f32 v[186:187], v[18:19], s[60:61]
    v_exp_f32 v184, v184
    v_exp_f32 v185, v185
    v_exp_f32 v186, v186
    v_exp_f32 v187, v187
    v_cvt_pk_bf16_f32 v20, 0, v20
    v_cvt_pk_bf16_f32 v21, 0, v21
    v_cvt_pk_bf16_f32 v22, 0, v22
    v_cvt_pk_bf16_f32 v23, 0, v23
    v_pk_add_f32 v[184:185], v[184:185], s[62:63]
    v_pk_add_f32 v[186:187], v[186:187], s[62:63]
    v_rcp_f32 v184, v184
    v_rcp_f32 v185, v185
    v_rcp_f32 v186, v186
    v_rcp_f32 v187, v187
    s_nop 0
    v_pk_mul_f32 v[184:185], v[16:17], v[184:185]
    v_pk_mul_f32 v[186:187], v[18:19], v[186:187]
    v_cvt_pk_bf16_f32 v184, 0, v184
    v_cvt_pk_bf16_f32 v185, 0, v185
    v_cvt_pk_bf16_f32 v186, 0, v186
    v_cvt_pk_bf16_f32 v187, 0, v187
    v_pk_mul_f32 v[184:185], v[184:185], v[20:21]
    v_pk_mul_f32 v[186:187], v[186:187], v[22:23]
    v_cvt_pk_bf16_f32 v16, v184, v185
    v_cvt_pk_bf16_f32 v17, v186, v187
    v_cvt_pk_bf16_f32 v32, 0, v32
    v_cvt_pk_bf16_f32 v33, 0, v33
    v_cvt_pk_bf16_f32 v34, 0, v34
    v_cvt_pk_bf16_f32 v35, 0, v35
    v_pk_mul_f32 v[184:185], v[32:33], s[60:61]
    v_pk_mul_f32 v[186:187], v[34:35], s[60:61]
    v_exp_f32 v184, v184
    v_exp_f32 v185, v185
    v_exp_f32 v186, v186
    v_exp_f32 v187, v187
    v_cvt_pk_bf16_f32 v36, 0, v36
    v_cvt_pk_bf16_f32 v37, 0, v37
    v_cvt_pk_bf16_f32 v38, 0, v38
    v_cvt_pk_bf16_f32 v39, 0, v39
    v_pk_add_f32 v[184:185], v[184:185], s[62:63]
    v_pk_add_f32 v[186:187], v[186:187], s[62:63]
    v_rcp_f32 v184, v184
    v_rcp_f32 v185, v185
    v_rcp_f32 v186, v186
    v_rcp_f32 v187, v187
    s_nop 0
    v_pk_mul_f32 v[184:185], v[32:33], v[184:185]
    v_pk_mul_f32 v[186:187], v[34:35], v[186:187]
    v_cvt_pk_bf16_f32 v184, 0, v184
    v_cvt_pk_bf16_f32 v185, 0, v185
    v_cvt_pk_bf16_f32 v186, 0, v186
    v_cvt_pk_bf16_f32 v187, 0, v187
    v_pk_mul_f32 v[184:185], v[184:185], v[36:37]
    v_pk_mul_f32 v[186:187], v[186:187], v[38:39]
    v_cvt_pk_bf16_f32 v18, v184, v185
    v_cvt_pk_bf16_f32 v19, v186, v187
    buffer_store_dwordx4 v[16:19], v1, s[16:19], s35 offen offset:0 sc1
    v_cvt_pk_bf16_f32 v24, 0, v24
    v_cvt_pk_bf16_f32 v25, 0, v25
    v_cvt_pk_bf16_f32 v26, 0, v26
    v_cvt_pk_bf16_f32 v27, 0, v27
    v_pk_mul_f32 v[184:185], v[24:25], s[60:61]
    v_pk_mul_f32 v[186:187], v[26:27], s[60:61]
    v_exp_f32 v184, v184
    v_exp_f32 v185, v185
    v_exp_f32 v186, v186
    v_exp_f32 v187, v187
    v_cvt_pk_bf16_f32 v28, 0, v28
    v_cvt_pk_bf16_f32 v29, 0, v29
    v_cvt_pk_bf16_f32 v30, 0, v30
    v_cvt_pk_bf16_f32 v31, 0, v31
    v_pk_add_f32 v[184:185], v[184:185], s[62:63]
    v_pk_add_f32 v[186:187], v[186:187], s[62:63]
    v_rcp_f32 v184, v184
    v_rcp_f32 v185, v185
    v_rcp_f32 v186, v186
    v_rcp_f32 v187, v187
    s_nop 0
    v_pk_mul_f32 v[184:185], v[24:25], v[184:185]
    v_pk_mul_f32 v[186:187], v[26:27], v[186:187]
    v_cvt_pk_bf16_f32 v184, 0, v184
    v_cvt_pk_bf16_f32 v185, 0, v185
    v_cvt_pk_bf16_f32 v186, 0, v186
    v_cvt_pk_bf16_f32 v187, 0, v187
    v_pk_mul_f32 v[184:185], v[184:185], v[28:29]
    v_pk_mul_f32 v[186:187], v[186:187], v[30:31]
    v_cvt_pk_bf16_f32 v24, v184, v185
    v_cvt_pk_bf16_f32 v25, v186, v187
    v_cvt_pk_bf16_f32 v40, 0, v40
    v_cvt_pk_bf16_f32 v41, 0, v41
    v_cvt_pk_bf16_f32 v42, 0, v42
    v_cvt_pk_bf16_f32 v43, 0, v43
    v_pk_mul_f32 v[184:185], v[40:41], s[60:61]
    v_pk_mul_f32 v[186:187], v[42:43], s[60:61]
    v_exp_f32 v184, v184
    v_exp_f32 v185, v185
    v_exp_f32 v186, v186
    v_exp_f32 v187, v187
    v_cvt_pk_bf16_f32 v44, 0, v44
    v_cvt_pk_bf16_f32 v45, 0, v45
    v_cvt_pk_bf16_f32 v46, 0, v46
    v_cvt_pk_bf16_f32 v47, 0, v47
    v_pk_add_f32 v[184:185], v[184:185], s[62:63]
    v_pk_add_f32 v[186:187], v[186:187], s[62:63]
    v_rcp_f32 v184, v184
    v_rcp_f32 v185, v185
    v_rcp_f32 v186, v186
    v_rcp_f32 v187, v187
    s_nop 0
    v_pk_mul_f32 v[184:185], v[40:41], v[184:185]
    v_pk_mul_f32 v[186:187], v[42:43], v[186:187]
    v_cvt_pk_bf16_f32 v184, 0, v184
    v_cvt_pk_bf16_f32 v185, 0, v185
    v_cvt_pk_bf16_f32 v186, 0, v186
    v_cvt_pk_bf16_f32 v187, 0, v187
    v_pk_mul_f32 v[184:185], v[184:185], v[44:45]
    v_pk_mul_f32 v[186:187], v[186:187], v[46:47]
    v_cvt_pk_bf16_f32 v26, v184, v185
    v_cvt_pk_bf16_f32 v27, v186, v187
    buffer_store_dwordx4 v[24:27], v1, s[16:19], s35 offen offset:1024 sc1
    s_branch K1_g_end_2
K1_g_odd_1:
    v_cvt_pk_bf16_f32 v16, 0, v16
    v_cvt_pk_bf16_f32 v17, 0, v17
    v_cvt_pk_bf16_f32 v18, 0, v18
    v_cvt_pk_bf16_f32 v19, 0, v19
    v_pk_mul_f32 v[184:185], v[16:17], s[60:61]
    v_pk_mul_f32 v[186:187], v[18:19], s[60:61]
    v_exp_f32 v184, v184
    v_exp_f32 v185, v185
    v_exp_f32 v186, v186
    v_exp_f32 v187, v187
    v_cvt_pk_bf16_f32 v20, 0, v20
    v_cvt_pk_bf16_f32 v21, 0, v21
    v_cvt_pk_bf16_f32 v22, 0, v22
    v_cvt_pk_bf16_f32 v23, 0, v23
    v_pk_add_f32 v[184:185], v[184:185], s[62:63]
    v_pk_add_f32 v[186:187], v[186:187], s[62:63]
    v_rcp_f32 v184, v184
    v_rcp_f32 v185, v185
    v_rcp_f32 v186, v186
    v_rcp_f32 v187, v187
    s_nop 0
    v_pk_mul_f32 v[184:185], v[16:17], v[184:185]
    v_pk_mul_f32 v[186:187], v[18:19], v[186:187]
    v_cvt_pk_bf16_f32 v184, 0, v184
    v_cvt_pk_bf16_f32 v185, 0, v185
    v_cvt_pk_bf16_f32 v186, 0, v186
    v_cvt_pk_bf16_f32 v187, 0, v187
    v_pk_mul_f32 v[184:185], v[184:185], v[20:21]
    v_pk_mul_f32 v[186:187], v[186:187], v[22:23]
    v_cvt_pk_bf16_f32 v16, v184, v185
    v_cvt_pk_bf16_f32 v17, v186, v187
    buffer_store_dwordx2 v[16:17], v1, s[16:19], s35 offen offset:8 sc1
    v_cvt_pk_bf16_f32 v24, 0, v24
    v_cvt_pk_bf16_f32 v25, 0, v25
    v_cvt_pk_bf16_f32 v26, 0, v26
    v_cvt_pk_bf16_f32 v27, 0, v27
    v_pk_mul_f32 v[184:185], v[24:25], s[60:61]
    v_pk_mul_f32 v[186:187], v[26:27], s[60:61]
    v_exp_f32 v184, v184
    v_exp_f32 v185, v185
    v_exp_f32 v186, v186
    v_exp_f32 v187, v187
    v_cvt_pk_bf16_f32 v28, 0, v28
    v_cvt_pk_bf16_f32 v29, 0, v29
    v_cvt_pk_bf16_f32 v30, 0, v30
    v_cvt_pk_bf16_f32 v31, 0, v31
    v_pk_add_f32 v[184:185], v[184:185], s[62:63]
    v_pk_add_f32 v[186:187], v[186:187], s[62:63]
    v_rcp_f32 v184, v184
    v_rcp_f32 v185, v185
    v_rcp_f32 v186, v186
    v_rcp_f32 v187, v187
    s_nop 0
    v_pk_mul_f32 v[184:185], v[24:25], v[184:185]
    v_pk_mul_f32 v[186:187], v[26:27], v[186:187]
    v_cvt_pk_bf16_f32 v184, 0, v184
    v_cvt_pk_bf16_f32 v185, 0, v185
    v_cvt_pk_bf16_f32 v186, 0, v186
    v_cvt_pk_bf16_f32 v187, 0, v187
    v_pk_mul_f32 v[184:185], v[184:185], v[28:29]
    v_pk_mul_f32 v[186:187], v[186:187], v[30:31]
    v_cvt_pk_bf16_f32 v24, v184, v185
    v_cvt_pk_bf16_f32 v25, v186, v187
    buffer_store_dwordx2 v[24:25], v1, s[16:19], s35 offen offset:1032 sc1
K1_g_end_2:
KM_skipg0:
    s_waitcnt lgkmcnt(0)
    s_barrier
    s_cmp_lg_u32 s20, 0
    s_cbranch_scc1 K1_nopfx
    v_cmp_gt_u32 vcc, 18, v0
    s_and_saveexec_b64 s[50:51], vcc
    v_mul_u32_u24 v187, 160, v0
    v_add_u32 v187, 124416, v187
    ds_read_b128 v[188:191], v187 offset:16
    v_lshlrev_b32 v192, 3, v0
    v_add_u32 v192, 69632, v192
    ds_read_b64 v[160:161], v192 offset:0
    ds_read_b64 v[162:163], v192 offset:144
    ds_read_b64 v[164:165], v192 offset:288
    ds_read_b64 v[166:167], v192 offset:432
    ds_read_b64 v[168:169], v192 offset:576
    ds_read_b64 v[170:171], v192 offset:720
    ds_read_b64 v[172:173], v192 offset:864
    ds_read_b64 v[174:175], v192 offset:1008
    s_waitcnt lgkmcnt(0)
    v_fmac_f32 v162, v188, v160
    v_fmac_f32 v163, v188, v161
    v_fma_f32 v162, -v189, v161, v162
    v_fmac_f32 v163, v189, v160
    v_fmac_f32 v164, v188, v162
    v_fmac_f32 v165, v188, v163
    v_fma_f32 v164, -v189, v163, v164
    v_fmac_f32 v165, v189, v162
    v_fmac_f32 v166, v188, v164
    v_fmac_f32 v167, v188, v165
    v_fma_f32 v166, -v189, v165, v166
    v_fmac_f32 v167, v189, v164
    v_fmac_f32 v168, v188, v166
    v_fmac_f32 v169, v188, v167
    v_fma_f32 v168, -v189, v167, v168
    v_fmac_f32 v169, v189, v166
    v_fmac_f32 v170, v188, v168
    v_fmac_f32 v171, v188, v169
    v_fma_f32 v170, -v189, v169, v170
    v_fmac_f32 v171, v189, v168
    v_fmac_f32 v172, v188, v170
    v_fmac_f32 v173, v188, v171
    v_fma_f32 v172, -v189, v171, v172
    v_fmac_f32 v173, v189, v170
    v_fmac_f32 v174, v188, v172
    v_fmac_f32 v175, v188, v173
    v_fma_f32 v174, -v189, v173, v174
    v_fmac_f32 v175, v189, v172
    v_mov_b32 v176, v174
    v_mov_b32 v177, v175
    ds_read_b64 v[160:161], v192 offset:1152
    ds_read_b64 v[162:163], v192 offset:1296
    ds_read_b64 v[164:165], v192 offset:1440
    ds_read_b64 v[166:167], v192 offset:1584
    ds_read_b64 v[168:169], v192 offset:1728
    ds_read_b64 v[170:171], v192 offset:1872
    ds_read_b64 v[172:173], v192 offset:2016
    ds_read_b64 v[174:175], v192 offset:2160
    s_waitcnt lgkmcnt(0)
    v_fmac_f32 v160, v188, v176
    v_fmac_f32 v161, v188, v177
    v_fma_f32 v160, -v189, v177, v160
    v_fmac_f32 v161, v189, v176
    v_fmac_f32 v162, v188, v160
    v_fmac_f32 v163, v188, v161
    v_fma_f32 v162, -v189, v161, v162
    v_fmac_f32 v163, v189, v160
    v_fmac_f32 v164, v188, v162
    v_fmac_f32 v165, v188, v163
    v_fma_f32 v164, -v189, v163, v164
    v_fmac_f32 v165, v189, v162
    v_fmac_f32 v166, v188, v164
    v_fmac_f32 v167, v188, v165
    v_fma_f32 v166, -v189, v165, v166
    v_fmac_f32 v167, v189, v164
    v_fmac_f32 v168, v188, v166
    v_fmac_f32 v169, v188, v167
    v_fma_f32 v168, -v189, v167, v168
    v_fmac_f32 v169, v189, v166
    v_fmac_f32 v170, v188, v168
    v_fmac_f32 v171, v188, v169
    v_fma_f32 v170, -v189, v169, v170
    v_fmac_f32 v171, v189, v168
    v_fmac_f32 v172, v188, v170
    v_fmac_f32 v173, v188, v171
    v_fma_f32 v172, -v189, v171, v172
    v_fmac_f32 v173, v189, v170
    v_fmac_f32 v174, v188, v172
    v_fmac_f32 v175, v188, v173
    v_fma_f32 v174, -v189, v173, v174
    v_fmac_f32 v175, v189, v172
    s_mul_i32 s52, s22, 9216
    s_add_u32 s52, s52, 46137344
    v_mov_b32 v176, v174
    v_mov_b32 v177, s3
    v_mov_b32 v178, v175
    v_mov_b32 v179, s3
    buffer_store_dwordx4 v[176:179], v193, s[16:19], s52 offen sc1
    s_mov_b64 exec, 1
    s_add_u32 s100, s3, 2
    v_mov_b32 v194, s100
    v_mov_b32 v195, 0
    buffer_store_dword v194, v195, s[16:19], s101 offen sc1
    s_mov_b64 exec, -1
    s_add_u32 s35, s32, 0
    s_cmp_eq_u32 s33, 1
    s_cbranch_scc1 K1_g_odd_3
    v_cvt_pk_bf16_f32 v16, 0, v16
    v_cvt_pk_bf16_f32 v17, 0, v17
    v_cvt_pk_bf16_f32 v18, 0, v18
    v_cvt_pk_bf16_f32 v19, 0, v19
    v_pk_mul_f32 v[184:185], v[16:17], s[60:61]
    v_pk_mul_f32 v[186:187], v[18:19], s[60:61]
    v_exp_f32 v184, v184
    v_exp_f32 v185, v185
    v_exp_f32 v186, v186
    v_exp_f32 v187, v187
    v_cvt_pk_bf16_f32 v20, 0, v20
    v_cvt_pk_bf16_f32 v21, 0, v21
    v_cvt_pk_bf16_f32 v22, 0, v22
    v_cvt_pk_bf16_f32 v23, 0, v23
    v_pk_add_f32 v[184:185], v[184:185], s[62:63]
    v_pk_add_f32 v[186:187], v[186:187], s[62:63]
    v_rcp_f32 v184, v184
    v_rcp_f32 v185, v185
    v_rcp_f32 v186, v186
    v_rcp_f32 v187, v187
    s_nop 0
    v_pk_mul_f32 v[184:185], v[16:17], v[184:185]
    v_pk_mul_f32 v[186:187], v[18:19], v[186:187]
    v_cvt_pk_bf16_f32 v184, 0, v184
    v_cvt_pk_bf16_f32 v185, 0, v185
    v_cvt_pk_bf16_f32 v186, 0, v186
    v_cvt_pk_bf16_f32 v187, 0, v187
    v_pk_mul_f32 v[184:185], v[184:185], v[20:21]
    v_pk_mul_f32 v[186:187], v[186:187], v[22:23]
    v_cvt_pk_bf16_f32 v16, v184, v185
    v_cvt_pk_bf16_f32 v17, v186, v187
    v_cvt_pk_bf16_f32 v32, 0, v32
    v_cvt_pk_bf16_f32 v33, 0, v33
    v_cvt_pk_bf16_f32 v34, 0, v34
    v_cvt_pk_bf16_f32 v35, 0, v35
    v_pk_mul_f32 v[184:185], v[32:33], s[60:61]
    v_pk_mul_f32 v[186:187], v[34:35], s[60:61]
    v_exp_f32 v184, v184
    v_exp_f32 v185, v185
    v_exp_f32 v186, v186
    v_exp_f32 v187, v187
    v_cvt_pk_bf16_f32 v36, 0, v36
    v_cvt_pk_bf16_f32 v37, 0, v37
    v_cvt_pk_bf16_f32 v38, 0, v38
    v_cvt_pk_bf16_f32 v39, 0, v39
    v_pk_add_f32 v[184:185], v[184:185], s[62:63]
    v_pk_add_f32 v[186:187], v[186:187], s[62:63]
    v_rcp_f32 v184, v184
    v_rcp_f32 v185, v185
    v_rcp_f32 v186, v186
    v_rcp_f32 v187, v187
    s_nop 0
    v_pk_mul_f32 v[184:185], v[32:33], v[184:185]
    v_pk_mul_f32 v[186:187], v[34:35], v[186:187]
    v_cvt_pk_bf16_f32 v184, 0, v184
    v_cvt_pk_bf16_f32 v185, 0, v185
    v_cvt_pk_bf16_f32 v186, 0, v186
    v_cvt_pk_bf16_f32 v187, 0, v187
    v_pk_mul_f32 v[184:185], v[184:185], v[36:37]
    v_pk_mul_f32 v[186:187], v[186:187], v[38:39]
    v_cvt_pk_bf16_f32 v18, v184, v185
    v_cvt_pk_bf16_f32 v19, v186, v187
    buffer_store_dwordx4 v[16:19], v1, s[16:19], s35 offen offset:0 sc1
    v_cvt_pk_bf16_f32 v24, 0, v24
    v_cvt_pk_bf16_f32 v25, 0, v25
    v_cvt_pk_bf16_f32 v26, 0, v26
    v_cvt_pk_bf16_f32 v27, 0, v27
    v_pk_mul_f32 v[184:185], v[24:25], s[60:61]
    v_pk_mul_f32 v[186:187], v[26:27], s[60:61]
    v_exp_f32 v184, v184
    v_exp_f32 v185, v185
    v_exp_f32 v186, v186
    v_exp_f32 v187, v187
    v_cvt_pk_bf16_f32 v28, 0, v28
    v_cvt_pk_bf16_f32 v29, 0, v29
    v_cvt_pk_bf16_f32 v30, 0, v30
    v_cvt_pk_bf16_f32 v31, 0, v31
    v_pk_add_f32 v[184:185], v[184:185], s[62:63]
    v_pk_add_f32 v[186:187], v[186:187], s[62:63]
    v_rcp_f32 v184, v184
    v_rcp_f32 v185, v185
    v_rcp_f32 v186, v186
    v_rcp_f32 v187, v187
    s_nop 0
    v_pk_mul_f32 v[184:185], v[24:25], v[184:185]
    v_pk_mul_f32 v[186:187], v[26:27], v[186:187]
    v_cvt_pk_bf16_f32 v184, 0, v184
    v_cvt_pk_bf16_f32 v185, 0, v185
    v_cvt_pk_bf16_f32 v186, 0, v186
    v_cvt_pk_bf16_f32 v187, 0, v187
    v_pk_mul_f32 v[184:185], v[184:185], v[28:29]
    v_pk_mul_f32 v[186:187], v[186:187], v[30:31]
    v_cvt_pk_bf16_f32 v24, v184, v185
    v_cvt_pk_bf16_f32 v25, v186, v187
    v_cvt_pk_bf16_f32 v40, 0, v40
    v_cvt_pk_bf16_f32 v41, 0, v41
    v_cvt_pk_bf16_f32 v42, 0, v42
    v_cvt_pk_bf16_f32 v43, 0, v43
    v_pk_mul_f32 v[184:185], v[40:41], s[60:61]
    v_pk_mul_f32 v[186:187], v[42:43], s[60:61]
    v_exp_f32 v184, v184
    v_exp_f32 v185, v185
    v_exp_f32 v186, v186
    v_exp_f32 v187, v187
    v_cvt_pk_bf16_f32 v44, 0, v44
    v_cvt_pk_bf16_f32 v45, 0, v45
    v_cvt_pk_bf16_f32 v46, 0, v46
    v_cvt_pk_bf16_f32 v47, 0, v47
    v_pk_add_f32 v[184:185], v[184:185], s[62:63]
    v_pk_add_f32 v[186:187], v[186:187], s[62:63]
    v_rcp_f32 v184, v184
    v_rcp_f32 v185, v185
    v_rcp_f32 v186, v186
    v_rcp_f32 v187, v187
    s_nop 0
    v_pk_mul_f32 v[184:185], v[40:41], v[184:185]
    v_pk_mul_f32 v[186:187], v[42:43], v[186:187]
    v_cvt_pk_bf16_f32 v184, 0, v184
    v_cvt_pk_bf16_f32 v185, 0, v185
    v_cvt_pk_bf16_f32 v186, 0, v186
    v_cvt_pk_bf16_f32 v187, 0, v187
    v_pk_mul_f32 v[184:185], v[184:185], v[44:45]
    v_pk_mul_f32 v[186:187], v[186:187], v[46:47]
    v_cvt_pk_bf16_f32 v26, v184, v185
    v_cvt_pk_bf16_f32 v27, v186, v187
    buffer_store_dwordx4 v[24:27], v1, s[16:19], s35 offen offset:1024 sc1
    s_branch K1_g_end_4
K1_g_odd_3:
    v_cvt_pk_bf16_f32 v16, 0, v16
    v_cvt_pk_bf16_f32 v17, 0, v17
    v_cvt_pk_bf16_f32 v18, 0, v18
    v_cvt_pk_bf16_f32 v19, 0, v19
    v_pk_mul_f32 v[184:185], v[16:17], s[60:61]
    v_pk_mul_f32 v[186:187], v[18:19], s[60:61]
    v_exp_f32 v184, v184
    v_exp_f32 v185, v185
    v_exp_f32 v186, v186
    v_exp_f32 v187, v187
    v_cvt_pk_bf16_f32 v20, 0, v20
    v_cvt_pk_bf16_f32 v21, 0, v21
    v_cvt_pk_bf16_f32 v22, 0, v22
    v_cvt_pk_bf16_f32 v23, 0, v23
    v_pk_add_f32 v[184:185], v[184:185], s[62:63]
    v_pk_add_f32 v[186:187], v[186:187], s[62:63]
    v_rcp_f32 v184, v184
    v_rcp_f32 v185, v185
    v_rcp_f32 v186, v186
    v_rcp_f32 v187, v187
    s_nop 0
    v_pk_mul_f32 v[184:185], v[16:17], v[184:185]
    v_pk_mul_f32 v[186:187], v[18:19], v[186:187]
    v_cvt_pk_bf16_f32 v184, 0, v184
    v_cvt_pk_bf16_f32 v185, 0, v185
    v_cvt_pk_bf16_f32 v186, 0, v186
    v_cvt_pk_bf16_f32 v187, 0, v187
    v_pk_mul_f32 v[184:185], v[184:185], v[20:21]
    v_pk_mul_f32 v[186:187], v[186:187], v[22:23]
    v_cvt_pk_bf16_f32 v16, v184, v185
    v_cvt_pk_bf16_f32 v17, v186, v187
    buffer_store_dwordx2 v[16:17], v1, s[16:19], s35 offen offset:8 sc1
    v_cvt_pk_bf16_f32 v24, 0, v24
    v_cvt_pk_bf16_f32 v25, 0, v25
    v_cvt_pk_bf16_f32 v26, 0, v26
    v_cvt_pk_bf16_f32 v27, 0, v27
    v_pk_mul_f32 v[184:185], v[24:25], s[60:61]
    v_pk_mul_f32 v[186:187], v[26:27], s[60:61]
    v_exp_f32 v184, v184
    v_exp_f32 v185, v185
    v_exp_f32 v186, v186
    v_exp_f32 v187, v187
    v_cvt_pk_bf16_f32 v28, 0, v28
    v_cvt_pk_bf16_f32 v29, 0, v29
    v_cvt_pk_bf16_f32 v30, 0, v30
    v_cvt_pk_bf16_f32 v31, 0, v31
    v_pk_add_f32 v[184:185], v[184:185], s[62:63]
    v_pk_add_f32 v[186:187], v[186:187], s[62:63]
    v_rcp_f32 v184, v184
    v_rcp_f32 v185, v185
    v_rcp_f32 v186, v186
    v_rcp_f32 v187, v187
    s_nop 0
    v_pk_mul_f32 v[184:185], v[24:25], v[184:185]
    v_pk_mul_f32 v[186:187], v[26:27], v[186:187]
    v_cvt_pk_bf16_f32 v184, 0, v184
    v_cvt_pk_bf16_f32 v185, 0, v185
    v_cvt_pk_bf16_f32 v186, 0, v186
    v_cvt_pk_bf16_f32 v187, 0, v187
    v_pk_mul_f32 v[184:185], v[184:185], v[28:29]
    v_pk_mul_f32 v[186:187], v[186:187], v[30:31]
    v_cvt_pk_bf16_f32 v24, v184, v185
    v_cvt_pk_bf16_f32 v25, v186, v187
    buffer_store_dwordx2 v[24:25], v1, s[16:19], s35 offen offset:1032 sc1
K1_g_end_4:
K1_nopfx:
    s_add_u32 s35, s32, 2048
    s_cmp_eq_u32 s33, 1
    s_cbranch_scc1 K1_g_odd_5
    v_cvt_pk_bf16_f32 v48, 0, v48
    v_cvt_pk_bf16_f32 v49, 0, v49
    v_cvt_pk_bf16_f32 v50, 0, v50
    v_cvt_pk_bf16_f32 v51, 0, v51
    v_pk_mul_f32 v[184:185], v[48:49], s[60:61]
    v_pk_mul_f32 v[186:187], v[50:51], s[60:61]
    v_exp_f32 v184, v184
    v_exp_f32 v185, v185
    v_exp_f32 v186, v186
    v_exp_f32 v187, v187
    v_cvt_pk_bf16_f32 v52, 0, v52
    v_cvt_pk_bf16_f32 v53, 0, v53
    v_cvt_pk_bf16_f32 v54, 0, v54
    v_cvt_pk_bf16_f32 v55, 0, v55
    v_pk_add_f32 v[184:185], v[184:185], s[62:63]
    v_pk_add_f32 v[186:187], v[186:187], s[62:63]
    v_rcp_f32 v184, v184
    v_rcp_f32 v185, v185
    v_rcp_f32 v186, v186
    v_rcp_f32 v187, v187
    s_nop 0
    v_pk_mul_f32 v[184:185], v[48:49], v[184:185]
    v_pk_mul_f32 v[186:187], v[50:51], v[186:187]
    v_cvt_pk_bf16_f32 v184, 0, v184
    v_cvt_pk_bf16_f32 v185, 0, v185
    v_cvt_pk_bf16_f32 v186, 0, v186
    v_cvt_pk_bf16_f32 v187, 0, v187
    v_pk_mul_f32 v[184:185], v[184:185], v[52:53]
    v_pk_mul_f32 v[186:187], v[186:187], v[54:55]
    v_cvt_pk_bf16_f32 v48, v184, v185
    v_cvt_pk_bf16_f32 v49, v186, v187
    v_cvt_pk_bf16_f32 v64, 0, v64
    v_cvt_pk_bf16_f32 v65, 0, v65
    v_cvt_pk_bf16_f32 v66, 0, v66
    v_cvt_pk_bf16_f32 v67, 0, v67
    v_pk_mul_f32 v[184:185], v[64:65], s[60:61]
    v_pk_mul_f32 v[186:187], v[66:67], s[60:61]
    v_exp_f32 v184, v184
    v_exp_f32 v185, v185
    v_exp_f32 v186, v186
    v_exp_f32 v187, v187
    v_cvt_pk_bf16_f32 v68, 0, v68
    v_cvt_pk_bf16_f32 v69, 0, v69
    v_cvt_pk_bf16_f32 v70, 0, v70
    v_cvt_pk_bf16_f32 v71, 0, v71
    v_pk_add_f32 v[184:185], v[184:185], s[62:63]
    v_pk_add_f32 v[186:187], v[186:187], s[62:63]
    v_rcp_f32 v184, v184
    v_rcp_f32 v185, v185
    v_rcp_f32 v186, v186
    v_rcp_f32 v187, v187
    s_nop 0
    v_pk_mul_f32 v[184:185], v[64:65], v[184:185]
    v_pk_mul_f32 v[186:187], v[66:67], v[186:187]
    v_cvt_pk_bf16_f32 v184, 0, v184
    v_cvt_pk_bf16_f32 v185, 0, v185
    v_cvt_pk_bf16_f32 v186, 0, v186
    v_cvt_pk_bf16_f32 v187, 0, v187
    v_pk_mul_f32 v[184:185], v[184:185], v[68:69]
    v_pk_mul_f32 v[186:187], v[186:187], v[70:71]
    v_cvt_pk_bf16_f32 v50, v184, v185
    v_cvt_pk_bf16_f32 v51, v186, v187
    buffer_store_dwordx4 v[48:51], v1, s[16:19], s35 offen offset:0 sc1
    v_cvt_pk_bf16_f32 v56, 0, v56
    v_cvt_pk_bf16_f32 v57, 0, v57
    v_cvt_pk_bf16_f32 v58, 0, v58
    v_cvt_pk_bf16_f32 v59, 0, v59
    v_pk_mul_f32 v[184:185], v[56:57], s[60:61]
    v_pk_mul_f32 v[186:187], v[58:59], s[60:61]
    v_exp_f32 v184, v184
    v_exp_f32 v185, v185
    v_exp_f32 v186, v186
    v_exp_f32 v187, v187
    v_cvt_pk_bf16_f32 v60, 0, v60
    v_cvt_pk_bf16_f32 v61, 0, v61
    v_cvt_pk_bf16_f32 v62, 0, v62
    v_cvt_pk_bf16_f32 v63, 0, v63
    v_pk_add_f32 v[184:185], v[184:185], s[62:63]
    v_pk_add_f32 v[186:187], v[186:187], s[62:63]
    v_rcp_f32 v184, v184
    v_rcp_f32 v185, v185
    v_rcp_f32 v186, v186
    v_rcp_f32 v187, v187
    s_nop 0
    v_pk_mul_f32 v[184:185], v[56:57], v[184:185]
    v_pk_mul_f32 v[186:187], v[58:59], v[186:187]
    v_cvt_pk_bf16_f32 v184, 0, v184
    v_cvt_pk_bf16_f32 v185, 0, v185
    v_cvt_pk_bf16_f32 v186, 0, v186
    v_cvt_pk_bf16_f32 v187, 0, v187
    v_pk_mul_f32 v[184:185], v[184:185], v[60:61]
    v_pk_mul_f32 v[186:187], v[186:187], v[62:63]
    v_cvt_pk_bf16_f32 v56, v184, v185
    v_cvt_pk_bf16_f32 v57, v186, v187
    v_cvt_pk_bf16_f32 v72, 0, v72
    v_cvt_pk_bf16_f32 v73, 0, v73
    v_cvt_pk_bf16_f32 v74, 0, v74
    v_cvt_pk_bf16_f32 v75, 0, v75
    v_pk_mul_f32 v[184:185], v[72:73], s[60:61]
    v_pk_mul_f32 v[186:187], v[74:75], s[60:61]
    v_exp_f32 v184, v184
    v_exp_f32 v185, v185
    v_exp_f32 v186, v186
    v_exp_f32 v187, v187
    v_cvt_pk_bf16_f32 v76, 0, v76
    v_cvt_pk_bf16_f32 v77, 0, v77
    v_cvt_pk_bf16_f32 v78, 0, v78
    v_cvt_pk_bf16_f32 v79, 0, v79
    v_pk_add_f32 v[184:185], v[184:185], s[62:63]
    v_pk_add_f32 v[186:187], v[186:187], s[62:63]
    v_rcp_f32 v184, v184
    v_rcp_f32 v185, v185
    v_rcp_f32 v186, v186
    v_rcp_f32 v187, v187
    s_nop 0
    v_pk_mul_f32 v[184:185], v[72:73], v[184:185]
    v_pk_mul_f32 v[186:187], v[74:75], v[186:187]
    v_cvt_pk_bf16_f32 v184, 0, v184
    v_cvt_pk_bf16_f32 v185, 0, v185
    v_cvt_pk_bf16_f32 v186, 0, v186
    v_cvt_pk_bf16_f32 v187, 0, v187
    v_pk_mul_f32 v[184:185], v[184:185], v[76:77]
    v_pk_mul_f32 v[186:187], v[186:187], v[78:79]
    v_cvt_pk_bf16_f32 v58, v184, v185
    v_cvt_pk_bf16_f32 v59, v186, v187
    buffer_store_dwordx4 v[56:59], v1, s[16:19], s35 offen offset:1024 sc1
    s_branch K1_g_end_6
K1_g_odd_5:
    v_cvt_pk_bf16_f32 v32, 0, v32
    v_cvt_pk_bf16_f32 v33, 0, v33
    v_cvt_pk_bf16_f32 v34, 0, v34
    v_cvt_pk_bf16_f32 v35, 0, v35
    v_pk_mul_f32 v[184:185], v[32:33], s[60:61]
    v_pk_mul_f32 v[186:187], v[34:35], s[60:61]
    v_exp_f32 v184, v184
    v_exp_f32 v185, v185
    v_exp_f32 v186, v186
    v_exp_f32 v187, v187
    v_cvt_pk_bf16_f32 v36, 0, v36
    v_cvt_pk_bf16_f32 v37, 0, v37
    v_cvt_pk_bf16_f32 v38, 0, v38
    v_cvt_pk_bf16_f32 v39, 0, v39
    v_pk_add_f32 v[184:185], v[184:185], s[62:63]
    v_pk_add_f32 v[186:187], v[186:187], s[62:63]
    v_rcp_f32 v184, v184
    v_rcp_f32 v185, v185
    v_rcp_f32 v186, v186
    v_rcp_f32 v187, v187
    s_nop 0
    v_pk_mul_f32 v[184:185], v[32:33], v[184:185]
    v_pk_mul_f32 v[186:187], v[34:35], v[186:187]
    v_cvt_pk_bf16_f32 v184, 0, v184
    v_cvt_pk_bf16_f32 v185, 0, v185
    v_cvt_pk_bf16_f32 v186, 0, v186
    v_cvt_pk_bf16_f32 v187, 0, v187
    v_pk_mul_f32 v[184:185], v[184:185], v[36:37]
    v_pk_mul_f32 v[186:187], v[186:187], v[38:39]
    v_cvt_pk_bf16_f32 v32, v184, v185
    v_cvt_pk_bf16_f32 v33, v186, v187
    v_cvt_pk_bf16_f32 v48, 0, v48
    v_cvt_pk_bf16_f32 v49, 0, v49
    v_cvt_pk_bf16_f32 v50, 0, v50
    v_cvt_pk_bf16_f32 v51, 0, v51
    v_pk_mul_f32 v[184:185], v[48:49], s[60:61]
    v_pk_mul_f32 v[186:187], v[50:51], s[60:61]
    v_exp_f32 v184, v184
    v_exp_f32 v185, v185
    v_exp_f32 v186, v186
    v_exp_f32 v187, v187
    v_cvt_pk_bf16_f32 v52, 0, v52
    v_cvt_pk_bf16_f32 v53, 0, v53
    v_cvt_pk_bf16_f32 v54, 0, v54
    v_cvt_pk_bf16_f32 v55, 0, v55
    v_pk_add_f32 v[184:185], v[184:185], s[62:63]
    v_pk_add_f32 v[186:187], v[186:187], s[62:63]
    v_rcp_f32 v184, v184
    v_rcp_f32 v185, v185
    v_rcp_f32 v186, v186
    v_rcp_f32 v187, v187
    s_nop 0
    v_pk_mul_f32 v[184:185], v[48:49], v[184:185]
    v_pk_mul_f32 v[186:187], v[50:51], v[186:187]
    v_cvt_pk_bf16_f32 v184, 0, v184
    v_cvt_pk_bf16_f32 v185, 0, v185
    v_cvt_pk_bf16_f32 v186, 0, v186
    v_cvt_pk_bf16_f32 v187, 0, v187
    v_pk_mul_f32 v[184:185], v[184:185], v[52:53]
    v_pk_mul_f32 v[186:187], v[186:187], v[54:55]
    v_cvt_pk_bf16_f32 v34, v184, v185
    v_cvt_pk_bf16_f32 v35, v186, v187
    buffer_store_dwordx4 v[32:35], v1, s[16:19], s35 offen offset:0 sc1
    v_cvt_pk_bf16_f32 v40, 0, v40
    v_cvt_pk_bf16_f32 v41, 0, v41
    v_cvt_pk_bf16_f32 v42, 0, v42
    v_cvt_pk_bf16_f32 v43, 0, v43
    v_pk_mul_f32 v[184:185], v[40:41], s[60:61]
    v_pk_mul_f32 v[186:187], v[42:43], s[60:61]
    v_exp_f32 v184, v184
    v_exp_f32 v185, v185
    v_exp_f32 v186, v186
    v_exp_f32 v187, v187
    v_cvt_pk_bf16_f32 v44, 0, v44
    v_cvt_pk_bf16_f32 v45, 0, v45
    v_cvt_pk_bf16_f32 v46, 0, v46
    v_cvt_pk_bf16_f32 v47, 0, v47
    v_pk_add_f32 v[184:185], v[184:185], s[62:63]
    v_pk_add_f32 v[186:187], v[186:187], s[62:63]
    v_rcp_f32 v184, v184
    v_rcp_f32 v185, v185
    v_rcp_f32 v186, v186
    v_rcp_f32 v187, v187
    s_nop 0
    v_pk_mul_f32 v[184:185], v[40:41], v[184:185]
    v_pk_mul_f32 v[186:187], v[42:43], v[186:187]
    v_cvt_pk_bf16_f32 v184, 0, v184
    v_cvt_pk_bf16_f32 v185, 0, v185
    v_cvt_pk_bf16_f32 v186, 0, v186
    v_cvt_pk_bf16_f32 v187, 0, v187
    v_pk_mul_f32 v[184:185], v[184:185], v[44:45]
    v_pk_mul_f32 v[186:187], v[186:187], v[46:47]
    v_cvt_pk_bf16_f32 v40, v184, v185
    v_cvt_pk_bf16_f32 v41, v186, v187
    v_cvt_pk_bf16_f32 v56, 0, v56
    v_cvt_pk_bf16_f32 v57, 0, v57
    v_cvt_pk_bf16_f32 v58, 0, v58
    v_cvt_pk_bf16_f32 v59, 0, v59
    v_pk_mul_f32 v[184:185], v[56:57], s[60:61]
    v_pk_mul_f32 v[186:187], v[58:59], s[60:61]
    v_exp_f32 v184, v184
    v_exp_f32 v185, v185
    v_exp_f32 v186, v186
    v_exp_f32 v187, v187
    v_cvt_pk_bf16_f32 v60, 0, v60
    v_cvt_pk_bf16_f32 v61, 0, v61
    v_cvt_pk_bf16_f32 v62, 0, v62
    v_cvt_pk_bf16_f32 v63, 0, v63
    v_pk_add_f32 v[184:185], v[184:185], s[62:63]
    v_pk_add_f32 v[186:187], v[186:187], s[62:63]
    v_rcp_f32 v184, v184
    v_rcp_f32 v185, v185
    v_rcp_f32 v186, v186
    v_rcp_f32 v187, v187
    s_nop 0
    v_pk_mul_f32 v[184:185], v[56:57], v[184:185]
    v_pk_mul_f32 v[186:187], v[58:59], v[186:187]
    v_cvt_pk_bf16_f32 v184, 0, v184
    v_cvt_pk_bf16_f32 v185, 0, v185
    v_cvt_pk_bf16_f32 v186, 0, v186
    v_cvt_pk_bf16_f32 v187, 0, v187
    v_pk_mul_f32 v[184:185], v[184:185], v[60:61]
    v_pk_mul_f32 v[186:187], v[186:187], v[62:63]
    v_cvt_pk_bf16_f32 v42, v184, v185
    v_cvt_pk_bf16_f32 v43, v186, v187
    buffer_store_dwordx4 v[40:43], v1, s[16:19], s35 offen offset:1024 sc1
K1_g_end_6:
    s_add_u32 s35, s32, 4096
    s_cmp_eq_u32 s33, 1
    s_cbranch_scc1 K1_g_odd_7
    v_cvt_pk_bf16_f32 v80, 0, v80
    v_cvt_pk_bf16_f32 v81, 0, v81
    v_cvt_pk_bf16_f32 v82, 0, v82
    v_cvt_pk_bf16_f32 v83, 0, v83
    v_pk_mul_f32 v[184:185], v[80:81], s[60:61]
    v_pk_mul_f32 v[186:187], v[82:83], s[60:61]
    v_exp_f32 v184, v184
    v_exp_f32 v185, v185
    v_exp_f32 v186, v186
    v_exp_f32 v187, v187
    v_cvt_pk_bf16_f32 v84, 0, v84
    v_cvt_pk_bf16_f32 v85, 0, v85
    v_cvt_pk_bf16_f32 v86, 0, v86
    v_cvt_pk_bf16_f32 v87, 0, v87
    v_pk_add_f32 v[184:185], v[184:185], s[62:63]
    v_pk_add_f32 v[186:187], v[186:187], s[62:63]
    v_rcp_f32 v184, v184
    v_rcp_f32 v185, v185
    v_rcp_f32 v186, v186
    v_rcp_f32 v187, v187
    s_nop 0
    v_pk_mul_f32 v[184:185], v[80:81], v[184:185]
    v_pk_mul_f32 v[186:187], v[82:83], v[186:187]
    v_cvt_pk_bf16_f32 v184, 0, v184
    v_cvt_pk_bf16_f32 v185, 0, v185
    v_cvt_pk_bf16_f32 v186, 0, v186
    v_cvt_pk_bf16_f32 v187, 0, v187
    v_pk_mul_f32 v[184:185], v[184:185], v[84:85]
    v_pk_mul_f32 v[186:187], v[186:187], v[86:87]
    v_cvt_pk_bf16_f32 v80, v184, v185
    v_cvt_pk_bf16_f32 v81, v186, v187
    v_cvt_pk_bf16_f32 v96, 0, v96
    v_cvt_pk_bf16_f32 v97, 0, v97
    v_cvt_pk_bf16_f32 v98, 0, v98
    v_cvt_pk_bf16_f32 v99, 0, v99
    v_pk_mul_f32 v[184:185], v[96:97], s[60:61]
    v_pk_mul_f32 v[186:187], v[98:99], s[60:61]
    v_exp_f32 v184, v184
    v_exp_f32 v185, v185
    v_exp_f32 v186, v186
    v_exp_f32 v187, v187
    v_cvt_pk_bf16_f32 v100, 0, v100
    v_cvt_pk_bf16_f32 v101, 0, v101
    v_cvt_pk_bf16_f32 v102, 0, v102
    v_cvt_pk_bf16_f32 v103, 0, v103
    v_pk_add_f32 v[184:185], v[184:185], s[62:63]
    v_pk_add_f32 v[186:187], v[186:187], s[62:63]
    v_rcp_f32 v184, v184
    v_rcp_f32 v185, v185
    v_rcp_f32 v186, v186
    v_rcp_f32 v187, v187
    s_nop 0
    v_pk_mul_f32 v[184:185], v[96:97], v[184:185]
    v_pk_mul_f32 v[186:187], v[98:99], v[186:187]
    v_cvt_pk_bf16_f32 v184, 0, v184
    v_cvt_pk_bf16_f32 v185, 0, v185
    v_cvt_pk_bf16_f32 v186, 0, v186
    v_cvt_pk_bf16_f32 v187, 0, v187
    v_pk_mul_f32 v[184:185], v[184:185], v[100:101]
    v_pk_mul_f32 v[186:187], v[186:187], v[102:103]
    v_cvt_pk_bf16_f32 v82, v184, v185
    v_cvt_pk_bf16_f32 v83, v186, v187
    buffer_store_dwordx4 v[80:83], v1, s[16:19], s35 offen offset:0 sc1
    v_cvt_pk_bf16_f32 v88, 0, v88
    v_cvt_pk_bf16_f32 v89, 0, v89
    v_cvt_pk_bf16_f32 v90, 0, v90
    v_cvt_pk_bf16_f32 v91, 0, v91
    v_pk_mul_f32 v[184:185], v[88:89], s[60:61]
    v_pk_mul_f32 v[186:187], v[90:91], s[60:61]
    v_exp_f32 v184, v184
    v_exp_f32 v185, v185
    v_exp_f32 v186, v186
    v_exp_f32 v187, v187
    v_cvt_pk_bf16_f32 v92, 0, v92
    v_cvt_pk_bf16_f32 v93, 0, v93
    v_cvt_pk_bf16_f32 v94, 0, v94
    v_cvt_pk_bf16_f32 v95, 0, v95
    v_pk_add_f32 v[184:185], v[184:185], s[62:63]
    v_pk_add_f32 v[186:187], v[186:187], s[62:63]
    v_rcp_f32 v184, v184
    v_rcp_f32 v185, v185
    v_rcp_f32 v186, v186
    v_rcp_f32 v187, v187
    s_nop 0
    v_pk_mul_f32 v[184:185], v[88:89], v[184:185]
    v_pk_mul_f32 v[186:187], v[90:91], v[186:187]
    v_cvt_pk_bf16_f32 v184, 0, v184
    v_cvt_pk_bf16_f32 v185, 0, v185
    v_cvt_pk_bf16_f32 v186, 0, v186
    v_cvt_pk_bf16_f32 v187, 0, v187
    v_pk_mul_f32 v[184:185], v[184:185], v[92:93]
    v_pk_mul_f32 v[186:187], v[186:187], v[94:95]
    v_cvt_pk_bf16_f32 v88, v184, v185
    v_cvt_pk_bf16_f32 v89, v186, v187
    v_cvt_pk_bf16_f32 v104, 0, v104
    v_cvt_pk_bf16_f32 v105, 0, v105
    v_cvt_pk_bf16_f32 v106, 0, v106
    v_cvt_pk_bf16_f32 v107, 0, v107
    v_pk_mul_f32 v[184:185], v[104:105], s[60:61]
    v_pk_mul_f32 v[186:187], v[106:107], s[60:61]
    v_exp_f32 v184, v184
    v_exp_f32 v185, v185
    v_exp_f32 v186, v186
    v_exp_f32 v187, v187
    v_cvt_pk_bf16_f32 v108, 0, v108
    v_cvt_pk_bf16_f32 v109, 0, v109
    v_cvt_pk_bf16_f32 v110, 0, v110
    v_cvt_pk_bf16_f32 v111, 0, v111
    v_pk_add_f32 v[184:185], v[184:185], s[62:63]
    v_pk_add_f32 v[186:187], v[186:187], s[62:63]
    v_rcp_f32 v184, v184
    v_rcp_f32 v185, v185
    v_rcp_f32 v186, v186
    v_rcp_f32 v187, v187
    s_nop 0
    v_pk_mul_f32 v[184:185], v[104:105], v[184:185]
    v_pk_mul_f32 v[186:187], v[106:107], v[186:187]
    v_cvt_pk_bf16_f32 v184, 0, v184
    v_cvt_pk_bf16_f32 v185, 0, v185
    v_cvt_pk_bf16_f32 v186, 0, v186
    v_cvt_pk_bf16_f32 v187, 0, v187
    v_pk_mul_f32 v[184:185], v[184:185], v[108:109]
    v_pk_mul_f32 v[186:187], v[186:187], v[110:111]
    v_cvt_pk_bf16_f32 v90, v184, v185
    v_cvt_pk_bf16_f32 v91, v186, v187
    buffer_store_dwordx4 v[88:91], v1, s[16:19], s35 offen offset:1024 sc1
    s_branch K1_g_end_8
K1_g_odd_7:
    v_cvt_pk_bf16_f32 v64, 0, v64
    v_cvt_pk_bf16_f32 v65, 0, v65
    v_cvt_pk_bf16_f32 v66, 0, v66
    v_cvt_pk_bf16_f32 v67, 0, v67
    v_pk_mul_f32 v[184:185], v[64:65], s[60:61]
    v_pk_mul_f32 v[186:187], v[66:67], s[60:61]
    v_exp_f32 v184, v184
    v_exp_f32 v185, v185
    v_exp_f32 v186, v186
    v_exp_f32 v187, v187
    v_cvt_pk_bf16_f32 v68, 0, v68
    v_cvt_pk_bf16_f32 v69, 0, v69
    v_cvt_pk_bf16_f32 v70, 0, v70
    v_cvt_pk_bf16_f32 v71, 0, v71
    v_pk_add_f32 v[184:185], v[184:185], s[62:63]
    v_pk_add_f32 v[186:187], v[186:187], s[62:63]
    v_rcp_f32 v184, v184
    v_rcp_f32 v185, v185
    v_rcp_f32 v186, v186
    v_rcp_f32 v187, v187
    s_nop 0
    v_pk_mul_f32 v[184:185], v[64:65], v[184:185]
    v_pk_mul_f32 v[186:187], v[66:67], v[186:187]
    v_cvt_pk_bf16_f32 v184, 0, v184
    v_cvt_pk_bf16_f32 v185, 0, v185
    v_cvt_pk_bf16_f32 v186, 0, v186
    v_cvt_pk_bf16_f32 v187, 0, v187
    v_pk_mul_f32 v[184:185], v[184:185], v[68:69]
    v_pk_mul_f32 v[186:187], v[186:187], v[70:71]
    v_cvt_pk_bf16_f32 v64, v184, v185
    v_cvt_pk_bf16_f32 v65, v186, v187
    v_cvt_pk_bf16_f32 v80, 0, v80
    v_cvt_pk_bf16_f32 v81, 0, v81
    v_cvt_pk_bf16_f32 v82, 0, v82
    v_cvt_pk_bf16_f32 v83, 0, v83
    v_pk_mul_f32 v[184:185], v[80:81], s[60:61]
    v_pk_mul_f32 v[186:187], v[82:83], s[60:61]
    v_exp_f32 v184, v184
    v_exp_f32 v185, v185
    v_exp_f32 v186, v186
    v_exp_f32 v187, v187
    v_cvt_pk_bf16_f32 v84, 0, v84
    v_cvt_pk_bf16_f32 v85, 0, v85
    v_cvt_pk_bf16_f32 v86, 0, v86
    v_cvt_pk_bf16_f32 v87, 0, v87
    v_pk_add_f32 v[184:185], v[184:185], s[62:63]
    v_pk_add_f32 v[186:187], v[186:187], s[62:63]
    v_rcp_f32 v184, v184
    v_rcp_f32 v185, v185
    v_rcp_f32 v186, v186
    v_rcp_f32 v187, v187
    s_nop 0
    v_pk_mul_f32 v[184:185], v[80:81], v[184:185]
    v_pk_mul_f32 v[186:187], v[82:83], v[186:187]
    v_cvt_pk_bf16_f32 v184, 0, v184
    v_cvt_pk_bf16_f32 v185, 0, v185
    v_cvt_pk_bf16_f32 v186, 0, v186
    v_cvt_pk_bf16_f32 v187, 0, v187
    v_pk_mul_f32 v[184:185], v[184:185], v[84:85]
    v_pk_mul_f32 v[186:187], v[186:187], v[86:87]
    v_cvt_pk_bf16_f32 v66, v184, v185
    v_cvt_pk_bf16_f32 v67, v186, v187
    buffer_store_dwordx4 v[64:67], v1, s[16:19], s35 offen offset:0 sc1
    v_cvt_pk_bf16_f32 v72, 0, v72
    v_cvt_pk_bf16_f32 v73, 0, v73
    v_cvt_pk_bf16_f32 v74, 0, v74
    v_cvt_pk_bf16_f32 v75, 0, v75
    v_pk_mul_f32 v[184:185], v[72:73], s[60:61]
    v_pk_mul_f32 v[186:187], v[74:75], s[60:61]
    v_exp_f32 v184, v184
    v_exp_f32 v185, v185
    v_exp_f32 v186, v186
    v_exp_f32 v187, v187
    v_cvt_pk_bf16_f32 v76, 0, v76
    v_cvt_pk_bf16_f32 v77, 0, v77
    v_cvt_pk_bf16_f32 v78, 0, v78
    v_cvt_pk_bf16_f32 v79, 0, v79
    v_pk_add_f32 v[184:185], v[184:185], s[62:63]
    v_pk_add_f32 v[186:187], v[186:187], s[62:63]
    v_rcp_f32 v184, v184
    v_rcp_f32 v185, v185
    v_rcp_f32 v186, v186
    v_rcp_f32 v187, v187
    s_nop 0
    v_pk_mul_f32 v[184:185], v[72:73], v[184:185]
    v_pk_mul_f32 v[186:187], v[74:75], v[186:187]
    v_cvt_pk_bf16_f32 v184, 0, v184
    v_cvt_pk_bf16_f32 v185, 0, v185
    v_cvt_pk_bf16_f32 v186, 0, v186
    v_cvt_pk_bf16_f32 v187, 0, v187
    v_pk_mul_f32 v[184:185], v[184:185], v[76:77]
    v_pk_mul_f32 v[186:187], v[186:187], v[78:79]
    v_cvt_pk_bf16_f32 v72, v184, v185
    v_cvt_pk_bf16_f32 v73, v186, v187
    v_cvt_pk_bf16_f32 v88, 0, v88
    v_cvt_pk_bf16_f32 v89, 0, v89
    v_cvt_pk_bf16_f32 v90, 0, v90
    v_cvt_pk_bf16_f32 v91, 0, v91
    v_pk_mul_f32 v[184:185], v[88:89], s[60:61]
    v_pk_mul_f32 v[186:187], v[90:91], s[60:61]
    v_exp_f32 v184, v184
    v_exp_f32 v185, v185
    v_exp_f32 v186, v186
    v_exp_f32 v187, v187
    v_cvt_pk_bf16_f32 v92, 0, v92
    v_cvt_pk_bf16_f32 v93, 0, v93
    v_cvt_pk_bf16_f32 v94, 0, v94
    v_cvt_pk_bf16_f32 v95, 0, v95
    v_pk_add_f32 v[184:185], v[184:185], s[62:63]
    v_pk_add_f32 v[186:187], v[186:187], s[62:63]
    v_rcp_f32 v184, v184
    v_rcp_f32 v185, v185
    v_rcp_f32 v186, v186
    v_rcp_f32 v187, v187
    s_nop 0
    v_pk_mul_f32 v[184:185], v[88:89], v[184:185]
    v_pk_mul_f32 v[186:187], v[90:91], v[186:187]
    v_cvt_pk_bf16_f32 v184, 0, v184
    v_cvt_pk_bf16_f32 v185, 0, v185
    v_cvt_pk_bf16_f32 v186, 0, v186
    v_cvt_pk_bf16_f32 v187, 0, v187
    v_pk_mul_f32 v[184:185], v[184:185], v[92:93]
    v_pk_mul_f32 v[186:187], v[186:187], v[94:95]
    v_cvt_pk_bf16_f32 v74, v184, v185
    v_cvt_pk_bf16_f32 v75, v186, v187
    buffer_store_dwordx4 v[72:75], v1, s[16:19], s35 offen offset:1024 sc1
K1_g_end_8:
    s_cmp_lg_u32 s20, 0
    s_cbranch_scc1 K1_nopfx2
    v_mov_b32 v176, 0
    v_mov_b32 v177, 0
    s_cmp_eq_u32 s22, 0
    s_cbranch_scc1 K1_nogather
    v_cmp_gt_u32 vcc, 18, v0
    s_and_saveexec_b64 s[50:51], vcc
K1_poll:
    s_mov_b32 s52, 46137344
    v_mov_b32 v17, s3
    v_mov_b32 v19, s3
    v_mov_b32 v21, s3
    v_mov_b32 v23, s3
    v_mov_b32 v25, s3
    v_mov_b32 v27, s3
    v_mov_b32 v29, s3
    v_mov_b32 v31, s3
    v_mov_b32 v33, s3
    v_mov_b32 v35, s3
    v_mov_b32 v37, s3
    v_mov_b32 v39, s3
    v_mov_b32 v41, s3
    v_mov_b32 v43, s3
    s_cmp_le_u32 s22, 0
    s_cbranch_scc1 K1_gld
    buffer_load_dwordx4 v[16:19], v193, s[16:19], s52 offen sc1
    s_add_u32 s52, s52, 9216
    s_cmp_le_u32 s22, 1
    s_cbranch_scc1 K1_gld
    buffer_load_dwordx4 v[20:23], v193, s[16:19], s52 offen sc1
    s_add_u32 s52, s52, 9216
    s_cmp_le_u32 s22, 2
    s_cbranch_scc1 K1_gld
    buffer_load_dwordx4 v[24:27], v193, s[16:19], s52 offen sc1
    s_add_u32 s52, s52, 9216
    s_cmp_le_u32 s22, 3
    s_cbranch_scc1 K1_gld
    buffer_load_dwordx4 v[28:31], v193, s[16:19], s52 offen sc1
    s_add_u32 s52, s52, 9216
    s_cmp_le_u32 s22, 4
    s_cbranch_scc1 K1_gld
    buffer_load_dwordx4 v[32:35], v193, s[16:19], s52 offen sc1
    s_add_u32 s52, s52, 9216
    s_cmp_le_u32 s22, 5
    s_cbranch_scc1 K1_gld
    buffer_load_dwordx4 v[36:39], v193, s[16:19], s52 offen sc1
    s_add_u32 s52, s52, 9216
    s_cmp_le_u32 s22, 6
    s_cbranch_scc1 K1_gld
    buffer_load_dwordx4 v[40:43], v193, s[16:19], s52 offen sc1
    s_add_u32 s52, s52, 9216
K1_gld:
    s_waitcnt vmcnt(0)
    v_mov_b32 v194, 0
    v_xor_b32 v195, s3, v17
    v_or_b32 v194, v194, v195
    v_xor_b32 v195, s3, v19
    v_or_b32 v194, v194, v195
    v_xor_b32 v195, s3, v21
    v_or_b32 v194, v194, v195
    v_xor_b32 v195, s3, v23
    v_or_b32 v194, v194, v195
    v_xor_b32 v195, s3, v25
    v_or_b32 v194, v194, v195
    v_xor_b32 v195, s3, v27
    v_or_b32 v194, v194, v195
    v_xor_b32 v195, s3, v29
    v_or_b32 v194, v194, v195
    v_xor_b32 v195, s3, v31
    v_or_b32 v194, v194, v195
    v_xor_b32 v195, s3, v33
    v_or_b32 v194, v194, v195
    v_xor_b32 v195, s3, v35
    v_or_b32 v194, v194, v195
    v_xor_b32 v195, s3, v37
    v_or_b32 v194, v194, v195
    v_xor_b32 v195, s3, v39
    v_or_b32 v194, v194, v195
    v_xor_b32 v195, s3, v41
    v_or_b32 v194, v194, v195
    v_xor_b32 v195, s3, v43
    v_or_b32 v194, v194, v195
    v_cmp_ne_u32 vcc, 0, v194
    s_nop 4
    s_cbranch_vccz K1_polled
    s_sleep 2
    s_branch K1_poll
K1_polled:
    v_mov_b32 v160, v16
    v_mov_b32 v161, v18
    v_mov_b32 v162, v20
    v_mov_b32 v163, v22
    v_mov_b32 v164, v24
    v_mov_b32 v165, v26
    v_mov_b32 v166, v28
    v_mov_b32 v167, v30
    v_mov_b32 v168, v32
    v_mov_b32 v169, v34
    v_mov_b32 v170, v36
    v_mov_b32 v171, v38
    v_mov_b32 v172, v40
    v_mov_b32 v173, v42
    s_cmp_le_u32 s22, 0
    s_cbranch_scc1 K1_gdn
    v_fmac_f32 v160, v190, v176
    v_fmac_f32 v161, v190, v177
    v_fma_f32 v160, -v191, v177, v160
    v_fmac_f32 v161, v191, v176
    v_mov_b32 v176, v160
    v_mov_b32 v177, v161
    s_cmp_le_u32 s22, 1
    s_cbranch_scc1 K1_gdn
    v_fmac_f32 v162, v190, v176
    v_fmac_f32 v163, v190, v177
    v_fma_f32 v162, -v191, v177, v162
    v_fmac_f32 v163, v191, v176
    v_mov_b32 v176, v162
    v_mov_b32 v177, v163
    s_cmp_le_u32 s22, 2
    s_cbranch_scc1 K1_gdn
    v_fmac_f32 v164, v190, v176
    v_fmac_f32 v165, v190, v177
    v_fma_f32 v164, -v191, v177, v164
    v_fmac_f32 v165, v191, v176
    v_mov_b32 v176, v164
    v_mov_b32 v177, v165
    s_cmp_le_u32 s22, 3
    s_cbranch_scc1 K1_gdn
    v_fmac_f32 v166, v190, v176
    v_fmac_f32 v167, v190, v177
    v_fma_f32 v166, -v191, v177, v166
    v_fmac_f32 v167, v191, v176
    v_mov_b32 v176, v166
    v_mov_b32 v177, v167
    s_cmp_le_u32 s22, 4
    s_cbranch_scc1 K1_gdn
    v_fmac_f32 v168, v190, v176
    v_fmac_f32 v169, v190, v177
    v_fma_f32 v168, -v191, v177, v168
    v_fmac_f32 v169, v191, v176
    v_mov_b32 v176, v168
    v_mov_b32 v177, v169
    s_cmp_le_u32 s22, 5
    s_cbranch_scc1 K1_gdn
    v_fmac_f32 v170, v190, v176
    v_fmac_f32 v171, v190, v177
    v_fma_f32 v170, -v191, v177, v170
    v_fmac_f32 v171, v191, v176
    v_mov_b32 v176, v170
    v_mov_b32 v177, v171
    s_cmp_le_u32 s22, 6
    s_cbranch_scc1 K1_gdn
    v_fmac_f32 v172, v190, v176
    v_fmac_f32 v173, v190, v177
    v_fma_f32 v172, -v191, v177, v172
    v_fmac_f32 v173, v191, v176
    v_mov_b32 v176, v172
    v_mov_b32 v177, v173
K1_gdn:
    s_mov_b64 exec, s[50:51]
K1_nogather:
    v_cmp_gt_u32 vcc, 18, v0
    s_and_saveexec_b64 s[50:51], vcc
    ds_read_b64 v[160:161], v192 offset:0
    ds_read_b64 v[162:163], v192 offset:144
    ds_read_b64 v[164:165], v192 offset:288
    ds_read_b64 v[166:167], v192 offset:432
    ds_read_b64 v[168:169], v192 offset:576
    ds_read_b64 v[170:171], v192 offset:720
    ds_read_b64 v[172:173], v192 offset:864
    ds_read_b64 v[174:175], v192 offset:1008
    s_waitcnt lgkmcnt(0)
    ds_write_b64 v192, v[176:177] offset:0
    v_fmac_f32 v160, v188, v176
    v_fmac_f32 v161, v188, v177
    v_fma_f32 v160, -v189, v177, v160
    v_fmac_f32 v161, v189, v176
    ds_write_b64 v192, v[160:161] offset:144
    v_fmac_f32 v162, v188, v160
    v_fmac_f32 v163, v188, v161
    v_fma_f32 v162, -v189, v161, v162
    v_fmac_f32 v163, v189, v160
    ds_write_b64 v192, v[162:163] offset:288
    v_fmac_f32 v164, v188, v162
    v_fmac_f32 v165, v188, v163
    v_fma_f32 v164, -v189, v163, v164
    v_fmac_f32 v165, v189, v162
    ds_write_b64 v192, v[164:165] offset:432
    v_fmac_f32 v166, v188, v164
    v_fmac_f32 v167, v188, v165
    v_fma_f32 v166, -v189, v165, v166
    v_fmac_f32 v167, v189, v164
    ds_write_b64 v192, v[166:167] offset:576
    v_fmac_f32 v168, v188, v166
    v_fmac_f32 v169, v188, v167
    v_fma_f32 v168, -v189, v167, v168
    v_fmac_f32 v169, v189, v166
    ds_write_b64 v192, v[168:169] offset:720
    v_fmac_f32 v170, v188, v168
    v_fmac_f32 v171, v188, v169
    v_fma_f32 v170, -v189, v169, v170
    v_fmac_f32 v171, v189, v168
    ds_write_b64 v192, v[170:171] offset:864
    v_fmac_f32 v172, v188, v170
    v_fmac_f32 v173, v188, v171
    v_fma_f32 v172, -v189, v171, v172
    v_fmac_f32 v173, v189, v170
    ds_write_b64 v192, v[172:173] offset:1008
    v_fmac_f32 v174, v188, v172
    v_fmac_f32 v175, v188, v173
    v_fma_f32 v174, -v189, v173, v174
    v_fmac_f32 v175, v189, v172
    v_mov_b32 v176, v174
    v_mov_b32 v177, v175
    s_waitcnt lgkmcnt(0)
    ds_read_b64 v[160:161], v192 offset:1152
    ds_read_b64 v[162:163], v192 offset:1296
    ds_read_b64 v[164:165], v192 offset:1440
    ds_read_b64 v[166:167], v192 offset:1584
    ds_read_b64 v[168:169], v192 offset:1728
    ds_read_b64 v[170:171], v192 offset:1872
    ds_read_b64 v[172:173], v192 offset:2016
    ds_read_b64 v[174:175], v192 offset:2160
    s_waitcnt lgkmcnt(0)
    ds_write_b64 v192, v[176:177] offset:1152
    v_fmac_f32 v160, v188, v176
    v_fmac_f32 v161, v188, v177
    v_fma_f32 v160, -v189, v177, v160
    v_fmac_f32 v161, v189, v176
    ds_write_b64 v192, v[160:161] offset:1296
    v_fmac_f32 v162, v188, v160
    v_fmac_f32 v163, v188, v161
    v_fma_f32 v162, -v189, v161, v162
    v_fmac_f32 v163, v189, v160
    ds_write_b64 v192, v[162:163] offset:1440
    v_fmac_f32 v164, v188, v162
    v_fmac_f32 v165, v188, v163
    v_fma_f32 v164, -v189, v163, v164
    v_fmac_f32 v165, v189, v162
    ds_write_b64 v192, v[164:165] offset:1584
    v_fmac_f32 v166, v188, v164
    v_fmac_f32 v167, v188, v165
    v_fma_f32 v166, -v189, v165, v166
    v_fmac_f32 v167, v189, v164
    ds_write_b64 v192, v[166:167] offset:1728
    v_fmac_f32 v168, v188, v166
    v_fmac_f32 v169, v188, v167
    v_fma_f32 v168, -v189, v167, v168
    v_fmac_f32 v169, v189, v166
    ds_write_b64 v192, v[168:169] offset:1872
    v_fmac_f32 v170, v188, v168
    v_fmac_f32 v171, v188, v169
    v_fma_f32 v170, -v189, v169, v170
    v_fmac_f32 v171, v189, v168
    ds_write_b64 v192, v[170:171] offset:2016
    v_fmac_f32 v172, v188, v170
    v_fmac_f32 v173, v188, v171
    v_fma_f32 v172, -v189, v171, v172
    v_fmac_f32 v173, v189, v170
    ds_write_b64 v192, v[172:173] offset:2160
    v_fmac_f32 v174, v188, v172
    v_fmac_f32 v175, v188, v173
    v_fma_f32 v174, -v189, v173, v174
    v_fmac_f32 v175, v189, v172
    v_mov_b32 v176, v174
    v_mov_b32 v177, v175
    s_waitcnt lgkmcnt(0)
    s_mov_b64 exec, s[50:51]
K1_nopfx2:
    s_add_u32 s35, s32, 6144
    s_cmp_eq_u32 s33, 1
    s_cbranch_scc1 K1_g_odd_9
    v_cvt_pk_bf16_f32 v112, 0, v112
    v_cvt_pk_bf16_f32 v113, 0, v113
    v_cvt_pk_bf16_f32 v114, 0, v114
    v_cvt_pk_bf16_f32 v115, 0, v115
    v_pk_mul_f32 v[184:185], v[112:113], s[60:61]
    v_pk_mul_f32 v[186:187], v[114:115], s[60:61]
    v_exp_f32 v184, v184
    v_exp_f32 v185, v185
    v_exp_f32 v186, v186
    v_exp_f32 v187, v187
    v_cvt_pk_bf16_f32 v116, 0, v116
    v_cvt_pk_bf16_f32 v117, 0, v117
    v_cvt_pk_bf16_f32 v118, 0, v118
    v_cvt_pk_bf16_f32 v119, 0, v119
    v_pk_add_f32 v[184:185], v[184:185], s[62:63]
    v_pk_add_f32 v[186:187], v[186:187], s[62:63]
    v_rcp_f32 v184, v184
    v_rcp_f32 v185, v185
    v_rcp_f32 v186, v186
    v_rcp_f32 v187, v187
    s_nop 0
    v_pk_mul_f32 v[184:185], v[112:113], v[184:185]
    v_pk_mul_f32 v[186:187], v[114:115], v[186:187]
    v_cvt_pk_bf16_f32 v184, 0, v184
    v_cvt_pk_bf16_f32 v185, 0, v185
    v_cvt_pk_bf16_f32 v186, 0, v186
    v_cvt_pk_bf16_f32 v187, 0, v187
    v_pk_mul_f32 v[184:185], v[184:185], v[116:117]
    v_pk_mul_f32 v[186:187], v[186:187], v[118:119]
    v_cvt_pk_bf16_f32 v112, v184, v185
    v_cvt_pk_bf16_f32 v113, v186, v187
    v_cvt_pk_bf16_f32 v128, 0, v128
    v_cvt_pk_bf16_f32 v129, 0, v129
    v_cvt_pk_bf16_f32 v130, 0, v130
    v_cvt_pk_bf16_f32 v131, 0, v131
    v_pk_mul_f32 v[184:185], v[128:129], s[60:61]
    v_pk_mul_f32 v[186:187], v[130:131], s[60:61]
    v_exp_f32 v184, v184
    v_exp_f32 v185, v185
    v_exp_f32 v186, v186
    v_exp_f32 v187, v187
    v_cvt_pk_bf16_f32 v132, 0, v132
    v_cvt_pk_bf16_f32 v133, 0, v133
    v_cvt_pk_bf16_f32 v134, 0, v134
    v_cvt_pk_bf16_f32 v135, 0, v135
    v_pk_add_f32 v[184:185], v[184:185], s[62:63]
    v_pk_add_f32 v[186:187], v[186:187], s[62:63]
    v_rcp_f32 v184, v184
    v_rcp_f32 v185, v185
    v_rcp_f32 v186, v186
    v_rcp_f32 v187, v187
    s_nop 0
    v_pk_mul_f32 v[184:185], v[128:129], v[184:185]
    v_pk_mul_f32 v[186:187], v[130:131], v[186:187]
    v_cvt_pk_bf16_f32 v184, 0, v184
    v_cvt_pk_bf16_f32 v185, 0, v185
    v_cvt_pk_bf16_f32 v186, 0, v186
    v_cvt_pk_bf16_f32 v187, 0, v187
    v_pk_mul_f32 v[184:185], v[184:185], v[132:133]
    v_pk_mul_f32 v[186:187], v[186:187], v[134:135]
    v_cvt_pk_bf16_f32 v114, v184, v185
    v_cvt_pk_bf16_f32 v115, v186, v187
    buffer_store_dwordx4 v[112:115], v1, s[16:19], s35 offen offset:0 sc1
    v_cvt_pk_bf16_f32 v120, 0, v120
    v_cvt_pk_bf16_f32 v121, 0, v121
    v_cvt_pk_bf16_f32 v122, 0, v122
    v_cvt_pk_bf16_f32 v123, 0, v123
    v_pk_mul_f32 v[184:185], v[120:121], s[60:61]
    v_pk_mul_f32 v[186:187], v[122:123], s[60:61]
    v_exp_f32 v184, v184
    v_exp_f32 v185, v185
    v_exp_f32 v186, v186
    v_exp_f32 v187, v187
    v_cvt_pk_bf16_f32 v124, 0, v124
    v_cvt_pk_bf16_f32 v125, 0, v125
    v_cvt_pk_bf16_f32 v126, 0, v126
    v_cvt_pk_bf16_f32 v127, 0, v127
    v_pk_add_f32 v[184:185], v[184:185], s[62:63]
    v_pk_add_f32 v[186:187], v[186:187], s[62:63]
    v_rcp_f32 v184, v184
    v_rcp_f32 v185, v185
    v_rcp_f32 v186, v186
    v_rcp_f32 v187, v187
    s_nop 0
    v_pk_mul_f32 v[184:185], v[120:121], v[184:185]
    v_pk_mul_f32 v[186:187], v[122:123], v[186:187]
    v_cvt_pk_bf16_f32 v184, 0, v184
    v_cvt_pk_bf16_f32 v185, 0, v185
    v_cvt_pk_bf16_f32 v186, 0, v186
    v_cvt_pk_bf16_f32 v187, 0, v187
    v_pk_mul_f32 v[184:185], v[184:185], v[124:125]
    v_pk_mul_f32 v[186:187], v[186:187], v[126:127]
    v_cvt_pk_bf16_f32 v120, v184, v185
    v_cvt_pk_bf16_f32 v121, v186, v187
    v_cvt_pk_bf16_f32 v136, 0, v136
    v_cvt_pk_bf16_f32 v137, 0, v137
    v_cvt_pk_bf16_f32 v138, 0, v138
    v_cvt_pk_bf16_f32 v139, 0, v139
    v_pk_mul_f32 v[184:185], v[136:137], s[60:61]
    v_pk_mul_f32 v[186:187], v[138:139], s[60:61]
    v_exp_f32 v184, v184
    v_exp_f32 v185, v185
    v_exp_f32 v186, v186
    v_exp_f32 v187, v187
    v_cvt_pk_bf16_f32 v140, 0, v140
    v_cvt_pk_bf16_f32 v141, 0, v141
    v_cvt_pk_bf16_f32 v142, 0, v142
    v_cvt_pk_bf16_f32 v143, 0, v143
    v_pk_add_f32 v[184:185], v[184:185], s[62:63]
    v_pk_add_f32 v[186:187], v[186:187], s[62:63]
    v_rcp_f32 v184, v184
    v_rcp_f32 v185, v185
    v_rcp_f32 v186, v186
    v_rcp_f32 v187, v187
    s_nop 0
    v_pk_mul_f32 v[184:185], v[136:137], v[184:185]
    v_pk_mul_f32 v[186:187], v[138:139], v[186:187]
    v_cvt_pk_bf16_f32 v184, 0, v184
    v_cvt_pk_bf16_f32 v185, 0, v185
    v_cvt_pk_bf16_f32 v186, 0, v186
    v_cvt_pk_bf16_f32 v187, 0, v187
    v_pk_mul_f32 v[184:185], v[184:185], v[140:141]
    v_pk_mul_f32 v[186:187], v[186:187], v[142:143]
    v_cvt_pk_bf16_f32 v122, v184, v185
    v_cvt_pk_bf16_f32 v123, v186, v187
    buffer_store_dwordx4 v[120:123], v1, s[16:19], s35 offen offset:1024 sc1
    s_branch K1_g_end_10
K1_g_odd_9:
    v_cvt_pk_bf16_f32 v96, 0, v96
    v_cvt_pk_bf16_f32 v97, 0, v97
    v_cvt_pk_bf16_f32 v98, 0, v98
    v_cvt_pk_bf16_f32 v99, 0, v99
    v_pk_mul_f32 v[184:185], v[96:97], s[60:61]
    v_pk_mul_f32 v[186:187], v[98:99], s[60:61]
    v_exp_f32 v184, v184
    v_exp_f32 v185, v185
    v_exp_f32 v186, v186
    v_exp_f32 v187, v187
    v_cvt_pk_bf16_f32 v100, 0, v100
    v_cvt_pk_bf16_f32 v101, 0, v101
    v_cvt_pk_bf16_f32 v102, 0, v102
    v_cvt_pk_bf16_f32 v103, 0, v103
    v_pk_add_f32 v[184:185], v[184:185], s[62:63]
    v_pk_add_f32 v[186:187], v[186:187], s[62:63]
    v_rcp_f32 v184, v184
    v_rcp_f32 v185, v185
    v_rcp_f32 v186, v186
    v_rcp_f32 v187, v187
    s_nop 0
    v_pk_mul_f32 v[184:185], v[96:97], v[184:185]
    v_pk_mul_f32 v[186:187], v[98:99], v[186:187]
    v_cvt_pk_bf16_f32 v184, 0, v184
    v_cvt_pk_bf16_f32 v185, 0, v185
    v_cvt_pk_bf16_f32 v186, 0, v186
    v_cvt_pk_bf16_f32 v187, 0, v187
    v_pk_mul_f32 v[184:185], v[184:185], v[100:101]
    v_pk_mul_f32 v[186:187], v[186:187], v[102:103]
    v_cvt_pk_bf16_f32 v96, v184, v185
    v_cvt_pk_bf16_f32 v97, v186, v187
    v_cvt_pk_bf16_f32 v112, 0, v112
    v_cvt_pk_bf16_f32 v113, 0, v113
    v_cvt_pk_bf16_f32 v114, 0, v114
    v_cvt_pk_bf16_f32 v115, 0, v115
    v_pk_mul_f32 v[184:185], v[112:113], s[60:61]
    v_pk_mul_f32 v[186:187], v[114:115], s[60:61]
    v_exp_f32 v184, v184
    v_exp_f32 v185, v185
    v_exp_f32 v186, v186
    v_exp_f32 v187, v187
    v_cvt_pk_bf16_f32 v116, 0, v116
    v_cvt_pk_bf16_f32 v117, 0, v117
    v_cvt_pk_bf16_f32 v118, 0, v118
    v_cvt_pk_bf16_f32 v119, 0, v119
    v_pk_add_f32 v[184:185], v[184:185], s[62:63]
    v_pk_add_f32 v[186:187], v[186:187], s[62:63]
    v_rcp_f32 v184, v184
    v_rcp_f32 v185, v185
    v_rcp_f32 v186, v186
    v_rcp_f32 v187, v187
    s_nop 0
    v_pk_mul_f32 v[184:185], v[112:113], v[184:185]
    v_pk_mul_f32 v[186:187], v[114:115], v[186:187]
    v_cvt_pk_bf16_f32 v184, 0, v184
    v_cvt_pk_bf16_f32 v185, 0, v185
    v_cvt_pk_bf16_f32 v186, 0, v186
    v_cvt_pk_bf16_f32 v187, 0, v187
    v_pk_mul_f32 v[184:185], v[184:185], v[116:117]
    v_pk_mul_f32 v[186:187], v[186:187], v[118:119]
    v_cvt_pk_bf16_f32 v98, v184, v185
    v_cvt_pk_bf16_f32 v99, v186, v187
    buffer_store_dwordx4 v[96:99], v1, s[16:19], s35 offen offset:0 sc1
    v_cvt_pk_bf16_f32 v104, 0, v104
    v_cvt_pk_bf16_f32 v105, 0, v105
    v_cvt_pk_bf16_f32 v106, 0, v106
    v_cvt_pk_bf16_f32 v107, 0, v107
    v_pk_mul_f32 v[184:185], v[104:105], s[60:61]
    v_pk_mul_f32 v[186:187], v[106:107], s[60:61]
    v_exp_f32 v184, v184
    v_exp_f32 v185, v185
    v_exp_f32 v186, v186
    v_exp_f32 v187, v187
    v_cvt_pk_bf16_f32 v108, 0, v108
    v_cvt_pk_bf16_f32 v109, 0, v109
    v_cvt_pk_bf16_f32 v110, 0, v110
    v_cvt_pk_bf16_f32 v111, 0, v111
    v_pk_add_f32 v[184:185], v[184:185], s[62:63]
    v_pk_add_f32 v[186:187], v[186:187], s[62:63]
    v_rcp_f32 v184, v184
    v_rcp_f32 v185, v185
    v_rcp_f32 v186, v186
    v_rcp_f32 v187, v187
    s_nop 0
    v_pk_mul_f32 v[184:185], v[104:105], v[184:185]
    v_pk_mul_f32 v[186:187], v[106:107], v[186:187]
    v_cvt_pk_bf16_f32 v184, 0, v184
    v_cvt_pk_bf16_f32 v185, 0, v185
    v_cvt_pk_bf16_f32 v186, 0, v186
    v_cvt_pk_bf16_f32 v187, 0, v187
    v_pk_mul_f32 v[184:185], v[184:185], v[108:109]
    v_pk_mul_f32 v[186:187], v[186:187], v[110:111]
    v_cvt_pk_bf16_f32 v104, v184, v185
    v_cvt_pk_bf16_f32 v105, v186, v187
    v_cvt_pk_bf16_f32 v120, 0, v120
    v_cvt_pk_bf16_f32 v121, 0, v121
    v_cvt_pk_bf16_f32 v122, 0, v122
    v_cvt_pk_bf16_f32 v123, 0, v123
    v_pk_mul_f32 v[184:185], v[120:121], s[60:61]
    v_pk_mul_f32 v[186:187], v[122:123], s[60:61]
    v_exp_f32 v184, v184
    v_exp_f32 v185, v185
    v_exp_f32 v186, v186
    v_exp_f32 v187, v187
    v_cvt_pk_bf16_f32 v124, 0, v124
    v_cvt_pk_bf16_f32 v125, 0, v125
    v_cvt_pk_bf16_f32 v126, 0, v126
    v_cvt_pk_bf16_f32 v127, 0, v127
    v_pk_add_f32 v[184:185], v[184:185], s[62:63]
    v_pk_add_f32 v[186:187], v[186:187], s[62:63]
    v_rcp_f32 v184, v184
    v_rcp_f32 v185, v185
    v_rcp_f32 v186, v186
    v_rcp_f32 v187, v187
    s_nop 0
    v_pk_mul_f32 v[184:185], v[120:121], v[184:185]
    v_pk_mul_f32 v[186:187], v[122:123], v[186:187]
    v_cvt_pk_bf16_f32 v184, 0, v184
    v_cvt_pk_bf16_f32 v185, 0, v185
    v_cvt_pk_bf16_f32 v186, 0, v186
    v_cvt_pk_bf16_f32 v187, 0, v187
    v_pk_mul_f32 v[184:185], v[184:185], v[124:125]
    v_pk_mul_f32 v[186:187], v[186:187], v[126:127]
    v_cvt_pk_bf16_f32 v106, v184, v185
    v_cvt_pk_bf16_f32 v107, v186, v187
    buffer_store_dwordx4 v[104:107], v1, s[16:19], s35 offen offset:1024 sc1
K1_g_end_10:
    s_add_u32 s35, s32, 8192
    s_cmp_eq_u32 s33, 1
    s_cbranch_scc1 K1_g_odd_11
    v_cvt_pk_bf16_f32 v144, 0, v144
    v_cvt_pk_bf16_f32 v145, 0, v145
    v_cvt_pk_bf16_f32 v146, 0, v146
    v_cvt_pk_bf16_f32 v147, 0, v147
    v_pk_mul_f32 v[184:185], v[144:145], s[60:61]
    v_pk_mul_f32 v[186:187], v[146:147], s[60:61]
    v_exp_f32 v184, v184
    v_exp_f32 v185, v185
    v_exp_f32 v186, v186
    v_exp_f32 v187, v187
    v_cvt_pk_bf16_f32 v148, 0, v148
    v_cvt_pk_bf16_f32 v149, 0, v149
    v_cvt_pk_bf16_f32 v150, 0, v150
    v_cvt_pk_bf16_f32 v151, 0, v151
    v_pk_add_f32 v[184:185], v[184:185], s[62:63]
    v_pk_add_f32 v[186:187], v[186:187], s[62:63]
    v_rcp_f32 v184, v184
    v_rcp_f32 v185, v185
    v_rcp_f32 v186, v186
    v_rcp_f32 v187, v187
    s_nop 0
    v_pk_mul_f32 v[184:185], v[144:145], v[184:185]
    v_pk_mul_f32 v[186:187], v[146:147], v[186:187]
    v_cvt_pk_bf16_f32 v184, 0, v184
    v_cvt_pk_bf16_f32 v185, 0, v185
    v_cvt_pk_bf16_f32 v186, 0, v186
    v_cvt_pk_bf16_f32 v187, 0, v187
    v_pk_mul_f32 v[184:185], v[184:185], v[148:149]
    v_pk_mul_f32 v[186:187], v[186:187], v[150:151]
    v_cvt_pk_bf16_f32 v144, v184, v185
    v_cvt_pk_bf16_f32 v145, v186, v187
    buffer_store_dwordx2 v[144:145], v1, s[16:19], s35 offen offset:0 sc1
    v_cvt_pk_bf16_f32 v152, 0, v152
    v_cvt_pk_bf16_f32 v153, 0, v153
    v_cvt_pk_bf16_f32 v154, 0, v154
    v_cvt_pk_bf16_f32 v155, 0, v155
    v_pk_mul_f32 v[184:185], v[152:153], s[60:61]
    v_pk_mul_f32 v[186:187], v[154:155], s[60:61]
    v_exp_f32 v184, v184
    v_exp_f32 v185, v185
    v_exp_f32 v186, v186
    v_exp_f32 v187, v187
    v_cvt_pk_bf16_f32 v156, 0, v156
    v_cvt_pk_bf16_f32 v157, 0, v157
    v_cvt_pk_bf16_f32 v158, 0, v158
    v_cvt_pk_bf16_f32 v159, 0, v159
    v_pk_add_f32 v[184:185], v[184:185], s[62:63]
    v_pk_add_f32 v[186:187], v[186:187], s[62:63]
    v_rcp_f32 v184, v184
    v_rcp_f32 v185, v185
    v_rcp_f32 v186, v186
    v_rcp_f32 v187, v187
    s_nop 0
    v_pk_mul_f32 v[184:185], v[152:153], v[184:185]
    v_pk_mul_f32 v[186:187], v[154:155], v[186:187]
    v_cvt_pk_bf16_f32 v184, 0, v184
    v_cvt_pk_bf16_f32 v185, 0, v185
    v_cvt_pk_bf16_f32 v186, 0, v186
    v_cvt_pk_bf16_f32 v187, 0, v187
    v_pk_mul_f32 v[184:185], v[184:185], v[156:157]
    v_pk_mul_f32 v[186:187], v[186:187], v[158:159]
    v_cvt_pk_bf16_f32 v152, v184, v185
    v_cvt_pk_bf16_f32 v153, v186, v187
    buffer_store_dwordx2 v[152:153], v1, s[16:19], s35 offen offset:1024 sc1
    s_branch K1_g_end_12
K1_g_odd_11:
    v_cvt_pk_bf16_f32 v128, 0, v128
    v_cvt_pk_bf16_f32 v129, 0, v129
    v_cvt_pk_bf16_f32 v130, 0, v130
    v_cvt_pk_bf16_f32 v131, 0, v131
    v_pk_mul_f32 v[184:185], v[128:129], s[60:61]
    v_pk_mul_f32 v[186:187], v[130:131], s[60:61]
    v_exp_f32 v184, v184
    v_exp_f32 v185, v185
    v_exp_f32 v186, v186
    v_exp_f32 v187, v187
    v_cvt_pk_bf16_f32 v132, 0, v132
    v_cvt_pk_bf16_f32 v133, 0, v133
    v_cvt_pk_bf16_f32 v134, 0, v134
    v_cvt_pk_bf16_f32 v135, 0, v135
    v_pk_add_f32 v[184:185], v[184:185], s[62:63]
    v_pk_add_f32 v[186:187], v[186:187], s[62:63]
    v_rcp_f32 v184, v184
    v_rcp_f32 v185, v185
    v_rcp_f32 v186, v186
    v_rcp_f32 v187, v187
    s_nop 0
    v_pk_mul_f32 v[184:185], v[128:129], v[184:185]
    v_pk_mul_f32 v[186:187], v[130:131], v[186:187]
    v_cvt_pk_bf16_f32 v184, 0, v184
    v_cvt_pk_bf16_f32 v185, 0, v185
    v_cvt_pk_bf16_f32 v186, 0, v186
    v_cvt_pk_bf16_f32 v187, 0, v187
    v_pk_mul_f32 v[184:185], v[184:185], v[132:133]
    v_pk_mul_f32 v[186:187], v[186:187], v[134:135]
    v_cvt_pk_bf16_f32 v128, v184, v185
    v_cvt_pk_bf16_f32 v129, v186, v187
    v_cvt_pk_bf16_f32 v144, 0, v144
    v_cvt_pk_bf16_f32 v145, 0, v145
    v_cvt_pk_bf16_f32 v146, 0, v146
    v_cvt_pk_bf16_f32 v147, 0, v147
    v_pk_mul_f32 v[184:185], v[144:145], s[60:61]
    v_pk_mul_f32 v[186:187], v[146:147], s[60:61]
    v_exp_f32 v184, v184
    v_exp_f32 v185, v185
    v_exp_f32 v186, v186
    v_exp_f32 v187, v187
    v_cvt_pk_bf16_f32 v148, 0, v148
    v_cvt_pk_bf16_f32 v149, 0, v149
    v_cvt_pk_bf16_f32 v150, 0, v150
    v_cvt_pk_bf16_f32 v151, 0, v151
    v_pk_add_f32 v[184:185], v[184:185], s[62:63]
    v_pk_add_f32 v[186:187], v[186:187], s[62:63]
    v_rcp_f32 v184, v184
    v_rcp_f32 v185, v185
    v_rcp_f32 v186, v186
    v_rcp_f32 v187, v187
    s_nop 0
    v_pk_mul_f32 v[184:185], v[144:145], v[184:185]
    v_pk_mul_f32 v[186:187], v[146:147], v[186:187]
    v_cvt_pk_bf16_f32 v184, 0, v184
    v_cvt_pk_bf16_f32 v185, 0, v185
    v_cvt_pk_bf16_f32 v186, 0, v186
    v_cvt_pk_bf16_f32 v187, 0, v187
    v_pk_mul_f32 v[184:185], v[184:185], v[148:149]
    v_pk_mul_f32 v[186:187], v[186:187], v[150:151]
    v_cvt_pk_bf16_f32 v130, v184, v185
    v_cvt_pk_bf16_f32 v131, v186, v187
    buffer_store_dwordx4 v[128:131], v1, s[16:19], s35 offen offset:0 sc1
    v_cvt_pk_bf16_f32 v136, 0, v136
    v_cvt_pk_bf16_f32 v137, 0, v137
    v_cvt_pk_bf16_f32 v138, 0, v138
    v_cvt_pk_bf16_f32 v139, 0, v139
    v_pk_mul_f32 v[184:185], v[136:137], s[60:61]
    v_pk_mul_f32 v[186:187], v[138:139], s[60:61]
    v_exp_f32 v184, v184
    v_exp_f32 v185, v185
    v_exp_f32 v186, v186
    v_exp_f32 v187, v187
    v_cvt_pk_bf16_f32 v140, 0, v140
    v_cvt_pk_bf16_f32 v141, 0, v141
    v_cvt_pk_bf16_f32 v142, 0, v142
    v_cvt_pk_bf16_f32 v143, 0, v143
    v_pk_add_f32 v[184:185], v[184:185], s[62:63]
    v_pk_add_f32 v[186:187], v[186:187], s[62:63]
    v_rcp_f32 v184, v184
    v_rcp_f32 v185, v185
    v_rcp_f32 v186, v186
    v_rcp_f32 v187, v187
    s_nop 0
    v_pk_mul_f32 v[184:185], v[136:137], v[184:185]
    v_pk_mul_f32 v[186:187], v[138:139], v[186:187]
    v_cvt_pk_bf16_f32 v184, 0, v184
    v_cvt_pk_bf16_f32 v185, 0, v185
    v_cvt_pk_bf16_f32 v186, 0, v186
    v_cvt_pk_bf16_f32 v187, 0, v187
    v_pk_mul_f32 v[184:185], v[184:185], v[140:141]
    v_pk_mul_f32 v[186:187], v[186:187], v[142:143]
    v_cvt_pk_bf16_f32 v136, v184, v185
    v_cvt_pk_bf16_f32 v137, v186, v187
    v_cvt_pk_bf16_f32 v152, 0, v152
    v_cvt_pk_bf16_f32 v153, 0, v153
    v_cvt_pk_bf16_f32 v154, 0, v154
    v_cvt_pk_bf16_f32 v155, 0, v155
    v_pk_mul_f32 v[184:185], v[152:153], s[60:61]
    v_pk_mul_f32 v[186:187], v[154:155], s[60:61]
    v_exp_f32 v184, v184
    v_exp_f32 v185, v185
    v_exp_f32 v186, v186
    v_exp_f32 v187, v187
    v_cvt_pk_bf16_f32 v156, 0, v156
    v_cvt_pk_bf16_f32 v157, 0, v157
    v_cvt_pk_bf16_f32 v158, 0, v158
    v_cvt_pk_bf16_f32 v159, 0, v159
    v_pk_add_f32 v[184:185], v[184:185], s[62:63]
    v_pk_add_f32 v[186:187], v[186:187], s[62:63]
    v_rcp_f32 v184, v184
    v_rcp_f32 v185, v185
    v_rcp_f32 v186, v186
    v_rcp_f32 v187, v187
    s_nop 0
    v_pk_mul_f32 v[184:185], v[152:153], v[184:185]
    v_pk_mul_f32 v[186:187], v[154:155], v[186:187]
    v_cvt_pk_bf16_f32 v184, 0, v184
    v_cvt_pk_bf16_f32 v185, 0, v185
    v_cvt_pk_bf16_f32 v186, 0, v186
    v_cvt_pk_bf16_f32 v187, 0, v187
    v_pk_mul_f32 v[184:185], v[184:185], v[156:157]
    v_pk_mul_f32 v[186:187], v[186:187], v[158:159]
    v_cvt_pk_bf16_f32 v138, v184, v185
    v_cvt_pk_bf16_f32 v139, v186, v187
    buffer_store_dwordx4 v[136:139], v1, s[16:19], s35 offen offset:1024 sc1
K1_g_end_12:
KM_nochk:
    s_lshr_b32 s50, s20, 1
    s_and_b32 s51, s20, 1
    s_lshl_b32 s53, s51, 1
    s_sub_u32 s53, s53, s33
    s_lshl_b32 s52, s50, 6
    v_add_u32 v184, s52, v0
    v_mul_u32_u24 v185, 208, v184
    s_lshl_b32 s54, s53, 3
    s_add_u32 s54, s54, 16384
    v_add_u32 v185, s54, v185
    v_and_b32 v186, 15, v0
    v_lshlrev_b32 v186, 3, v186
    s_mul_i32 s54, s53, 320
    s_add_u32 s54, s54, 124416
    v_add_u32 v186, s54, v186
    v_mov_b32 v188, s54
    v_lshrrev_b32 v187, 4, v184
    v_mul_u32_u24 v187, 144, v187
    s_lshl_b32 s55, s53, 4
    s_add_u32 s55, s55, 69632
    v_add_u32 v187, s55, v187
    v_lshrrev_b32 v189, 5, v0
    v_mul_u32_u24 v189, 368640, v189
    v_bfe_u32 v190, v0, 4, 1
    v_lshl_add_u32 v189, v190, 10, v189
    v_and_b32 v190, 15, v0
    v_lshl_add_u32 v189, v190, 4, v189
    s_lshl_b32 s56, s22, 3
    s_lshl_b32 s57, s50, 1
    s_add_u32 s56, s56, s57
    s_mul_i32 s56, s56, 180
    s_add_u32 s56, s56, 144
    s_lshl_b32 s56, s56, 11
    s_add_u32 s56, s56, 4194304
    s_mul_i32 s55, s21, 9
    s_add_u32 s55, s55, s53
    s_lshr_b32 s55, s55, 1
    ds_read_b64 v[16:17], v185 offset:0
    ds_read_b64 v[18:19], v185 offset:72
    ds_read_b64 v[20:21], v186 offset:32
    ds_read_b64 v[22:23], v186 offset:192
    ds_read_b64 v[28:29], v188 offset:8
    ds_read_b64 v[30:31], v188 offset:168
    ds_read_b64 v[32:33], v185 offset:8
    ds_read_b64 v[34:35], v185 offset:80
    ds_read_b64 v[36:37], v186 offset:352
    ds_read_b64 v[38:39], v186 offset:512
    ds_read_b64 v[44:45], v188 offset:328
    ds_read_b64 v[46:47], v188 offset:488
    s_waitcnt lgkmcnt(0)
    ds_read_b64 v[48:49], v185 offset:32
    ds_read_b64 v[50:51], v185 offset:104
    ds_read_b64 v[52:53], v186 offset:1312
    ds_read_b64 v[54:55], v186 offset:1472
    ds_read_b64 v[60:61], v188 offset:1288
    ds_read_b64 v[62:63], v188 offset:1448
    ds_read_b64 v[64:65], v185 offset:40
    ds_read_b64 v[66:67], v185 offset:112
    ds_read_b64 v[68:69], v186 offset:1632
    ds_read_b64 v[70:71], v186 offset:1792
    ds_read_b64 v[76:77], v188 offset:1608
    ds_read_b64 v[78:79], v188 offset:1768
    s_waitcnt lgkmcnt(0)
    ds_read_b64 v[80:81], v185 offset:64
    ds_read_b64 v[82:83], v185 offset:136
    ds_read_b64 v[84:85], v186 offset:2592
    ds_read_b64 v[86:87], v186 offset:2752
    ds_read_b64 v[92:93], v188 offset:2568
    ds_read_b64 v[94:95], v188 offset:2728
    ds_read_b64 v[96:97], v185 offset:72
    ds_read_b64 v[98:99], v185 offset:144
    ds_read_b64 v[100:101], v186 offset:2912
    ds_read_b64 v[102:103], v186 offset:3072
    ds_read_b64 v[108:109], v188 offset:2888
    ds_read_b64 v[110:111], v188 offset:3048
    s_waitcnt lgkmcnt(0)
    s_waitcnt vmcnt(0)
    s_barrier
    s_cmp_lg_u32 s20, 7
    s_cbranch_scc1 KM_nf3
    s_mov_b64 exec, 1
    s_add_u32 s100, s3, 3
    v_mov_b32 v191, s100
    v_mov_b32 v192, 0
    buffer_store_dword v191, v192, s[16:19], s101 offen sc1
    s_mov_b64 exec, -1
KM_nf3:
    ds_read_b128 v[24:27], v187 offset:0
    ds_read_b128 v[40:43], v187 offset:16
    ds_read_b128 v[56:59], v187 offset:64
    ds_read_b128 v[72:75], v187 offset:80
    ds_read_b128 v[88:91], v187 offset:128
    ds_read_b128 v[104:107], v187 offset:144
    s_add_u32 s57, s55, 0
    s_lshr_b32 s58, s57, 2
    s_lshl_b32 s58, s58, 11
    s_add_u32 s58, s58, s56
    s_and_b32 s59, s57, 3
    s_lshl_b32 s59, s59, 8
    s_add_u32 s58, s58, s59
    s_waitcnt lgkmcnt(4)
    v_fmac_f32 v16, v20, v24
    v_fmac_f32 v18, v20, v25
    v_fma_f32 v16, -v21, v25, v16
    v_fmac_f32 v18, v21, v24
    v_mul_f32 v20, v28, v16
    v_mul_f32 v21, v28, v18
    v_fma_f32 v20, -v29, v18, v20
    v_fmac_f32 v21, v29, v16
    v_fmac_f32 v17, v22, v26
    v_fmac_f32 v19, v22, v27
    v_fma_f32 v17, -v23, v27, v17
    v_fmac_f32 v19, v23, v26
    v_mul_f32 v22, v30, v17
    v_mul_f32 v23, v30, v19
    v_fma_f32 v22, -v31, v19, v22
    v_fmac_f32 v23, v31, v17
    v_cvt_pk_bf16_f32 v16, v20, v21
    v_cvt_pk_bf16_f32 v17, v22, v23
    v_fmac_f32 v32, v36, v40
    v_fmac_f32 v34, v36, v41
    v_fma_f32 v32, -v37, v41, v32
    v_fmac_f32 v34, v37, v40
    v_mul_f32 v36, v44, v32
    v_mul_f32 v37, v44, v34
    v_fma_f32 v36, -v45, v34, v36
    v_fmac_f32 v37, v45, v32
    v_fmac_f32 v33, v38, v42
    v_fmac_f32 v35, v38, v43
    v_fma_f32 v33, -v39, v43, v33
    v_fmac_f32 v35, v39, v42
    v_mul_f32 v38, v46, v33
    v_mul_f32 v39, v46, v35
    v_fma_f32 v38, -v47, v35, v38
    v_fmac_f32 v39, v47, v33
    v_cvt_pk_bf16_f32 v18, v36, v37
    v_cvt_pk_bf16_f32 v19, v38, v39
    s_cmp_lt_i32 s53, 0
    s_cbranch_scc1 KF_h_13
    buffer_store_dwordx4 v[16:19], v189, s[16:19], s58 offen sc1
    s_branch KF_e_14
KF_h_13:
    buffer_store_dwordx2 v[18:19], v189, s[16:19], s58 offen offset:8 sc1
KF_e_14:
    s_add_u32 s57, s55, 2
    s_lshr_b32 s58, s57, 2
    s_lshl_b32 s58, s58, 11
    s_add_u32 s58, s58, s56
    s_and_b32 s59, s57, 3
    s_lshl_b32 s59, s59, 8
    s_add_u32 s58, s58, s59
    s_waitcnt lgkmcnt(2)
    v_fmac_f32 v48, v52, v56
    v_fmac_f32 v50, v52, v57
    v_fma_f32 v48, -v53, v57, v48
    v_fmac_f32 v50, v53, v56
    v_mul_f32 v52, v60, v48
    v_mul_f32 v53, v60, v50
    v_fma_f32 v52, -v61, v50, v52
    v_fmac_f32 v53, v61, v48
    v_fmac_f32 v49, v54, v58
    v_fmac_f32 v51, v54, v59
    v_fma_f32 v49, -v55, v59, v49
    v_fmac_f32 v51, v55, v58
    v_mul_f32 v54, v62, v49
    v_mul_f32 v55, v62, v51
    v_fma_f32 v54, -v63, v51, v54
    v_fmac_f32 v55, v63, v49
    v_cvt_pk_bf16_f32 v48, v52, v53
    v_cvt_pk_bf16_f32 v49, v54, v55
    v_fmac_f32 v64, v68, v72
    v_fmac_f32 v66, v68, v73
    v_fma_f32 v64, -v69, v73, v64
    v_fmac_f32 v66, v69, v72
    v_mul_f32 v68, v76, v64
    v_mul_f32 v69, v76, v66
    v_fma_f32 v68, -v77, v66, v68
    v_fmac_f32 v69, v77, v64
    v_fmac_f32 v65, v70, v74
    v_fmac_f32 v67, v70, v75
    v_fma_f32 v65, -v71, v75, v65
    v_fmac_f32 v67, v71, v74
    v_mul_f32 v70, v78, v65
    v_mul_f32 v71, v78, v67
    v_fma_f32 v70, -v79, v67, v70
    v_fmac_f32 v71, v79, v65
    v_cvt_pk_bf16_f32 v50, v68, v69
    v_cvt_pk_bf16_f32 v51, v70, v71
    buffer_store_dwordx4 v[48:51], v189, s[16:19], s58 offen sc1
    s_cmp_eq_u32 s51, 1
    s_cbranch_scc1 K1_fin_end
    s_add_u32 s57, s55, 4
    s_lshr_b32 s58, s57, 2
    s_lshl_b32 s58, s58, 11
    s_add_u32 s58, s58, s56
    s_and_b32 s59, s57, 3
    s_lshl_b32 s59, s59, 8
    s_add_u32 s58, s58, s59
    s_waitcnt lgkmcnt(0)
    v_fmac_f32 v80, v84, v88
    v_fmac_f32 v82, v84, v89
    v_fma_f32 v80, -v85, v89, v80
    v_fmac_f32 v82, v85, v88
    v_mul_f32 v84, v92, v80
    v_mul_f32 v85, v92, v82
    v_fma_f32 v84, -v93, v82, v84
    v_fmac_f32 v85, v93, v80
    v_fmac_f32 v81, v86, v90
    v_fmac_f32 v83, v86, v91
    v_fma_f32 v81, -v87, v91, v81
    v_fmac_f32 v83, v87, v90
    v_mul_f32 v86, v94, v81
    v_mul_f32 v87, v94, v83
    v_fma_f32 v86, -v95, v83, v86
    v_fmac_f32 v87, v95, v81
    v_cvt_pk_bf16_f32 v80, v84, v85
    v_cvt_pk_bf16_f32 v81, v86, v87
    v_fmac_f32 v96, v100, v104
    v_fmac_f32 v98, v100, v105
    v_fma_f32 v96, -v101, v105, v96
    v_fmac_f32 v98, v101, v104
    v_mul_f32 v100, v108, v96
    v_mul_f32 v101, v108, v98
    v_fma_f32 v100, -v109, v98, v100
    v_fmac_f32 v101, v109, v96
    v_fmac_f32 v97, v102, v106
    v_fmac_f32 v99, v102, v107
    v_fma_f32 v97, -v103, v107, v97
    v_fmac_f32 v99, v103, v106
    v_mul_f32 v102, v110, v97
    v_mul_f32 v103, v110, v99
    v_fma_f32 v102, -v111, v99, v102
    v_fmac_f32 v103, v111, v97
    v_cvt_pk_bf16_f32 v82, v100, v101
    v_cvt_pk_bf16_f32 v83, v102, v103
    s_cmp_eq_u32 s33, 0
    s_cbranch_scc1 KF_h_15
    buffer_store_dwordx4 v[80:83], v189, s[16:19], s58 offen sc1
    s_branch KF_e_16
KF_h_15:
    buffer_store_dwordx2 v[80:81], v189, s[16:19], s58 offen sc1
KF_e_16:
K1_fin_end:
    s_waitcnt lgkmcnt(0)
    s_barrier
    s_cmp_lt_u32 s20, 4
    s_cbranch_scc1 KM_p2
    s_waitcnt vmcnt(0)
    s_barrier
    s_cmp_lg_u32 s20, 4
    s_cbranch_scc1 KM_exit
    s_mov_b64 exec, 1
    s_add_u32 s100, s3, 4
    v_mov_b32 v194, s100
    v_mov_b32 v195, 0
    buffer_store_dword v194, v195, s[16:19], s101 offen sc1
    s_mov_b64 exec, -1
KM_exit:
    s_endpgm
KM_p2:
    s_mov_b32 s4, s10
    s_mov_b32 s5, s11
    v_lshlrev_b32 v1, 4, v0
    s_and_b32 s23, s2, 7
    s_lshr_b32 s24, s2, 3
    s_and_b32 s25, s23, 3
    s_lshr_b32 s23, s23, 2
    s_lshl_b32 s23, s23, 3
    s_lshr_b32 s22, s24, 2
    s_add_u32 s22, s22, s23
    s_and_b32 s21, s24, 3
    s_mul_i32 s23, s20, 24
    s_mul_i32 s24, s21, 288
    s_movk_i32 s26, 3641
    s_movk_i32 s27, 1152
    v_mov_b32 v88, v0
    v_mul_lo_u32 v89, v88, s26
    v_lshrrev_b32 v89, 16, v89
    v_mul_u32_u24 v90, 18, v89
    v_sub_u32 v90, v88, v90
    v_add_u32 v89, s23, v89
    v_mul_lo_u32 v89, v89, s27
    v_lshl_add_u32 v89, v90, 4, v89
    v_add_u32 v2, s24, v89
    v_add_u32 v88, 64, v0
    v_mul_lo_u32 v89, v88, s26
    v_lshrrev_b32 v89, 16, v89
    v_mul_u32_u24 v90, 18, v89
    v_sub_u32 v90, v88, v90
    v_add_u32 v89, s23, v89
    v_mul_lo_u32 v89, v89, s27
    v_lshl_add_u32 v89, v90, 4, v89
    v_add_u32 v3, s24, v89
    v_add_u32 v88, 128, v0
    v_mul_lo_u32 v89, v88, s26
    v_lshrrev_b32 v89, 16, v89
    v_mul_u32_u24 v90, 18, v89
    v_sub_u32 v90, v88, v90
    v_add_u32 v89, s23, v89
    v_mul_lo_u32 v89, v89, s27
    v_lshl_add_u32 v89, v90, 4, v89
    v_add_u32 v4, s24, v89
    v_add_u32 v88, 192, v0
    v_mul_lo_u32 v89, v88, s26
    v_lshrrev_b32 v89, 16, v89
    v_mul_u32_u24 v90, 18, v89
    v_sub_u32 v90, v88, v90
    v_add_u32 v89, s23, v89
    v_mul_lo_u32 v89, v89, s27
    v_lshl_add_u32 v89, v90, 4, v89
    v_add_u32 v5, s24, v89
    v_add_u32 v88, 256, v0
    v_mul_lo_u32 v89, v88, s26
    v_lshrrev_b32 v89, 16, v89
    v_mul_u32_u24 v90, 18, v89
    v_sub_u32 v90, v88, v90
    v_add_u32 v89, s23, v89
    v_mul_lo_u32 v89, v89, s27
    v_lshl_add_u32 v89, v90, 4, v89
    v_add_u32 v6, s24, v89
    v_add_u32 v88, 320, v0
    v_mul_lo_u32 v89, v88, s26
    v_lshrrev_b32 v89, 16, v89
    v_mul_u32_u24 v90, 18, v89
    v_sub_u32 v90, v88, v90
    v_add_u32 v89, s23, v89
    v_mul_lo_u32 v89, v89, s27
    v_lshl_add_u32 v89, v90, 4, v89
    v_add_u32 v7, s24, v89
    v_add_u32 v88, 384, v0
    v_mul_lo_u32 v89, v88, s26
    v_lshrrev_b32 v89, 16, v89
    v_mul_u32_u24 v90, 18, v89
    v_sub_u32 v90, v88, v90
    v_add_u32 v89, s23, v89
    v_mul_lo_u32 v89, v89, s27
    v_lshl_add_u32 v89, v90, 4, v89
    v_add_u32 v8, s24, v89
    s_mul_i32 s27, s20, 6912
    s_lshl_b32 s28, s22, 2
    s_add_u32 s28, s28, s20
    s_mul_i32 s28, s28, 180
    s_mul_i32 s29, s25, 48
    s_add_u32 s28, s28, s29
    s_lshl_b32 s28, s28, 11
    s_add_u32 s28, s28, 4194304
    s_mov_b32 s16, s8
    s_and_b32 s17, s9, 0xffff
    s_mov_b32 s18, 268435456
    s_mov_b32 s19, 0x00020000
    s_add_u32 s36, s8, 33554432
    s_addc_u32 s37, s9, 0
    s_cmp_lt_u32 s25, 3
    s_cselect_b32 s40, s4, s36
    s_cselect_b32 s41, s5, s37
    s_mov_b32 s38, 1327104
    s_cselect_b32 s42, 5308416, s38
    s_mov_b32 s43, 0x00020000
    s_mul_i32 s29, s25, 1769472
    s_cselect_b32 s29, s29, 0
    s_and_b32 s41, s41, 0xffff
    v_lshrrev_b32 v88, 2, v0
    v_mul_u32_u24 v88, 288, v88
    v_and_b32 v89, 3, v0
    v_lshl_add_u32 v9, v89, 3, v88
    v_add_u32 v10, 27648, v9
    v_add_u32 v11, 55296, v9
    v_add_u32 v12, 82944, v9
    v_add_u32 v13, 110592, v9
    s_cmp_lg_u32 s25, 3
    s_cbranch_scc1 KM_nocst
    v_lshlrev_b32 v88, 8, v0
    s_mov_b32 s49, 49283072
KM_pollc0:
    buffer_load_dword v89, v88, s[16:19], s49 offen sc1
    s_add_u32 s100, s3, 2
    s_waitcnt vmcnt(0)
    v_subrev_u32 v89, s100, v89
    v_cmp_le_u32 vcc, 6, v89
    s_nop 4
    s_cbranch_vccz KM_pollc0_ok
    s_sleep 2
    s_branch KM_pollc0
KM_pollc0_ok:
    s_mov_b32 s49, 49299456
KM_pollc1:
    buffer_load_dword v89, v88, s[16:19], s49 offen sc1
    s_add_u32 s100, s3, 2
    s_waitcnt vmcnt(0)
    v_subrev_u32 v89, s100, v89
    v_cmp_le_u32 vcc, 6, v89
    s_nop 4
    s_cbranch_vccz KM_pollc1_ok
    s_sleep 2
    s_branch KM_pollc1
KM_pollc1_ok:
    s_mov_b32 s49, 49315840
KM_pollc2:
    buffer_load_dword v89, v88, s[16:19], s49 offen sc1
    s_add_u32 s100, s3, 2
    s_waitcnt vmcnt(0)
    v_subrev_u32 v89, s100, v89
    v_cmp_le_u32 vcc, 6, v89
    s_nop 4
    s_cbranch_vccz KM_pollc2_ok
    s_sleep 2
    s_branch KM_pollc2
KM_pollc2_ok:
    s_mov_b32 s49, 49332224
KM_pollc3:
    buffer_load_dword v89, v88, s[16:19], s49 offen sc1
    s_add_u32 s100, s3, 2
    s_waitcnt vmcnt(0)
    v_subrev_u32 v89, s100, v89
    v_cmp_le_u32 vcc, 6, v89
    s_nop 4
    s_cbranch_vccz KM_pollc3_ok
    s_sleep 2
    s_branch KM_pollc3
KM_pollc3_ok:
KM_nocst:
    s_add_u32 s30, s29, 0
    s_add_u32 m0, s27, 0
    s_nop 0
    buffer_load_dwordx4 v2, s[40:43], s30 offen sc1 lds
    s_add_u32 m0, s27, 1024
    s_nop 0
    buffer_load_dwordx4 v3, s[40:43], s30 offen sc1 lds
    s_add_u32 m0, s27, 2048
    s_nop 0
    buffer_load_dwordx4 v4, s[40:43], s30 offen sc1 lds
    s_add_u32 m0, s27, 3072
    s_nop 0
    buffer_load_dwordx4 v5, s[40:43], s30 offen sc1 lds
    s_add_u32 m0, s27, 4096
    s_nop 0
    buffer_load_dwordx4 v6, s[40:43], s30 offen sc1 lds
    s_add_u32 m0, s27, 5120
    s_nop 0
    buffer_load_dwordx4 v7, s[40:43], s30 offen sc1 lds
    s_add_u32 m0, s27, 6144
    s_mov_b32 exec_hi, 0xffff
    buffer_load_dwordx4 v8, s[40:43], s30 offen sc1 lds
    s_mov_b32 exec_hi, -1
    s_add_u32 s30, s29, 110592
    s_add_u32 m0, s27, 27648
    s_nop 0
    buffer_load_dwordx4 v2, s[40:43], s30 offen sc1 lds
    s_add_u32 m0, s27, 28672
    s_nop 0
    buffer_load_dwordx4 v3, s[40:43], s30 offen sc1 lds
    s_add_u32 m0, s27, 29696
    s_nop 0
    buffer_load_dwordx4 v4, s[40:43], s30 offen sc1 lds
    s_add_u32 m0, s27, 30720
    s_nop 0
    buffer_load_dwordx4 v5, s[40:43], s30 offen sc1 lds
    s_add_u32 m0, s27, 31744
    s_nop 0
    buffer_load_dwordx4 v6, s[40:43], s30 offen sc1 lds
    s_add_u32 m0, s27, 32768
    s_nop 0
    buffer_load_dwordx4 v7, s[40:43], s30 offen sc1 lds
    s_add_u32 m0, s27, 33792
    s_mov_b32 exec_hi, 0xffff
    buffer_load_dwordx4 v8, s[40:43], s30 offen sc1 lds
    s_mov_b32 exec_hi, -1
    s_add_u32 s30, s29, 221184
    s_add_u32 m0, s27, 55296
    s_nop 0
    buffer_load_dwordx4 v2, s[40:43], s30 offen sc1 lds
    s_add_u32 m0, s27, 56320
    s_nop 0
    buffer_load_dwordx4 v3, s[40:43], s30 offen sc1 lds
    s_add_u32 m0, s27, 57344
    s_nop 0
    buffer_load_dwordx4 v4, s[40:43], s30 offen sc1 lds
    s_add_u32 m0, s27, 58368
    s_nop 0
    buffer_load_dwordx4 v5, s[40:43], s30 offen sc1 lds
    s_add_u32 m0, s27, 59392
    s_nop 0
    buffer_load_dwordx4 v6, s[40:43], s30 offen sc1 lds
    s_add_u32 m0, s27, 60416
    s_nop 0
    buffer_load_dwordx4 v7, s[40:43], s30 offen sc1 lds
    s_add_u32 m0, s27, 61440
    s_mov_b32 exec_hi, 0xffff
    buffer_load_dwordx4 v8, s[40:43], s30 offen sc1 lds
    s_mov_b32 exec_hi, -1
    s_add_u32 s30, s29, 331776
    s_add_u32 m0, s27, 82944
    s_nop 0
    buffer_load_dwordx4 v2, s[40:43], s30 offen sc1 lds
    s_add_u32 m0, s27, 83968
    s_nop 0
    buffer_load_dwordx4 v3, s[40:43], s30 offen sc1 lds
    s_add_u32 m0, s27, 84992
    s_nop 0
    buffer_load_dwordx4 v4, s[40:43], s30 offen sc1 lds
    s_add_u32 m0, s27, 86016
    s_nop 0
    buffer_load_dwordx4 v5, s[40:43], s30 offen sc1 lds
    s_add_u32 m0, s27, 87040
    s_nop 0
    buffer_load_dwordx4 v6, s[40:43], s30 offen sc1 lds
    s_add_u32 m0, s27, 88064
    s_nop 0
    buffer_load_dwordx4 v7, s[40:43], s30 offen sc1 lds
    s_add_u32 m0, s27, 89088
    s_mov_b32 exec_hi, 0xffff
    buffer_load_dwordx4 v8, s[40:43], s30 offen sc1 lds
    s_mov_b32 exec_hi, -1
    v_lshlrev_b32 v88, 8, v0
    s_lshr_b32 s44, s22, 1
    s_lshl_b32 s44, s44, 13
    s_add_u32 s44, s44, 49283072
    s_cmp_eq_u32 s25, 3
    s_cbranch_scc1 KM_p2s
    s_mov_b32 exec_hi, 0
KM_poll2:
    buffer_load_dword v89, v88, s[16:19], s44 offen sc1
    s_add_u32 s100, s3, 3
    s_waitcnt vmcnt(0)
    v_subrev_u32 v89, s100, v89
    v_cmp_le_u32 vcc, 5, v89
    s_nop 4
    s_cbranch_vccz KM_poll2_ok
    s_sleep 2
    s_branch KM_poll2
KM_poll2_ok:
    s_mov_b32 exec_hi, -1
    s_branch KM_p2e
KM_p2s:
    s_waitcnt vmcnt(0)
    s_barrier
    s_mov_b32 exec_hi, 0
KM_poll2s:
    buffer_load_dword v89, v88, s[16:19], s44 offen sc1
    s_add_u32 s100, s3, 4
    s_waitcnt vmcnt(0)
    v_subrev_u32 v89, s100, v89
    v_cmp_le_u32 vcc, 4, v89
    s_nop 4
    s_cbranch_vccz KM_poll2s_ok
    s_sleep 2
    s_branch KM_poll2s
KM_poll2s_ok:
    s_mov_b32 exec_hi, -1
KM_p2e:
    s_load_dwordx2 s[46:47], s[0:1], 0
    s_load_dwordx2 s[6:7], s[0:1], 64
    v_and_b32 v90, 15, v0
    v_lshrrev_b32 v91, 4, v0
    v_mul_u32_u24 v92, 1152, v90
    v_lshl_add_u32 v92, v91, 3, v92
    v_lshrrev_b32 v93, 1, v91
    v_lshlrev_b32 v93, 8, v93
    v_lshl_add_u32 v93, v90, 4, v93
    v_and_b32 v94, 1, v91
    v_lshl_add_u32 v93, v94, 3, v93
    v_lshlrev_b32 v94, 3, v91
    s_waitcnt lgkmcnt(0)
    s_mov_b32 s12, s46
    s_and_b32 s13, s47, 0xffff
    s_mov_b32 s14, 2359296
    s_mov_b32 s15, 0x00020000
    s_mov_b32 s36, s6
    s_and_b32 s37, s7, 0xffff
    s_mov_b32 s38, 1152
    s_mov_b32 s39, 0x00020000
    s_add_u32 s44, s20, 0
    s_min_u32 s44, s44, 17
    s_cmp_ge_u32 s44, 9
    s_cselect_b32 s45, 1, 0
    s_mul_i32 s46, s45, 9
    s_sub_u32 s46, s44, s46
    s_lshl_b32 s47, s22, 3
    s_lshl_b32 s48, s25, 1
    s_add_u32 s47, s47, s48
    s_add_u32 s47, s47, s45
    s_mul_i32 s48, s21, 9
    s_add_u32 s48, s48, s46
    s_mul_i32 s49, s47, 18432
    s_lshl_b32 s50, s48, 5
    s_add_u32 s49, s49, s50
    s_mov_b32 s52, s49
    buffer_load_dwordx2 a[0:1], v92, s[12:15], s49 offen
    s_lshr_b32 s51, s47, 1
    s_mul_i32 s51, s51, 18
    s_lshr_b32 s49, s48, 1
    s_add_u32 s51, s51, s49
    s_lshl_b32 s51, s51, 11
    s_and_b32 s49, s47, 1
    s_lshl_b32 s49, s49, 10
    s_add_u32 s51, s51, s49
    s_and_b32 s49, s48, 1
    s_lshl_b32 s49, s49, 9
    s_add_u32 s51, s51, s49
    buffer_load_dwordx2 a[2:3], v93, s[16:19], s51 offen sc1
    buffer_load_dwordx2 a[4:5], v94, s[36:39], s50 offen
    s_add_u32 s44, s20, 4
    s_min_u32 s44, s44, 17
    s_cmp_ge_u32 s44, 9
    s_cselect_b32 s45, 1, 0
    s_mul_i32 s46, s45, 9
    s_sub_u32 s46, s44, s46
    s_lshl_b32 s47, s22, 3
    s_lshl_b32 s48, s25, 1
    s_add_u32 s47, s47, s48
    s_add_u32 s47, s47, s45
    s_mul_i32 s48, s21, 9
    s_add_u32 s48, s48, s46
    s_mul_i32 s49, s47, 18432
    s_lshl_b32 s50, s48, 5
    s_add_u32 s49, s49, s50
    s_mov_b32 s53, s49
    buffer_load_dwordx2 a[6:7], v92, s[12:15], s49 offen
    s_lshr_b32 s51, s47, 1
    s_mul_i32 s51, s51, 18
    s_lshr_b32 s49, s48, 1
    s_add_u32 s51, s51, s49
    s_lshl_b32 s51, s51, 11
    s_and_b32 s49, s47, 1
    s_lshl_b32 s49, s49, 10
    s_add_u32 s51, s51, s49
    s_and_b32 s49, s48, 1
    s_lshl_b32 s49, s49, 9
    s_add_u32 s51, s51, s49
    buffer_load_dwordx2 a[8:9], v93, s[16:19], s51 offen sc1
    buffer_load_dwordx2 a[10:11], v94, s[36:39], s50 offen
    s_add_u32 s44, s20, 8
    s_min_u32 s44, s44, 17
    s_cmp_ge_u32 s44, 9
    s_cselect_b32 s45, 1, 0
    s_mul_i32 s46, s45, 9
    s_sub_u32 s46, s44, s46
    s_lshl_b32 s47, s22, 3
    s_lshl_b32 s48, s25, 1
    s_add_u32 s47, s47, s48
    s_add_u32 s47, s47, s45
    s_mul_i32 s48, s21, 9
    s_add_u32 s48, s48, s46
    s_mul_i32 s49, s47, 18432
    s_lshl_b32 s50, s48, 5
    s_add_u32 s49, s49, s50
    s_mov_b32 s54, s49
    buffer_load_dwordx2 a[12:13], v92, s[12:15], s49 offen
    s_lshr_b32 s51, s47, 1
    s_mul_i32 s51, s51, 18
    s_lshr_b32 s49, s48, 1
    s_add_u32 s51, s51, s49
    s_lshl_b32 s51, s51, 11
    s_and_b32 s49, s47, 1
    s_lshl_b32 s49, s49, 10
    s_add_u32 s51, s51, s49
    s_and_b32 s49, s48, 1
    s_lshl_b32 s49, s49, 9
    s_add_u32 s51, s51, s49
    buffer_load_dwordx2 a[14:15], v93, s[16:19], s51 offen sc1
    buffer_load_dwordx2 a[16:17], v94, s[36:39], s50 offen
    s_add_u32 s44, s20, 12
    s_min_u32 s44, s44, 17
    s_cmp_ge_u32 s44, 9
    s_cselect_b32 s45, 1, 0
    s_mul_i32 s46, s45, 9
    s_sub_u32 s46, s44, s46
    s_lshl_b32 s47, s22, 3
    s_lshl_b32 s48, s25, 1
    s_add_u32 s47, s47, s48
    s_add_u32 s47, s47, s45
    s_mul_i32 s48, s21, 9
    s_add_u32 s48, s48, s46
    s_mul_i32 s49, s47, 18432
    s_lshl_b32 s50, s48, 5
    s_add_u32 s49, s49, s50
    s_mov_b32 s55, s49
    buffer_load_dwordx2 a[18:19], v92, s[12:15], s49 offen
    s_lshr_b32 s51, s47, 1
    s_mul_i32 s51, s51, 18
    s_lshr_b32 s49, s48, 1
    s_add_u32 s51, s51, s49
    s_lshl_b32 s51, s51, 11
    s_and_b32 s49, s47, 1
    s_lshl_b32 s49, s49, 10
    s_add_u32 s51, s51, s49
    s_and_b32 s49, s48, 1
    s_lshl_b32 s49, s49, 9
    s_add_u32 s51, s51, s49
    buffer_load_dwordx2 a[20:21], v93, s[16:19], s51 offen sc1
    buffer_load_dwordx2 a[22:23], v94, s[36:39], s50 offen
    s_add_u32 s44, s20, 16
    s_min_u32 s44, s44, 17
    s_cmp_ge_u32 s44, 9
    s_cselect_b32 s45, 1, 0
    s_mul_i32 s46, s45, 9
    s_sub_u32 s46, s44, s46
    s_lshl_b32 s47, s22, 3
    s_lshl_b32 s48, s25, 1
    s_add_u32 s47, s47, s48
    s_add_u32 s47, s47, s45
    s_mul_i32 s48, s21, 9
    s_add_u32 s48, s48, s46
    s_mul_i32 s49, s47, 18432
    s_lshl_b32 s50, s48, 5
    s_add_u32 s49, s49, s50
    s_mov_b32 s56, s49
    buffer_load_dwordx2 a[24:25], v92, s[12:15], s49 offen
    s_lshr_b32 s51, s47, 1
    s_mul_i32 s51, s51, 18
    s_lshr_b32 s49, s48, 1
    s_add_u32 s51, s51, s49
    s_lshl_b32 s51, s51, 11
    s_and_b32 s49, s47, 1
    s_lshl_b32 s49, s49, 10
    s_add_u32 s51, s51, s49
    s_and_b32 s49, s48, 1
    s_lshl_b32 s49, s49, 9
    s_add_u32 s51, s51, s49
    buffer_load_dwordx2 a[26:27], v93, s[16:19], s51 offen sc1
    buffer_load_dwordx2 a[28:29], v94, s[36:39], s50 offen
    s_cmp_eq_u32 s25, 3
    s_cbranch_scc1 K2_ssm
    s_add_u32 s33, s28, 0
    buffer_load_dwordx4 v[96:99], v1, s[16:19], s33 offen offset:0 sc1
    buffer_load_dwordx4 v[100:103], v1, s[16:19], s33 offen offset:1024 sc1
    s_add_u32 s33, s28, 2048
    buffer_load_dwordx4 v[104:107], v1, s[16:19], s33 offen offset:0 sc1
    buffer_load_dwordx4 v[108:111], v1, s[16:19], s33 offen offset:1024 sc1
    s_add_u32 s33, s28, 4096
    buffer_load_dwordx4 v[112:115], v1, s[16:19], s33 offen offset:0 sc1
    buffer_load_dwordx4 v[116:119], v1, s[16:19], s33 offen offset:1024 sc1
    s_add_u32 s33, s28, 6144
    buffer_load_dwordx4 v[120:123], v1, s[16:19], s33 offen offset:0 sc1
    buffer_load_dwordx4 v[124:127], v1, s[16:19], s33 offen offset:1024 sc1
    s_add_u32 s33, s28, 8192
    buffer_load_dwordx4 v[128:131], v1, s[16:19], s33 offen offset:0 sc1
    buffer_load_dwordx4 v[132:135], v1, s[16:19], s33 offen offset:1024 sc1
    s_add_u32 s33, s28, 10240
    buffer_load_dwordx4 v[136:139], v1, s[16:19], s33 offen offset:0 sc1
    buffer_load_dwordx4 v[140:143], v1, s[16:19], s33 offen offset:1024 sc1
    s_add_u32 s33, s28, 12288
    buffer_load_dwordx4 v[144:147], v1, s[16:19], s33 offen offset:0 sc1
    buffer_load_dwordx4 v[148:151], v1, s[16:19], s33 offen offset:1024 sc1
    s_add_u32 s33, s28, 14336
    buffer_load_dwordx4 v[152:155], v1, s[16:19], s33 offen offset:0 sc1
    buffer_load_dwordx4 v[156:159], v1, s[16:19], s33 offen offset:1024 sc1
    s_barrier
    ds_read_b64_tr_b16 v[168:169], v9 offset:0
    ds_read_b64_tr_b16 v[170:171], v9 offset:4608
    ds_read_b64_tr_b16 v[172:173], v9 offset:32
    ds_read_b64_tr_b16 v[174:175], v9 offset:4640
    ds_read_b64_tr_b16 v[176:177], v9 offset:64
    ds_read_b64_tr_b16 v[178:179], v9 offset:4672
    ds_read_b64_tr_b16 v[180:181], v9 offset:96
    ds_read_b64_tr_b16 v[182:183], v9 offset:4704
    ds_read_b64_tr_b16 v[184:185], v9 offset:128
    ds_read_b64_tr_b16 v[186:187], v9 offset:4736
    ds_read_b64_tr_b16 v[188:189], v9 offset:160
    ds_read_b64_tr_b16 v[190:191], v9 offset:4768
    s_waitcnt vmcnt(14) lgkmcnt(10)
    v_mfma_f32_16x16x32_bf16 v[16:19], v[168:171], v[96:99], 0
    ds_read_b64_tr_b16 v[192:193], v9 offset:192
    v_mfma_f32_16x16x32_bf16 v[20:23], v[168:171], v[100:103], 0
    ds_read_b64_tr_b16 v[194:195], v9 offset:4800
    s_add_u32 s33, s28, 16384
    buffer_load_dwordx4 v[160:163], v1, s[16:19], s33 offen offset:0 sc1
    buffer_load_dwordx4 v[164:167], v1, s[16:19], s33 offen offset:1024 sc1
    s_waitcnt lgkmcnt(10)
    v_mfma_f32_16x16x32_bf16 v[24:27], v[172:175], v[96:99], 0
    ds_read_b64_tr_b16 v[196:197], v9 offset:224
    v_mfma_f32_16x16x32_bf16 v[28:31], v[172:175], v[100:103], 0
    ds_read_b64_tr_b16 v[198:199], v9 offset:4832
    s_waitcnt lgkmcnt(10)
    v_mfma_f32_16x16x32_bf16 v[32:35], v[176:179], v[96:99], 0
    ds_read_b64_tr_b16 v[168:169], v9 offset:256
    v_mfma_f32_16x16x32_bf16 v[36:39], v[176:179], v[100:103], 0
    ds_read_b64_tr_b16 v[170:171], v9 offset:4864
    s_waitcnt lgkmcnt(10)
    v_mfma_f32_16x16x32_bf16 v[40:43], v[180:183], v[96:99], 0
    ds_read_b64_tr_b16 v[172:173], v9 offset:9216
    v_mfma_f32_16x16x32_bf16 v[44:47], v[180:183], v[100:103], 0
    ds_read_b64_tr_b16 v[174:175], v9 offset:13824
    s_waitcnt lgkmcnt(10)
    v_mfma_f32_16x16x32_bf16 v[48:51], v[184:187], v[96:99], 0
    ds_read_b64_tr_b16 v[176:177], v9 offset:9248
    v_mfma_f32_16x16x32_bf16 v[52:55], v[184:187], v[100:103], 0
    ds_read_b64_tr_b16 v[178:179], v9 offset:13856
    s_waitcnt lgkmcnt(10)
    v_mfma_f32_16x16x32_bf16 v[56:59], v[188:191], v[96:99], 0
    ds_read_b64_tr_b16 v[180:181], v9 offset:9280
    v_mfma_f32_16x16x32_bf16 v[60:63], v[188:191], v[100:103], 0
    ds_read_b64_tr_b16 v[182:183], v9 offset:13888
    s_waitcnt lgkmcnt(10)
    v_mfma_f32_16x16x32_bf16 v[64:67], v[192:195], v[96:99], 0
    ds_read_b64_tr_b16 v[184:185], v9 offset:9312
    v_mfma_f32_16x16x32_bf16 v[68:71], v[192:195], v[100:103], 0
    ds_read_b64_tr_b16 v[186:187], v9 offset:13920
    s_waitcnt lgkmcnt(10)
    v_mfma_f32_16x16x32_bf16 v[72:75], v[196:199], v[96:99], 0
    ds_read_b64_tr_b16 v[188:189], v9 offset:9344
    v_mfma_f32_16x16x32_bf16 v[76:79], v[196:199], v[100:103], 0
    ds_read_b64_tr_b16 v[190:191], v9 offset:13952
    s_waitcnt lgkmcnt(10)
    v_mfma_f32_16x16x32_bf16 v[80:83], v[168:171], v[96:99], 0
    ds_read_b64_tr_b16 v[192:193], v9 offset:9376
    v_mfma_f32_16x16x32_bf16 v[84:87], v[168:171], v[100:103], 0
    ds_read_b64_tr_b16 v[194:195], v9 offset:13984
    s_waitcnt vmcnt(14) lgkmcnt(10)
    v_mfma_f32_16x16x32_bf16 v[16:19], v[172:175], v[104:107], v[16:19]
    ds_read_b64_tr_b16 v[196:197], v9 offset:9408
    v_mfma_f32_16x16x32_bf16 v[20:23], v[172:175], v[108:111], v[20:23]
    ds_read_b64_tr_b16 v[198:199], v9 offset:14016
    s_add_u32 s33, s28, 18432
    buffer_load_dwordx4 v[96:99], v1, s[16:19], s33 offen offset:0 sc1
    buffer_load_dwordx4 v[100:103], v1, s[16:19], s33 offen offset:1024 sc1
    s_waitcnt lgkmcnt(10)
    v_mfma_f32_16x16x32_bf16 v[24:27], v[176:179], v[104:107], v[24:27]
    ds_read_b64_tr_b16 v[168:169], v9 offset:9440
    v_mfma_f32_16x16x32_bf16 v[28:31], v[176:179], v[108:111], v[28:31]
    ds_read_b64_tr_b16 v[170:171], v9 offset:14048
    s_waitcnt lgkmcnt(10)
    v_mfma_f32_16x16x32_bf16 v[32:35], v[180:183], v[104:107], v[32:35]
    ds_read_b64_tr_b16 v[172:173], v9 offset:9472
    v_mfma_f32_16x16x32_bf16 v[36:39], v[180:183], v[108:111], v[36:39]
    ds_read_b64_tr_b16 v[174:175], v9 offset:14080
    s_waitcnt lgkmcnt(10)
    v_mfma_f32_16x16x32_bf16 v[40:43], v[184:187], v[104:107], v[40:43]
    ds_read_b64_tr_b16 v[176:177], v9 offset:18432
    v_mfma_f32_16x16x32_bf16 v[44:47], v[184:187], v[108:111], v[44:47]
    ds_read_b64_tr_b16 v[178:179], v9 offset:23040
    s_waitcnt lgkmcnt(10)
    v_mfma_f32_16x16x32_bf16 v[48:51], v[188:191], v[104:107], v[48:51]
    ds_read_b64_tr_b16 v[180:181], v9 offset:18464
    v_mfma_f32_16x16x32_bf16 v[52:55], v[188:191], v[108:111], v[52:55]
    ds_read_b64_tr_b16 v[182:183], v9 offset:23072
    s_waitcnt lgkmcnt(10)
    v_mfma_f32_16x16x32_bf16 v[56:59], v[192:195], v[104:107], v[56:59]
    ds_read_b64_tr_b16 v[184:185], v9 offset:18496
    v_mfma_f32_16x16x32_bf16 v[60:63], v[192:195], v[108:111], v[60:63]
    ds_read_b64_tr_b16 v[186:187], v9 offset:23104
    s_waitcnt lgkmcnt(10)
    v_mfma_f32_16x16x32_bf16 v[64:67], v[196:199], v[104:107], v[64:67]
    ds_read_b64_tr_b16 v[188:189], v9 offset:18528
    v_mfma_f32_16x16x32_bf16 v[68:71], v[196:199], v[108:111], v[68:71]
    ds_read_b64_tr_b16 v[190:191], v9 offset:23136
    s_waitcnt lgkmcnt(10)
    v_mfma_f32_16x16x32_bf16 v[72:75], v[168:171], v[104:107], v[72:75]
    ds_read_b64_tr_b16 v[192:193], v9 offset:18560
    v_mfma_f32_16x16x32_bf16 v[76:79], v[168:171], v[108:111], v[76:79]
    ds_read_b64_tr_b16 v[194:195], v9 offset:23168
    s_waitcnt lgkmcnt(10)
    v_mfma_f32_16x16x32_bf16 v[80:83], v[172:175], v[104:107], v[80:83]
    ds_read_b64_tr_b16 v[196:197], v9 offset:18592
    v_mfma_f32_16x16x32_bf16 v[84:87], v[172:175], v[108:111], v[84:87]
    ds_read_b64_tr_b16 v[198:199], v9 offset:23200
    s_waitcnt vmcnt(14) lgkmcnt(10)
    v_mfma_f32_16x16x32_bf16 v[16:19], v[176:179], v[112:115], v[16:19]
    ds_read_b64_tr_b16 v[168:169], v9 offset:18624
    v_mfma_f32_16x16x32_bf16 v[20:23], v[176:179], v[116:119], v[20:23]
    ds_read_b64_tr_b16 v[170:171], v9 offset:23232
    s_add_u32 s33, s28, 20480
    buffer_load_dwordx4 v[104:107], v1, s[16:19], s33 offen offset:0 sc1
    buffer_load_dwordx4 v[108:111], v1, s[16:19], s33 offen offset:1024 sc1
    s_waitcnt lgkmcnt(10)
    v_mfma_f32_16x16x32_bf16 v[24:27], v[180:183], v[112:115], v[24:27]
    ds_read_b64_tr_b16 v[172:173], v9 offset:18656
    v_mfma_f32_16x16x32_bf16 v[28:31], v[180:183], v[116:119], v[28:31]
    ds_read_b64_tr_b16 v[174:175], v9 offset:23264
    s_waitcnt lgkmcnt(10)
    v_mfma_f32_16x16x32_bf16 v[32:35], v[184:187], v[112:115], v[32:35]
    ds_read_b64_tr_b16 v[176:177], v9 offset:18688
    v_mfma_f32_16x16x32_bf16 v[36:39], v[184:187], v[116:119], v[36:39]
    ds_read_b64_tr_b16 v[178:179], v9 offset:23296
    s_barrier
    s_waitcnt lgkmcnt(10)
    v_mfma_f32_16x16x32_bf16 v[40:43], v[188:191], v[112:115], v[40:43]
    ds_read_b64_tr_b16 v[180:181], v10 offset:0
    v_mfma_f32_16x16x32_bf16 v[44:47], v[188:191], v[116:119], v[44:47]
    ds_read_b64_tr_b16 v[182:183], v10 offset:4608
    s_add_u32 s30, s29, 442368
    s_add_u32 m0, s27, 110592
    s_nop 0
    buffer_load_dwordx4 v2, s[40:43], s30 offen sc1 lds
    s_waitcnt lgkmcnt(10)
    v_mfma_f32_16x16x32_bf16 v[48:51], v[192:195], v[112:115], v[48:51]
    ds_read_b64_tr_b16 v[184:185], v10 offset:32
    v_mfma_f32_16x16x32_bf16 v[52:55], v[192:195], v[116:119], v[52:55]
    ds_read_b64_tr_b16 v[186:187], v10 offset:4640
    s_waitcnt lgkmcnt(10)
    v_mfma_f32_16x16x32_bf16 v[56:59], v[196:199], v[112:115], v[56:59]
    ds_read_b64_tr_b16 v[188:189], v10 offset:64
    v_mfma_f32_16x16x32_bf16 v[60:63], v[196:199], v[116:119], v[60:63]
    ds_read_b64_tr_b16 v[190:191], v10 offset:4672
    s_add_u32 m0, s27, 111616
    s_nop 0
    buffer_load_dwordx4 v3, s[40:43], s30 offen sc1 lds
    s_waitcnt lgkmcnt(10)
    v_mfma_f32_16x16x32_bf16 v[64:67], v[168:171], v[112:115], v[64:67]
    ds_read_b64_tr_b16 v[192:193], v10 offset:96
    v_mfma_f32_16x16x32_bf16 v[68:71], v[168:171], v[116:119], v[68:71]
    ds_read_b64_tr_b16 v[194:195], v10 offset:4704
    s_waitcnt lgkmcnt(10)
    v_mfma_f32_16x16x32_bf16 v[72:75], v[172:175], v[112:115], v[72:75]
    ds_read_b64_tr_b16 v[196:197], v10 offset:128
    v_mfma_f32_16x16x32_bf16 v[76:79], v[172:175], v[116:119], v[76:79]
    ds_read_b64_tr_b16 v[198:199], v10 offset:4736
    s_add_u32 m0, s27, 112640
    s_nop 0
    buffer_load_dwordx4 v4, s[40:43], s30 offen sc1 lds
    s_waitcnt lgkmcnt(10)
    v_mfma_f32_16x16x32_bf16 v[80:83], v[176:179], v[112:115], v[80:83]
    ds_read_b64_tr_b16 v[168:169], v10 offset:160
    v_mfma_f32_16x16x32_bf16 v[84:87], v[176:179], v[116:119], v[84:87]
    ds_read_b64_tr_b16 v[170:171], v10 offset:4768
    s_waitcnt vmcnt(17) lgkmcnt(10)
    v_mfma_f32_16x16x32_bf16 v[16:19], v[180:183], v[120:123], v[16:19]
    ds_read_b64_tr_b16 v[172:173], v10 offset:192
    v_mfma_f32_16x16x32_bf16 v[20:23], v[180:183], v[124:127], v[20:23]
    ds_read_b64_tr_b16 v[174:175], v10 offset:4800
    s_add_u32 s33, s28, 22528
    buffer_load_dwordx4 v[112:115], v1, s[16:19], s33 offen offset:0 sc1
    buffer_load_dwordx4 v[116:119], v1, s[16:19], s33 offen offset:1024 sc1
    s_waitcnt lgkmcnt(10)
    v_mfma_f32_16x16x32_bf16 v[24:27], v[184:187], v[120:123], v[24:27]
    ds_read_b64_tr_b16 v[176:177], v10 offset:224
    v_mfma_f32_16x16x32_bf16 v[28:31], v[184:187], v[124:127], v[28:31]
    ds_read_b64_tr_b16 v[178:179], v10 offset:4832
    s_add_u32 m0, s27, 113664
    s_nop 0
    buffer_load_dwordx4 v5, s[40:43], s30 offen sc1 lds
    s_waitcnt lgkmcnt(10)
    v_mfma_f32_16x16x32_bf16 v[32:35], v[188:191], v[120:123], v[32:35]
    ds_read_b64_tr_b16 v[180:181], v10 offset:256
    v_mfma_f32_16x16x32_bf16 v[36:39], v[188:191], v[124:127], v[36:39]
    ds_read_b64_tr_b16 v[182:183], v10 offset:4864
    s_waitcnt lgkmcnt(10)
    v_mfma_f32_16x16x32_bf16 v[40:43], v[192:195], v[120:123], v[40:43]
    ds_read_b64_tr_b16 v[184:185], v10 offset:9216
    v_mfma_f32_16x16x32_bf16 v[44:47], v[192:195], v[124:127], v[44:47]
    ds_read_b64_tr_b16 v[186:187], v10 offset:13824
    s_add_u32 m0, s27, 114688
    s_nop 0
    buffer_load_dwordx4 v6, s[40:43], s30 offen sc1 lds
    s_waitcnt lgkmcnt(10)
    v_mfma_f32_16x16x32_bf16 v[48:51], v[196:199], v[120:123], v[48:51]
    ds_read_b64_tr_b16 v[188:189], v10 offset:9248
    v_mfma_f32_16x16x32_bf16 v[52:55], v[196:199], v[124:127], v[52:55]
    ds_read_b64_tr_b16 v[190:191], v10 offset:13856
    s_waitcnt lgkmcnt(10)
    v_mfma_f32_16x16x32_bf16 v[56:59], v[168:171], v[120:123], v[56:59]
    ds_read_b64_tr_b16 v[192:193], v10 offset:9280
    v_mfma_f32_16x16x32_bf16 v[60:63], v[168:171], v[124:127], v[60:63]
    ds_read_b64_tr_b16 v[194:195], v10 offset:13888
    s_add_u32 m0, s27, 115712
    s_nop 0
    buffer_load_dwordx4 v7, s[40:43], s30 offen sc1 lds
    s_waitcnt lgkmcnt(10)
    v_mfma_f32_16x16x32_bf16 v[64:67], v[172:175], v[120:123], v[64:67]
    ds_read_b64_tr_b16 v[196:197], v10 offset:9312
    v_mfma_f32_16x16x32_bf16 v[68:71], v[172:175], v[124:127], v[68:71]
    ds_read_b64_tr_b16 v[198:199], v10 offset:13920
    s_waitcnt lgkmcnt(10)
    v_mfma_f32_16x16x32_bf16 v[72:75], v[176:179], v[120:123], v[72:75]
    ds_read_b64_tr_b16 v[168:169], v10 offset:9344
    v_mfma_f32_16x16x32_bf16 v[76:79], v[176:179], v[124:127], v[76:79]
    ds_read_b64_tr_b16 v[170:171], v10 offset:13952
    s_add_u32 m0, s27, 116736
    s_mov_b32 exec_hi, 0xffff
    buffer_load_dwordx4 v8, s[40:43], s30 offen sc1 lds
    s_mov_b32 exec_hi, -1
    s_waitcnt lgkmcnt(10)
    v_mfma_f32_16x16x32_bf16 v[80:83], v[180:183], v[120:123], v[80:83]
    ds_read_b64_tr_b16 v[172:173], v10 offset:9376
    v_mfma_f32_16x16x32_bf16 v[84:87], v[180:183], v[124:127], v[84:87]
    ds_read_b64_tr_b16 v[174:175], v10 offset:13984
    s_waitcnt vmcnt(21) lgkmcnt(10)
    v_mfma_f32_16x16x32_bf16 v[16:19], v[184:187], v[128:131], v[16:19]
    ds_read_b64_tr_b16 v[176:177], v10 offset:9408
    v_mfma_f32_16x16x32_bf16 v[20:23], v[184:187], v[132:135], v[20:23]
    ds_read_b64_tr_b16 v[178:179], v10 offset:14016
    s_add_u32 s33, s28, 24576
    buffer_load_dwordx4 v[120:123], v1, s[16:19], s33 offen offset:0 sc1
    buffer_load_dwordx4 v[124:127], v1, s[16:19], s33 offen offset:1024 sc1
    s_waitcnt lgkmcnt(10)
    v_mfma_f32_16x16x32_bf16 v[24:27], v[188:191], v[128:131], v[24:27]
    ds_read_b64_tr_b16 v[180:181], v10 offset:9440
    v_mfma_f32_16x16x32_bf16 v[28:31], v[188:191], v[132:135], v[28:31]
    ds_read_b64_tr_b16 v[182:183], v10 offset:14048
    s_waitcnt lgkmcnt(10)
    v_mfma_f32_16x16x32_bf16 v[32:35], v[192:195], v[128:131], v[32:35]
    ds_read_b64_tr_b16 v[184:185], v10 offset:9472
    v_mfma_f32_16x16x32_bf16 v[36:39], v[192:195], v[132:135], v[36:39]
    ds_read_b64_tr_b16 v[186:187], v10 offset:14080
    s_waitcnt lgkmcnt(10)
    v_mfma_f32_16x16x32_bf16 v[40:43], v[196:199], v[128:131], v[40:43]
    ds_read_b64_tr_b16 v[188:189], v10 offset:18432
    v_mfma_f32_16x16x32_bf16 v[44:47], v[196:199], v[132:135], v[44:47]
    ds_read_b64_tr_b16 v[190:191], v10 offset:23040
    s_waitcnt lgkmcnt(10)
    v_mfma_f32_16x16x32_bf16 v[48:51], v[168:171], v[128:131], v[48:51]
    ds_read_b64_tr_b16 v[192:193], v10 offset:18464
    v_mfma_f32_16x16x32_bf16 v[52:55], v[168:171], v[132:135], v[52:55]
    ds_read_b64_tr_b16 v[194:195], v10 offset:23072
    s_waitcnt lgkmcnt(10)
    v_mfma_f32_16x16x32_bf16 v[56:59], v[172:175], v[128:131], v[56:59]
    ds_read_b64_tr_b16 v[196:197], v10 offset:18496
    v_mfma_f32_16x16x32_bf16 v[60:63], v[172:175], v[132:135], v[60:63]
    ds_read_b64_tr_b16 v[198:199], v10 offset:23104
    s_waitcnt lgkmcnt(10)
    v_mfma_f32_16x16x32_bf16 v[64:67], v[176:179], v[128:131], v[64:67]
    ds_read_b64_tr_b16 v[168:169], v10 offset:18528
    v_mfma_f32_16x16x32_bf16 v[68:71], v[176:179], v[132:135], v[68:71]
    ds_read_b64_tr_b16 v[170:171], v10 offset:23136
    s_waitcnt lgkmcnt(10)
    v_mfma_f32_16x16x32_bf16 v[72:75], v[180:183], v[128:131], v[72:75]
    ds_read_b64_tr_b16 v[172:173], v10 offset:18560
    v_mfma_f32_16x16x32_bf16 v[76:79], v[180:183], v[132:135], v[76:79]
    ds_read_b64_tr_b16 v[174:175], v10 offset:23168
    s_waitcnt lgkmcnt(10)
    v_mfma_f32_16x16x32_bf16 v[80:83], v[184:187], v[128:131], v[80:83]
    ds_read_b64_tr_b16 v[176:177], v10 offset:18592
    v_mfma_f32_16x16x32_bf16 v[84:87], v[184:187], v[132:135], v[84:87]
    ds_read_b64_tr_b16 v[178:179], v10 offset:23200
    s_waitcnt vmcnt(21) lgkmcnt(10)
    v_mfma_f32_16x16x32_bf16 v[16:19], v[188:191], v[136:139], v[16:19]
    ds_read_b64_tr_b16 v[180:181], v10 offset:18624
    v_mfma_f32_16x16x32_bf16 v[20:23], v[188:191], v[140:143], v[20:23]
    ds_read_b64_tr_b16 v[182:183], v10 offset:23232
    s_add_u32 s33, s28, 26624
    buffer_load_dwordx4 v[128:131], v1, s[16:19], s33 offen offset:0 sc1
    buffer_load_dwordx4 v[132:135], v1, s[16:19], s33 offen offset:1024 sc1
    s_waitcnt lgkmcnt(10)
    v_mfma_f32_16x16x32_bf16 v[24:27], v[192:195], v[136:139], v[24:27]
    ds_read_b64_tr_b16 v[184:185], v10 offset:18656
    v_mfma_f32_16x16x32_bf16 v[28:31], v[192:195], v[140:143], v[28:31]
    ds_read_b64_tr_b16 v[186:187], v10 offset:23264
    s_waitcnt lgkmcnt(10)
    v_mfma_f32_16x16x32_bf16 v[32:35], v[196:199], v[136:139], v[32:35]
    ds_read_b64_tr_b16 v[188:189], v10 offset:18688
    v_mfma_f32_16x16x32_bf16 v[36:39], v[196:199], v[140:143], v[36:39]
    ds_read_b64_tr_b16 v[190:191], v10 offset:23296
    s_barrier
    s_waitcnt lgkmcnt(10)
    v_mfma_f32_16x16x32_bf16 v[40:43], v[168:171], v[136:139], v[40:43]
    ds_read_b64_tr_b16 v[192:193], v11 offset:0
    v_mfma_f32_16x16x32_bf16 v[44:47], v[168:171], v[140:143], v[44:47]
    ds_read_b64_tr_b16 v[194:195], v11 offset:4608
    s_add_u32 s30, s29, 552960
    s_add_u32 m0, s27, 0
    s_nop 0
    buffer_load_dwordx4 v2, s[40:43], s30 offen sc1 lds
    s_waitcnt lgkmcnt(10)
    v_mfma_f32_16x16x32_bf16 v[48:51], v[172:175], v[136:139], v[48:51]
    ds_read_b64_tr_b16 v[196:197], v11 offset:32
    v_mfma_f32_16x16x32_bf16 v[52:55], v[172:175], v[140:143], v[52:55]
    ds_read_b64_tr_b16 v[198:199], v11 offset:4640
    s_waitcnt lgkmcnt(10)
    v_mfma_f32_16x16x32_bf16 v[56:59], v[176:179], v[136:139], v[56:59]
    ds_read_b64_tr_b16 v[168:169], v11 offset:64
    v_mfma_f32_16x16x32_bf16 v[60:63], v[176:179], v[140:143], v[60:63]
    ds_read_b64_tr_b16 v[170:171], v11 offset:4672
    s_add_u32 m0, s27, 1024
    s_nop 0
    buffer_load_dwordx4 v3, s[40:43], s30 offen sc1 lds
    s_waitcnt lgkmcnt(10)
    v_mfma_f32_16x16x32_bf16 v[64:67], v[180:183], v[136:139], v[64:67]
    ds_read_b64_tr_b16 v[172:173], v11 offset:96
    v_mfma_f32_16x16x32_bf16 v[68:71], v[180:183], v[140:143], v[68:71]
    ds_read_b64_tr_b16 v[174:175], v11 offset:4704
    s_waitcnt lgkmcnt(10)
    v_mfma_f32_16x16x32_bf16 v[72:75], v[184:187], v[136:139], v[72:75]
    ds_read_b64_tr_b16 v[176:177], v11 offset:128
    v_mfma_f32_16x16x32_bf16 v[76:79], v[184:187], v[140:143], v[76:79]
    ds_read_b64_tr_b16 v[178:179], v11 offset:4736
    s_add_u32 m0, s27, 2048
    s_nop 0
    buffer_load_dwordx4 v4, s[40:43], s30 offen sc1 lds
    s_waitcnt lgkmcnt(10)
    v_mfma_f32_16x16x32_bf16 v[80:83], v[188:191], v[136:139], v[80:83]
    ds_read_b64_tr_b16 v[180:181], v11 offset:160
    v_mfma_f32_16x16x32_bf16 v[84:87], v[188:191], v[140:143], v[84:87]
    ds_read_b64_tr_b16 v[182:183], v11 offset:4768
    s_waitcnt vmcnt(24) lgkmcnt(10)
    v_mfma_f32_16x16x32_bf16 v[16:19], v[192:195], v[144:147], v[16:19]
    ds_read_b64_tr_b16 v[184:185], v11 offset:192
    v_mfma_f32_16x16x32_bf16 v[20:23], v[192:195], v[148:151], v[20:23]
    ds_read_b64_tr_b16 v[186:187], v11 offset:4800
    s_add_u32 s33, s28, 28672
    buffer_load_dwordx4 v[136:139], v1, s[16:19], s33 offen offset:0 sc1
    buffer_load_dwordx4 v[140:143], v1, s[16:19], s33 offen offset:1024 sc1
    s_waitcnt lgkmcnt(10)
    v_mfma_f32_16x16x32_bf16 v[24:27], v[196:199], v[144:147], v[24:27]
    ds_read_b64_tr_b16 v[188:189], v11 offset:224
    v_mfma_f32_16x16x32_bf16 v[28:31], v[196:199], v[148:151], v[28:31]
    ds_read_b64_tr_b16 v[190:191], v11 offset:4832
    s_add_u32 m0, s27, 3072
    s_nop 0
    buffer_load_dwordx4 v5, s[40:43], s30 offen sc1 lds
    s_waitcnt lgkmcnt(10)
    v_mfma_f32_16x16x32_bf16 v[32:35], v[168:171], v[144:147], v[32:35]
    ds_read_b64_tr_b16 v[192:193], v11 offset:256
    v_mfma_f32_16x16x32_bf16 v[36:39], v[168:171], v[148:151], v[36:39]
    ds_read_b64_tr_b16 v[194:195], v11 offset:4864
    s_waitcnt lgkmcnt(10)
    v_mfma_f32_16x16x32_bf16 v[40:43], v[172:175], v[144:147], v[40:43]
    ds_read_b64_tr_b16 v[196:197], v11 offset:9216
    v_mfma_f32_16x16x32_bf16 v[44:47], v[172:175], v[148:151], v[44:47]
    ds_read_b64_tr_b16 v[198:199], v11 offset:13824
    s_add_u32 m0, s27, 4096
    s_nop 0
    buffer_load_dwordx4 v6, s[40:43], s30 offen sc1 lds
    s_waitcnt lgkmcnt(10)
    v_mfma_f32_16x16x32_bf16 v[48:51], v[176:179], v[144:147], v[48:51]
    ds_read_b64_tr_b16 v[168:169], v11 offset:9248
    v_mfma_f32_16x16x32_bf16 v[52:55], v[176:179], v[148:151], v[52:55]
    ds_read_b64_tr_b16 v[170:171], v11 offset:13856
    s_waitcnt lgkmcnt(10)
    v_mfma_f32_16x16x32_bf16 v[56:59], v[180:183], v[144:147], v[56:59]
    ds_read_b64_tr_b16 v[172:173], v11 offset:9280
    v_mfma_f32_16x16x32_bf16 v[60:63], v[180:183], v[148:151], v[60:63]
    ds_read_b64_tr_b16 v[174:175], v11 offset:13888
    s_add_u32 m0, s27, 5120
    s_nop 0
    buffer_load_dwordx4 v7, s[40:43], s30 offen sc1 lds
    s_waitcnt lgkmcnt(10)
    v_mfma_f32_16x16x32_bf16 v[64:67], v[184:187], v[144:147], v[64:67]
    ds_read_b64_tr_b16 v[176:177], v11 offset:9312
    v_mfma_f32_16x16x32_bf16 v[68:71], v[184:187], v[148:151], v[68:71]
    ds_read_b64_tr_b16 v[178:179], v11 offset:13920
    s_waitcnt lgkmcnt(10)
    v_mfma_f32_16x16x32_bf16 v[72:75], v[188:191], v[144:147], v[72:75]
    ds_read_b64_tr_b16 v[180:181], v11 offset:9344
    v_mfma_f32_16x16x32_bf16 v[76:79], v[188:191], v[148:151], v[76:79]
    ds_read_b64_tr_b16 v[182:183], v11 offset:13952
    s_add_u32 m0, s27, 6144
    s_mov_b32 exec_hi, 0xffff
    buffer_load_dwordx4 v8, s[40:43], s30 offen sc1 lds
    s_mov_b32 exec_hi, -1
    s_waitcnt lgkmcnt(10)
    v_mfma_f32_16x16x32_bf16 v[80:83], v[192:195], v[144:147], v[80:83]
    ds_read_b64_tr_b16 v[184:185], v11 offset:9376
    v_mfma_f32_16x16x32_bf16 v[84:87], v[192:195], v[148:151], v[84:87]
    ds_read_b64_tr_b16 v[186:187], v11 offset:13984
    s_waitcnt vmcnt(28) lgkmcnt(10)
    v_mfma_f32_16x16x32_bf16 v[16:19], v[196:199], v[152:155], v[16:19]
    ds_read_b64_tr_b16 v[188:189], v11 offset:9408
    v_mfma_f32_16x16x32_bf16 v[20:23], v[196:199], v[156:159], v[20:23]
    ds_read_b64_tr_b16 v[190:191], v11 offset:14016
    s_add_u32 s33, s28, 30720
    buffer_load_dwordx4 v[144:147], v1, s[16:19], s33 offen offset:0 sc1
    buffer_load_dwordx4 v[148:151], v1, s[16:19], s33 offen offset:1024 sc1
    s_waitcnt lgkmcnt(10)
    v_mfma_f32_16x16x32_bf16 v[24:27], v[168:171], v[152:155], v[24:27]
    ds_read_b64_tr_b16 v[192:193], v11 offset:9440
    v_mfma_f32_16x16x32_bf16 v[28:31], v[168:171], v[156:159], v[28:31]
    ds_read_b64_tr_b16 v[194:195], v11 offset:14048
    s_waitcnt lgkmcnt(10)
    v_mfma_f32_16x16x32_bf16 v[32:35], v[172:175], v[152:155], v[32:35]
    ds_read_b64_tr_b16 v[196:197], v11 offset:9472
    v_mfma_f32_16x16x32_bf16 v[36:39], v[172:175], v[156:159], v[36:39]
    ds_read_b64_tr_b16 v[198:199], v11 offset:14080
    s_waitcnt lgkmcnt(10)
    v_mfma_f32_16x16x32_bf16 v[40:43], v[176:179], v[152:155], v[40:43]
    ds_read_b64_tr_b16 v[168:169], v11 offset:18432
    v_mfma_f32_16x16x32_bf16 v[44:47], v[176:179], v[156:159], v[44:47]
    ds_read_b64_tr_b16 v[170:171], v11 offset:23040
    s_waitcnt lgkmcnt(10)
    v_mfma_f32_16x16x32_bf16 v[48:51], v[180:183], v[152:155], v[48:51]
    ds_read_b64_tr_b16 v[172:173], v11 offset:18464
    v_mfma_f32_16x16x32_bf16 v[52:55], v[180:183], v[156:159], v[52:55]
    ds_read_b64_tr_b16 v[174:175], v11 offset:23072
    s_waitcnt lgkmcnt(10)
    v_mfma_f32_16x16x32_bf16 v[56:59], v[184:187], v[152:155], v[56:59]
    ds_read_b64_tr_b16 v[176:177], v11 offset:18496
    v_mfma_f32_16x16x32_bf16 v[60:63], v[184:187], v[156:159], v[60:63]
    ds_read_b64_tr_b16 v[178:179], v11 offset:23104
    s_waitcnt lgkmcnt(10)
    v_mfma_f32_16x16x32_bf16 v[64:67], v[188:191], v[152:155], v[64:67]
    ds_read_b64_tr_b16 v[180:181], v11 offset:18528
    v_mfma_f32_16x16x32_bf16 v[68:71], v[188:191], v[156:159], v[68:71]
    ds_read_b64_tr_b16 v[182:183], v11 offset:23136
    s_waitcnt lgkmcnt(10)
    v_mfma_f32_16x16x32_bf16 v[72:75], v[192:195], v[152:155], v[72:75]
    ds_read_b64_tr_b16 v[184:185], v11 offset:18560
    v_mfma_f32_16x16x32_bf16 v[76:79], v[192:195], v[156:159], v[76:79]
    ds_read_b64_tr_b16 v[186:187], v11 offset:23168
    s_waitcnt lgkmcnt(10)
    v_mfma_f32_16x16x32_bf16 v[80:83], v[196:199], v[152:155], v[80:83]
    ds_read_b64_tr_b16 v[188:189], v11 offset:18592
    v_mfma_f32_16x16x32_bf16 v[84:87], v[196:199], v[156:159], v[84:87]
    ds_read_b64_tr_b16 v[190:191], v11 offset:23200
    s_waitcnt vmcnt(28) lgkmcnt(10)
    v_mfma_f32_16x16x32_bf16 v[16:19], v[168:171], v[160:163], v[16:19]
    ds_read_b64_tr_b16 v[192:193], v11 offset:18624
    v_mfma_f32_16x16x32_bf16 v[20:23], v[168:171], v[164:167], v[20:23]
    ds_read_b64_tr_b16 v[194:195], v11 offset:23232
    s_add_u32 s33, s28, 32768
    buffer_load_dwordx4 v[152:155], v1, s[16:19], s33 offen offset:0 sc1
    buffer_load_dwordx4 v[156:159], v1, s[16:19], s33 offen offset:1024 sc1
    s_waitcnt lgkmcnt(10)
    v_mfma_f32_16x16x32_bf16 v[24:27], v[172:175], v[160:163], v[24:27]
    ds_read_b64_tr_b16 v[196:197], v11 offset:18656
    v_mfma_f32_16x16x32_bf16 v[28:31], v[172:175], v[164:167], v[28:31]
    ds_read_b64_tr_b16 v[198:199], v11 offset:23264
    s_waitcnt lgkmcnt(10)
    v_mfma_f32_16x16x32_bf16 v[32:35], v[176:179], v[160:163], v[32:35]
    ds_read_b64_tr_b16 v[168:169], v11 offset:18688
    v_mfma_f32_16x16x32_bf16 v[36:39], v[176:179], v[164:167], v[36:39]
    ds_read_b64_tr_b16 v[170:171], v11 offset:23296
    s_barrier
    s_waitcnt lgkmcnt(10)
    v_mfma_f32_16x16x32_bf16 v[40:43], v[180:183], v[160:163], v[40:43]
    ds_read_b64_tr_b16 v[172:173], v12 offset:0
    v_mfma_f32_16x16x32_bf16 v[44:47], v[180:183], v[164:167], v[44:47]
    ds_read_b64_tr_b16 v[174:175], v12 offset:4608
    s_add_u32 s30, s29, 663552
    s_add_u32 m0, s27, 27648
    s_nop 0
    buffer_load_dwordx4 v2, s[40:43], s30 offen sc1 lds
    s_waitcnt lgkmcnt(10)
    v_mfma_f32_16x16x32_bf16 v[48:51], v[184:187], v[160:163], v[48:51]
    ds_read_b64_tr_b16 v[176:177], v12 offset:32
    v_mfma_f32_16x16x32_bf16 v[52:55], v[184:187], v[164:167], v[52:55]
    ds_read_b64_tr_b16 v[178:179], v12 offset:4640
    s_waitcnt lgkmcnt(10)
    v_mfma_f32_16x16x32_bf16 v[56:59], v[188:191], v[160:163], v[56:59]
    ds_read_b64_tr_b16 v[180:181], v12 offset:64
    v_mfma_f32_16x16x32_bf16 v[60:63], v[188:191], v[164:167], v[60:63]
    ds_read_b64_tr_b16 v[182:183], v12 offset:4672
    s_add_u32 m0, s27, 28672
    s_nop 0
    buffer_load_dwordx4 v3, s[40:43], s30 offen sc1 lds
    s_waitcnt lgkmcnt(10)
    v_mfma_f32_16x16x32_bf16 v[64:67], v[192:195], v[160:163], v[64:67]
    ds_read_b64_tr_b16 v[184:185], v12 offset:96
    v_mfma_f32_16x16x32_bf16 v[68:71], v[192:195], v[164:167], v[68:71]
    ds_read_b64_tr_b16 v[186:187], v12 offset:4704
    s_waitcnt lgkmcnt(10)
    v_mfma_f32_16x16x32_bf16 v[72:75], v[196:199], v[160:163], v[72:75]
    ds_read_b64_tr_b16 v[188:189], v12 offset:128
    v_mfma_f32_16x16x32_bf16 v[76:79], v[196:199], v[164:167], v[76:79]
    ds_read_b64_tr_b16 v[190:191], v12 offset:4736
    s_add_u32 m0, s27, 29696
    s_nop 0
    buffer_load_dwordx4 v4, s[40:43], s30 offen sc1 lds
    s_waitcnt lgkmcnt(10)
    v_mfma_f32_16x16x32_bf16 v[80:83], v[168:171], v[160:163], v[80:83]
    ds_read_b64_tr_b16 v[192:193], v12 offset:160
    v_mfma_f32_16x16x32_bf16 v[84:87], v[168:171], v[164:167], v[84:87]
    ds_read_b64_tr_b16 v[194:195], v12 offset:4768
    s_waitcnt vmcnt(31) lgkmcnt(10)
    v_mfma_f32_16x16x32_bf16 v[16:19], v[172:175], v[96:99], v[16:19]
    ds_read_b64_tr_b16 v[196:197], v12 offset:192
    v_mfma_f32_16x16x32_bf16 v[20:23], v[172:175], v[100:103], v[20:23]
    ds_read_b64_tr_b16 v[198:199], v12 offset:4800
    s_add_u32 s33, s28, 34816
    buffer_load_dwordx4 v[160:163], v1, s[16:19], s33 offen offset:0 sc1
    buffer_load_dwordx4 v[164:167], v1, s[16:19], s33 offen offset:1024 sc1
    s_waitcnt lgkmcnt(10)
    v_mfma_f32_16x16x32_bf16 v[24:27], v[176:179], v[96:99], v[24:27]
    ds_read_b64_tr_b16 v[168:169], v12 offset:224
    v_mfma_f32_16x16x32_bf16 v[28:31], v[176:179], v[100:103], v[28:31]
    ds_read_b64_tr_b16 v[170:171], v12 offset:4832
    s_add_u32 m0, s27, 30720
    s_nop 0
    buffer_load_dwordx4 v5, s[40:43], s30 offen sc1 lds
    s_waitcnt lgkmcnt(10)
    v_mfma_f32_16x16x32_bf16 v[32:35], v[180:183], v[96:99], v[32:35]
    ds_read_b64_tr_b16 v[172:173], v12 offset:256
    v_mfma_f32_16x16x32_bf16 v[36:39], v[180:183], v[100:103], v[36:39]
    ds_read_b64_tr_b16 v[174:175], v12 offset:4864
    s_waitcnt lgkmcnt(10)
    v_mfma_f32_16x16x32_bf16 v[40:43], v[184:187], v[96:99], v[40:43]
    ds_read_b64_tr_b16 v[176:177], v12 offset:9216
    v_mfma_f32_16x16x32_bf16 v[44:47], v[184:187], v[100:103], v[44:47]
    ds_read_b64_tr_b16 v[178:179], v12 offset:13824
    s_add_u32 m0, s27, 31744
    s_nop 0
    buffer_load_dwordx4 v6, s[40:43], s30 offen sc1 lds
    s_waitcnt lgkmcnt(10)
    v_mfma_f32_16x16x32_bf16 v[48:51], v[188:191], v[96:99], v[48:51]
    ds_read_b64_tr_b16 v[180:181], v12 offset:9248
    v_mfma_f32_16x16x32_bf16 v[52:55], v[188:191], v[100:103], v[52:55]
    ds_read_b64_tr_b16 v[182:183], v12 offset:13856
    s_waitcnt lgkmcnt(10)
    v_mfma_f32_16x16x32_bf16 v[56:59], v[192:195], v[96:99], v[56:59]
    ds_read_b64_tr_b16 v[184:185], v12 offset:9280
    v_mfma_f32_16x16x32_bf16 v[60:63], v[192:195], v[100:103], v[60:63]
    ds_read_b64_tr_b16 v[186:187], v12 offset:13888
    s_add_u32 m0, s27, 32768
    s_nop 0
    buffer_load_dwordx4 v7, s[40:43], s30 offen sc1 lds
    s_waitcnt lgkmcnt(10)
    v_mfma_f32_16x16x32_bf16 v[64:67], v[196:199], v[96:99], v[64:67]
    ds_read_b64_tr_b16 v[188:189], v12 offset:9312
    v_mfma_f32_16x16x32_bf16 v[68:71], v[196:199], v[100:103], v[68:71]
    ds_read_b64_tr_b16 v[190:191], v12 offset:13920
    s_waitcnt lgkmcnt(10)
    v_mfma_f32_16x16x32_bf16 v[72:75], v[168:171], v[96:99], v[72:75]
    ds_read_b64_tr_b16 v[192:193], v12 offset:9344
    v_mfma_f32_16x16x32_bf16 v[76:79], v[168:171], v[100:103], v[76:79]
    ds_read_b64_tr_b16 v[194:195], v12 offset:13952
    s_add_u32 m0, s27, 33792
    s_mov_b32 exec_hi, 0xffff
    buffer_load_dwordx4 v8, s[40:43], s30 offen sc1 lds
    s_mov_b32 exec_hi, -1
    s_waitcnt lgkmcnt(10)
    v_mfma_f32_16x16x32_bf16 v[80:83], v[172:175], v[96:99], v[80:83]
    ds_read_b64_tr_b16 v[196:197], v12 offset:9376
    v_mfma_f32_16x16x32_bf16 v[84:87], v[172:175], v[100:103], v[84:87]
    ds_read_b64_tr_b16 v[198:199], v12 offset:13984
    s_waitcnt vmcnt(35) lgkmcnt(10)
    v_mfma_f32_16x16x32_bf16 v[16:19], v[176:179], v[104:107], v[16:19]
    ds_read_b64_tr_b16 v[168:169], v12 offset:9408
    v_mfma_f32_16x16x32_bf16 v[20:23], v[176:179], v[108:111], v[20:23]
    ds_read_b64_tr_b16 v[170:171], v12 offset:14016
    s_add_u32 s33, s28, 36864
    buffer_load_dwordx4 v[96:99], v1, s[16:19], s33 offen offset:0 sc1
    buffer_load_dwordx4 v[100:103], v1, s[16:19], s33 offen offset:1024 sc1
    s_waitcnt lgkmcnt(10)
    v_mfma_f32_16x16x32_bf16 v[24:27], v[180:183], v[104:107], v[24:27]
    ds_read_b64_tr_b16 v[172:173], v12 offset:9440
    v_mfma_f32_16x16x32_bf16 v[28:31], v[180:183], v[108:111], v[28:31]
    ds_read_b64_tr_b16 v[174:175], v12 offset:14048
    s_waitcnt lgkmcnt(10)
    v_mfma_f32_16x16x32_bf16 v[32:35], v[184:187], v[104:107], v[32:35]
    ds_read_b64_tr_b16 v[176:177], v12 offset:9472
    v_mfma_f32_16x16x32_bf16 v[36:39], v[184:187], v[108:111], v[36:39]
    ds_read_b64_tr_b16 v[178:179], v12 offset:14080
    s_waitcnt lgkmcnt(10)
    v_mfma_f32_16x16x32_bf16 v[40:43], v[188:191], v[104:107], v[40:43]
    ds_read_b64_tr_b16 v[180:181], v12 offset:18432
    v_mfma_f32_16x16x32_bf16 v[44:47], v[188:191], v[108:111], v[44:47]
    ds_read_b64_tr_b16 v[182:183], v12 offset:23040
    s_waitcnt lgkmcnt(10)
    v_mfma_f32_16x16x32_bf16 v[48:51], v[192:195], v[104:107], v[48:51]
    ds_read_b64_tr_b16 v[184:185], v12 offset:18464
    v_mfma_f32_16x16x32_bf16 v[52:55], v[192:195], v[108:111], v[52:55]
    ds_read_b64_tr_b16 v[186:187], v12 offset:23072
    s_waitcnt lgkmcnt(10)
    v_mfma_f32_16x16x32_bf16 v[56:59], v[196:199], v[104:107], v[56:59]
    ds_read_b64_tr_b16 v[188:189], v12 offset:18496
    v_mfma_f32_16x16x32_bf16 v[60:63], v[196:199], v[108:111], v[60:63]
    ds_read_b64_tr_b16 v[190:191], v12 offset:23104
    s_waitcnt lgkmcnt(10)
    v_mfma_f32_16x16x32_bf16 v[64:67], v[168:171], v[104:107], v[64:67]
    ds_read_b64_tr_b16 v[192:193], v12 offset:18528
    v_mfma_f32_16x16x32_bf16 v[68:71], v[168:171], v[108:111], v[68:71]
    ds_read_b64_tr_b16 v[194:195], v12 offset:23136
    s_waitcnt lgkmcnt(10)
    v_mfma_f32_16x16x32_bf16 v[72:75], v[172:175], v[104:107], v[72:75]
    ds_read_b64_tr_b16 v[196:197], v12 offset:18560
    v_mfma_f32_16x16x32_bf16 v[76:79], v[172:175], v[108:111], v[76:79]
    ds_read_b64_tr_b16 v[198:199], v12 offset:23168
    s_waitcnt lgkmcnt(10)
    v_mfma_f32_16x16x32_bf16 v[80:83], v[176:179], v[104:107], v[80:83]
    ds_read_b64_tr_b16 v[168:169], v12 offset:18592
    v_mfma_f32_16x16x32_bf16 v[84:87], v[176:179], v[108:111], v[84:87]
    ds_read_b64_tr_b16 v[170:171], v12 offset:23200
    s_waitcnt vmcnt(32) lgkmcnt(10)
    v_mfma_f32_16x16x32_bf16 v[16:19], v[180:183], v[112:115], v[16:19]
    ds_read_b64_tr_b16 v[172:173], v12 offset:18624
    v_mfma_f32_16x16x32_bf16 v[20:23], v[180:183], v[116:119], v[20:23]
    ds_read_b64_tr_b16 v[174:175], v12 offset:23232
    s_add_u32 s33, s28, 38912
    buffer_load_dwordx4 v[104:107], v1, s[16:19], s33 offen offset:0 sc1
    buffer_load_dwordx4 v[108:111], v1, s[16:19], s33 offen offset:1024 sc1
    s_waitcnt lgkmcnt(10)
    v_mfma_f32_16x16x32_bf16 v[24:27], v[184:187], v[112:115], v[24:27]
    ds_read_b64_tr_b16 v[176:177], v12 offset:18656
    v_mfma_f32_16x16x32_bf16 v[28:31], v[184:187], v[116:119], v[28:31]
    ds_read_b64_tr_b16 v[178:179], v12 offset:23264
    s_waitcnt lgkmcnt(10)
    v_mfma_f32_16x16x32_bf16 v[32:35], v[188:191], v[112:115], v[32:35]
    ds_read_b64_tr_b16 v[180:181], v12 offset:18688
    v_mfma_f32_16x16x32_bf16 v[36:39], v[188:191], v[116:119], v[36:39]
    ds_read_b64_tr_b16 v[182:183], v12 offset:23296
    s_waitcnt vmcnt(30)
    s_barrier
    s_waitcnt lgkmcnt(10)
    v_mfma_f32_16x16x32_bf16 v[40:43], v[192:195], v[112:115], v[40:43]
    ds_read_b64_tr_b16 v[184:185], v13 offset:0
    v_mfma_f32_16x16x32_bf16 v[44:47], v[192:195], v[116:119], v[44:47]
    ds_read_b64_tr_b16 v[186:187], v13 offset:4608
    s_add_u32 s30, s29, 774144
    s_add_u32 m0, s27, 55296
    s_nop 0
    buffer_load_dwordx4 v2, s[40:43], s30 offen sc1 lds
    s_waitcnt lgkmcnt(10)
    v_mfma_f32_16x16x32_bf16 v[48:51], v[196:199], v[112:115], v[48:51]
    ds_read_b64_tr_b16 v[188:189], v13 offset:32
    v_mfma_f32_16x16x32_bf16 v[52:55], v[196:199], v[116:119], v[52:55]
    ds_read_b64_tr_b16 v[190:191], v13 offset:4640
    s_waitcnt lgkmcnt(10)
    v_mfma_f32_16x16x32_bf16 v[56:59], v[168:171], v[112:115], v[56:59]
    ds_read_b64_tr_b16 v[192:193], v13 offset:64
    v_mfma_f32_16x16x32_bf16 v[60:63], v[168:171], v[116:119], v[60:63]
    ds_read_b64_tr_b16 v[194:195], v13 offset:4672
    s_add_u32 m0, s27, 56320
    s_nop 0
    buffer_load_dwordx4 v3, s[40:43], s30 offen sc1 lds
    s_waitcnt lgkmcnt(10)
    v_mfma_f32_16x16x32_bf16 v[64:67], v[172:175], v[112:115], v[64:67]
    ds_read_b64_tr_b16 v[196:197], v13 offset:96
    v_mfma_f32_16x16x32_bf16 v[68:71], v[172:175], v[116:119], v[68:71]
    ds_read_b64_tr_b16 v[198:199], v13 offset:4704
    s_waitcnt lgkmcnt(10)
    v_mfma_f32_16x16x32_bf16 v[72:75], v[176:179], v[112:115], v[72:75]
    ds_read_b64_tr_b16 v[168:169], v13 offset:128
    v_mfma_f32_16x16x32_bf16 v[76:79], v[176:179], v[116:119], v[76:79]
    ds_read_b64_tr_b16 v[170:171], v13 offset:4736
    s_add_u32 m0, s27, 57344
    s_nop 0
    buffer_load_dwordx4 v4, s[40:43], s30 offen sc1 lds
    s_waitcnt lgkmcnt(10)
    v_mfma_f32_16x16x32_bf16 v[80:83], v[180:183], v[112:115], v[80:83]
    ds_read_b64_tr_b16 v[172:173], v13 offset:160
    v_mfma_f32_16x16x32_bf16 v[84:87], v[180:183], v[116:119], v[84:87]
    ds_read_b64_tr_b16 v[174:175], v13 offset:4768
    s_waitcnt vmcnt(31) lgkmcnt(10)
    v_mfma_f32_16x16x32_bf16 v[16:19], v[184:187], v[120:123], v[16:19]
    ds_read_b64_tr_b16 v[176:177], v13 offset:192
    v_mfma_f32_16x16x32_bf16 v[20:23], v[184:187], v[124:127], v[20:23]
    ds_read_b64_tr_b16 v[178:179], v13 offset:4800
    s_add_u32 s33, s28, 40960
    buffer_load_dwordx4 v[112:115], v1, s[16:19], s33 offen offset:0 sc1
    buffer_load_dwordx4 v[116:119], v1, s[16:19], s33 offen offset:1024 sc1
    s_waitcnt lgkmcnt(10)
    v_mfma_f32_16x16x32_bf16 v[24:27], v[188:191], v[120:123], v[24:27]
    ds_read_b64_tr_b16 v[180:181], v13 offset:224
    v_mfma_f32_16x16x32_bf16 v[28:31], v[188:191], v[124:127], v[28:31]
    ds_read_b64_tr_b16 v[182:183], v13 offset:4832
    s_add_u32 m0, s27, 58368
    s_nop 0
    buffer_load_dwordx4 v5, s[40:43], s30 offen sc1 lds
    s_waitcnt lgkmcnt(10)
    v_mfma_f32_16x16x32_bf16 v[32:35], v[192:195], v[120:123], v[32:35]
    ds_read_b64_tr_b16 v[184:185], v13 offset:256
    v_mfma_f32_16x16x32_bf16 v[36:39], v[192:195], v[124:127], v[36:39]
    ds_read_b64_tr_b16 v[186:187], v13 offset:4864
    s_waitcnt lgkmcnt(10)
    v_mfma_f32_16x16x32_bf16 v[40:43], v[196:199], v[120:123], v[40:43]
    ds_read_b64_tr_b16 v[188:189], v13 offset:9216
    v_mfma_f32_16x16x32_bf16 v[44:47], v[196:199], v[124:127], v[44:47]
    ds_read_b64_tr_b16 v[190:191], v13 offset:13824
    s_add_u32 m0, s27, 59392
    s_nop 0
    buffer_load_dwordx4 v6, s[40:43], s30 offen sc1 lds
    s_waitcnt lgkmcnt(10)
    v_mfma_f32_16x16x32_bf16 v[48:51], v[168:171], v[120:123], v[48:51]
    ds_read_b64_tr_b16 v[192:193], v13 offset:9248
    v_mfma_f32_16x16x32_bf16 v[52:55], v[168:171], v[124:127], v[52:55]
    ds_read_b64_tr_b16 v[194:195], v13 offset:13856
    s_waitcnt lgkmcnt(10)
    v_mfma_f32_16x16x32_bf16 v[56:59], v[172:175], v[120:123], v[56:59]
    ds_read_b64_tr_b16 v[196:197], v13 offset:9280
    v_mfma_f32_16x16x32_bf16 v[60:63], v[172:175], v[124:127], v[60:63]
    ds_read_b64_tr_b16 v[198:199], v13 offset:13888
    s_add_u32 m0, s27, 60416
    s_nop 0
    buffer_load_dwordx4 v7, s[40:43], s30 offen sc1 lds
    s_waitcnt lgkmcnt(10)
    v_mfma_f32_16x16x32_bf16 v[64:67], v[176:179], v[120:123], v[64:67]
    ds_read_b64_tr_b16 v[168:169], v13 offset:9312
    v_mfma_f32_16x16x32_bf16 v[68:71], v[176:179], v[124:127], v[68:71]
    ds_read_b64_tr_b16 v[170:171], v13 offset:13920
    s_waitcnt lgkmcnt(10)
    v_mfma_f32_16x16x32_bf16 v[72:75], v[180:183], v[120:123], v[72:75]
    ds_read_b64_tr_b16 v[172:173], v13 offset:9344
    v_mfma_f32_16x16x32_bf16 v[76:79], v[180:183], v[124:127], v[76:79]
    ds_read_b64_tr_b16 v[174:175], v13 offset:13952
    s_add_u32 m0, s27, 61440
    s_mov_b32 exec_hi, 0xffff
    buffer_load_dwordx4 v8, s[40:43], s30 offen sc1 lds
    s_mov_b32 exec_hi, -1
    s_waitcnt lgkmcnt(10)
    v_mfma_f32_16x16x32_bf16 v[80:83], v[184:187], v[120:123], v[80:83]
    ds_read_b64_tr_b16 v[176:177], v13 offset:9376
    v_mfma_f32_16x16x32_bf16 v[84:87], v[184:187], v[124:127], v[84:87]
    ds_read_b64_tr_b16 v[178:179], v13 offset:13984
    s_waitcnt vmcnt(35) lgkmcnt(10)
    v_mfma_f32_16x16x32_bf16 v[16:19], v[188:191], v[128:131], v[16:19]
    ds_read_b64_tr_b16 v[180:181], v13 offset:9408
    v_mfma_f32_16x16x32_bf16 v[20:23], v[188:191], v[132:135], v[20:23]
    ds_read_b64_tr_b16 v[182:183], v13 offset:14016
    s_add_u32 s33, s28, 43008
    buffer_load_dwordx4 v[120:123], v1, s[16:19], s33 offen offset:0 sc1
    buffer_load_dwordx4 v[124:127], v1, s[16:19], s33 offen offset:1024 sc1
    s_waitcnt lgkmcnt(10)
    v_mfma_f32_16x16x32_bf16 v[24:27], v[192:195], v[128:131], v[24:27]
    ds_read_b64_tr_b16 v[184:185], v13 offset:9440
    v_mfma_f32_16x16x32_bf16 v[28:31], v[192:195], v[132:135], v[28:31]
    ds_read_b64_tr_b16 v[186:187], v13 offset:14048
    s_waitcnt lgkmcnt(10)
    v_mfma_f32_16x16x32_bf16 v[32:35], v[196:199], v[128:131], v[32:35]
    ds_read_b64_tr_b16 v[188:189], v13 offset:9472
    v_mfma_f32_16x16x32_bf16 v[36:39], v[196:199], v[132:135], v[36:39]
    ds_read_b64_tr_b16 v[190:191], v13 offset:14080
    s_waitcnt lgkmcnt(10)
    v_mfma_f32_16x16x32_bf16 v[40:43], v[168:171], v[128:131], v[40:43]
    ds_read_b64_tr_b16 v[192:193], v13 offset:18432
    v_mfma_f32_16x16x32_bf16 v[44:47], v[168:171], v[132:135], v[44:47]
    ds_read_b64_tr_b16 v[194:195], v13 offset:23040
    s_waitcnt lgkmcnt(10)
    v_mfma_f32_16x16x32_bf16 v[48:51], v[172:175], v[128:131], v[48:51]
    ds_read_b64_tr_b16 v[196:197], v13 offset:18464
    v_mfma_f32_16x16x32_bf16 v[52:55], v[172:175], v[132:135], v[52:55]
    ds_read_b64_tr_b16 v[198:199], v13 offset:23072
    s_waitcnt lgkmcnt(10)
    v_mfma_f32_16x16x32_bf16 v[56:59], v[176:179], v[128:131], v[56:59]
    ds_read_b64_tr_b16 v[168:169], v13 offset:18496
    v_mfma_f32_16x16x32_bf16 v[60:63], v[176:179], v[132:135], v[60:63]
    ds_read_b64_tr_b16 v[170:171], v13 offset:23104
    s_waitcnt lgkmcnt(10)
    v_mfma_f32_16x16x32_bf16 v[64:67], v[180:183], v[128:131], v[64:67]
    ds_read_b64_tr_b16 v[172:173], v13 offset:18528
    v_mfma_f32_16x16x32_bf16 v[68:71], v[180:183], v[132:135], v[68:71]
    ds_read_b64_tr_b16 v[174:175], v13 offset:23136
    s_waitcnt lgkmcnt(10)
    v_mfma_f32_16x16x32_bf16 v[72:75], v[184:187], v[128:131], v[72:75]
    ds_read_b64_tr_b16 v[176:177], v13 offset:18560
    v_mfma_f32_16x16x32_bf16 v[76:79], v[184:187], v[132:135], v[76:79]
    ds_read_b64_tr_b16 v[178:179], v13 offset:23168
    s_waitcnt lgkmcnt(10)
    v_mfma_f32_16x16x32_bf16 v[80:83], v[188:191], v[128:131], v[80:83]
    ds_read_b64_tr_b16 v[180:181], v13 offset:18592
    v_mfma_f32_16x16x32_bf16 v[84:87], v[188:191], v[132:135], v[84:87]
    ds_read_b64_tr_b16 v[182:183], v13 offset:23200
    s_waitcnt vmcnt(32) lgkmcnt(10)
    v_mfma_f32_16x16x32_bf16 v[16:19], v[192:195], v[136:139], v[16:19]
    ds_read_b64_tr_b16 v[184:185], v13 offset:18624
    v_mfma_f32_16x16x32_bf16 v[20:23], v[192:195], v[140:143], v[20:23]
    ds_read_b64_tr_b16 v[186:187], v13 offset:23232
    s_add_u32 s33, s28, 45056
    buffer_load_dwordx4 v[128:131], v1, s[16:19], s33 offen offset:0 sc1
    buffer_load_dwordx4 v[132:135], v1, s[16:19], s33 offen offset:1024 sc1
    s_waitcnt lgkmcnt(10)
    v_mfma_f32_16x16x32_bf16 v[24:27], v[196:199], v[136:139], v[24:27]
    ds_read_b64_tr_b16 v[188:189], v13 offset:18656
    v_mfma_f32_16x16x32_bf16 v[28:31], v[196:199], v[140:143], v[28:31]
    ds_read_b64_tr_b16 v[190:191], v13 offset:23264
    s_waitcnt lgkmcnt(10)
    v_mfma_f32_16x16x32_bf16 v[32:35], v[168:171], v[136:139], v[32:35]
    ds_read_b64_tr_b16 v[192:193], v13 offset:18688
    v_mfma_f32_16x16x32_bf16 v[36:39], v[168:171], v[140:143], v[36:39]
    ds_read_b64_tr_b16 v[194:195], v13 offset:23296
    s_waitcnt vmcnt(30)
    s_barrier
    s_waitcnt lgkmcnt(10)
    v_mfma_f32_16x16x32_bf16 v[40:43], v[172:175], v[136:139], v[40:43]
    ds_read_b64_tr_b16 v[196:197], v9 offset:0
    v_mfma_f32_16x16x32_bf16 v[44:47], v[172:175], v[140:143], v[44:47]
    ds_read_b64_tr_b16 v[198:199], v9 offset:4608
    s_add_u32 s30, s29, 884736
    s_add_u32 m0, s27, 82944
    s_nop 0
    buffer_load_dwordx4 v2, s[40:43], s30 offen sc1 lds
    s_waitcnt lgkmcnt(10)
    v_mfma_f32_16x16x32_bf16 v[48:51], v[176:179], v[136:139], v[48:51]
    ds_read_b64_tr_b16 v[168:169], v9 offset:32
    v_mfma_f32_16x16x32_bf16 v[52:55], v[176:179], v[140:143], v[52:55]
    ds_read_b64_tr_b16 v[170:171], v9 offset:4640
    s_waitcnt lgkmcnt(10)
    v_mfma_f32_16x16x32_bf16 v[56:59], v[180:183], v[136:139], v[56:59]
    ds_read_b64_tr_b16 v[172:173], v9 offset:64
    v_mfma_f32_16x16x32_bf16 v[60:63], v[180:183], v[140:143], v[60:63]
    ds_read_b64_tr_b16 v[174:175], v9 offset:4672
    s_add_u32 m0, s27, 83968
    s_nop 0
    buffer_load_dwordx4 v3, s[40:43], s30 offen sc1 lds
    s_waitcnt lgkmcnt(10)
    v_mfma_f32_16x16x32_bf16 v[64:67], v[184:187], v[136:139], v[64:67]
    ds_read_b64_tr_b16 v[176:177], v9 offset:96
    v_mfma_f32_16x16x32_bf16 v[68:71], v[184:187], v[140:143], v[68:71]
    ds_read_b64_tr_b16 v[178:179], v9 offset:4704
    s_waitcnt lgkmcnt(10)
    v_mfma_f32_16x16x32_bf16 v[72:75], v[188:191], v[136:139], v[72:75]
    ds_read_b64_tr_b16 v[180:181], v9 offset:128
    v_mfma_f32_16x16x32_bf16 v[76:79], v[188:191], v[140:143], v[76:79]
    ds_read_b64_tr_b16 v[182:183], v9 offset:4736
    s_add_u32 m0, s27, 84992
    s_nop 0
    buffer_load_dwordx4 v4, s[40:43], s30 offen sc1 lds
    s_waitcnt lgkmcnt(10)
    v_mfma_f32_16x16x32_bf16 v[80:83], v[192:195], v[136:139], v[80:83]
    ds_read_b64_tr_b16 v[184:185], v9 offset:160
    v_mfma_f32_16x16x32_bf16 v[84:87], v[192:195], v[140:143], v[84:87]
    ds_read_b64_tr_b16 v[186:187], v9 offset:4768
    s_waitcnt vmcnt(31) lgkmcnt(10)
    v_mfma_f32_16x16x32_bf16 v[16:19], v[196:199], v[144:147], v[16:19]
    ds_read_b64_tr_b16 v[188:189], v9 offset:192
    v_mfma_f32_16x16x32_bf16 v[20:23], v[196:199], v[148:151], v[20:23]
    ds_read_b64_tr_b16 v[190:191], v9 offset:4800
    s_add_u32 s33, s28, 47104
    buffer_load_dwordx4 v[136:139], v1, s[16:19], s33 offen offset:0 sc1
    buffer_load_dwordx4 v[140:143], v1, s[16:19], s33 offen offset:1024 sc1
    s_waitcnt lgkmcnt(10)
    v_mfma_f32_16x16x32_bf16 v[24:27], v[168:171], v[144:147], v[24:27]
    ds_read_b64_tr_b16 v[192:193], v9 offset:224
    v_mfma_f32_16x16x32_bf16 v[28:31], v[168:171], v[148:151], v[28:31]
    ds_read_b64_tr_b16 v[194:195], v9 offset:4832
    s_add_u32 m0, s27, 86016
    s_nop 0
    buffer_load_dwordx4 v5, s[40:43], s30 offen sc1 lds
    s_waitcnt lgkmcnt(10)
    v_mfma_f32_16x16x32_bf16 v[32:35], v[172:175], v[144:147], v[32:35]
    ds_read_b64_tr_b16 v[196:197], v9 offset:256
    v_mfma_f32_16x16x32_bf16 v[36:39], v[172:175], v[148:151], v[36:39]
    ds_read_b64_tr_b16 v[198:199], v9 offset:4864
    s_waitcnt lgkmcnt(10)
    v_mfma_f32_16x16x32_bf16 v[40:43], v[176:179], v[144:147], v[40:43]
    ds_read_b64_tr_b16 v[168:169], v9 offset:9216
    v_mfma_f32_16x16x32_bf16 v[44:47], v[176:179], v[148:151], v[44:47]
    ds_read_b64_tr_b16 v[170:171], v9 offset:13824
    s_add_u32 m0, s27, 87040
    s_nop 0
    buffer_load_dwordx4 v6, s[40:43], s30 offen sc1 lds
    s_waitcnt lgkmcnt(10)
    v_mfma_f32_16x16x32_bf16 v[48:51], v[180:183], v[144:147], v[48:51]
    ds_read_b64_tr_b16 v[172:173], v9 offset:9248
    v_mfma_f32_16x16x32_bf16 v[52:55], v[180:183], v[148:151], v[52:55]
    ds_read_b64_tr_b16 v[174:175], v9 offset:13856
    s_waitcnt lgkmcnt(10)
    v_mfma_f32_16x16x32_bf16 v[56:59], v[184:187], v[144:147], v[56:59]
    ds_read_b64_tr_b16 v[176:177], v9 offset:9280
    v_mfma_f32_16x16x32_bf16 v[60:63], v[184:187], v[148:151], v[60:63]
    ds_read_b64_tr_b16 v[178:179], v9 offset:13888
    s_add_u32 m0, s27, 88064
    s_nop 0
    buffer_load_dwordx4 v7, s[40:43], s30 offen sc1 lds
    s_waitcnt lgkmcnt(10)
    v_mfma_f32_16x16x32_bf16 v[64:67], v[188:191], v[144:147], v[64:67]
    ds_read_b64_tr_b16 v[180:181], v9 offset:9312
    v_mfma_f32_16x16x32_bf16 v[68:71], v[188:191], v[148:151], v[68:71]
    ds_read_b64_tr_b16 v[182:183], v9 offset:13920
    s_waitcnt lgkmcnt(10)
    v_mfma_f32_16x16x32_bf16 v[72:75], v[192:195], v[144:147], v[72:75]
    ds_read_b64_tr_b16 v[184:185], v9 offset:9344
    v_mfma_f32_16x16x32_bf16 v[76:79], v[192:195], v[148:151], v[76:79]
    ds_read_b64_tr_b16 v[186:187], v9 offset:13952
    s_add_u32 m0, s27, 89088
    s_mov_b32 exec_hi, 0xffff
    buffer_load_dwordx4 v8, s[40:43], s30 offen sc1 lds
    s_mov_b32 exec_hi, -1
    s_waitcnt lgkmcnt(10)
    v_mfma_f32_16x16x32_bf16 v[80:83], v[196:199], v[144:147], v[80:83]
    ds_read_b64_tr_b16 v[188:189], v9 offset:9376
    v_mfma_f32_16x16x32_bf16 v[84:87], v[196:199], v[148:151], v[84:87]
    ds_read_b64_tr_b16 v[190:191], v9 offset:13984
    s_waitcnt vmcnt(35) lgkmcnt(10)
    v_mfma_f32_16x16x32_bf16 v[16:19], v[168:171], v[152:155], v[16:19]
    ds_read_b64_tr_b16 v[192:193], v9 offset:9408
    v_mfma_f32_16x16x32_bf16 v[20:23], v[168:171], v[156:159], v[20:23]
    ds_read_b64_tr_b16 v[194:195], v9 offset:14016
    s_add_u32 s33, s28, 49152
    buffer_load_dwordx4 v[144:147], v1, s[16:19], s33 offen offset:0 sc1
    buffer_load_dwordx4 v[148:151], v1, s[16:19], s33 offen offset:1024 sc1
    s_waitcnt lgkmcnt(10)
    v_mfma_f32_16x16x32_bf16 v[24:27], v[172:175], v[152:155], v[24:27]
    ds_read_b64_tr_b16 v[196:197], v9 offset:9440
    v_mfma_f32_16x16x32_bf16 v[28:31], v[172:175], v[156:159], v[28:31]
    ds_read_b64_tr_b16 v[198:199], v9 offset:14048
    s_waitcnt lgkmcnt(10)
    v_mfma_f32_16x16x32_bf16 v[32:35], v[176:179], v[152:155], v[32:35]
    ds_read_b64_tr_b16 v[168:169], v9 offset:9472
    v_mfma_f32_16x16x32_bf16 v[36:39], v[176:179], v[156:159], v[36:39]
    ds_read_b64_tr_b16 v[170:171], v9 offset:14080
    s_waitcnt lgkmcnt(10)
    v_mfma_f32_16x16x32_bf16 v[40:43], v[180:183], v[152:155], v[40:43]
    ds_read_b64_tr_b16 v[172:173], v9 offset:18432
    v_mfma_f32_16x16x32_bf16 v[44:47], v[180:183], v[156:159], v[44:47]
    ds_read_b64_tr_b16 v[174:175], v9 offset:23040
    s_waitcnt lgkmcnt(10)
    v_mfma_f32_16x16x32_bf16 v[48:51], v[184:187], v[152:155], v[48:51]
    ds_read_b64_tr_b16 v[176:177], v9 offset:18464
    v_mfma_f32_16x16x32_bf16 v[52:55], v[184:187], v[156:159], v[52:55]
    ds_read_b64_tr_b16 v[178:179], v9 offset:23072
    s_waitcnt lgkmcnt(10)
    v_mfma_f32_16x16x32_bf16 v[56:59], v[188:191], v[152:155], v[56:59]
    ds_read_b64_tr_b16 v[180:181], v9 offset:18496
    v_mfma_f32_16x16x32_bf16 v[60:63], v[188:191], v[156:159], v[60:63]
    ds_read_b64_tr_b16 v[182:183], v9 offset:23104
    s_waitcnt lgkmcnt(10)
    v_mfma_f32_16x16x32_bf16 v[64:67], v[192:195], v[152:155], v[64:67]
    ds_read_b64_tr_b16 v[184:185], v9 offset:18528
    v_mfma_f32_16x16x32_bf16 v[68:71], v[192:195], v[156:159], v[68:71]
    ds_read_b64_tr_b16 v[186:187], v9 offset:23136
    s_waitcnt lgkmcnt(10)
    v_mfma_f32_16x16x32_bf16 v[72:75], v[196:199], v[152:155], v[72:75]
    ds_read_b64_tr_b16 v[188:189], v9 offset:18560
    v_mfma_f32_16x16x32_bf16 v[76:79], v[196:199], v[156:159], v[76:79]
    ds_read_b64_tr_b16 v[190:191], v9 offset:23168
    s_waitcnt lgkmcnt(10)
    v_mfma_f32_16x16x32_bf16 v[80:83], v[168:171], v[152:155], v[80:83]
    ds_read_b64_tr_b16 v[192:193], v9 offset:18592
    v_mfma_f32_16x16x32_bf16 v[84:87], v[168:171], v[156:159], v[84:87]
    ds_read_b64_tr_b16 v[194:195], v9 offset:23200
    s_waitcnt vmcnt(32) lgkmcnt(10)
    v_mfma_f32_16x16x32_bf16 v[16:19], v[172:175], v[160:163], v[16:19]
    ds_read_b64_tr_b16 v[196:197], v9 offset:18624
    v_mfma_f32_16x16x32_bf16 v[20:23], v[172:175], v[164:167], v[20:23]
    ds_read_b64_tr_b16 v[198:199], v9 offset:23232
    s_add_u32 s33, s28, 51200
    buffer_load_dwordx4 v[152:155], v1, s[16:19], s33 offen offset:0 sc1
    buffer_load_dwordx4 v[156:159], v1, s[16:19], s33 offen offset:1024 sc1
    s_waitcnt lgkmcnt(10)
    v_mfma_f32_16x16x32_bf16 v[24:27], v[176:179], v[160:163], v[24:27]
    ds_read_b64_tr_b16 v[168:169], v9 offset:18656
    v_mfma_f32_16x16x32_bf16 v[28:31], v[176:179], v[164:167], v[28:31]
    ds_read_b64_tr_b16 v[170:171], v9 offset:23264
    s_waitcnt lgkmcnt(10)
    v_mfma_f32_16x16x32_bf16 v[32:35], v[180:183], v[160:163], v[32:35]
    ds_read_b64_tr_b16 v[172:173], v9 offset:18688
    v_mfma_f32_16x16x32_bf16 v[36:39], v[180:183], v[164:167], v[36:39]
    ds_read_b64_tr_b16 v[174:175], v9 offset:23296
    s_waitcnt vmcnt(30)
    s_barrier
    s_waitcnt lgkmcnt(10)
    v_mfma_f32_16x16x32_bf16 v[40:43], v[184:187], v[160:163], v[40:43]
    ds_read_b64_tr_b16 v[176:177], v10 offset:0
    v_mfma_f32_16x16x32_bf16 v[44:47], v[184:187], v[164:167], v[44:47]
    ds_read_b64_tr_b16 v[178:179], v10 offset:4608
    s_add_u32 s30, s29, 995328
    s_add_u32 m0, s27, 110592
    s_nop 0
    buffer_load_dwordx4 v2, s[40:43], s30 offen sc1 lds
    s_waitcnt lgkmcnt(10)
    v_mfma_f32_16x16x32_bf16 v[48:51], v[188:191], v[160:163], v[48:51]
    ds_read_b64_tr_b16 v[180:181], v10 offset:32
    v_mfma_f32_16x16x32_bf16 v[52:55], v[188:191], v[164:167], v[52:55]
    ds_read_b64_tr_b16 v[182:183], v10 offset:4640
    s_waitcnt lgkmcnt(10)
    v_mfma_f32_16x16x32_bf16 v[56:59], v[192:195], v[160:163], v[56:59]
    ds_read_b64_tr_b16 v[184:185], v10 offset:64
    v_mfma_f32_16x16x32_bf16 v[60:63], v[192:195], v[164:167], v[60:63]
    ds_read_b64_tr_b16 v[186:187], v10 offset:4672
    s_add_u32 m0, s27, 111616
    s_nop 0
    buffer_load_dwordx4 v3, s[40:43], s30 offen sc1 lds
    s_waitcnt lgkmcnt(10)
    v_mfma_f32_16x16x32_bf16 v[64:67], v[196:199], v[160:163], v[64:67]
    ds_read_b64_tr_b16 v[188:189], v10 offset:96
    v_mfma_f32_16x16x32_bf16 v[68:71], v[196:199], v[164:167], v[68:71]
    ds_read_b64_tr_b16 v[190:191], v10 offset:4704
    s_waitcnt lgkmcnt(10)
    v_mfma_f32_16x16x32_bf16 v[72:75], v[168:171], v[160:163], v[72:75]
    ds_read_b64_tr_b16 v[192:193], v10 offset:128
    v_mfma_f32_16x16x32_bf16 v[76:79], v[168:171], v[164:167], v[76:79]
    ds_read_b64_tr_b16 v[194:195], v10 offset:4736
    s_add_u32 m0, s27, 112640
    s_nop 0
    buffer_load_dwordx4 v4, s[40:43], s30 offen sc1 lds
    s_waitcnt lgkmcnt(10)
    v_mfma_f32_16x16x32_bf16 v[80:83], v[172:175], v[160:163], v[80:83]
    ds_read_b64_tr_b16 v[196:197], v10 offset:160
    v_mfma_f32_16x16x32_bf16 v[84:87], v[172:175], v[164:167], v[84:87]
    ds_read_b64_tr_b16 v[198:199], v10 offset:4768
    s_waitcnt vmcnt(31) lgkmcnt(10)
    v_mfma_f32_16x16x32_bf16 v[16:19], v[176:179], v[96:99], v[16:19]
    ds_read_b64_tr_b16 v[168:169], v10 offset:192
    v_mfma_f32_16x16x32_bf16 v[20:23], v[176:179], v[100:103], v[20:23]
    ds_read_b64_tr_b16 v[170:171], v10 offset:4800
    s_add_u32 s33, s28, 53248
    buffer_load_dwordx4 v[160:163], v1, s[16:19], s33 offen offset:0 sc1
    buffer_load_dwordx4 v[164:167], v1, s[16:19], s33 offen offset:1024 sc1
    s_waitcnt lgkmcnt(10)
    v_mfma_f32_16x16x32_bf16 v[24:27], v[180:183], v[96:99], v[24:27]
    ds_read_b64_tr_b16 v[172:173], v10 offset:224
    v_mfma_f32_16x16x32_bf16 v[28:31], v[180:183], v[100:103], v[28:31]
    ds_read_b64_tr_b16 v[174:175], v10 offset:4832
    s_add_u32 m0, s27, 113664
    s_nop 0
    buffer_load_dwordx4 v5, s[40:43], s30 offen sc1 lds
    s_waitcnt lgkmcnt(10)
    v_mfma_f32_16x16x32_bf16 v[32:35], v[184:187], v[96:99], v[32:35]
    ds_read_b64_tr_b16 v[176:177], v10 offset:256
    v_mfma_f32_16x16x32_bf16 v[36:39], v[184:187], v[100:103], v[36:39]
    ds_read_b64_tr_b16 v[178:179], v10 offset:4864
    s_waitcnt lgkmcnt(10)
    v_mfma_f32_16x16x32_bf16 v[40:43], v[188:191], v[96:99], v[40:43]
    ds_read_b64_tr_b16 v[180:181], v10 offset:9216
    v_mfma_f32_16x16x32_bf16 v[44:47], v[188:191], v[100:103], v[44:47]
    ds_read_b64_tr_b16 v[182:183], v10 offset:13824
    s_add_u32 m0, s27, 114688
    s_nop 0
    buffer_load_dwordx4 v6, s[40:43], s30 offen sc1 lds
    s_waitcnt lgkmcnt(10)
    v_mfma_f32_16x16x32_bf16 v[48:51], v[192:195], v[96:99], v[48:51]
    ds_read_b64_tr_b16 v[184:185], v10 offset:9248
    v_mfma_f32_16x16x32_bf16 v[52:55], v[192:195], v[100:103], v[52:55]
    ds_read_b64_tr_b16 v[186:187], v10 offset:13856
    s_waitcnt lgkmcnt(10)
    v_mfma_f32_16x16x32_bf16 v[56:59], v[196:199], v[96:99], v[56:59]
    ds_read_b64_tr_b16 v[188:189], v10 offset:9280
    v_mfma_f32_16x16x32_bf16 v[60:63], v[196:199], v[100:103], v[60:63]
    ds_read_b64_tr_b16 v[190:191], v10 offset:13888
    s_add_u32 m0, s27, 115712
    s_nop 0
    buffer_load_dwordx4 v7, s[40:43], s30 offen sc1 lds
    s_waitcnt lgkmcnt(10)
    v_mfma_f32_16x16x32_bf16 v[64:67], v[168:171], v[96:99], v[64:67]
    ds_read_b64_tr_b16 v[192:193], v10 offset:9312
    v_mfma_f32_16x16x32_bf16 v[68:71], v[168:171], v[100:103], v[68:71]
    ds_read_b64_tr_b16 v[194:195], v10 offset:13920
    s_waitcnt lgkmcnt(10)
    v_mfma_f32_16x16x32_bf16 v[72:75], v[172:175], v[96:99], v[72:75]
    ds_read_b64_tr_b16 v[196:197], v10 offset:9344
    v_mfma_f32_16x16x32_bf16 v[76:79], v[172:175], v[100:103], v[76:79]
    ds_read_b64_tr_b16 v[198:199], v10 offset:13952
    s_add_u32 m0, s27, 116736
    s_mov_b32 exec_hi, 0xffff
    buffer_load_dwordx4 v8, s[40:43], s30 offen sc1 lds
    s_mov_b32 exec_hi, -1
    s_waitcnt lgkmcnt(10)
    v_mfma_f32_16x16x32_bf16 v[80:83], v[176:179], v[96:99], v[80:83]
    ds_read_b64_tr_b16 v[168:169], v10 offset:9376
    v_mfma_f32_16x16x32_bf16 v[84:87], v[176:179], v[100:103], v[84:87]
    ds_read_b64_tr_b16 v[170:171], v10 offset:13984
    s_waitcnt vmcnt(35) lgkmcnt(10)
    v_mfma_f32_16x16x32_bf16 v[16:19], v[180:183], v[104:107], v[16:19]
    ds_read_b64_tr_b16 v[172:173], v10 offset:9408
    v_mfma_f32_16x16x32_bf16 v[20:23], v[180:183], v[108:111], v[20:23]
    ds_read_b64_tr_b16 v[174:175], v10 offset:14016
    s_add_u32 s33, s28, 55296
    buffer_load_dwordx4 v[96:99], v1, s[16:19], s33 offen offset:0 sc1
    buffer_load_dwordx4 v[100:103], v1, s[16:19], s33 offen offset:1024 sc1
    s_waitcnt lgkmcnt(10)
    v_mfma_f32_16x16x32_bf16 v[24:27], v[184:187], v[104:107], v[24:27]
    ds_read_b64_tr_b16 v[176:177], v10 offset:9440
    v_mfma_f32_16x16x32_bf16 v[28:31], v[184:187], v[108:111], v[28:31]
    ds_read_b64_tr_b16 v[178:179], v10 offset:14048
    s_waitcnt lgkmcnt(10)
    v_mfma_f32_16x16x32_bf16 v[32:35], v[188:191], v[104:107], v[32:35]
    ds_read_b64_tr_b16 v[180:181], v10 offset:9472
    v_mfma_f32_16x16x32_bf16 v[36:39], v[188:191], v[108:111], v[36:39]
    ds_read_b64_tr_b16 v[182:183], v10 offset:14080
    s_waitcnt lgkmcnt(10)
    v_mfma_f32_16x16x32_bf16 v[40:43], v[192:195], v[104:107], v[40:43]
    ds_read_b64_tr_b16 v[184:185], v10 offset:18432
    v_mfma_f32_16x16x32_bf16 v[44:47], v[192:195], v[108:111], v[44:47]
    ds_read_b64_tr_b16 v[186:187], v10 offset:23040
    s_waitcnt lgkmcnt(10)
    v_mfma_f32_16x16x32_bf16 v[48:51], v[196:199], v[104:107], v[48:51]
    ds_read_b64_tr_b16 v[188:189], v10 offset:18464
    v_mfma_f32_16x16x32_bf16 v[52:55], v[196:199], v[108:111], v[52:55]
    ds_read_b64_tr_b16 v[190:191], v10 offset:23072
    s_waitcnt lgkmcnt(10)
    v_mfma_f32_16x16x32_bf16 v[56:59], v[168:171], v[104:107], v[56:59]
    ds_read_b64_tr_b16 v[192:193], v10 offset:18496
    v_mfma_f32_16x16x32_bf16 v[60:63], v[168:171], v[108:111], v[60:63]
    ds_read_b64_tr_b16 v[194:195], v10 offset:23104
    s_waitcnt lgkmcnt(10)
    v_mfma_f32_16x16x32_bf16 v[64:67], v[172:175], v[104:107], v[64:67]
    ds_read_b64_tr_b16 v[196:197], v10 offset:18528
    v_mfma_f32_16x16x32_bf16 v[68:71], v[172:175], v[108:111], v[68:71]
    ds_read_b64_tr_b16 v[198:199], v10 offset:23136
    s_waitcnt lgkmcnt(10)
    v_mfma_f32_16x16x32_bf16 v[72:75], v[176:179], v[104:107], v[72:75]
    ds_read_b64_tr_b16 v[168:169], v10 offset:18560
    v_mfma_f32_16x16x32_bf16 v[76:79], v[176:179], v[108:111], v[76:79]
    ds_read_b64_tr_b16 v[170:171], v10 offset:23168
    s_waitcnt lgkmcnt(10)
    v_mfma_f32_16x16x32_bf16 v[80:83], v[180:183], v[104:107], v[80:83]
    ds_read_b64_tr_b16 v[172:173], v10 offset:18592
    v_mfma_f32_16x16x32_bf16 v[84:87], v[180:183], v[108:111], v[84:87]
    ds_read_b64_tr_b16 v[174:175], v10 offset:23200
    s_waitcnt vmcnt(32) lgkmcnt(10)
    v_mfma_f32_16x16x32_bf16 v[16:19], v[184:187], v[112:115], v[16:19]
    ds_read_b64_tr_b16 v[176:177], v10 offset:18624
    v_mfma_f32_16x16x32_bf16 v[20:23], v[184:187], v[116:119], v[20:23]
    ds_read_b64_tr_b16 v[178:179], v10 offset:23232
    s_add_u32 s33, s28, 57344
    buffer_load_dwordx4 v[104:107], v1, s[16:19], s33 offen offset:0 sc1
    buffer_load_dwordx4 v[108:111], v1, s[16:19], s33 offen offset:1024 sc1
    s_waitcnt lgkmcnt(10)
    v_mfma_f32_16x16x32_bf16 v[24:27], v[188:191], v[112:115], v[24:27]
    ds_read_b64_tr_b16 v[180:181], v10 offset:18656
    v_mfma_f32_16x16x32_bf16 v[28:31], v[188:191], v[116:119], v[28:31]
    ds_read_b64_tr_b16 v[182:183], v10 offset:23264
    s_waitcnt lgkmcnt(10)
    v_mfma_f32_16x16x32_bf16 v[32:35], v[192:195], v[112:115], v[32:35]
    ds_read_b64_tr_b16 v[184:185], v10 offset:18688
    v_mfma_f32_16x16x32_bf16 v[36:39], v[192:195], v[116:119], v[36:39]
    ds_read_b64_tr_b16 v[186:187], v10 offset:23296
    s_waitcnt vmcnt(30)
    s_barrier
    s_waitcnt lgkmcnt(10)
    v_mfma_f32_16x16x32_bf16 v[40:43], v[196:199], v[112:115], v[40:43]
    ds_read_b64_tr_b16 v[188:189], v11 offset:0
    v_mfma_f32_16x16x32_bf16 v[44:47], v[196:199], v[116:119], v[44:47]
    ds_read_b64_tr_b16 v[190:191], v11 offset:4608
    s_add_u32 s30, s29, 1105920
    s_add_u32 m0, s27, 0
    s_nop 0
    buffer_load_dwordx4 v2, s[40:43], s30 offen sc1 lds
    s_waitcnt lgkmcnt(10)
    v_mfma_f32_16x16x32_bf16 v[48:51], v[168:171], v[112:115], v[48:51]
    ds_read_b64_tr_b16 v[192:193], v11 offset:32
    v_mfma_f32_16x16x32_bf16 v[52:55], v[168:171], v[116:119], v[52:55]
    ds_read_b64_tr_b16 v[194:195], v11 offset:4640
    s_waitcnt lgkmcnt(10)
    v_mfma_f32_16x16x32_bf16 v[56:59], v[172:175], v[112:115], v[56:59]
    ds_read_b64_tr_b16 v[196:197], v11 offset:64
    v_mfma_f32_16x16x32_bf16 v[60:63], v[172:175], v[116:119], v[60:63]
    ds_read_b64_tr_b16 v[198:199], v11 offset:4672
    s_add_u32 m0, s27, 1024
    s_nop 0
    buffer_load_dwordx4 v3, s[40:43], s30 offen sc1 lds
    s_waitcnt lgkmcnt(10)
    v_mfma_f32_16x16x32_bf16 v[64:67], v[176:179], v[112:115], v[64:67]
    ds_read_b64_tr_b16 v[168:169], v11 offset:96
    v_mfma_f32_16x16x32_bf16 v[68:71], v[176:179], v[116:119], v[68:71]
    ds_read_b64_tr_b16 v[170:171], v11 offset:4704
    s_waitcnt lgkmcnt(10)
    v_mfma_f32_16x16x32_bf16 v[72:75], v[180:183], v[112:115], v[72:75]
    ds_read_b64_tr_b16 v[172:173], v11 offset:128
    v_mfma_f32_16x16x32_bf16 v[76:79], v[180:183], v[116:119], v[76:79]
    ds_read_b64_tr_b16 v[174:175], v11 offset:4736
    s_add_u32 m0, s27, 2048
    s_nop 0
    buffer_load_dwordx4 v4, s[40:43], s30 offen sc1 lds
    s_waitcnt lgkmcnt(10)
    v_mfma_f32_16x16x32_bf16 v[80:83], v[184:187], v[112:115], v[80:83]
    ds_read_b64_tr_b16 v[176:177], v11 offset:160
    v_mfma_f32_16x16x32_bf16 v[84:87], v[184:187], v[116:119], v[84:87]
    ds_read_b64_tr_b16 v[178:179], v11 offset:4768
    s_waitcnt vmcnt(31) lgkmcnt(10)
    v_mfma_f32_16x16x32_bf16 v[16:19], v[188:191], v[120:123], v[16:19]
    ds_read_b64_tr_b16 v[180:181], v11 offset:192
    v_mfma_f32_16x16x32_bf16 v[20:23], v[188:191], v[124:127], v[20:23]
    ds_read_b64_tr_b16 v[182:183], v11 offset:4800
    s_add_u32 s33, s28, 59392
    buffer_load_dwordx4 v[112:115], v1, s[16:19], s33 offen offset:0 sc1
    buffer_load_dwordx4 v[116:119], v1, s[16:19], s33 offen offset:1024 sc1
    s_waitcnt lgkmcnt(10)
    v_mfma_f32_16x16x32_bf16 v[24:27], v[192:195], v[120:123], v[24:27]
    ds_read_b64_tr_b16 v[184:185], v11 offset:224
    v_mfma_f32_16x16x32_bf16 v[28:31], v[192:195], v[124:127], v[28:31]
    ds_read_b64_tr_b16 v[186:187], v11 offset:4832
    s_add_u32 m0, s27, 3072
    s_nop 0
    buffer_load_dwordx4 v5, s[40:43], s30 offen sc1 lds
    s_waitcnt lgkmcnt(10)
    v_mfma_f32_16x16x32_bf16 v[32:35], v[196:199], v[120:123], v[32:35]
    ds_read_b64_tr_b16 v[188:189], v11 offset:256
    v_mfma_f32_16x16x32_bf16 v[36:39], v[196:199], v[124:127], v[36:39]
    ds_read_b64_tr_b16 v[190:191], v11 offset:4864
    s_waitcnt lgkmcnt(10)
    v_mfma_f32_16x16x32_bf16 v[40:43], v[168:171], v[120:123], v[40:43]
    ds_read_b64_tr_b16 v[192:193], v11 offset:9216
    v_mfma_f32_16x16x32_bf16 v[44:47], v[168:171], v[124:127], v[44:47]
    ds_read_b64_tr_b16 v[194:195], v11 offset:13824
    s_add_u32 m0, s27, 4096
    s_nop 0
    buffer_load_dwordx4 v6, s[40:43], s30 offen sc1 lds
    s_waitcnt lgkmcnt(10)
    v_mfma_f32_16x16x32_bf16 v[48:51], v[172:175], v[120:123], v[48:51]
    ds_read_b64_tr_b16 v[196:197], v11 offset:9248
    v_mfma_f32_16x16x32_bf16 v[52:55], v[172:175], v[124:127], v[52:55]
    ds_read_b64_tr_b16 v[198:199], v11 offset:13856
    s_waitcnt lgkmcnt(10)
    v_mfma_f32_16x16x32_bf16 v[56:59], v[176:179], v[120:123], v[56:59]
    ds_read_b64_tr_b16 v[168:169], v11 offset:9280
    v_mfma_f32_16x16x32_bf16 v[60:63], v[176:179], v[124:127], v[60:63]
    ds_read_b64_tr_b16 v[170:171], v11 offset:13888
    s_add_u32 m0, s27, 5120
    s_nop 0
    buffer_load_dwordx4 v7, s[40:43], s30 offen sc1 lds
    s_waitcnt lgkmcnt(10)
    v_mfma_f32_16x16x32_bf16 v[64:67], v[180:183], v[120:123], v[64:67]
    ds_read_b64_tr_b16 v[172:173], v11 offset:9312
    v_mfma_f32_16x16x32_bf16 v[68:71], v[180:183], v[124:127], v[68:71]
    ds_read_b64_tr_b16 v[174:175], v11 offset:13920
    s_waitcnt lgkmcnt(10)
    v_mfma_f32_16x16x32_bf16 v[72:75], v[184:187], v[120:123], v[72:75]
    ds_read_b64_tr_b16 v[176:177], v11 offset:9344
    v_mfma_f32_16x16x32_bf16 v[76:79], v[184:187], v[124:127], v[76:79]
    ds_read_b64_tr_b16 v[178:179], v11 offset:13952
    s_add_u32 m0, s27, 6144
    s_mov_b32 exec_hi, 0xffff
    buffer_load_dwordx4 v8, s[40:43], s30 offen sc1 lds
    s_mov_b32 exec_hi, -1
    s_waitcnt lgkmcnt(10)
    v_mfma_f32_16x16x32_bf16 v[80:83], v[188:191], v[120:123], v[80:83]
    ds_read_b64_tr_b16 v[180:181], v11 offset:9376
    v_mfma_f32_16x16x32_bf16 v[84:87], v[188:191], v[124:127], v[84:87]
    ds_read_b64_tr_b16 v[182:183], v11 offset:13984
    s_waitcnt vmcnt(35) lgkmcnt(10)
    v_mfma_f32_16x16x32_bf16 v[16:19], v[192:195], v[128:131], v[16:19]
    ds_read_b64_tr_b16 v[184:185], v11 offset:9408
    v_mfma_f32_16x16x32_bf16 v[20:23], v[192:195], v[132:135], v[20:23]
    ds_read_b64_tr_b16 v[186:187], v11 offset:14016
    s_add_u32 s33, s28, 61440
    buffer_load_dwordx4 v[120:123], v1, s[16:19], s33 offen offset:0 sc1
    buffer_load_dwordx4 v[124:127], v1, s[16:19], s33 offen offset:1024 sc1
    s_waitcnt lgkmcnt(10)
    v_mfma_f32_16x16x32_bf16 v[24:27], v[196:199], v[128:131], v[24:27]
    ds_read_b64_tr_b16 v[188:189], v11 offset:9440
    v_mfma_f32_16x16x32_bf16 v[28:31], v[196:199], v[132:135], v[28:31]
    ds_read_b64_tr_b16 v[190:191], v11 offset:14048
    s_waitcnt lgkmcnt(10)
    v_mfma_f32_16x16x32_bf16 v[32:35], v[168:171], v[128:131], v[32:35]
    ds_read_b64_tr_b16 v[192:193], v11 offset:9472
    v_mfma_f32_16x16x32_bf16 v[36:39], v[168:171], v[132:135], v[36:39]
    ds_read_b64_tr_b16 v[194:195], v11 offset:14080
    s_waitcnt lgkmcnt(10)
    v_mfma_f32_16x16x32_bf16 v[40:43], v[172:175], v[128:131], v[40:43]
    ds_read_b64_tr_b16 v[196:197], v11 offset:18432
    v_mfma_f32_16x16x32_bf16 v[44:47], v[172:175], v[132:135], v[44:47]
    ds_read_b64_tr_b16 v[198:199], v11 offset:23040
    s_waitcnt lgkmcnt(10)
    v_mfma_f32_16x16x32_bf16 v[48:51], v[176:179], v[128:131], v[48:51]
    ds_read_b64_tr_b16 v[168:169], v11 offset:18464
    v_mfma_f32_16x16x32_bf16 v[52:55], v[176:179], v[132:135], v[52:55]
    ds_read_b64_tr_b16 v[170:171], v11 offset:23072
    s_waitcnt lgkmcnt(10)
    v_mfma_f32_16x16x32_bf16 v[56:59], v[180:183], v[128:131], v[56:59]
    ds_read_b64_tr_b16 v[172:173], v11 offset:18496
    v_mfma_f32_16x16x32_bf16 v[60:63], v[180:183], v[132:135], v[60:63]
    ds_read_b64_tr_b16 v[174:175], v11 offset:23104
    s_waitcnt lgkmcnt(10)
    v_mfma_f32_16x16x32_bf16 v[64:67], v[184:187], v[128:131], v[64:67]
    ds_read_b64_tr_b16 v[176:177], v11 offset:18528
    v_mfma_f32_16x16x32_bf16 v[68:71], v[184:187], v[132:135], v[68:71]
    ds_read_b64_tr_b16 v[178:179], v11 offset:23136
    s_waitcnt lgkmcnt(10)
    v_mfma_f32_16x16x32_bf16 v[72:75], v[188:191], v[128:131], v[72:75]
    ds_read_b64_tr_b16 v[180:181], v11 offset:18560
    v_mfma_f32_16x16x32_bf16 v[76:79], v[188:191], v[132:135], v[76:79]
    ds_read_b64_tr_b16 v[182:183], v11 offset:23168
    s_waitcnt lgkmcnt(10)
    v_mfma_f32_16x16x32_bf16 v[80:83], v[192:195], v[128:131], v[80:83]
    ds_read_b64_tr_b16 v[184:185], v11 offset:18592
    v_mfma_f32_16x16x32_bf16 v[84:87], v[192:195], v[132:135], v[84:87]
    ds_read_b64_tr_b16 v[186:187], v11 offset:23200
    s_waitcnt vmcnt(32) lgkmcnt(10)
    v_mfma_f32_16x16x32_bf16 v[16:19], v[196:199], v[136:139], v[16:19]
    ds_read_b64_tr_b16 v[188:189], v11 offset:18624
    v_mfma_f32_16x16x32_bf16 v[20:23], v[196:199], v[140:143], v[20:23]
    ds_read_b64_tr_b16 v[190:191], v11 offset:23232
    s_add_u32 s33, s28, 63488
    buffer_load_dwordx4 v[128:131], v1, s[16:19], s33 offen offset:0 sc1
    buffer_load_dwordx4 v[132:135], v1, s[16:19], s33 offen offset:1024 sc1
    s_waitcnt lgkmcnt(10)
    v_mfma_f32_16x16x32_bf16 v[24:27], v[168:171], v[136:139], v[24:27]
    ds_read_b64_tr_b16 v[192:193], v11 offset:18656
    v_mfma_f32_16x16x32_bf16 v[28:31], v[168:171], v[140:143], v[28:31]
    ds_read_b64_tr_b16 v[194:195], v11 offset:23264
    s_waitcnt lgkmcnt(10)
    v_mfma_f32_16x16x32_bf16 v[32:35], v[172:175], v[136:139], v[32:35]
    ds_read_b64_tr_b16 v[196:197], v11 offset:18688
    v_mfma_f32_16x16x32_bf16 v[36:39], v[172:175], v[140:143], v[36:39]
    ds_read_b64_tr_b16 v[198:199], v11 offset:23296
    s_waitcnt vmcnt(30)
    s_barrier
    s_waitcnt lgkmcnt(10)
    v_mfma_f32_16x16x32_bf16 v[40:43], v[176:179], v[136:139], v[40:43]
    ds_read_b64_tr_b16 v[168:169], v12 offset:0
    v_mfma_f32_16x16x32_bf16 v[44:47], v[176:179], v[140:143], v[44:47]
    ds_read_b64_tr_b16 v[170:171], v12 offset:4608
    s_add_u32 s30, s29, 1216512
    s_add_u32 m0, s27, 27648
    s_nop 0
    buffer_load_dwordx4 v2, s[40:43], s30 offen sc1 lds
    s_waitcnt lgkmcnt(10)
    v_mfma_f32_16x16x32_bf16 v[48:51], v[180:183], v[136:139], v[48:51]
    ds_read_b64_tr_b16 v[172:173], v12 offset:32
    v_mfma_f32_16x16x32_bf16 v[52:55], v[180:183], v[140:143], v[52:55]
    ds_read_b64_tr_b16 v[174:175], v12 offset:4640
    s_waitcnt lgkmcnt(10)
    v_mfma_f32_16x16x32_bf16 v[56:59], v[184:187], v[136:139], v[56:59]
    ds_read_b64_tr_b16 v[176:177], v12 offset:64
    v_mfma_f32_16x16x32_bf16 v[60:63], v[184:187], v[140:143], v[60:63]
    ds_read_b64_tr_b16 v[178:179], v12 offset:4672
    s_add_u32 m0, s27, 28672
    s_nop 0
    buffer_load_dwordx4 v3, s[40:43], s30 offen sc1 lds
    s_waitcnt lgkmcnt(10)
    v_mfma_f32_16x16x32_bf16 v[64:67], v[188:191], v[136:139], v[64:67]
    ds_read_b64_tr_b16 v[180:181], v12 offset:96
    v_mfma_f32_16x16x32_bf16 v[68:71], v[188:191], v[140:143], v[68:71]
    ds_read_b64_tr_b16 v[182:183], v12 offset:4704
    s_waitcnt lgkmcnt(10)
    v_mfma_f32_16x16x32_bf16 v[72:75], v[192:195], v[136:139], v[72:75]
    ds_read_b64_tr_b16 v[184:185], v12 offset:128
    v_mfma_f32_16x16x32_bf16 v[76:79], v[192:195], v[140:143], v[76:79]
    ds_read_b64_tr_b16 v[186:187], v12 offset:4736
    s_add_u32 m0, s27, 29696
    s_nop 0
    buffer_load_dwordx4 v4, s[40:43], s30 offen sc1 lds
    s_waitcnt lgkmcnt(10)
    v_mfma_f32_16x16x32_bf16 v[80:83], v[196:199], v[136:139], v[80:83]
    ds_read_b64_tr_b16 v[188:189], v12 offset:160
    v_mfma_f32_16x16x32_bf16 v[84:87], v[196:199], v[140:143], v[84:87]
    ds_read_b64_tr_b16 v[190:191], v12 offset:4768
    s_waitcnt vmcnt(31) lgkmcnt(10)
    v_mfma_f32_16x16x32_bf16 v[16:19], v[168:171], v[144:147], v[16:19]
    ds_read_b64_tr_b16 v[192:193], v12 offset:192
    v_mfma_f32_16x16x32_bf16 v[20:23], v[168:171], v[148:151], v[20:23]
    ds_read_b64_tr_b16 v[194:195], v12 offset:4800
    s_add_u32 s33, s28, 65536
    buffer_load_dwordx4 v[136:139], v1, s[16:19], s33 offen offset:0 sc1
    buffer_load_dwordx4 v[140:143], v1, s[16:19], s33 offen offset:1024 sc1
    s_waitcnt lgkmcnt(10)
    v_mfma_f32_16x16x32_bf16 v[24:27], v[172:175], v[144:147], v[24:27]
    ds_read_b64_tr_b16 v[196:197], v12 offset:224
    v_mfma_f32_16x16x32_bf16 v[28:31], v[172:175], v[148:151], v[28:31]
    ds_read_b64_tr_b16 v[198:199], v12 offset:4832
    s_add_u32 m0, s27, 30720
    s_nop 0
    buffer_load_dwordx4 v5, s[40:43], s30 offen sc1 lds
    s_waitcnt lgkmcnt(10)
    v_mfma_f32_16x16x32_bf16 v[32:35], v[176:179], v[144:147], v[32:35]
    ds_read_b64_tr_b16 v[168:169], v12 offset:256
    v_mfma_f32_16x16x32_bf16 v[36:39], v[176:179], v[148:151], v[36:39]
    ds_read_b64_tr_b16 v[170:171], v12 offset:4864
    s_waitcnt lgkmcnt(10)
    v_mfma_f32_16x16x32_bf16 v[40:43], v[180:183], v[144:147], v[40:43]
    ds_read_b64_tr_b16 v[172:173], v12 offset:9216
    v_mfma_f32_16x16x32_bf16 v[44:47], v[180:183], v[148:151], v[44:47]
    ds_read_b64_tr_b16 v[174:175], v12 offset:13824
    s_add_u32 m0, s27, 31744
    s_nop 0
    buffer_load_dwordx4 v6, s[40:43], s30 offen sc1 lds
    s_waitcnt lgkmcnt(10)
    v_mfma_f32_16x16x32_bf16 v[48:51], v[184:187], v[144:147], v[48:51]
    ds_read_b64_tr_b16 v[176:177], v12 offset:9248
    v_mfma_f32_16x16x32_bf16 v[52:55], v[184:187], v[148:151], v[52:55]
    ds_read_b64_tr_b16 v[178:179], v12 offset:13856
    s_waitcnt lgkmcnt(10)
    v_mfma_f32_16x16x32_bf16 v[56:59], v[188:191], v[144:147], v[56:59]
    ds_read_b64_tr_b16 v[180:181], v12 offset:9280
    v_mfma_f32_16x16x32_bf16 v[60:63], v[188:191], v[148:151], v[60:63]
    ds_read_b64_tr_b16 v[182:183], v12 offset:13888
    s_add_u32 m0, s27, 32768
    s_nop 0
    buffer_load_dwordx4 v7, s[40:43], s30 offen sc1 lds
    s_waitcnt lgkmcnt(10)
    v_mfma_f32_16x16x32_bf16 v[64:67], v[192:195], v[144:147], v[64:67]
    ds_read_b64_tr_b16 v[184:185], v12 offset:9312
    v_mfma_f32_16x16x32_bf16 v[68:71], v[192:195], v[148:151], v[68:71]
    ds_read_b64_tr_b16 v[186:187], v12 offset:13920
    s_waitcnt lgkmcnt(10)
    v_mfma_f32_16x16x32_bf16 v[72:75], v[196:199], v[144:147], v[72:75]
    ds_read_b64_tr_b16 v[188:189], v12 offset:9344
    v_mfma_f32_16x16x32_bf16 v[76:79], v[196:199], v[148:151], v[76:79]
    ds_read_b64_tr_b16 v[190:191], v12 offset:13952
    s_add_u32 m0, s27, 33792
    s_mov_b32 exec_hi, 0xffff
    buffer_load_dwordx4 v8, s[40:43], s30 offen sc1 lds
    s_mov_b32 exec_hi, -1
    s_waitcnt lgkmcnt(10)
    v_mfma_f32_16x16x32_bf16 v[80:83], v[168:171], v[144:147], v[80:83]
    ds_read_b64_tr_b16 v[192:193], v12 offset:9376
    v_mfma_f32_16x16x32_bf16 v[84:87], v[168:171], v[148:151], v[84:87]
    ds_read_b64_tr_b16 v[194:195], v12 offset:13984
    s_waitcnt vmcnt(35) lgkmcnt(10)
    v_mfma_f32_16x16x32_bf16 v[16:19], v[172:175], v[152:155], v[16:19]
    ds_read_b64_tr_b16 v[196:197], v12 offset:9408
    v_mfma_f32_16x16x32_bf16 v[20:23], v[172:175], v[156:159], v[20:23]
    ds_read_b64_tr_b16 v[198:199], v12 offset:14016
    s_add_u32 s33, s28, 67584
    buffer_load_dwordx4 v[144:147], v1, s[16:19], s33 offen offset:0 sc1
    buffer_load_dwordx4 v[148:151], v1, s[16:19], s33 offen offset:1024 sc1
    s_waitcnt lgkmcnt(10)
    v_mfma_f32_16x16x32_bf16 v[24:27], v[176:179], v[152:155], v[24:27]
    ds_read_b64_tr_b16 v[168:169], v12 offset:9440
    v_mfma_f32_16x16x32_bf16 v[28:31], v[176:179], v[156:159], v[28:31]
    ds_read_b64_tr_b16 v[170:171], v12 offset:14048
    s_waitcnt lgkmcnt(10)
    v_mfma_f32_16x16x32_bf16 v[32:35], v[180:183], v[152:155], v[32:35]
    ds_read_b64_tr_b16 v[172:173], v12 offset:9472
    v_mfma_f32_16x16x32_bf16 v[36:39], v[180:183], v[156:159], v[36:39]
    ds_read_b64_tr_b16 v[174:175], v12 offset:14080
    s_waitcnt lgkmcnt(10)
    v_mfma_f32_16x16x32_bf16 v[40:43], v[184:187], v[152:155], v[40:43]
    ds_read_b64_tr_b16 v[176:177], v12 offset:18432
    v_mfma_f32_16x16x32_bf16 v[44:47], v[184:187], v[156:159], v[44:47]
    ds_read_b64_tr_b16 v[178:179], v12 offset:23040
    s_waitcnt lgkmcnt(10)
    v_mfma_f32_16x16x32_bf16 v[48:51], v[188:191], v[152:155], v[48:51]
    ds_read_b64_tr_b16 v[180:181], v12 offset:18464
    v_mfma_f32_16x16x32_bf16 v[52:55], v[188:191], v[156:159], v[52:55]
    ds_read_b64_tr_b16 v[182:183], v12 offset:23072
    s_waitcnt lgkmcnt(10)
    v_mfma_f32_16x16x32_bf16 v[56:59], v[192:195], v[152:155], v[56:59]
    ds_read_b64_tr_b16 v[184:185], v12 offset:18496
    v_mfma_f32_16x16x32_bf16 v[60:63], v[192:195], v[156:159], v[60:63]
    ds_read_b64_tr_b16 v[186:187], v12 offset:23104
    s_waitcnt lgkmcnt(10)
    v_mfma_f32_16x16x32_bf16 v[64:67], v[196:199], v[152:155], v[64:67]
    ds_read_b64_tr_b16 v[188:189], v12 offset:18528
    v_mfma_f32_16x16x32_bf16 v[68:71], v[196:199], v[156:159], v[68:71]
    ds_read_b64_tr_b16 v[190:191], v12 offset:23136
    s_waitcnt lgkmcnt(10)
    v_mfma_f32_16x16x32_bf16 v[72:75], v[168:171], v[152:155], v[72:75]
    ds_read_b64_tr_b16 v[192:193], v12 offset:18560
    v_mfma_f32_16x16x32_bf16 v[76:79], v[168:171], v[156:159], v[76:79]
    ds_read_b64_tr_b16 v[194:195], v12 offset:23168
    s_waitcnt lgkmcnt(10)
    v_mfma_f32_16x16x32_bf16 v[80:83], v[172:175], v[152:155], v[80:83]
    ds_read_b64_tr_b16 v[196:197], v12 offset:18592
    v_mfma_f32_16x16x32_bf16 v[84:87], v[172:175], v[156:159], v[84:87]
    ds_read_b64_tr_b16 v[198:199], v12 offset:23200
    s_waitcnt vmcnt(32) lgkmcnt(10)
    v_mfma_f32_16x16x32_bf16 v[16:19], v[176:179], v[160:163], v[16:19]
    ds_read_b64_tr_b16 v[168:169], v12 offset:18624
    v_mfma_f32_16x16x32_bf16 v[20:23], v[176:179], v[164:167], v[20:23]
    ds_read_b64_tr_b16 v[170:171], v12 offset:23232
    s_add_u32 s33, s28, 69632
    buffer_load_dwordx4 v[152:155], v1, s[16:19], s33 offen offset:0 sc1
    buffer_load_dwordx4 v[156:159], v1, s[16:19], s33 offen offset:1024 sc1
    s_waitcnt lgkmcnt(10)
    v_mfma_f32_16x16x32_bf16 v[24:27], v[180:183], v[160:163], v[24:27]
    ds_read_b64_tr_b16 v[172:173], v12 offset:18656
    v_mfma_f32_16x16x32_bf16 v[28:31], v[180:183], v[164:167], v[28:31]
    ds_read_b64_tr_b16 v[174:175], v12 offset:23264
    s_waitcnt lgkmcnt(10)
    v_mfma_f32_16x16x32_bf16 v[32:35], v[184:187], v[160:163], v[32:35]
    ds_read_b64_tr_b16 v[176:177], v12 offset:18688
    v_mfma_f32_16x16x32_bf16 v[36:39], v[184:187], v[164:167], v[36:39]
    ds_read_b64_tr_b16 v[178:179], v12 offset:23296
    s_waitcnt vmcnt(30)
    s_barrier
    s_waitcnt lgkmcnt(10)
    v_mfma_f32_16x16x32_bf16 v[40:43], v[188:191], v[160:163], v[40:43]
    ds_read_b64_tr_b16 v[180:181], v13 offset:0
    v_mfma_f32_16x16x32_bf16 v[44:47], v[188:191], v[164:167], v[44:47]
    ds_read_b64_tr_b16 v[182:183], v13 offset:4608
    s_add_u32 s30, s29, 1327104
    s_add_u32 m0, s27, 55296
    s_nop 0
    buffer_load_dwordx4 v2, s[40:43], s30 offen sc1 lds
    s_waitcnt lgkmcnt(10)
    v_mfma_f32_16x16x32_bf16 v[48:51], v[192:195], v[160:163], v[48:51]
    ds_read_b64_tr_b16 v[184:185], v13 offset:32
    v_mfma_f32_16x16x32_bf16 v[52:55], v[192:195], v[164:167], v[52:55]
    ds_read_b64_tr_b16 v[186:187], v13 offset:4640
    s_waitcnt lgkmcnt(10)
    v_mfma_f32_16x16x32_bf16 v[56:59], v[196:199], v[160:163], v[56:59]
    ds_read_b64_tr_b16 v[188:189], v13 offset:64
    v_mfma_f32_16x16x32_bf16 v[60:63], v[196:199], v[164:167], v[60:63]
    ds_read_b64_tr_b16 v[190:191], v13 offset:4672
    s_add_u32 m0, s27, 56320
    s_nop 0
    buffer_load_dwordx4 v3, s[40:43], s30 offen sc1 lds
    s_waitcnt lgkmcnt(10)
    v_mfma_f32_16x16x32_bf16 v[64:67], v[168:171], v[160:163], v[64:67]
    ds_read_b64_tr_b16 v[192:193], v13 offset:96
    v_mfma_f32_16x16x32_bf16 v[68:71], v[168:171], v[164:167], v[68:71]
    ds_read_b64_tr_b16 v[194:195], v13 offset:4704
    s_waitcnt lgkmcnt(10)
    v_mfma_f32_16x16x32_bf16 v[72:75], v[172:175], v[160:163], v[72:75]
    ds_read_b64_tr_b16 v[196:197], v13 offset:128
    v_mfma_f32_16x16x32_bf16 v[76:79], v[172:175], v[164:167], v[76:79]
    ds_read_b64_tr_b16 v[198:199], v13 offset:4736
    s_add_u32 m0, s27, 57344
    s_nop 0
    buffer_load_dwordx4 v4, s[40:43], s30 offen sc1 lds
    s_waitcnt lgkmcnt(10)
    v_mfma_f32_16x16x32_bf16 v[80:83], v[176:179], v[160:163], v[80:83]
    ds_read_b64_tr_b16 v[168:169], v13 offset:160
    v_mfma_f32_16x16x32_bf16 v[84:87], v[176:179], v[164:167], v[84:87]
    ds_read_b64_tr_b16 v[170:171], v13 offset:4768
    s_waitcnt vmcnt(31) lgkmcnt(10)
    v_mfma_f32_16x16x32_bf16 v[16:19], v[180:183], v[96:99], v[16:19]
    ds_read_b64_tr_b16 v[172:173], v13 offset:192
    v_mfma_f32_16x16x32_bf16 v[20:23], v[180:183], v[100:103], v[20:23]
    ds_read_b64_tr_b16 v[174:175], v13 offset:4800
    s_add_u32 s33, s28, 71680
    buffer_load_dwordx4 v[160:163], v1, s[16:19], s33 offen offset:0 sc1
    buffer_load_dwordx4 v[164:167], v1, s[16:19], s33 offen offset:1024 sc1
    s_waitcnt lgkmcnt(10)
    v_mfma_f32_16x16x32_bf16 v[24:27], v[184:187], v[96:99], v[24:27]
    ds_read_b64_tr_b16 v[176:177], v13 offset:224
    v_mfma_f32_16x16x32_bf16 v[28:31], v[184:187], v[100:103], v[28:31]
    ds_read_b64_tr_b16 v[178:179], v13 offset:4832
    s_add_u32 m0, s27, 58368
    s_nop 0
    buffer_load_dwordx4 v5, s[40:43], s30 offen sc1 lds
    s_waitcnt lgkmcnt(10)
    v_mfma_f32_16x16x32_bf16 v[32:35], v[188:191], v[96:99], v[32:35]
    ds_read_b64_tr_b16 v[180:181], v13 offset:256
    v_mfma_f32_16x16x32_bf16 v[36:39], v[188:191], v[100:103], v[36:39]
    ds_read_b64_tr_b16 v[182:183], v13 offset:4864
    s_waitcnt lgkmcnt(10)
    v_mfma_f32_16x16x32_bf16 v[40:43], v[192:195], v[96:99], v[40:43]
    ds_read_b64_tr_b16 v[184:185], v13 offset:9216
    v_mfma_f32_16x16x32_bf16 v[44:47], v[192:195], v[100:103], v[44:47]
    ds_read_b64_tr_b16 v[186:187], v13 offset:13824
    s_add_u32 m0, s27, 59392
    s_nop 0
    buffer_load_dwordx4 v6, s[40:43], s30 offen sc1 lds
    s_waitcnt lgkmcnt(10)
    v_mfma_f32_16x16x32_bf16 v[48:51], v[196:199], v[96:99], v[48:51]
    ds_read_b64_tr_b16 v[188:189], v13 offset:9248
    v_mfma_f32_16x16x32_bf16 v[52:55], v[196:199], v[100:103], v[52:55]
    ds_read_b64_tr_b16 v[190:191], v13 offset:13856
    s_waitcnt lgkmcnt(10)
    v_mfma_f32_16x16x32_bf16 v[56:59], v[168:171], v[96:99], v[56:59]
    ds_read_b64_tr_b16 v[192:193], v13 offset:9280
    v_mfma_f32_16x16x32_bf16 v[60:63], v[168:171], v[100:103], v[60:63]
    ds_read_b64_tr_b16 v[194:195], v13 offset:13888
    s_add_u32 m0, s27, 60416
    s_nop 0
    buffer_load_dwordx4 v7, s[40:43], s30 offen sc1 lds
    s_waitcnt lgkmcnt(10)
    v_mfma_f32_16x16x32_bf16 v[64:67], v[172:175], v[96:99], v[64:67]
    ds_read_b64_tr_b16 v[196:197], v13 offset:9312
    v_mfma_f32_16x16x32_bf16 v[68:71], v[172:175], v[100:103], v[68:71]
    ds_read_b64_tr_b16 v[198:199], v13 offset:13920
    s_waitcnt lgkmcnt(10)
    v_mfma_f32_16x16x32_bf16 v[72:75], v[176:179], v[96:99], v[72:75]
    ds_read_b64_tr_b16 v[168:169], v13 offset:9344
    v_mfma_f32_16x16x32_bf16 v[76:79], v[176:179], v[100:103], v[76:79]
    ds_read_b64_tr_b16 v[170:171], v13 offset:13952
    s_add_u32 m0, s27, 61440
    s_mov_b32 exec_hi, 0xffff
    buffer_load_dwordx4 v8, s[40:43], s30 offen sc1 lds
    s_mov_b32 exec_hi, -1
    s_waitcnt lgkmcnt(10)
    v_mfma_f32_16x16x32_bf16 v[80:83], v[180:183], v[96:99], v[80:83]
    ds_read_b64_tr_b16 v[172:173], v13 offset:9376
    v_mfma_f32_16x16x32_bf16 v[84:87], v[180:183], v[100:103], v[84:87]
    ds_read_b64_tr_b16 v[174:175], v13 offset:13984
    s_waitcnt vmcnt(35) lgkmcnt(10)
    v_mfma_f32_16x16x32_bf16 v[16:19], v[184:187], v[104:107], v[16:19]
    ds_read_b64_tr_b16 v[176:177], v13 offset:9408
    v_mfma_f32_16x16x32_bf16 v[20:23], v[184:187], v[108:111], v[20:23]
    ds_read_b64_tr_b16 v[178:179], v13 offset:14016
    s_add_u32 s33, s28, 73728
    buffer_load_dwordx4 v[96:99], v1, s[16:19], s33 offen offset:0 sc1
    buffer_load_dwordx4 v[100:103], v1, s[16:19], s33 offen offset:1024 sc1
    s_waitcnt lgkmcnt(10)
    v_mfma_f32_16x16x32_bf16 v[24:27], v[188:191], v[104:107], v[24:27]
    ds_read_b64_tr_b16 v[180:181], v13 offset:9440
    v_mfma_f32_16x16x32_bf16 v[28:31], v[188:191], v[108:111], v[28:31]
    ds_read_b64_tr_b16 v[182:183], v13 offset:14048
    s_waitcnt lgkmcnt(10)
    v_mfma_f32_16x16x32_bf16 v[32:35], v[192:195], v[104:107], v[32:35]
    ds_read_b64_tr_b16 v[184:185], v13 offset:9472
    v_mfma_f32_16x16x32_bf16 v[36:39], v[192:195], v[108:111], v[36:39]
    ds_read_b64_tr_b16 v[186:187], v13 offset:14080
    s_waitcnt lgkmcnt(10)
    v_mfma_f32_16x16x32_bf16 v[40:43], v[196:199], v[104:107], v[40:43]
    ds_read_b64_tr_b16 v[188:189], v13 offset:18432
    v_mfma_f32_16x16x32_bf16 v[44:47], v[196:199], v[108:111], v[44:47]
    ds_read_b64_tr_b16 v[190:191], v13 offset:23040
    s_waitcnt lgkmcnt(10)
    v_mfma_f32_16x16x32_bf16 v[48:51], v[168:171], v[104:107], v[48:51]
    ds_read_b64_tr_b16 v[192:193], v13 offset:18464
    v_mfma_f32_16x16x32_bf16 v[52:55], v[168:171], v[108:111], v[52:55]
    ds_read_b64_tr_b16 v[194:195], v13 offset:23072
    s_waitcnt lgkmcnt(10)
    v_mfma_f32_16x16x32_bf16 v[56:59], v[172:175], v[104:107], v[56:59]
    ds_read_b64_tr_b16 v[196:197], v13 offset:18496
    v_mfma_f32_16x16x32_bf16 v[60:63], v[172:175], v[108:111], v[60:63]
    ds_read_b64_tr_b16 v[198:199], v13 offset:23104
    s_waitcnt lgkmcnt(10)
    v_mfma_f32_16x16x32_bf16 v[64:67], v[176:179], v[104:107], v[64:67]
    ds_read_b64_tr_b16 v[168:169], v13 offset:18528
    v_mfma_f32_16x16x32_bf16 v[68:71], v[176:179], v[108:111], v[68:71]
    ds_read_b64_tr_b16 v[170:171], v13 offset:23136
    s_waitcnt lgkmcnt(10)
    v_mfma_f32_16x16x32_bf16 v[72:75], v[180:183], v[104:107], v[72:75]
    ds_read_b64_tr_b16 v[172:173], v13 offset:18560
    v_mfma_f32_16x16x32_bf16 v[76:79], v[180:183], v[108:111], v[76:79]
    ds_read_b64_tr_b16 v[174:175], v13 offset:23168
    s_waitcnt lgkmcnt(10)
    v_mfma_f32_16x16x32_bf16 v[80:83], v[184:187], v[104:107], v[80:83]
    ds_read_b64_tr_b16 v[176:177], v13 offset:18592
    v_mfma_f32_16x16x32_bf16 v[84:87], v[184:187], v[108:111], v[84:87]
    ds_read_b64_tr_b16 v[178:179], v13 offset:23200
    s_waitcnt vmcnt(32) lgkmcnt(10)
    v_mfma_f32_16x16x32_bf16 v[16:19], v[188:191], v[112:115], v[16:19]
    ds_read_b64_tr_b16 v[180:181], v13 offset:18624
    v_mfma_f32_16x16x32_bf16 v[20:23], v[188:191], v[116:119], v[20:23]
    ds_read_b64_tr_b16 v[182:183], v13 offset:23232
    s_add_u32 s33, s28, 75776
    buffer_load_dwordx4 v[104:107], v1, s[16:19], s33 offen offset:0 sc1
    buffer_load_dwordx4 v[108:111], v1, s[16:19], s33 offen offset:1024 sc1
    s_waitcnt lgkmcnt(10)
    v_mfma_f32_16x16x32_bf16 v[24:27], v[192:195], v[112:115], v[24:27]
    ds_read_b64_tr_b16 v[184:185], v13 offset:18656
    v_mfma_f32_16x16x32_bf16 v[28:31], v[192:195], v[116:119], v[28:31]
    ds_read_b64_tr_b16 v[186:187], v13 offset:23264
    s_waitcnt lgkmcnt(10)
    v_mfma_f32_16x16x32_bf16 v[32:35], v[196:199], v[112:115], v[32:35]
    ds_read_b64_tr_b16 v[188:189], v13 offset:18688
    v_mfma_f32_16x16x32_bf16 v[36:39], v[196:199], v[116:119], v[36:39]
    ds_read_b64_tr_b16 v[190:191], v13 offset:23296
    s_waitcnt vmcnt(30)
    s_barrier
    s_waitcnt lgkmcnt(10)
    v_mfma_f32_16x16x32_bf16 v[40:43], v[168:171], v[112:115], v[40:43]
    ds_read_b64_tr_b16 v[192:193], v9 offset:0
    v_mfma_f32_16x16x32_bf16 v[44:47], v[168:171], v[116:119], v[44:47]
    ds_read_b64_tr_b16 v[194:195], v9 offset:4608
    s_add_u32 s30, s29, 1437696
    s_add_u32 m0, s27, 82944
    s_nop 0
    buffer_load_dwordx4 v2, s[40:43], s30 offen sc1 lds
    s_waitcnt lgkmcnt(10)
    v_mfma_f32_16x16x32_bf16 v[48:51], v[172:175], v[112:115], v[48:51]
    ds_read_b64_tr_b16 v[196:197], v9 offset:32
    v_mfma_f32_16x16x32_bf16 v[52:55], v[172:175], v[116:119], v[52:55]
    ds_read_b64_tr_b16 v[198:199], v9 offset:4640
    s_waitcnt lgkmcnt(10)
    v_mfma_f32_16x16x32_bf16 v[56:59], v[176:179], v[112:115], v[56:59]
    ds_read_b64_tr_b16 v[168:169], v9 offset:64
    v_mfma_f32_16x16x32_bf16 v[60:63], v[176:179], v[116:119], v[60:63]
    ds_read_b64_tr_b16 v[170:171], v9 offset:4672
    s_add_u32 m0, s27, 83968
    s_nop 0
    buffer_load_dwordx4 v3, s[40:43], s30 offen sc1 lds
    s_waitcnt lgkmcnt(10)
    v_mfma_f32_16x16x32_bf16 v[64:67], v[180:183], v[112:115], v[64:67]
    ds_read_b64_tr_b16 v[172:173], v9 offset:96
    v_mfma_f32_16x16x32_bf16 v[68:71], v[180:183], v[116:119], v[68:71]
    ds_read_b64_tr_b16 v[174:175], v9 offset:4704
    s_waitcnt lgkmcnt(10)
    v_mfma_f32_16x16x32_bf16 v[72:75], v[184:187], v[112:115], v[72:75]
    ds_read_b64_tr_b16 v[176:177], v9 offset:128
    v_mfma_f32_16x16x32_bf16 v[76:79], v[184:187], v[116:119], v[76:79]
    ds_read_b64_tr_b16 v[178:179], v9 offset:4736
    s_add_u32 m0, s27, 84992
    s_nop 0
    buffer_load_dwordx4 v4, s[40:43], s30 offen sc1 lds
    s_waitcnt lgkmcnt(10)
    v_mfma_f32_16x16x32_bf16 v[80:83], v[188:191], v[112:115], v[80:83]
    ds_read_b64_tr_b16 v[180:181], v9 offset:160
    v_mfma_f32_16x16x32_bf16 v[84:87], v[188:191], v[116:119], v[84:87]
    ds_read_b64_tr_b16 v[182:183], v9 offset:4768
    s_waitcnt vmcnt(31) lgkmcnt(10)
    v_mfma_f32_16x16x32_bf16 v[16:19], v[192:195], v[120:123], v[16:19]
    ds_read_b64_tr_b16 v[184:185], v9 offset:192
    v_mfma_f32_16x16x32_bf16 v[20:23], v[192:195], v[124:127], v[20:23]
    ds_read_b64_tr_b16 v[186:187], v9 offset:4800
    s_add_u32 s33, s28, 77824
    buffer_load_dwordx4 v[112:115], v1, s[16:19], s33 offen offset:0 sc1
    buffer_load_dwordx4 v[116:119], v1, s[16:19], s33 offen offset:1024 sc1
    s_waitcnt lgkmcnt(10)
    v_mfma_f32_16x16x32_bf16 v[24:27], v[196:199], v[120:123], v[24:27]
    ds_read_b64_tr_b16 v[188:189], v9 offset:224
    v_mfma_f32_16x16x32_bf16 v[28:31], v[196:199], v[124:127], v[28:31]
    ds_read_b64_tr_b16 v[190:191], v9 offset:4832
    s_add_u32 m0, s27, 86016
    s_nop 0
    buffer_load_dwordx4 v5, s[40:43], s30 offen sc1 lds
    s_waitcnt lgkmcnt(10)
    v_mfma_f32_16x16x32_bf16 v[32:35], v[168:171], v[120:123], v[32:35]
    ds_read_b64_tr_b16 v[192:193], v9 offset:256
    v_mfma_f32_16x16x32_bf16 v[36:39], v[168:171], v[124:127], v[36:39]
    ds_read_b64_tr_b16 v[194:195], v9 offset:4864
    s_waitcnt lgkmcnt(10)
    v_mfma_f32_16x16x32_bf16 v[40:43], v[172:175], v[120:123], v[40:43]
    ds_read_b64_tr_b16 v[196:197], v9 offset:9216
    v_mfma_f32_16x16x32_bf16 v[44:47], v[172:175], v[124:127], v[44:47]
    ds_read_b64_tr_b16 v[198:199], v9 offset:13824
    s_add_u32 m0, s27, 87040
    s_nop 0
    buffer_load_dwordx4 v6, s[40:43], s30 offen sc1 lds
    s_waitcnt lgkmcnt(10)
    v_mfma_f32_16x16x32_bf16 v[48:51], v[176:179], v[120:123], v[48:51]
    ds_read_b64_tr_b16 v[168:169], v9 offset:9248
    v_mfma_f32_16x16x32_bf16 v[52:55], v[176:179], v[124:127], v[52:55]
    ds_read_b64_tr_b16 v[170:171], v9 offset:13856
    s_waitcnt lgkmcnt(10)
    v_mfma_f32_16x16x32_bf16 v[56:59], v[180:183], v[120:123], v[56:59]
    ds_read_b64_tr_b16 v[172:173], v9 offset:9280
    v_mfma_f32_16x16x32_bf16 v[60:63], v[180:183], v[124:127], v[60:63]
    ds_read_b64_tr_b16 v[174:175], v9 offset:13888
    s_add_u32 m0, s27, 88064
    s_nop 0
    buffer_load_dwordx4 v7, s[40:43], s30 offen sc1 lds
    s_waitcnt lgkmcnt(10)
    v_mfma_f32_16x16x32_bf16 v[64:67], v[184:187], v[120:123], v[64:67]
    ds_read_b64_tr_b16 v[176:177], v9 offset:9312
    v_mfma_f32_16x16x32_bf16 v[68:71], v[184:187], v[124:127], v[68:71]
    ds_read_b64_tr_b16 v[178:179], v9 offset:13920
    s_waitcnt lgkmcnt(10)
    v_mfma_f32_16x16x32_bf16 v[72:75], v[188:191], v[120:123], v[72:75]
    ds_read_b64_tr_b16 v[180:181], v9 offset:9344
    v_mfma_f32_16x16x32_bf16 v[76:79], v[188:191], v[124:127], v[76:79]
    ds_read_b64_tr_b16 v[182:183], v9 offset:13952
    s_add_u32 m0, s27, 89088
    s_mov_b32 exec_hi, 0xffff
    buffer_load_dwordx4 v8, s[40:43], s30 offen sc1 lds
    s_mov_b32 exec_hi, -1
    s_waitcnt lgkmcnt(10)
    v_mfma_f32_16x16x32_bf16 v[80:83], v[192:195], v[120:123], v[80:83]
    ds_read_b64_tr_b16 v[184:185], v9 offset:9376
    v_mfma_f32_16x16x32_bf16 v[84:87], v[192:195], v[124:127], v[84:87]
    ds_read_b64_tr_b16 v[186:187], v9 offset:13984
    s_waitcnt vmcnt(35) lgkmcnt(10)
    v_mfma_f32_16x16x32_bf16 v[16:19], v[196:199], v[128:131], v[16:19]
    ds_read_b64_tr_b16 v[188:189], v9 offset:9408
    v_mfma_f32_16x16x32_bf16 v[20:23], v[196:199], v[132:135], v[20:23]
    ds_read_b64_tr_b16 v[190:191], v9 offset:14016
    s_add_u32 s33, s28, 79872
    buffer_load_dwordx4 v[120:123], v1, s[16:19], s33 offen offset:0 sc1
    buffer_load_dwordx4 v[124:127], v1, s[16:19], s33 offen offset:1024 sc1
    s_waitcnt lgkmcnt(10)
    v_mfma_f32_16x16x32_bf16 v[24:27], v[168:171], v[128:131], v[24:27]
    ds_read_b64_tr_b16 v[192:193], v9 offset:9440
    v_mfma_f32_16x16x32_bf16 v[28:31], v[168:171], v[132:135], v[28:31]
    ds_read_b64_tr_b16 v[194:195], v9 offset:14048
    s_waitcnt lgkmcnt(10)
    v_mfma_f32_16x16x32_bf16 v[32:35], v[172:175], v[128:131], v[32:35]
    ds_read_b64_tr_b16 v[196:197], v9 offset:9472
    v_mfma_f32_16x16x32_bf16 v[36:39], v[172:175], v[132:135], v[36:39]
    ds_read_b64_tr_b16 v[198:199], v9 offset:14080
    s_waitcnt lgkmcnt(10)
    v_mfma_f32_16x16x32_bf16 v[40:43], v[176:179], v[128:131], v[40:43]
    ds_read_b64_tr_b16 v[168:169], v9 offset:18432
    v_mfma_f32_16x16x32_bf16 v[44:47], v[176:179], v[132:135], v[44:47]
    ds_read_b64_tr_b16 v[170:171], v9 offset:23040
    s_waitcnt lgkmcnt(10)
    v_mfma_f32_16x16x32_bf16 v[48:51], v[180:183], v[128:131], v[48:51]
    ds_read_b64_tr_b16 v[172:173], v9 offset:18464
    v_mfma_f32_16x16x32_bf16 v[52:55], v[180:183], v[132:135], v[52:55]
    ds_read_b64_tr_b16 v[174:175], v9 offset:23072
    s_waitcnt lgkmcnt(10)
    v_mfma_f32_16x16x32_bf16 v[56:59], v[184:187], v[128:131], v[56:59]
    ds_read_b64_tr_b16 v[176:177], v9 offset:18496
    v_mfma_f32_16x16x32_bf16 v[60:63], v[184:187], v[132:135], v[60:63]
    ds_read_b64_tr_b16 v[178:179], v9 offset:23104
    s_waitcnt lgkmcnt(10)
    v_mfma_f32_16x16x32_bf16 v[64:67], v[188:191], v[128:131], v[64:67]
    ds_read_b64_tr_b16 v[180:181], v9 offset:18528
    v_mfma_f32_16x16x32_bf16 v[68:71], v[188:191], v[132:135], v[68:71]
    ds_read_b64_tr_b16 v[182:183], v9 offset:23136
    s_waitcnt lgkmcnt(10)
    v_mfma_f32_16x16x32_bf16 v[72:75], v[192:195], v[128:131], v[72:75]
    ds_read_b64_tr_b16 v[184:185], v9 offset:18560
    v_mfma_f32_16x16x32_bf16 v[76:79], v[192:195], v[132:135], v[76:79]
    ds_read_b64_tr_b16 v[186:187], v9 offset:23168
    s_waitcnt lgkmcnt(10)
    v_mfma_f32_16x16x32_bf16 v[80:83], v[196:199], v[128:131], v[80:83]
    ds_read_b64_tr_b16 v[188:189], v9 offset:18592
    v_mfma_f32_16x16x32_bf16 v[84:87], v[196:199], v[132:135], v[84:87]
    ds_read_b64_tr_b16 v[190:191], v9 offset:23200
    s_waitcnt vmcnt(32) lgkmcnt(10)
    v_mfma_f32_16x16x32_bf16 v[16:19], v[168:171], v[136:139], v[16:19]
    ds_read_b64_tr_b16 v[192:193], v9 offset:18624
    v_mfma_f32_16x16x32_bf16 v[20:23], v[168:171], v[140:143], v[20:23]
    ds_read_b64_tr_b16 v[194:195], v9 offset:23232
    s_add_u32 s33, s28, 81920
    buffer_load_dwordx4 v[128:131], v1, s[16:19], s33 offen offset:0 sc1
    buffer_load_dwordx4 v[132:135], v1, s[16:19], s33 offen offset:1024 sc1
    s_waitcnt lgkmcnt(10)
    v_mfma_f32_16x16x32_bf16 v[24:27], v[172:175], v[136:139], v[24:27]
    ds_read_b64_tr_b16 v[196:197], v9 offset:18656
    v_mfma_f32_16x16x32_bf16 v[28:31], v[172:175], v[140:143], v[28:31]
    ds_read_b64_tr_b16 v[198:199], v9 offset:23264
    s_waitcnt lgkmcnt(10)
    v_mfma_f32_16x16x32_bf16 v[32:35], v[176:179], v[136:139], v[32:35]
    ds_read_b64_tr_b16 v[168:169], v9 offset:18688
    v_mfma_f32_16x16x32_bf16 v[36:39], v[176:179], v[140:143], v[36:39]
    ds_read_b64_tr_b16 v[170:171], v9 offset:23296
    s_waitcnt vmcnt(30)
    s_barrier
    s_waitcnt lgkmcnt(10)
    v_mfma_f32_16x16x32_bf16 v[40:43], v[180:183], v[136:139], v[40:43]
    ds_read_b64_tr_b16 v[172:173], v10 offset:0
    v_mfma_f32_16x16x32_bf16 v[44:47], v[180:183], v[140:143], v[44:47]
    ds_read_b64_tr_b16 v[174:175], v10 offset:4608
    s_add_u32 s30, s29, 1548288
    s_add_u32 m0, s27, 110592
    s_nop 0
    buffer_load_dwordx4 v2, s[40:43], s30 offen sc1 lds
    s_waitcnt lgkmcnt(10)
    v_mfma_f32_16x16x32_bf16 v[48:51], v[184:187], v[136:139], v[48:51]
    ds_read_b64_tr_b16 v[176:177], v10 offset:32
    v_mfma_f32_16x16x32_bf16 v[52:55], v[184:187], v[140:143], v[52:55]
    ds_read_b64_tr_b16 v[178:179], v10 offset:4640
    s_waitcnt lgkmcnt(10)
    v_mfma_f32_16x16x32_bf16 v[56:59], v[188:191], v[136:139], v[56:59]
    ds_read_b64_tr_b16 v[180:181], v10 offset:64
    v_mfma_f32_16x16x32_bf16 v[60:63], v[188:191], v[140:143], v[60:63]
    ds_read_b64_tr_b16 v[182:183], v10 offset:4672
    s_add_u32 m0, s27, 111616
    s_nop 0
    buffer_load_dwordx4 v3, s[40:43], s30 offen sc1 lds
    s_waitcnt lgkmcnt(10)
    v_mfma_f32_16x16x32_bf16 v[64:67], v[192:195], v[136:139], v[64:67]
    ds_read_b64_tr_b16 v[184:185], v10 offset:96
    v_mfma_f32_16x16x32_bf16 v[68:71], v[192:195], v[140:143], v[68:71]
    ds_read_b64_tr_b16 v[186:187], v10 offset:4704
    s_waitcnt lgkmcnt(10)
    v_mfma_f32_16x16x32_bf16 v[72:75], v[196:199], v[136:139], v[72:75]
    ds_read_b64_tr_b16 v[188:189], v10 offset:128
    v_mfma_f32_16x16x32_bf16 v[76:79], v[196:199], v[140:143], v[76:79]
    ds_read_b64_tr_b16 v[190:191], v10 offset:4736
    s_add_u32 m0, s27, 112640
    s_nop 0
    buffer_load_dwordx4 v4, s[40:43], s30 offen sc1 lds
    s_waitcnt lgkmcnt(10)
    v_mfma_f32_16x16x32_bf16 v[80:83], v[168:171], v[136:139], v[80:83]
    ds_read_b64_tr_b16 v[192:193], v10 offset:160
    v_mfma_f32_16x16x32_bf16 v[84:87], v[168:171], v[140:143], v[84:87]
    ds_read_b64_tr_b16 v[194:195], v10 offset:4768
    s_waitcnt vmcnt(31) lgkmcnt(10)
    v_mfma_f32_16x16x32_bf16 v[16:19], v[172:175], v[144:147], v[16:19]
    ds_read_b64_tr_b16 v[196:197], v10 offset:192
    v_mfma_f32_16x16x32_bf16 v[20:23], v[172:175], v[148:151], v[20:23]
    ds_read_b64_tr_b16 v[198:199], v10 offset:4800
    s_add_u32 s33, s28, 83968
    buffer_load_dwordx4 v[136:139], v1, s[16:19], s33 offen offset:0 sc1
    buffer_load_dwordx4 v[140:143], v1, s[16:19], s33 offen offset:1024 sc1
    s_waitcnt lgkmcnt(10)
    v_mfma_f32_16x16x32_bf16 v[24:27], v[176:179], v[144:147], v[24:27]
    ds_read_b64_tr_b16 v[168:169], v10 offset:224
    v_mfma_f32_16x16x32_bf16 v[28:31], v[176:179], v[148:151], v[28:31]
    ds_read_b64_tr_b16 v[170:171], v10 offset:4832
    s_add_u32 m0, s27, 113664
    s_nop 0
    buffer_load_dwordx4 v5, s[40:43], s30 offen sc1 lds
    s_waitcnt lgkmcnt(10)
    v_mfma_f32_16x16x32_bf16 v[32:35], v[180:183], v[144:147], v[32:35]
    ds_read_b64_tr_b16 v[172:173], v10 offset:256
    v_mfma_f32_16x16x32_bf16 v[36:39], v[180:183], v[148:151], v[36:39]
    ds_read_b64_tr_b16 v[174:175], v10 offset:4864
    s_waitcnt lgkmcnt(10)
    v_mfma_f32_16x16x32_bf16 v[40:43], v[184:187], v[144:147], v[40:43]
    ds_read_b64_tr_b16 v[176:177], v10 offset:9216
    v_mfma_f32_16x16x32_bf16 v[44:47], v[184:187], v[148:151], v[44:47]
    ds_read_b64_tr_b16 v[178:179], v10 offset:13824
    s_add_u32 m0, s27, 114688
    s_nop 0
    buffer_load_dwordx4 v6, s[40:43], s30 offen sc1 lds
    s_waitcnt lgkmcnt(10)
    v_mfma_f32_16x16x32_bf16 v[48:51], v[188:191], v[144:147], v[48:51]
    ds_read_b64_tr_b16 v[180:181], v10 offset:9248
    v_mfma_f32_16x16x32_bf16 v[52:55], v[188:191], v[148:151], v[52:55]
    ds_read_b64_tr_b16 v[182:183], v10 offset:13856
    s_waitcnt lgkmcnt(10)
    v_mfma_f32_16x16x32_bf16 v[56:59], v[192:195], v[144:147], v[56:59]
    ds_read_b64_tr_b16 v[184:185], v10 offset:9280
    v_mfma_f32_16x16x32_bf16 v[60:63], v[192:195], v[148:151], v[60:63]
    ds_read_b64_tr_b16 v[186:187], v10 offset:13888
    s_add_u32 m0, s27, 115712
    s_nop 0
    buffer_load_dwordx4 v7, s[40:43], s30 offen sc1 lds
    s_waitcnt lgkmcnt(10)
    v_mfma_f32_16x16x32_bf16 v[64:67], v[196:199], v[144:147], v[64:67]
    ds_read_b64_tr_b16 v[188:189], v10 offset:9312
    v_mfma_f32_16x16x32_bf16 v[68:71], v[196:199], v[148:151], v[68:71]
    ds_read_b64_tr_b16 v[190:191], v10 offset:13920
    s_waitcnt lgkmcnt(10)
    v_mfma_f32_16x16x32_bf16 v[72:75], v[168:171], v[144:147], v[72:75]
    ds_read_b64_tr_b16 v[192:193], v10 offset:9344
    v_mfma_f32_16x16x32_bf16 v[76:79], v[168:171], v[148:151], v[76:79]
    ds_read_b64_tr_b16 v[194:195], v10 offset:13952
    s_add_u32 m0, s27, 116736
    s_mov_b32 exec_hi, 0xffff
    buffer_load_dwordx4 v8, s[40:43], s30 offen sc1 lds
    s_mov_b32 exec_hi, -1
    s_waitcnt lgkmcnt(10)
    v_mfma_f32_16x16x32_bf16 v[80:83], v[172:175], v[144:147], v[80:83]
    ds_read_b64_tr_b16 v[196:197], v10 offset:9376
    v_mfma_f32_16x16x32_bf16 v[84:87], v[172:175], v[148:151], v[84:87]
    ds_read_b64_tr_b16 v[198:199], v10 offset:13984
    s_waitcnt vmcnt(35) lgkmcnt(10)
    v_mfma_f32_16x16x32_bf16 v[16:19], v[176:179], v[152:155], v[16:19]
    ds_read_b64_tr_b16 v[168:169], v10 offset:9408
    v_mfma_f32_16x16x32_bf16 v[20:23], v[176:179], v[156:159], v[20:23]
    ds_read_b64_tr_b16 v[170:171], v10 offset:14016
    s_add_u32 s33, s28, 86016
    buffer_load_dwordx4 v[144:147], v1, s[16:19], s33 offen offset:0 sc1
    buffer_load_dwordx4 v[148:151], v1, s[16:19], s33 offen offset:1024 sc1
    s_waitcnt lgkmcnt(10)
    v_mfma_f32_16x16x32_bf16 v[24:27], v[180:183], v[152:155], v[24:27]
    ds_read_b64_tr_b16 v[172:173], v10 offset:9440
    v_mfma_f32_16x16x32_bf16 v[28:31], v[180:183], v[156:159], v[28:31]
    ds_read_b64_tr_b16 v[174:175], v10 offset:14048
    s_waitcnt lgkmcnt(10)
    v_mfma_f32_16x16x32_bf16 v[32:35], v[184:187], v[152:155], v[32:35]
    ds_read_b64_tr_b16 v[176:177], v10 offset:9472
    v_mfma_f32_16x16x32_bf16 v[36:39], v[184:187], v[156:159], v[36:39]
    ds_read_b64_tr_b16 v[178:179], v10 offset:14080
    s_waitcnt lgkmcnt(10)
    v_mfma_f32_16x16x32_bf16 v[40:43], v[188:191], v[152:155], v[40:43]
    ds_read_b64_tr_b16 v[180:181], v10 offset:18432
    v_mfma_f32_16x16x32_bf16 v[44:47], v[188:191], v[156:159], v[44:47]
    ds_read_b64_tr_b16 v[182:183], v10 offset:23040
    s_waitcnt lgkmcnt(10)
    v_mfma_f32_16x16x32_bf16 v[48:51], v[192:195], v[152:155], v[48:51]
    ds_read_b64_tr_b16 v[184:185], v10 offset:18464
    v_mfma_f32_16x16x32_bf16 v[52:55], v[192:195], v[156:159], v[52:55]
    ds_read_b64_tr_b16 v[186:187], v10 offset:23072
    s_waitcnt lgkmcnt(10)
    v_mfma_f32_16x16x32_bf16 v[56:59], v[196:199], v[152:155], v[56:59]
    ds_read_b64_tr_b16 v[188:189], v10 offset:18496
    v_mfma_f32_16x16x32_bf16 v[60:63], v[196:199], v[156:159], v[60:63]
    ds_read_b64_tr_b16 v[190:191], v10 offset:23104
    s_waitcnt lgkmcnt(10)
    v_mfma_f32_16x16x32_bf16 v[64:67], v[168:171], v[152:155], v[64:67]
    ds_read_b64_tr_b16 v[192:193], v10 offset:18528
    v_mfma_f32_16x16x32_bf16 v[68:71], v[168:171], v[156:159], v[68:71]
    ds_read_b64_tr_b16 v[194:195], v10 offset:23136
    s_waitcnt lgkmcnt(10)
    v_mfma_f32_16x16x32_bf16 v[72:75], v[172:175], v[152:155], v[72:75]
    ds_read_b64_tr_b16 v[196:197], v10 offset:18560
    v_mfma_f32_16x16x32_bf16 v[76:79], v[172:175], v[156:159], v[76:79]
    ds_read_b64_tr_b16 v[198:199], v10 offset:23168
    s_waitcnt lgkmcnt(10)
    v_mfma_f32_16x16x32_bf16 v[80:83], v[176:179], v[152:155], v[80:83]
    ds_read_b64_tr_b16 v[168:169], v10 offset:18592
    v_mfma_f32_16x16x32_bf16 v[84:87], v[176:179], v[156:159], v[84:87]
    ds_read_b64_tr_b16 v[170:171], v10 offset:23200
    s_waitcnt vmcnt(32) lgkmcnt(10)
    v_mfma_f32_16x16x32_bf16 v[16:19], v[180:183], v[160:163], v[16:19]
    ds_read_b64_tr_b16 v[172:173], v10 offset:18624
    v_mfma_f32_16x16x32_bf16 v[20:23], v[180:183], v[164:167], v[20:23]
    ds_read_b64_tr_b16 v[174:175], v10 offset:23232
    s_add_u32 s33, s28, 88064
    buffer_load_dwordx4 v[152:155], v1, s[16:19], s33 offen offset:0 sc1
    buffer_load_dwordx4 v[156:159], v1, s[16:19], s33 offen offset:1024 sc1
    s_waitcnt lgkmcnt(10)
    v_mfma_f32_16x16x32_bf16 v[24:27], v[184:187], v[160:163], v[24:27]
    ds_read_b64_tr_b16 v[176:177], v10 offset:18656
    v_mfma_f32_16x16x32_bf16 v[28:31], v[184:187], v[164:167], v[28:31]
    ds_read_b64_tr_b16 v[178:179], v10 offset:23264
    s_waitcnt lgkmcnt(10)
    v_mfma_f32_16x16x32_bf16 v[32:35], v[188:191], v[160:163], v[32:35]
    ds_read_b64_tr_b16 v[180:181], v10 offset:18688
    v_mfma_f32_16x16x32_bf16 v[36:39], v[188:191], v[164:167], v[36:39]
    ds_read_b64_tr_b16 v[182:183], v10 offset:23296
    s_waitcnt vmcnt(30)
    s_barrier
    s_waitcnt lgkmcnt(10)
    v_mfma_f32_16x16x32_bf16 v[40:43], v[192:195], v[160:163], v[40:43]
    ds_read_b64_tr_b16 v[184:185], v11 offset:0
    v_mfma_f32_16x16x32_bf16 v[44:47], v[192:195], v[164:167], v[44:47]
    ds_read_b64_tr_b16 v[186:187], v11 offset:4608
    s_add_u32 s30, s29, 1658880
    s_add_u32 m0, s27, 0
    s_nop 0
    buffer_load_dwordx4 v2, s[40:43], s30 offen sc1 lds
    s_waitcnt lgkmcnt(10)
    v_mfma_f32_16x16x32_bf16 v[48:51], v[196:199], v[160:163], v[48:51]
    ds_read_b64_tr_b16 v[188:189], v11 offset:32
    v_mfma_f32_16x16x32_bf16 v[52:55], v[196:199], v[164:167], v[52:55]
    ds_read_b64_tr_b16 v[190:191], v11 offset:4640
    s_waitcnt lgkmcnt(10)
    v_mfma_f32_16x16x32_bf16 v[56:59], v[168:171], v[160:163], v[56:59]
    ds_read_b64_tr_b16 v[192:193], v11 offset:64
    v_mfma_f32_16x16x32_bf16 v[60:63], v[168:171], v[164:167], v[60:63]
    ds_read_b64_tr_b16 v[194:195], v11 offset:4672
    s_add_u32 m0, s27, 1024
    s_nop 0
    buffer_load_dwordx4 v3, s[40:43], s30 offen sc1 lds
    s_waitcnt lgkmcnt(10)
    v_mfma_f32_16x16x32_bf16 v[64:67], v[172:175], v[160:163], v[64:67]
    ds_read_b64_tr_b16 v[196:197], v11 offset:96
    v_mfma_f32_16x16x32_bf16 v[68:71], v[172:175], v[164:167], v[68:71]
    ds_read_b64_tr_b16 v[198:199], v11 offset:4704
    s_waitcnt lgkmcnt(10)
    v_mfma_f32_16x16x32_bf16 v[72:75], v[176:179], v[160:163], v[72:75]
    ds_read_b64_tr_b16 v[168:169], v11 offset:128
    v_mfma_f32_16x16x32_bf16 v[76:79], v[176:179], v[164:167], v[76:79]
    ds_read_b64_tr_b16 v[170:171], v11 offset:4736
    s_add_u32 m0, s27, 2048
    s_nop 0
    buffer_load_dwordx4 v4, s[40:43], s30 offen sc1 lds
    s_waitcnt lgkmcnt(10)
    v_mfma_f32_16x16x32_bf16 v[80:83], v[180:183], v[160:163], v[80:83]
    ds_read_b64_tr_b16 v[172:173], v11 offset:160
    v_mfma_f32_16x16x32_bf16 v[84:87], v[180:183], v[164:167], v[84:87]
    ds_read_b64_tr_b16 v[174:175], v11 offset:4768
    s_waitcnt vmcnt(31) lgkmcnt(10)
    v_mfma_f32_16x16x32_bf16 v[16:19], v[184:187], v[96:99], v[16:19]
    ds_read_b64_tr_b16 v[176:177], v11 offset:192
    v_mfma_f32_16x16x32_bf16 v[20:23], v[184:187], v[100:103], v[20:23]
    ds_read_b64_tr_b16 v[178:179], v11 offset:4800
    s_add_u32 s33, s28, 90112
    buffer_load_dwordx4 v[160:163], v1, s[16:19], s33 offen offset:0 sc1
    buffer_load_dwordx4 v[164:167], v1, s[16:19], s33 offen offset:1024 sc1
    s_waitcnt lgkmcnt(10)
    v_mfma_f32_16x16x32_bf16 v[24:27], v[188:191], v[96:99], v[24:27]
    ds_read_b64_tr_b16 v[180:181], v11 offset:224
    v_mfma_f32_16x16x32_bf16 v[28:31], v[188:191], v[100:103], v[28:31]
    ds_read_b64_tr_b16 v[182:183], v11 offset:4832
    s_add_u32 m0, s27, 3072
    s_nop 0
    buffer_load_dwordx4 v5, s[40:43], s30 offen sc1 lds
    s_waitcnt lgkmcnt(10)
    v_mfma_f32_16x16x32_bf16 v[32:35], v[192:195], v[96:99], v[32:35]
    ds_read_b64_tr_b16 v[184:185], v11 offset:256
    v_mfma_f32_16x16x32_bf16 v[36:39], v[192:195], v[100:103], v[36:39]
    ds_read_b64_tr_b16 v[186:187], v11 offset:4864
    s_waitcnt lgkmcnt(10)
    v_mfma_f32_16x16x32_bf16 v[40:43], v[196:199], v[96:99], v[40:43]
    ds_read_b64_tr_b16 v[188:189], v11 offset:9216
    v_mfma_f32_16x16x32_bf16 v[44:47], v[196:199], v[100:103], v[44:47]
    ds_read_b64_tr_b16 v[190:191], v11 offset:13824
    s_add_u32 m0, s27, 4096
    s_nop 0
    buffer_load_dwordx4 v6, s[40:43], s30 offen sc1 lds
    s_waitcnt lgkmcnt(10)
    v_mfma_f32_16x16x32_bf16 v[48:51], v[168:171], v[96:99], v[48:51]
    ds_read_b64_tr_b16 v[192:193], v11 offset:9248
    v_mfma_f32_16x16x32_bf16 v[52:55], v[168:171], v[100:103], v[52:55]
    ds_read_b64_tr_b16 v[194:195], v11 offset:13856
    s_waitcnt lgkmcnt(10)
    v_mfma_f32_16x16x32_bf16 v[56:59], v[172:175], v[96:99], v[56:59]
    ds_read_b64_tr_b16 v[196:197], v11 offset:9280
    v_mfma_f32_16x16x32_bf16 v[60:63], v[172:175], v[100:103], v[60:63]
    ds_read_b64_tr_b16 v[198:199], v11 offset:13888
    s_add_u32 m0, s27, 5120
    s_nop 0
    buffer_load_dwordx4 v7, s[40:43], s30 offen sc1 lds
    s_waitcnt lgkmcnt(10)
    v_mfma_f32_16x16x32_bf16 v[64:67], v[176:179], v[96:99], v[64:67]
    ds_read_b64_tr_b16 v[168:169], v11 offset:9312
    v_mfma_f32_16x16x32_bf16 v[68:71], v[176:179], v[100:103], v[68:71]
    ds_read_b64_tr_b16 v[170:171], v11 offset:13920
    s_waitcnt lgkmcnt(10)
    v_mfma_f32_16x16x32_bf16 v[72:75], v[180:183], v[96:99], v[72:75]
    ds_read_b64_tr_b16 v[172:173], v11 offset:9344
    v_mfma_f32_16x16x32_bf16 v[76:79], v[180:183], v[100:103], v[76:79]
    ds_read_b64_tr_b16 v[174:175], v11 offset:13952
    s_add_u32 m0, s27, 6144
    s_mov_b32 exec_hi, 0xffff
    buffer_load_dwordx4 v8, s[40:43], s30 offen sc1 lds
    s_mov_b32 exec_hi, -1
    s_waitcnt lgkmcnt(10)
    v_mfma_f32_16x16x32_bf16 v[80:83], v[184:187], v[96:99], v[80:83]
    ds_read_b64_tr_b16 v[176:177], v11 offset:9376
    v_mfma_f32_16x16x32_bf16 v[84:87], v[184:187], v[100:103], v[84:87]
    ds_read_b64_tr_b16 v[178:179], v11 offset:13984
    s_waitcnt vmcnt(35) lgkmcnt(10)
    v_mfma_f32_16x16x32_bf16 v[16:19], v[188:191], v[104:107], v[16:19]
    ds_read_b64_tr_b16 v[180:181], v11 offset:9408
    v_mfma_f32_16x16x32_bf16 v[20:23], v[188:191], v[108:111], v[20:23]
    ds_read_b64_tr_b16 v[182:183], v11 offset:14016
    s_add_u32 s33, s28, 92160
    buffer_load_dwordx4 v[96:99], v1, s[16:19], s33 offen offset:0 sc1
    buffer_load_dwordx4 v[100:103], v1, s[16:19], s33 offen offset:1024 sc1
    s_waitcnt lgkmcnt(10)
    v_mfma_f32_16x16x32_bf16 v[24:27], v[192:195], v[104:107], v[24:27]
    ds_read_b64_tr_b16 v[184:185], v11 offset:9440
    v_mfma_f32_16x16x32_bf16 v[28:31], v[192:195], v[108:111], v[28:31]
    ds_read_b64_tr_b16 v[186:187], v11 offset:14048
    s_waitcnt lgkmcnt(10)
    v_mfma_f32_16x16x32_bf16 v[32:35], v[196:199], v[104:107], v[32:35]
    ds_read_b64_tr_b16 v[188:189], v11 offset:9472
    v_mfma_f32_16x16x32_bf16 v[36:39], v[196:199], v[108:111], v[36:39]
    ds_read_b64_tr_b16 v[190:191], v11 offset:14080
    s_waitcnt lgkmcnt(10)
    v_mfma_f32_16x16x32_bf16 v[40:43], v[168:171], v[104:107], v[40:43]
    ds_read_b64_tr_b16 v[192:193], v11 offset:18432
    v_mfma_f32_16x16x32_bf16 v[44:47], v[168:171], v[108:111], v[44:47]
    ds_read_b64_tr_b16 v[194:195], v11 offset:23040
    s_waitcnt lgkmcnt(10)
    v_mfma_f32_16x16x32_bf16 v[48:51], v[172:175], v[104:107], v[48:51]
    ds_read_b64_tr_b16 v[196:197], v11 offset:18464
    v_mfma_f32_16x16x32_bf16 v[52:55], v[172:175], v[108:111], v[52:55]
    ds_read_b64_tr_b16 v[198:199], v11 offset:23072
    s_waitcnt lgkmcnt(10)
    v_mfma_f32_16x16x32_bf16 v[56:59], v[176:179], v[104:107], v[56:59]
    ds_read_b64_tr_b16 v[168:169], v11 offset:18496
    v_mfma_f32_16x16x32_bf16 v[60:63], v[176:179], v[108:111], v[60:63]
    ds_read_b64_tr_b16 v[170:171], v11 offset:23104
    s_waitcnt lgkmcnt(10)
    v_mfma_f32_16x16x32_bf16 v[64:67], v[180:183], v[104:107], v[64:67]
    ds_read_b64_tr_b16 v[172:173], v11 offset:18528
    v_mfma_f32_16x16x32_bf16 v[68:71], v[180:183], v[108:111], v[68:71]
    ds_read_b64_tr_b16 v[174:175], v11 offset:23136
    s_waitcnt lgkmcnt(10)
    v_mfma_f32_16x16x32_bf16 v[72:75], v[184:187], v[104:107], v[72:75]
    ds_read_b64_tr_b16 v[176:177], v11 offset:18560
    v_mfma_f32_16x16x32_bf16 v[76:79], v[184:187], v[108:111], v[76:79]
    ds_read_b64_tr_b16 v[178:179], v11 offset:23168
    s_waitcnt lgkmcnt(10)
    v_mfma_f32_16x16x32_bf16 v[80:83], v[188:191], v[104:107], v[80:83]
    ds_read_b64_tr_b16 v[180:181], v11 offset:18592
    v_mfma_f32_16x16x32_bf16 v[84:87], v[188:191], v[108:111], v[84:87]
    ds_read_b64_tr_b16 v[182:183], v11 offset:23200
    s_waitcnt vmcnt(32) lgkmcnt(10)
    v_mfma_f32_16x16x32_bf16 v[16:19], v[192:195], v[112:115], v[16:19]
    ds_read_b64_tr_b16 v[184:185], v11 offset:18624
    v_mfma_f32_16x16x32_bf16 v[20:23], v[192:195], v[116:119], v[20:23]
    ds_read_b64_tr_b16 v[186:187], v11 offset:23232
    s_add_u32 s33, s28, 94208
    buffer_load_dwordx4 v[104:107], v1, s[16:19], s33 offen offset:0 sc1
    buffer_load_dwordx4 v[108:111], v1, s[16:19], s33 offen offset:1024 sc1
    s_waitcnt lgkmcnt(10)
    v_mfma_f32_16x16x32_bf16 v[24:27], v[196:199], v[112:115], v[24:27]
    ds_read_b64_tr_b16 v[188:189], v11 offset:18656
    v_mfma_f32_16x16x32_bf16 v[28:31], v[196:199], v[116:119], v[28:31]
    ds_read_b64_tr_b16 v[190:191], v11 offset:23264
    s_waitcnt lgkmcnt(10)
    v_mfma_f32_16x16x32_bf16 v[32:35], v[168:171], v[112:115], v[32:35]
    ds_read_b64_tr_b16 v[192:193], v11 offset:18688
    v_mfma_f32_16x16x32_bf16 v[36:39], v[168:171], v[116:119], v[36:39]
    ds_read_b64_tr_b16 v[194:195], v11 offset:23296
    s_waitcnt vmcnt(30)
    s_barrier
    s_waitcnt lgkmcnt(10)
    v_mfma_f32_16x16x32_bf16 v[40:43], v[172:175], v[112:115], v[40:43]
    ds_read_b64_tr_b16 v[196:197], v12 offset:0
    v_mfma_f32_16x16x32_bf16 v[44:47], v[172:175], v[116:119], v[44:47]
    ds_read_b64_tr_b16 v[198:199], v12 offset:4608
    s_waitcnt lgkmcnt(10)
    v_mfma_f32_16x16x32_bf16 v[48:51], v[176:179], v[112:115], v[48:51]
    ds_read_b64_tr_b16 v[168:169], v12 offset:32
    v_mfma_f32_16x16x32_bf16 v[52:55], v[176:179], v[116:119], v[52:55]
    ds_read_b64_tr_b16 v[170:171], v12 offset:4640
    s_waitcnt lgkmcnt(10)
    v_mfma_f32_16x16x32_bf16 v[56:59], v[180:183], v[112:115], v[56:59]
    ds_read_b64_tr_b16 v[172:173], v12 offset:64
    v_mfma_f32_16x16x32_bf16 v[60:63], v[180:183], v[116:119], v[60:63]
    ds_read_b64_tr_b16 v[174:175], v12 offset:4672
    s_waitcnt lgkmcnt(10)
    v_mfma_f32_16x16x32_bf16 v[64:67], v[184:187], v[112:115], v[64:67]
    ds_read_b64_tr_b16 v[176:177], v12 offset:96
    v_mfma_f32_16x16x32_bf16 v[68:71], v[184:187], v[116:119], v[68:71]
    ds_read_b64_tr_b16 v[178:179], v12 offset:4704
    s_waitcnt lgkmcnt(10)
    v_mfma_f32_16x16x32_bf16 v[72:75], v[188:191], v[112:115], v[72:75]
    ds_read_b64_tr_b16 v[180:181], v12 offset:128
    v_mfma_f32_16x16x32_bf16 v[76:79], v[188:191], v[116:119], v[76:79]
    ds_read_b64_tr_b16 v[182:183], v12 offset:4736
    s_waitcnt lgkmcnt(10)
    v_mfma_f32_16x16x32_bf16 v[80:83], v[192:195], v[112:115], v[80:83]
    ds_read_b64_tr_b16 v[184:185], v12 offset:160
    v_mfma_f32_16x16x32_bf16 v[84:87], v[192:195], v[116:119], v[84:87]
    ds_read_b64_tr_b16 v[186:187], v12 offset:4768
    s_waitcnt vmcnt(28) lgkmcnt(10)
    v_mfma_f32_16x16x32_bf16 v[16:19], v[196:199], v[120:123], v[16:19]
    ds_read_b64_tr_b16 v[188:189], v12 offset:192
    v_mfma_f32_16x16x32_bf16 v[20:23], v[196:199], v[124:127], v[20:23]
    ds_read_b64_tr_b16 v[190:191], v12 offset:4800
    s_add_u32 s33, s28, 96256
    buffer_load_dwordx4 v[112:115], v1, s[16:19], s33 offen offset:0 sc1
    buffer_load_dwordx4 v[116:119], v1, s[16:19], s33 offen offset:1024 sc1
    s_waitcnt lgkmcnt(10)
    v_mfma_f32_16x16x32_bf16 v[24:27], v[168:171], v[120:123], v[24:27]
    ds_read_b64_tr_b16 v[192:193], v12 offset:224
    v_mfma_f32_16x16x32_bf16 v[28:31], v[168:171], v[124:127], v[28:31]
    ds_read_b64_tr_b16 v[194:195], v12 offset:4832
    s_waitcnt lgkmcnt(10)
    v_mfma_f32_16x16x32_bf16 v[32:35], v[172:175], v[120:123], v[32:35]
    ds_read_b64_tr_b16 v[196:197], v12 offset:256
    v_mfma_f32_16x16x32_bf16 v[36:39], v[172:175], v[124:127], v[36:39]
    ds_read_b64_tr_b16 v[198:199], v12 offset:4864
    s_waitcnt lgkmcnt(10)
    v_mfma_f32_16x16x32_bf16 v[40:43], v[176:179], v[120:123], v[40:43]
    ds_read_b64_tr_b16 v[168:169], v12 offset:9216
    v_mfma_f32_16x16x32_bf16 v[44:47], v[176:179], v[124:127], v[44:47]
    ds_read_b64_tr_b16 v[170:171], v12 offset:13824
    s_waitcnt lgkmcnt(10)
    v_mfma_f32_16x16x32_bf16 v[48:51], v[180:183], v[120:123], v[48:51]
    ds_read_b64_tr_b16 v[172:173], v12 offset:9248
    v_mfma_f32_16x16x32_bf16 v[52:55], v[180:183], v[124:127], v[52:55]
    ds_read_b64_tr_b16 v[174:175], v12 offset:13856
    s_waitcnt lgkmcnt(10)
    v_mfma_f32_16x16x32_bf16 v[56:59], v[184:187], v[120:123], v[56:59]
    ds_read_b64_tr_b16 v[176:177], v12 offset:9280
    v_mfma_f32_16x16x32_bf16 v[60:63], v[184:187], v[124:127], v[60:63]
    ds_read_b64_tr_b16 v[178:179], v12 offset:13888
    s_waitcnt lgkmcnt(10)
    v_mfma_f32_16x16x32_bf16 v[64:67], v[188:191], v[120:123], v[64:67]
    ds_read_b64_tr_b16 v[180:181], v12 offset:9312
    v_mfma_f32_16x16x32_bf16 v[68:71], v[188:191], v[124:127], v[68:71]
    ds_read_b64_tr_b16 v[182:183], v12 offset:13920
    s_waitcnt lgkmcnt(10)
    v_mfma_f32_16x16x32_bf16 v[72:75], v[192:195], v[120:123], v[72:75]
    ds_read_b64_tr_b16 v[184:185], v12 offset:9344
    v_mfma_f32_16x16x32_bf16 v[76:79], v[192:195], v[124:127], v[76:79]
    ds_read_b64_tr_b16 v[186:187], v12 offset:13952
    s_waitcnt lgkmcnt(10)
    v_mfma_f32_16x16x32_bf16 v[80:83], v[196:199], v[120:123], v[80:83]
    ds_read_b64_tr_b16 v[188:189], v12 offset:9376
    v_mfma_f32_16x16x32_bf16 v[84:87], v[196:199], v[124:127], v[84:87]
    ds_read_b64_tr_b16 v[190:191], v12 offset:13984
    s_waitcnt vmcnt(28) lgkmcnt(10)
    v_mfma_f32_16x16x32_bf16 v[16:19], v[168:171], v[128:131], v[16:19]
    ds_read_b64_tr_b16 v[192:193], v12 offset:9408
    v_mfma_f32_16x16x32_bf16 v[20:23], v[168:171], v[132:135], v[20:23]
    ds_read_b64_tr_b16 v[194:195], v12 offset:14016
    s_waitcnt lgkmcnt(10)
    v_mfma_f32_16x16x32_bf16 v[24:27], v[172:175], v[128:131], v[24:27]
    ds_read_b64_tr_b16 v[196:197], v12 offset:9440
    v_mfma_f32_16x16x32_bf16 v[28:31], v[172:175], v[132:135], v[28:31]
    ds_read_b64_tr_b16 v[198:199], v12 offset:14048
    s_waitcnt lgkmcnt(10)
    v_mfma_f32_16x16x32_bf16 v[32:35], v[176:179], v[128:131], v[32:35]
    ds_read_b64_tr_b16 v[168:169], v12 offset:9472
    v_mfma_f32_16x16x32_bf16 v[36:39], v[176:179], v[132:135], v[36:39]
    ds_read_b64_tr_b16 v[170:171], v12 offset:14080
    s_waitcnt lgkmcnt(10)
    v_mfma_f32_16x16x32_bf16 v[40:43], v[180:183], v[128:131], v[40:43]
    ds_read_b64_tr_b16 v[172:173], v12 offset:18432
    v_mfma_f32_16x16x32_bf16 v[44:47], v[180:183], v[132:135], v[44:47]
    ds_read_b64_tr_b16 v[174:175], v12 offset:23040
    s_waitcnt lgkmcnt(10)
    v_mfma_f32_16x16x32_bf16 v[48:51], v[184:187], v[128:131], v[48:51]
    ds_read_b64_tr_b16 v[176:177], v12 offset:18464
    v_mfma_f32_16x16x32_bf16 v[52:55], v[184:187], v[132:135], v[52:55]
    ds_read_b64_tr_b16 v[178:179], v12 offset:23072
    s_waitcnt lgkmcnt(10)
    v_mfma_f32_16x16x32_bf16 v[56:59], v[188:191], v[128:131], v[56:59]
    ds_read_b64_tr_b16 v[180:181], v12 offset:18496
    v_mfma_f32_16x16x32_bf16 v[60:63], v[188:191], v[132:135], v[60:63]
    ds_read_b64_tr_b16 v[182:183], v12 offset:23104
    s_waitcnt lgkmcnt(10)
    v_mfma_f32_16x16x32_bf16 v[64:67], v[192:195], v[128:131], v[64:67]
    ds_read_b64_tr_b16 v[184:185], v12 offset:18528
    v_mfma_f32_16x16x32_bf16 v[68:71], v[192:195], v[132:135], v[68:71]
    ds_read_b64_tr_b16 v[186:187], v12 offset:23136
    s_waitcnt lgkmcnt(10)
    v_mfma_f32_16x16x32_bf16 v[72:75], v[196:199], v[128:131], v[72:75]
    ds_read_b64_tr_b16 v[188:189], v12 offset:18560
    v_mfma_f32_16x16x32_bf16 v[76:79], v[196:199], v[132:135], v[76:79]
    ds_read_b64_tr_b16 v[190:191], v12 offset:23168
    s_waitcnt lgkmcnt(10)
    v_mfma_f32_16x16x32_bf16 v[80:83], v[168:171], v[128:131], v[80:83]
    ds_read_b64_tr_b16 v[192:193], v12 offset:18592
    v_mfma_f32_16x16x32_bf16 v[84:87], v[168:171], v[132:135], v[84:87]
    ds_read_b64_tr_b16 v[194:195], v12 offset:23200
    s_waitcnt vmcnt(23) lgkmcnt(10)
    v_mfma_f32_16x16x32_bf16 v[16:19], v[172:175], v[136:139], v[16:19]
    ds_read_b64_tr_b16 v[196:197], v12 offset:18624
    v_mfma_f32_16x16x32_bf16 v[20:23], v[172:175], v[140:143], v[20:23]
    ds_read_b64_tr_b16 v[198:199], v12 offset:23232
    s_waitcnt lgkmcnt(10)
    v_mfma_f32_16x16x32_bf16 v[24:27], v[176:179], v[136:139], v[24:27]
    ds_read_b64_tr_b16 v[168:169], v12 offset:18656
    v_mfma_f32_16x16x32_bf16 v[28:31], v[176:179], v[140:143], v[28:31]
    ds_read_b64_tr_b16 v[170:171], v12 offset:23264
    s_waitcnt lgkmcnt(10)
    v_mfma_f32_16x16x32_bf16 v[32:35], v[180:183], v[136:139], v[32:35]
    ds_read_b64_tr_b16 v[172:173], v12 offset:18688
    v_mfma_f32_16x16x32_bf16 v[36:39], v[180:183], v[140:143], v[36:39]
    ds_read_b64_tr_b16 v[174:175], v12 offset:23296
    s_waitcnt vmcnt(19)
    s_barrier
    s_waitcnt lgkmcnt(10)
    v_mfma_f32_16x16x32_bf16 v[40:43], v[184:187], v[136:139], v[40:43]
    ds_read_b64_tr_b16 v[176:177], v13 offset:0
    v_mfma_f32_16x16x32_bf16 v[44:47], v[184:187], v[140:143], v[44:47]
    ds_read_b64_tr_b16 v[178:179], v13 offset:4608
    s_waitcnt lgkmcnt(10)
    v_mfma_f32_16x16x32_bf16 v[48:51], v[188:191], v[136:139], v[48:51]
    ds_read_b64_tr_b16 v[180:181], v13 offset:32
    v_mfma_f32_16x16x32_bf16 v[52:55], v[188:191], v[140:143], v[52:55]
    ds_read_b64_tr_b16 v[182:183], v13 offset:4640
    s_waitcnt lgkmcnt(10)
    v_mfma_f32_16x16x32_bf16 v[56:59], v[192:195], v[136:139], v[56:59]
    ds_read_b64_tr_b16 v[184:185], v13 offset:64
    v_mfma_f32_16x16x32_bf16 v[60:63], v[192:195], v[140:143], v[60:63]
    ds_read_b64_tr_b16 v[186:187], v13 offset:4672
    s_waitcnt lgkmcnt(10)
    v_mfma_f32_16x16x32_bf16 v[64:67], v[196:199], v[136:139], v[64:67]
    ds_read_b64_tr_b16 v[188:189], v13 offset:96
    v_mfma_f32_16x16x32_bf16 v[68:71], v[196:199], v[140:143], v[68:71]
    ds_read_b64_tr_b16 v[190:191], v13 offset:4704
    s_waitcnt lgkmcnt(10)
    v_mfma_f32_16x16x32_bf16 v[72:75], v[168:171], v[136:139], v[72:75]
    ds_read_b64_tr_b16 v[192:193], v13 offset:128
    v_mfma_f32_16x16x32_bf16 v[76:79], v[168:171], v[140:143], v[76:79]
    ds_read_b64_tr_b16 v[194:195], v13 offset:4736
    s_waitcnt lgkmcnt(10)
    v_mfma_f32_16x16x32_bf16 v[80:83], v[172:175], v[136:139], v[80:83]
    ds_read_b64_tr_b16 v[196:197], v13 offset:160
    v_mfma_f32_16x16x32_bf16 v[84:87], v[172:175], v[140:143], v[84:87]
    ds_read_b64_tr_b16 v[198:199], v13 offset:4768
    s_waitcnt vmcnt(17) lgkmcnt(10)
    v_mfma_f32_16x16x32_bf16 v[16:19], v[176:179], v[144:147], v[16:19]
    ds_read_b64_tr_b16 v[168:169], v13 offset:192
    v_mfma_f32_16x16x32_bf16 v[20:23], v[176:179], v[148:151], v[20:23]
    ds_read_b64_tr_b16 v[170:171], v13 offset:4800
    s_waitcnt lgkmcnt(10)
    v_mfma_f32_16x16x32_bf16 v[24:27], v[180:183], v[144:147], v[24:27]
    ds_read_b64_tr_b16 v[172:173], v13 offset:224
    v_mfma_f32_16x16x32_bf16 v[28:31], v[180:183], v[148:151], v[28:31]
    ds_read_b64_tr_b16 v[174:175], v13 offset:4832
    s_waitcnt lgkmcnt(10)
    v_mfma_f32_16x16x32_bf16 v[32:35], v[184:187], v[144:147], v[32:35]
    ds_read_b64_tr_b16 v[176:177], v13 offset:256
    v_mfma_f32_16x16x32_bf16 v[36:39], v[184:187], v[148:151], v[36:39]
    ds_read_b64_tr_b16 v[178:179], v13 offset:4864
    s_waitcnt lgkmcnt(10)
    v_mfma_f32_16x16x32_bf16 v[40:43], v[188:191], v[144:147], v[40:43]
    ds_read_b64_tr_b16 v[180:181], v13 offset:9216
    v_mfma_f32_16x16x32_bf16 v[44:47], v[188:191], v[148:151], v[44:47]
    ds_read_b64_tr_b16 v[182:183], v13 offset:13824
    s_waitcnt lgkmcnt(10)
    v_mfma_f32_16x16x32_bf16 v[48:51], v[192:195], v[144:147], v[48:51]
    ds_read_b64_tr_b16 v[184:185], v13 offset:9248
    v_mfma_f32_16x16x32_bf16 v[52:55], v[192:195], v[148:151], v[52:55]
    ds_read_b64_tr_b16 v[186:187], v13 offset:13856
    s_waitcnt lgkmcnt(10)
    v_mfma_f32_16x16x32_bf16 v[56:59], v[196:199], v[144:147], v[56:59]
    ds_read_b64_tr_b16 v[188:189], v13 offset:9280
    v_mfma_f32_16x16x32_bf16 v[60:63], v[196:199], v[148:151], v[60:63]
    ds_read_b64_tr_b16 v[190:191], v13 offset:13888
    s_waitcnt lgkmcnt(10)
    v_mfma_f32_16x16x32_bf16 v[64:67], v[168:171], v[144:147], v[64:67]
    ds_read_b64_tr_b16 v[192:193], v13 offset:9312
    v_mfma_f32_16x16x32_bf16 v[68:71], v[168:171], v[148:151], v[68:71]
    ds_read_b64_tr_b16 v[194:195], v13 offset:13920
    s_waitcnt lgkmcnt(10)
    v_mfma_f32_16x16x32_bf16 v[72:75], v[172:175], v[144:147], v[72:75]
    ds_read_b64_tr_b16 v[196:197], v13 offset:9344
    v_mfma_f32_16x16x32_bf16 v[76:79], v[172:175], v[148:151], v[76:79]
    ds_read_b64_tr_b16 v[198:199], v13 offset:13952
    s_waitcnt lgkmcnt(10)
    v_mfma_f32_16x16x32_bf16 v[80:83], v[176:179], v[144:147], v[80:83]
    ds_read_b64_tr_b16 v[168:169], v13 offset:9376
    v_mfma_f32_16x16x32_bf16 v[84:87], v[176:179], v[148:151], v[84:87]
    ds_read_b64_tr_b16 v[170:171], v13 offset:13984
    s_waitcnt vmcnt(15) lgkmcnt(10)
    v_mfma_f32_16x16x32_bf16 v[16:19], v[180:183], v[152:155], v[16:19]
    ds_read_b64_tr_b16 v[172:173], v13 offset:9408
    v_mfma_f32_16x16x32_bf16 v[20:23], v[180:183], v[156:159], v[20:23]
    ds_read_b64_tr_b16 v[174:175], v13 offset:14016
    s_waitcnt lgkmcnt(10)
    v_mfma_f32_16x16x32_bf16 v[24:27], v[184:187], v[152:155], v[24:27]
    ds_read_b64_tr_b16 v[176:177], v13 offset:9440
    v_mfma_f32_16x16x32_bf16 v[28:31], v[184:187], v[156:159], v[28:31]
    ds_read_b64_tr_b16 v[178:179], v13 offset:14048
    s_waitcnt lgkmcnt(10)
    v_mfma_f32_16x16x32_bf16 v[32:35], v[188:191], v[152:155], v[32:35]
    ds_read_b64_tr_b16 v[180:181], v13 offset:9472
    v_mfma_f32_16x16x32_bf16 v[36:39], v[188:191], v[156:159], v[36:39]
    ds_read_b64_tr_b16 v[182:183], v13 offset:14080
    s_waitcnt lgkmcnt(10)
    v_mfma_f32_16x16x32_bf16 v[40:43], v[192:195], v[152:155], v[40:43]
    ds_read_b64_tr_b16 v[184:185], v13 offset:18432
    v_mfma_f32_16x16x32_bf16 v[44:47], v[192:195], v[156:159], v[44:47]
    ds_read_b64_tr_b16 v[186:187], v13 offset:23040
    s_waitcnt lgkmcnt(10)
    v_mfma_f32_16x16x32_bf16 v[48:51], v[196:199], v[152:155], v[48:51]
    ds_read_b64_tr_b16 v[188:189], v13 offset:18464
    v_mfma_f32_16x16x32_bf16 v[52:55], v[196:199], v[156:159], v[52:55]
    ds_read_b64_tr_b16 v[190:191], v13 offset:23072
    s_waitcnt lgkmcnt(10)
    v_mfma_f32_16x16x32_bf16 v[56:59], v[168:171], v[152:155], v[56:59]
    ds_read_b64_tr_b16 v[192:193], v13 offset:18496
    v_mfma_f32_16x16x32_bf16 v[60:63], v[168:171], v[156:159], v[60:63]
    ds_read_b64_tr_b16 v[194:195], v13 offset:23104
    s_waitcnt lgkmcnt(10)
    v_mfma_f32_16x16x32_bf16 v[64:67], v[172:175], v[152:155], v[64:67]
    ds_read_b64_tr_b16 v[196:197], v13 offset:18528
    v_mfma_f32_16x16x32_bf16 v[68:71], v[172:175], v[156:159], v[68:71]
    ds_read_b64_tr_b16 v[198:199], v13 offset:23136
    s_waitcnt lgkmcnt(10)
    v_mfma_f32_16x16x32_bf16 v[72:75], v[176:179], v[152:155], v[72:75]
    ds_read_b64_tr_b16 v[168:169], v13 offset:18560
    v_mfma_f32_16x16x32_bf16 v[76:79], v[176:179], v[156:159], v[76:79]
    ds_read_b64_tr_b16 v[170:171], v13 offset:23168
    s_waitcnt lgkmcnt(10)
    v_mfma_f32_16x16x32_bf16 v[80:83], v[180:183], v[152:155], v[80:83]
    ds_read_b64_tr_b16 v[172:173], v13 offset:18592
    v_mfma_f32_16x16x32_bf16 v[84:87], v[180:183], v[156:159], v[84:87]
    ds_read_b64_tr_b16 v[174:175], v13 offset:23200
    s_waitcnt vmcnt(10) lgkmcnt(10)
    v_mfma_f32_16x16x32_bf16 v[16:19], v[184:187], v[160:163], v[16:19]
    ds_read_b64_tr_b16 v[176:177], v13 offset:18624
    v_mfma_f32_16x16x32_bf16 v[20:23], v[184:187], v[164:167], v[20:23]
    ds_read_b64_tr_b16 v[178:179], v13 offset:23232
    s_waitcnt lgkmcnt(10)
    v_mfma_f32_16x16x32_bf16 v[24:27], v[188:191], v[160:163], v[24:27]
    ds_read_b64_tr_b16 v[180:181], v13 offset:18656
    v_mfma_f32_16x16x32_bf16 v[28:31], v[188:191], v[164:167], v[28:31]
    ds_read_b64_tr_b16 v[182:183], v13 offset:23264
    s_waitcnt lgkmcnt(10)
    v_mfma_f32_16x16x32_bf16 v[32:35], v[192:195], v[160:163], v[32:35]
    ds_read_b64_tr_b16 v[184:185], v13 offset:18688
    v_mfma_f32_16x16x32_bf16 v[36:39], v[192:195], v[164:167], v[36:39]
    ds_read_b64_tr_b16 v[186:187], v13 offset:23296
    s_waitcnt vmcnt(6)
    s_barrier
    s_waitcnt lgkmcnt(10)
    v_mfma_f32_16x16x32_bf16 v[40:43], v[196:199], v[160:163], v[40:43]
    ds_read_b64_tr_b16 v[188:189], v9 offset:0
    v_mfma_f32_16x16x32_bf16 v[44:47], v[196:199], v[164:167], v[44:47]
    ds_read_b64_tr_b16 v[190:191], v9 offset:4608
    s_waitcnt lgkmcnt(10)
    v_mfma_f32_16x16x32_bf16 v[48:51], v[168:171], v[160:163], v[48:51]
    ds_read_b64_tr_b16 v[192:193], v9 offset:32
    v_mfma_f32_16x16x32_bf16 v[52:55], v[168:171], v[164:167], v[52:55]
    ds_read_b64_tr_b16 v[194:195], v9 offset:4640
    s_waitcnt lgkmcnt(10)
    v_mfma_f32_16x16x32_bf16 v[56:59], v[172:175], v[160:163], v[56:59]
    ds_read_b64_tr_b16 v[196:197], v9 offset:64
    v_mfma_f32_16x16x32_bf16 v[60:63], v[172:175], v[164:167], v[60:63]
    ds_read_b64_tr_b16 v[198:199], v9 offset:4672
    s_waitcnt lgkmcnt(10)
    v_mfma_f32_16x16x32_bf16 v[64:67], v[176:179], v[160:163], v[64:67]
    ds_read_b64_tr_b16 v[168:169], v9 offset:96
    v_mfma_f32_16x16x32_bf16 v[68:71], v[176:179], v[164:167], v[68:71]
    ds_read_b64_tr_b16 v[170:171], v9 offset:4704
    s_waitcnt lgkmcnt(10)
    v_mfma_f32_16x16x32_bf16 v[72:75], v[180:183], v[160:163], v[72:75]
    ds_read_b64_tr_b16 v[172:173], v9 offset:128
    v_mfma_f32_16x16x32_bf16 v[76:79], v[180:183], v[164:167], v[76:79]
    ds_read_b64_tr_b16 v[174:175], v9 offset:4736
    s_waitcnt lgkmcnt(10)
    v_mfma_f32_16x16x32_bf16 v[80:83], v[184:187], v[160:163], v[80:83]
    ds_read_b64_tr_b16 v[176:177], v9 offset:160
    v_mfma_f32_16x16x32_bf16 v[84:87], v[184:187], v[164:167], v[84:87]
    ds_read_b64_tr_b16 v[178:179], v9 offset:4768
    s_waitcnt vmcnt(4) lgkmcnt(10)
    v_mfma_f32_16x16x32_bf16 v[16:19], v[188:191], v[96:99], v[16:19]
    ds_read_b64_tr_b16 v[180:181], v9 offset:192
    v_mfma_f32_16x16x32_bf16 v[20:23], v[188:191], v[100:103], v[20:23]
    ds_read_b64_tr_b16 v[182:183], v9 offset:4800
    s_waitcnt lgkmcnt(10)
    v_mfma_f32_16x16x32_bf16 v[24:27], v[192:195], v[96:99], v[24:27]
    ds_read_b64_tr_b16 v[184:185], v9 offset:224
    v_mfma_f32_16x16x32_bf16 v[28:31], v[192:195], v[100:103], v[28:31]
    ds_read_b64_tr_b16 v[186:187], v9 offset:4832
    s_waitcnt lgkmcnt(10)
    v_mfma_f32_16x16x32_bf16 v[32:35], v[196:199], v[96:99], v[32:35]
    ds_read_b64_tr_b16 v[188:189], v9 offset:256
    v_mfma_f32_16x16x32_bf16 v[36:39], v[196:199], v[100:103], v[36:39]
    ds_read_b64_tr_b16 v[190:191], v9 offset:4864
    s_waitcnt lgkmcnt(10)
    v_mfma_f32_16x16x32_bf16 v[40:43], v[168:171], v[96:99], v[40:43]
    ds_read_b64_tr_b16 v[192:193], v9 offset:9216
    v_mfma_f32_16x16x32_bf16 v[44:47], v[168:171], v[100:103], v[44:47]
    ds_read_b64_tr_b16 v[194:195], v9 offset:13824
    s_waitcnt lgkmcnt(10)
    v_mfma_f32_16x16x32_bf16 v[48:51], v[172:175], v[96:99], v[48:51]
    ds_read_b64_tr_b16 v[196:197], v9 offset:9248
    v_mfma_f32_16x16x32_bf16 v[52:55], v[172:175], v[100:103], v[52:55]
    ds_read_b64_tr_b16 v[198:199], v9 offset:13856
    s_waitcnt lgkmcnt(10)
    v_mfma_f32_16x16x32_bf16 v[56:59], v[176:179], v[96:99], v[56:59]
    ds_read_b64_tr_b16 v[168:169], v9 offset:9280
    v_mfma_f32_16x16x32_bf16 v[60:63], v[176:179], v[100:103], v[60:63]
    ds_read_b64_tr_b16 v[170:171], v9 offset:13888
    s_waitcnt lgkmcnt(10)
    v_mfma_f32_16x16x32_bf16 v[64:67], v[180:183], v[96:99], v[64:67]
    ds_read_b64_tr_b16 v[172:173], v9 offset:9312
    v_mfma_f32_16x16x32_bf16 v[68:71], v[180:183], v[100:103], v[68:71]
    ds_read_b64_tr_b16 v[174:175], v9 offset:13920
    s_waitcnt lgkmcnt(10)
    v_mfma_f32_16x16x32_bf16 v[72:75], v[184:187], v[96:99], v[72:75]
    ds_read_b64_tr_b16 v[176:177], v9 offset:9344
    v_mfma_f32_16x16x32_bf16 v[76:79], v[184:187], v[100:103], v[76:79]
    ds_read_b64_tr_b16 v[178:179], v9 offset:13952
    s_waitcnt lgkmcnt(10)
    v_mfma_f32_16x16x32_bf16 v[80:83], v[188:191], v[96:99], v[80:83]
    ds_read_b64_tr_b16 v[180:181], v9 offset:9376
    v_mfma_f32_16x16x32_bf16 v[84:87], v[188:191], v[100:103], v[84:87]
    ds_read_b64_tr_b16 v[182:183], v9 offset:13984
    s_waitcnt vmcnt(2) lgkmcnt(10)
    v_mfma_f32_16x16x32_bf16 v[16:19], v[192:195], v[104:107], v[16:19]
    ds_read_b64_tr_b16 v[184:185], v9 offset:9408
    v_mfma_f32_16x16x32_bf16 v[20:23], v[192:195], v[108:111], v[20:23]
    ds_read_b64_tr_b16 v[186:187], v9 offset:14016
    s_waitcnt lgkmcnt(10)
    v_mfma_f32_16x16x32_bf16 v[24:27], v[196:199], v[104:107], v[24:27]
    ds_read_b64_tr_b16 v[188:189], v9 offset:9440
    v_mfma_f32_16x16x32_bf16 v[28:31], v[196:199], v[108:111], v[28:31]
    ds_read_b64_tr_b16 v[190:191], v9 offset:14048
    s_waitcnt lgkmcnt(10)
    v_mfma_f32_16x16x32_bf16 v[32:35], v[168:171], v[104:107], v[32:35]
    ds_read_b64_tr_b16 v[192:193], v9 offset:9472
    v_mfma_f32_16x16x32_bf16 v[36:39], v[168:171], v[108:111], v[36:39]
    ds_read_b64_tr_b16 v[194:195], v9 offset:14080
    s_waitcnt lgkmcnt(10)
    v_mfma_f32_16x16x32_bf16 v[40:43], v[172:175], v[104:107], v[40:43]
    ds_read_b64_tr_b16 v[196:197], v9 offset:18432
    v_mfma_f32_16x16x32_bf16 v[44:47], v[172:175], v[108:111], v[44:47]
    ds_read_b64_tr_b16 v[198:199], v9 offset:23040
    s_waitcnt lgkmcnt(10)
    v_mfma_f32_16x16x32_bf16 v[48:51], v[176:179], v[104:107], v[48:51]
    ds_read_b64_tr_b16 v[168:169], v9 offset:18464
    v_mfma_f32_16x16x32_bf16 v[52:55], v[176:179], v[108:111], v[52:55]
    ds_read_b64_tr_b16 v[170:171], v9 offset:23072
    s_waitcnt lgkmcnt(10)
    v_mfma_f32_16x16x32_bf16 v[56:59], v[180:183], v[104:107], v[56:59]
    ds_read_b64_tr_b16 v[172:173], v9 offset:18496
    v_mfma_f32_16x16x32_bf16 v[60:63], v[180:183], v[108:111], v[60:63]
    ds_read_b64_tr_b16 v[174:175], v9 offset:23104
    s_waitcnt lgkmcnt(10)
    v_mfma_f32_16x16x32_bf16 v[64:67], v[184:187], v[104:107], v[64:67]
    ds_read_b64_tr_b16 v[176:177], v9 offset:18528
    v_mfma_f32_16x16x32_bf16 v[68:71], v[184:187], v[108:111], v[68:71]
    ds_read_b64_tr_b16 v[178:179], v9 offset:23136
    s_waitcnt lgkmcnt(10)
    v_mfma_f32_16x16x32_bf16 v[72:75], v[188:191], v[104:107], v[72:75]
    ds_read_b64_tr_b16 v[180:181], v9 offset:18560
    v_mfma_f32_16x16x32_bf16 v[76:79], v[188:191], v[108:111], v[76:79]
    ds_read_b64_tr_b16 v[182:183], v9 offset:23168
    s_waitcnt lgkmcnt(10)
    v_mfma_f32_16x16x32_bf16 v[80:83], v[192:195], v[104:107], v[80:83]
    ds_read_b64_tr_b16 v[184:185], v9 offset:18592
    v_mfma_f32_16x16x32_bf16 v[84:87], v[192:195], v[108:111], v[84:87]
    ds_read_b64_tr_b16 v[186:187], v9 offset:23200
    s_waitcnt vmcnt(0) lgkmcnt(10)
    v_mfma_f32_16x16x32_bf16 v[16:19], v[196:199], v[112:115], v[16:19]
    ds_read_b64_tr_b16 v[188:189], v9 offset:18624
    v_mfma_f32_16x16x32_bf16 v[20:23], v[196:199], v[116:119], v[20:23]
    ds_read_b64_tr_b16 v[190:191], v9 offset:23232
    s_waitcnt lgkmcnt(10)
    v_mfma_f32_16x16x32_bf16 v[24:27], v[168:171], v[112:115], v[24:27]
    ds_read_b64_tr_b16 v[192:193], v9 offset:18656
    v_mfma_f32_16x16x32_bf16 v[28:31], v[168:171], v[116:119], v[28:31]
    ds_read_b64_tr_b16 v[194:195], v9 offset:23264
    s_waitcnt lgkmcnt(10)
    v_mfma_f32_16x16x32_bf16 v[32:35], v[172:175], v[112:115], v[32:35]
    ds_read_b64_tr_b16 v[196:197], v9 offset:18688
    v_mfma_f32_16x16x32_bf16 v[36:39], v[172:175], v[116:119], v[36:39]
    ds_read_b64_tr_b16 v[198:199], v9 offset:23296
    s_waitcnt lgkmcnt(10)
    v_mfma_f32_16x16x32_bf16 v[40:43], v[176:179], v[112:115], v[40:43]
    v_mfma_f32_16x16x32_bf16 v[44:47], v[176:179], v[116:119], v[44:47]
    s_waitcnt lgkmcnt(8)
    v_mfma_f32_16x16x32_bf16 v[48:51], v[180:183], v[112:115], v[48:51]
    v_mfma_f32_16x16x32_bf16 v[52:55], v[180:183], v[116:119], v[52:55]
    s_waitcnt lgkmcnt(6)
    v_mfma_f32_16x16x32_bf16 v[56:59], v[184:187], v[112:115], v[56:59]
    v_mfma_f32_16x16x32_bf16 v[60:63], v[184:187], v[116:119], v[60:63]
    s_waitcnt lgkmcnt(4)
    v_mfma_f32_16x16x32_bf16 v[64:67], v[188:191], v[112:115], v[64:67]
    v_mfma_f32_16x16x32_bf16 v[68:71], v[188:191], v[116:119], v[68:71]
    s_waitcnt lgkmcnt(2)
    v_mfma_f32_16x16x32_bf16 v[72:75], v[192:195], v[112:115], v[72:75]
    v_mfma_f32_16x16x32_bf16 v[76:79], v[192:195], v[116:119], v[76:79]
    s_waitcnt lgkmcnt(0)
    v_mfma_f32_16x16x32_bf16 v[80:83], v[196:199], v[112:115], v[80:83]
    v_mfma_f32_16x16x32_bf16 v[84:87], v[196:199], v[116:119], v[84:87]
    s_branch K2_tail
K2_ssm:
    s_add_u32 s33, s28, 0
    buffer_load_dwordx4 v[96:99], v1, s[16:19], s33 offen offset:0 sc1
    buffer_load_dwordx4 v[100:103], v1, s[16:19], s33 offen offset:1024 sc1
    s_add_u32 s33, s28, 2048
    buffer_load_dwordx4 v[104:107], v1, s[16:19], s33 offen offset:0 sc1
    buffer_load_dwordx4 v[108:111], v1, s[16:19], s33 offen offset:1024 sc1
    s_add_u32 s33, s28, 4096
    buffer_load_dwordx4 v[112:115], v1, s[16:19], s33 offen offset:0 sc1
    buffer_load_dwordx4 v[116:119], v1, s[16:19], s33 offen offset:1024 sc1
    s_add_u32 s33, s28, 6144
    buffer_load_dwordx4 v[120:123], v1, s[16:19], s33 offen offset:0 sc1
    buffer_load_dwordx4 v[124:127], v1, s[16:19], s33 offen offset:1024 sc1
    s_add_u32 s33, s28, 8192
    buffer_load_dwordx4 v[128:131], v1, s[16:19], s33 offen offset:0 sc1
    buffer_load_dwordx4 v[132:135], v1, s[16:19], s33 offen offset:1024 sc1
    s_add_u32 s33, s28, 10240
    buffer_load_dwordx4 v[136:139], v1, s[16:19], s33 offen offset:0 sc1
    buffer_load_dwordx4 v[140:143], v1, s[16:19], s33 offen offset:1024 sc1
    s_add_u32 s33, s28, 12288
    buffer_load_dwordx4 v[144:147], v1, s[16:19], s33 offen offset:0 sc1
    buffer_load_dwordx4 v[148:151], v1, s[16:19], s33 offen offset:1024 sc1
    s_add_u32 s33, s28, 14336
    buffer_load_dwordx4 v[152:155], v1, s[16:19], s33 offen offset:0 sc1
    buffer_load_dwordx4 v[156:159], v1, s[16:19], s33 offen offset:1024 sc1
    s_barrier
    ds_read_b64_tr_b16 v[168:169], v9 offset:0
    ds_read_b64_tr_b16 v[170:171], v9 offset:4608
    ds_read_b64_tr_b16 v[172:173], v9 offset:32
    ds_read_b64_tr_b16 v[174:175], v9 offset:4640
    ds_read_b64_tr_b16 v[176:177], v9 offset:64
    ds_read_b64_tr_b16 v[178:179], v9 offset:4672
    ds_read_b64_tr_b16 v[180:181], v9 offset:96
    ds_read_b64_tr_b16 v[182:183], v9 offset:4704
    ds_read_b64_tr_b16 v[184:185], v9 offset:128
    ds_read_b64_tr_b16 v[186:187], v9 offset:4736
    ds_read_b64_tr_b16 v[188:189], v9 offset:160
    ds_read_b64_tr_b16 v[190:191], v9 offset:4768
    s_waitcnt vmcnt(14) lgkmcnt(10)
    v_mfma_f32_16x16x32_bf16 v[16:19], v[168:171], v[96:99], 0
    ds_read_b64_tr_b16 v[192:193], v9 offset:192
    v_mfma_f32_16x16x32_bf16 v[20:23], v[168:171], v[100:103], 0
    ds_read_b64_tr_b16 v[194:195], v9 offset:4800
    s_add_u32 s33, s28, 16384
    buffer_load_dwordx4 v[160:163], v1, s[16:19], s33 offen offset:0 sc1
    buffer_load_dwordx4 v[164:167], v1, s[16:19], s33 offen offset:1024 sc1
    s_waitcnt lgkmcnt(10)
    v_mfma_f32_16x16x32_bf16 v[24:27], v[172:175], v[96:99], 0
    ds_read_b64_tr_b16 v[196:197], v9 offset:224
    v_mfma_f32_16x16x32_bf16 v[28:31], v[172:175], v[100:103], 0
    ds_read_b64_tr_b16 v[198:199], v9 offset:4832
    s_waitcnt lgkmcnt(10)
    v_mfma_f32_16x16x32_bf16 v[32:35], v[176:179], v[96:99], 0
    ds_read_b64_tr_b16 v[168:169], v9 offset:256
    v_mfma_f32_16x16x32_bf16 v[36:39], v[176:179], v[100:103], 0
    ds_read_b64_tr_b16 v[170:171], v9 offset:4864
    s_waitcnt lgkmcnt(10)
    v_mfma_f32_16x16x32_bf16 v[40:43], v[180:183], v[96:99], 0
    ds_read_b64_tr_b16 v[172:173], v9 offset:9216
    v_mfma_f32_16x16x32_bf16 v[44:47], v[180:183], v[100:103], 0
    ds_read_b64_tr_b16 v[174:175], v9 offset:13824
    s_waitcnt lgkmcnt(10)
    v_mfma_f32_16x16x32_bf16 v[48:51], v[184:187], v[96:99], 0
    ds_read_b64_tr_b16 v[176:177], v9 offset:9248
    v_mfma_f32_16x16x32_bf16 v[52:55], v[184:187], v[100:103], 0
    ds_read_b64_tr_b16 v[178:179], v9 offset:13856
    s_waitcnt lgkmcnt(10)
    v_mfma_f32_16x16x32_bf16 v[56:59], v[188:191], v[96:99], 0
    ds_read_b64_tr_b16 v[180:181], v9 offset:9280
    v_mfma_f32_16x16x32_bf16 v[60:63], v[188:191], v[100:103], 0
    ds_read_b64_tr_b16 v[182:183], v9 offset:13888
    s_waitcnt lgkmcnt(10)
    v_mfma_f32_16x16x32_bf16 v[64:67], v[192:195], v[96:99], 0
    ds_read_b64_tr_b16 v[184:185], v9 offset:9312
    v_mfma_f32_16x16x32_bf16 v[68:71], v[192:195], v[100:103], 0
    ds_read_b64_tr_b16 v[186:187], v9 offset:13920
    s_waitcnt lgkmcnt(10)
    v_mfma_f32_16x16x32_bf16 v[72:75], v[196:199], v[96:99], 0
    ds_read_b64_tr_b16 v[188:189], v9 offset:9344
    v_mfma_f32_16x16x32_bf16 v[76:79], v[196:199], v[100:103], 0
    ds_read_b64_tr_b16 v[190:191], v9 offset:13952
    s_waitcnt lgkmcnt(10)
    v_mfma_f32_16x16x32_bf16 v[80:83], v[168:171], v[96:99], 0
    ds_read_b64_tr_b16 v[192:193], v9 offset:9376
    v_mfma_f32_16x16x32_bf16 v[84:87], v[168:171], v[100:103], 0
    ds_read_b64_tr_b16 v[194:195], v9 offset:13984
    s_waitcnt vmcnt(14) lgkmcnt(10)
    v_mfma_f32_16x16x32_bf16 v[16:19], v[172:175], v[104:107], v[16:19]
    ds_read_b64_tr_b16 v[196:197], v9 offset:9408
    v_mfma_f32_16x16x32_bf16 v[20:23], v[172:175], v[108:111], v[20:23]
    ds_read_b64_tr_b16 v[198:199], v9 offset:14016
    s_add_u32 s33, s28, 18432
    buffer_load_dwordx4 v[96:99], v1, s[16:19], s33 offen offset:0 sc1
    buffer_load_dwordx4 v[100:103], v1, s[16:19], s33 offen offset:1024 sc1
    s_waitcnt lgkmcnt(10)
    v_mfma_f32_16x16x32_bf16 v[24:27], v[176:179], v[104:107], v[24:27]
    ds_read_b64_tr_b16 v[168:169], v9 offset:9440
    v_mfma_f32_16x16x32_bf16 v[28:31], v[176:179], v[108:111], v[28:31]
    ds_read_b64_tr_b16 v[170:171], v9 offset:14048
    s_waitcnt lgkmcnt(10)
    v_mfma_f32_16x16x32_bf16 v[32:35], v[180:183], v[104:107], v[32:35]
    ds_read_b64_tr_b16 v[172:173], v9 offset:9472
    v_mfma_f32_16x16x32_bf16 v[36:39], v[180:183], v[108:111], v[36:39]
    ds_read_b64_tr_b16 v[174:175], v9 offset:14080
    s_waitcnt lgkmcnt(10)
    v_mfma_f32_16x16x32_bf16 v[40:43], v[184:187], v[104:107], v[40:43]
    ds_read_b64_tr_b16 v[176:177], v9 offset:18432
    v_mfma_f32_16x16x32_bf16 v[44:47], v[184:187], v[108:111], v[44:47]
    ds_read_b64_tr_b16 v[178:179], v9 offset:23040
    s_waitcnt lgkmcnt(10)
    v_mfma_f32_16x16x32_bf16 v[48:51], v[188:191], v[104:107], v[48:51]
    ds_read_b64_tr_b16 v[180:181], v9 offset:18464
    v_mfma_f32_16x16x32_bf16 v[52:55], v[188:191], v[108:111], v[52:55]
    ds_read_b64_tr_b16 v[182:183], v9 offset:23072
    s_waitcnt lgkmcnt(10)
    v_mfma_f32_16x16x32_bf16 v[56:59], v[192:195], v[104:107], v[56:59]
    ds_read_b64_tr_b16 v[184:185], v9 offset:18496
    v_mfma_f32_16x16x32_bf16 v[60:63], v[192:195], v[108:111], v[60:63]
    ds_read_b64_tr_b16 v[186:187], v9 offset:23104
    s_waitcnt lgkmcnt(10)
    v_mfma_f32_16x16x32_bf16 v[64:67], v[196:199], v[104:107], v[64:67]
    ds_read_b64_tr_b16 v[188:189], v9 offset:18528
    v_mfma_f32_16x16x32_bf16 v[68:71], v[196:199], v[108:111], v[68:71]
    ds_read_b64_tr_b16 v[190:191], v9 offset:23136
    s_waitcnt lgkmcnt(10)
    v_mfma_f32_16x16x32_bf16 v[72:75], v[168:171], v[104:107], v[72:75]
    ds_read_b64_tr_b16 v[192:193], v9 offset:18560
    v_mfma_f32_16x16x32_bf16 v[76:79], v[168:171], v[108:111], v[76:79]
    ds_read_b64_tr_b16 v[194:195], v9 offset:23168
    s_waitcnt lgkmcnt(10)
    v_mfma_f32_16x16x32_bf16 v[80:83], v[172:175], v[104:107], v[80:83]
    ds_read_b64_tr_b16 v[196:197], v9 offset:18592
    v_mfma_f32_16x16x32_bf16 v[84:87], v[172:175], v[108:111], v[84:87]
    ds_read_b64_tr_b16 v[198:199], v9 offset:23200
    s_waitcnt vmcnt(14) lgkmcnt(10)
    v_mfma_f32_16x16x32_bf16 v[16:19], v[176:179], v[112:115], v[16:19]
    ds_read_b64_tr_b16 v[168:169], v9 offset:18624
    v_mfma_f32_16x16x32_bf16 v[20:23], v[176:179], v[116:119], v[20:23]
    ds_read_b64_tr_b16 v[170:171], v9 offset:23232
    s_add_u32 s33, s28, 20480
    buffer_load_dwordx4 v[104:107], v1, s[16:19], s33 offen offset:0 sc1
    buffer_load_dwordx4 v[108:111], v1, s[16:19], s33 offen offset:1024 sc1
    s_waitcnt lgkmcnt(10)
    v_mfma_f32_16x16x32_bf16 v[24:27], v[180:183], v[112:115], v[24:27]
    ds_read_b64_tr_b16 v[172:173], v9 offset:18656
    v_mfma_f32_16x16x32_bf16 v[28:31], v[180:183], v[116:119], v[28:31]
    ds_read_b64_tr_b16 v[174:175], v9 offset:23264
    s_waitcnt lgkmcnt(10)
    v_mfma_f32_16x16x32_bf16 v[32:35], v[184:187], v[112:115], v[32:35]
    ds_read_b64_tr_b16 v[176:177], v9 offset:18688
    v_mfma_f32_16x16x32_bf16 v[36:39], v[184:187], v[116:119], v[36:39]
    ds_read_b64_tr_b16 v[178:179], v9 offset:23296
    s_barrier
    s_waitcnt lgkmcnt(10)
    v_mfma_f32_16x16x32_bf16 v[40:43], v[188:191], v[112:115], v[40:43]
    ds_read_b64_tr_b16 v[180:181], v10 offset:0
    v_mfma_f32_16x16x32_bf16 v[44:47], v[188:191], v[116:119], v[44:47]
    ds_read_b64_tr_b16 v[182:183], v10 offset:4608
    s_add_u32 s30, s29, 442368
    s_add_u32 m0, s27, 110592
    s_nop 0
    buffer_load_dwordx4 v2, s[40:43], s30 offen sc1 lds
    s_waitcnt lgkmcnt(10)
    v_mfma_f32_16x16x32_bf16 v[48:51], v[192:195], v[112:115], v[48:51]
    ds_read_b64_tr_b16 v[184:185], v10 offset:32
    v_mfma_f32_16x16x32_bf16 v[52:55], v[192:195], v[116:119], v[52:55]
    ds_read_b64_tr_b16 v[186:187], v10 offset:4640
    s_waitcnt lgkmcnt(10)
    v_mfma_f32_16x16x32_bf16 v[56:59], v[196:199], v[112:115], v[56:59]
    ds_read_b64_tr_b16 v[188:189], v10 offset:64
    v_mfma_f32_16x16x32_bf16 v[60:63], v[196:199], v[116:119], v[60:63]
    ds_read_b64_tr_b16 v[190:191], v10 offset:4672
    s_add_u32 m0, s27, 111616
    s_nop 0
    buffer_load_dwordx4 v3, s[40:43], s30 offen sc1 lds
    s_waitcnt lgkmcnt(10)
    v_mfma_f32_16x16x32_bf16 v[64:67], v[168:171], v[112:115], v[64:67]
    ds_read_b64_tr_b16 v[192:193], v10 offset:96
    v_mfma_f32_16x16x32_bf16 v[68:71], v[168:171], v[116:119], v[68:71]
    ds_read_b64_tr_b16 v[194:195], v10 offset:4704
    s_waitcnt lgkmcnt(10)
    v_mfma_f32_16x16x32_bf16 v[72:75], v[172:175], v[112:115], v[72:75]
    ds_read_b64_tr_b16 v[196:197], v10 offset:128
    v_mfma_f32_16x16x32_bf16 v[76:79], v[172:175], v[116:119], v[76:79]
    ds_read_b64_tr_b16 v[198:199], v10 offset:4736
    s_add_u32 m0, s27, 112640
    s_nop 0
    buffer_load_dwordx4 v4, s[40:43], s30 offen sc1 lds
    s_waitcnt lgkmcnt(10)
    v_mfma_f32_16x16x32_bf16 v[80:83], v[176:179], v[112:115], v[80:83]
    ds_read_b64_tr_b16 v[168:169], v10 offset:160
    v_mfma_f32_16x16x32_bf16 v[84:87], v[176:179], v[116:119], v[84:87]
    ds_read_b64_tr_b16 v[170:171], v10 offset:4768
    s_waitcnt vmcnt(17) lgkmcnt(10)
    v_mfma_f32_16x16x32_bf16 v[16:19], v[180:183], v[120:123], v[16:19]
    ds_read_b64_tr_b16 v[172:173], v10 offset:192
    v_mfma_f32_16x16x32_bf16 v[20:23], v[180:183], v[124:127], v[20:23]
    ds_read_b64_tr_b16 v[174:175], v10 offset:4800
    s_add_u32 s33, s28, 22528
    buffer_load_dwordx4 v[112:115], v1, s[16:19], s33 offen offset:0 sc1
    buffer_load_dwordx4 v[116:119], v1, s[16:19], s33 offen offset:1024 sc1
    s_waitcnt lgkmcnt(10)
    v_mfma_f32_16x16x32_bf16 v[24:27], v[184:187], v[120:123], v[24:27]
    ds_read_b64_tr_b16 v[176:177], v10 offset:224
    v_mfma_f32_16x16x32_bf16 v[28:31], v[184:187], v[124:127], v[28:31]
    ds_read_b64_tr_b16 v[178:179], v10 offset:4832
    s_add_u32 m0, s27, 113664
    s_nop 0
    buffer_load_dwordx4 v5, s[40:43], s30 offen sc1 lds
    s_waitcnt lgkmcnt(10)
    v_mfma_f32_16x16x32_bf16 v[32:35], v[188:191], v[120:123], v[32:35]
    ds_read_b64_tr_b16 v[180:181], v10 offset:256
    v_mfma_f32_16x16x32_bf16 v[36:39], v[188:191], v[124:127], v[36:39]
    ds_read_b64_tr_b16 v[182:183], v10 offset:4864
    s_waitcnt lgkmcnt(10)
    v_mfma_f32_16x16x32_bf16 v[40:43], v[192:195], v[120:123], v[40:43]
    ds_read_b64_tr_b16 v[184:185], v10 offset:9216
    v_mfma_f32_16x16x32_bf16 v[44:47], v[192:195], v[124:127], v[44:47]
    ds_read_b64_tr_b16 v[186:187], v10 offset:13824
    s_add_u32 m0, s27, 114688
    s_nop 0
    buffer_load_dwordx4 v6, s[40:43], s30 offen sc1 lds
    s_waitcnt lgkmcnt(10)
    v_mfma_f32_16x16x32_bf16 v[48:51], v[196:199], v[120:123], v[48:51]
    ds_read_b64_tr_b16 v[188:189], v10 offset:9248
    v_mfma_f32_16x16x32_bf16 v[52:55], v[196:199], v[124:127], v[52:55]
    ds_read_b64_tr_b16 v[190:191], v10 offset:13856
    s_waitcnt lgkmcnt(10)
    v_mfma_f32_16x16x32_bf16 v[56:59], v[168:171], v[120:123], v[56:59]
    ds_read_b64_tr_b16 v[192:193], v10 offset:9280
    v_mfma_f32_16x16x32_bf16 v[60:63], v[168:171], v[124:127], v[60:63]
    ds_read_b64_tr_b16 v[194:195], v10 offset:13888
    s_add_u32 m0, s27, 115712
    s_nop 0
    buffer_load_dwordx4 v7, s[40:43], s30 offen sc1 lds
    s_waitcnt lgkmcnt(10)
    v_mfma_f32_16x16x32_bf16 v[64:67], v[172:175], v[120:123], v[64:67]
    ds_read_b64_tr_b16 v[196:197], v10 offset:9312
    v_mfma_f32_16x16x32_bf16 v[68:71], v[172:175], v[124:127], v[68:71]
    ds_read_b64_tr_b16 v[198:199], v10 offset:13920
    s_waitcnt lgkmcnt(10)
    v_mfma_f32_16x16x32_bf16 v[72:75], v[176:179], v[120:123], v[72:75]
    ds_read_b64_tr_b16 v[168:169], v10 offset:9344
    v_mfma_f32_16x16x32_bf16 v[76:79], v[176:179], v[124:127], v[76:79]
    ds_read_b64_tr_b16 v[170:171], v10 offset:13952
    s_add_u32 m0, s27, 116736
    s_mov_b32 exec_hi, 0xffff
    buffer_load_dwordx4 v8, s[40:43], s30 offen sc1 lds
    s_mov_b32 exec_hi, -1
    s_waitcnt lgkmcnt(10)
    v_mfma_f32_16x16x32_bf16 v[80:83], v[180:183], v[120:123], v[80:83]
    ds_read_b64_tr_b16 v[172:173], v10 offset:9376
    v_mfma_f32_16x16x32_bf16 v[84:87], v[180:183], v[124:127], v[84:87]
    ds_read_b64_tr_b16 v[174:175], v10 offset:13984
    s_waitcnt vmcnt(21) lgkmcnt(10)
    v_mfma_f32_16x16x32_bf16 v[16:19], v[184:187], v[128:131], v[16:19]
    ds_read_b64_tr_b16 v[176:177], v10 offset:9408
    v_mfma_f32_16x16x32_bf16 v[20:23], v[184:187], v[132:135], v[20:23]
    ds_read_b64_tr_b16 v[178:179], v10 offset:14016
    s_add_u32 s33, s28, 24576
    buffer_load_dwordx4 v[120:123], v1, s[16:19], s33 offen offset:0 sc1
    buffer_load_dwordx4 v[124:127], v1, s[16:19], s33 offen offset:1024 sc1
    s_waitcnt lgkmcnt(10)
    v_mfma_f32_16x16x32_bf16 v[24:27], v[188:191], v[128:131], v[24:27]
    ds_read_b64_tr_b16 v[180:181], v10 offset:9440
    v_mfma_f32_16x16x32_bf16 v[28:31], v[188:191], v[132:135], v[28:31]
    ds_read_b64_tr_b16 v[182:183], v10 offset:14048
    s_waitcnt lgkmcnt(10)
    v_mfma_f32_16x16x32_bf16 v[32:35], v[192:195], v[128:131], v[32:35]
    ds_read_b64_tr_b16 v[184:185], v10 offset:9472
    v_mfma_f32_16x16x32_bf16 v[36:39], v[192:195], v[132:135], v[36:39]
    ds_read_b64_tr_b16 v[186:187], v10 offset:14080
    s_waitcnt lgkmcnt(10)
    v_mfma_f32_16x16x32_bf16 v[40:43], v[196:199], v[128:131], v[40:43]
    ds_read_b64_tr_b16 v[188:189], v10 offset:18432
    v_mfma_f32_16x16x32_bf16 v[44:47], v[196:199], v[132:135], v[44:47]
    ds_read_b64_tr_b16 v[190:191], v10 offset:23040
    s_waitcnt lgkmcnt(10)
    v_mfma_f32_16x16x32_bf16 v[48:51], v[168:171], v[128:131], v[48:51]
    ds_read_b64_tr_b16 v[192:193], v10 offset:18464
    v_mfma_f32_16x16x32_bf16 v[52:55], v[168:171], v[132:135], v[52:55]
    ds_read_b64_tr_b16 v[194:195], v10 offset:23072
    s_waitcnt lgkmcnt(10)
    v_mfma_f32_16x16x32_bf16 v[56:59], v[172:175], v[128:131], v[56:59]
    ds_read_b64_tr_b16 v[196:197], v10 offset:18496
    v_mfma_f32_16x16x32_bf16 v[60:63], v[172:175], v[132:135], v[60:63]
    ds_read_b64_tr_b16 v[198:199], v10 offset:23104
    s_waitcnt lgkmcnt(10)
    v_mfma_f32_16x16x32_bf16 v[64:67], v[176:179], v[128:131], v[64:67]
    ds_read_b64_tr_b16 v[168:169], v10 offset:18528
    v_mfma_f32_16x16x32_bf16 v[68:71], v[176:179], v[132:135], v[68:71]
    ds_read_b64_tr_b16 v[170:171], v10 offset:23136
    s_waitcnt lgkmcnt(10)
    v_mfma_f32_16x16x32_bf16 v[72:75], v[180:183], v[128:131], v[72:75]
    ds_read_b64_tr_b16 v[172:173], v10 offset:18560
    v_mfma_f32_16x16x32_bf16 v[76:79], v[180:183], v[132:135], v[76:79]
    ds_read_b64_tr_b16 v[174:175], v10 offset:23168
    s_waitcnt lgkmcnt(10)
    v_mfma_f32_16x16x32_bf16 v[80:83], v[184:187], v[128:131], v[80:83]
    ds_read_b64_tr_b16 v[176:177], v10 offset:18592
    v_mfma_f32_16x16x32_bf16 v[84:87], v[184:187], v[132:135], v[84:87]
    ds_read_b64_tr_b16 v[178:179], v10 offset:23200
    s_waitcnt vmcnt(21) lgkmcnt(10)
    v_mfma_f32_16x16x32_bf16 v[16:19], v[188:191], v[136:139], v[16:19]
    ds_read_b64_tr_b16 v[180:181], v10 offset:18624
    v_mfma_f32_16x16x32_bf16 v[20:23], v[188:191], v[140:143], v[20:23]
    ds_read_b64_tr_b16 v[182:183], v10 offset:23232
    s_add_u32 s33, s28, 26624
    buffer_load_dwordx4 v[128:131], v1, s[16:19], s33 offen offset:0 sc1
    buffer_load_dwordx4 v[132:135], v1, s[16:19], s33 offen offset:1024 sc1
    s_waitcnt lgkmcnt(10)
    v_mfma_f32_16x16x32_bf16 v[24:27], v[192:195], v[136:139], v[24:27]
    ds_read_b64_tr_b16 v[184:185], v10 offset:18656
    v_mfma_f32_16x16x32_bf16 v[28:31], v[192:195], v[140:143], v[28:31]
    ds_read_b64_tr_b16 v[186:187], v10 offset:23264
    s_waitcnt lgkmcnt(10)
    v_mfma_f32_16x16x32_bf16 v[32:35], v[196:199], v[136:139], v[32:35]
    ds_read_b64_tr_b16 v[188:189], v10 offset:18688
    v_mfma_f32_16x16x32_bf16 v[36:39], v[196:199], v[140:143], v[36:39]
    ds_read_b64_tr_b16 v[190:191], v10 offset:23296
    s_barrier
    s_waitcnt lgkmcnt(10)
    v_mfma_f32_16x16x32_bf16 v[40:43], v[168:171], v[136:139], v[40:43]
    ds_read_b64_tr_b16 v[192:193], v11 offset:0
    v_mfma_f32_16x16x32_bf16 v[44:47], v[168:171], v[140:143], v[44:47]
    ds_read_b64_tr_b16 v[194:195], v11 offset:4608
    s_add_u32 s30, s29, 552960
    s_add_u32 m0, s27, 0
    s_nop 0
    buffer_load_dwordx4 v2, s[40:43], s30 offen sc1 lds
    s_waitcnt lgkmcnt(10)
    v_mfma_f32_16x16x32_bf16 v[48:51], v[172:175], v[136:139], v[48:51]
    ds_read_b64_tr_b16 v[196:197], v11 offset:32
    v_mfma_f32_16x16x32_bf16 v[52:55], v[172:175], v[140:143], v[52:55]
    ds_read_b64_tr_b16 v[198:199], v11 offset:4640
    s_waitcnt lgkmcnt(10)
    v_mfma_f32_16x16x32_bf16 v[56:59], v[176:179], v[136:139], v[56:59]
    ds_read_b64_tr_b16 v[168:169], v11 offset:64
    v_mfma_f32_16x16x32_bf16 v[60:63], v[176:179], v[140:143], v[60:63]
    ds_read_b64_tr_b16 v[170:171], v11 offset:4672
    s_add_u32 m0, s27, 1024
    s_nop 0
    buffer_load_dwordx4 v3, s[40:43], s30 offen sc1 lds
    s_waitcnt lgkmcnt(10)
    v_mfma_f32_16x16x32_bf16 v[64:67], v[180:183], v[136:139], v[64:67]
    ds_read_b64_tr_b16 v[172:173], v11 offset:96
    v_mfma_f32_16x16x32_bf16 v[68:71], v[180:183], v[140:143], v[68:71]
    ds_read_b64_tr_b16 v[174:175], v11 offset:4704
    s_waitcnt lgkmcnt(10)
    v_mfma_f32_16x16x32_bf16 v[72:75], v[184:187], v[136:139], v[72:75]
    ds_read_b64_tr_b16 v[176:177], v11 offset:128
    v_mfma_f32_16x16x32_bf16 v[76:79], v[184:187], v[140:143], v[76:79]
    ds_read_b64_tr_b16 v[178:179], v11 offset:4736
    s_add_u32 m0, s27, 2048
    s_nop 0
    buffer_load_dwordx4 v4, s[40:43], s30 offen sc1 lds
    s_waitcnt lgkmcnt(10)
    v_mfma_f32_16x16x32_bf16 v[80:83], v[188:191], v[136:139], v[80:83]
    ds_read_b64_tr_b16 v[180:181], v11 offset:160
    v_mfma_f32_16x16x32_bf16 v[84:87], v[188:191], v[140:143], v[84:87]
    ds_read_b64_tr_b16 v[182:183], v11 offset:4768
    s_waitcnt vmcnt(24) lgkmcnt(10)
    v_mfma_f32_16x16x32_bf16 v[16:19], v[192:195], v[144:147], v[16:19]
    ds_read_b64_tr_b16 v[184:185], v11 offset:192
    v_mfma_f32_16x16x32_bf16 v[20:23], v[192:195], v[148:151], v[20:23]
    ds_read_b64_tr_b16 v[186:187], v11 offset:4800
    s_add_u32 s33, s28, 28672
    buffer_load_dwordx4 v[136:139], v1, s[16:19], s33 offen offset:0 sc1
    buffer_load_dwordx4 v[140:143], v1, s[16:19], s33 offen offset:1024 sc1
    s_waitcnt lgkmcnt(10)
    v_mfma_f32_16x16x32_bf16 v[24:27], v[196:199], v[144:147], v[24:27]
    ds_read_b64_tr_b16 v[188:189], v11 offset:224
    v_mfma_f32_16x16x32_bf16 v[28:31], v[196:199], v[148:151], v[28:31]
    ds_read_b64_tr_b16 v[190:191], v11 offset:4832
    s_add_u32 m0, s27, 3072
    s_nop 0
    buffer_load_dwordx4 v5, s[40:43], s30 offen sc1 lds
    s_waitcnt lgkmcnt(10)
    v_mfma_f32_16x16x32_bf16 v[32:35], v[168:171], v[144:147], v[32:35]
    ds_read_b64_tr_b16 v[192:193], v11 offset:256
    v_mfma_f32_16x16x32_bf16 v[36:39], v[168:171], v[148:151], v[36:39]
    ds_read_b64_tr_b16 v[194:195], v11 offset:4864
    s_waitcnt lgkmcnt(10)
    v_mfma_f32_16x16x32_bf16 v[40:43], v[172:175], v[144:147], v[40:43]
    ds_read_b64_tr_b16 v[196:197], v11 offset:9216
    v_mfma_f32_16x16x32_bf16 v[44:47], v[172:175], v[148:151], v[44:47]
    ds_read_b64_tr_b16 v[198:199], v11 offset:13824
    s_add_u32 m0, s27, 4096
    s_nop 0
    buffer_load_dwordx4 v6, s[40:43], s30 offen sc1 lds
    s_waitcnt lgkmcnt(10)
    v_mfma_f32_16x16x32_bf16 v[48:51], v[176:179], v[144:147], v[48:51]
    ds_read_b64_tr_b16 v[168:169], v11 offset:9248
    v_mfma_f32_16x16x32_bf16 v[52:55], v[176:179], v[148:151], v[52:55]
    ds_read_b64_tr_b16 v[170:171], v11 offset:13856
    s_waitcnt lgkmcnt(10)
    v_mfma_f32_16x16x32_bf16 v[56:59], v[180:183], v[144:147], v[56:59]
    ds_read_b64_tr_b16 v[172:173], v11 offset:9280
    v_mfma_f32_16x16x32_bf16 v[60:63], v[180:183], v[148:151], v[60:63]
    ds_read_b64_tr_b16 v[174:175], v11 offset:13888
    s_add_u32 m0, s27, 5120
    s_nop 0
    buffer_load_dwordx4 v7, s[40:43], s30 offen sc1 lds
    s_waitcnt lgkmcnt(10)
    v_mfma_f32_16x16x32_bf16 v[64:67], v[184:187], v[144:147], v[64:67]
    ds_read_b64_tr_b16 v[176:177], v11 offset:9312
    v_mfma_f32_16x16x32_bf16 v[68:71], v[184:187], v[148:151], v[68:71]
    ds_read_b64_tr_b16 v[178:179], v11 offset:13920
    s_waitcnt lgkmcnt(10)
    v_mfma_f32_16x16x32_bf16 v[72:75], v[188:191], v[144:147], v[72:75]
    ds_read_b64_tr_b16 v[180:181], v11 offset:9344
    v_mfma_f32_16x16x32_bf16 v[76:79], v[188:191], v[148:151], v[76:79]
    ds_read_b64_tr_b16 v[182:183], v11 offset:13952
    s_add_u32 m0, s27, 6144
    s_mov_b32 exec_hi, 0xffff
    buffer_load_dwordx4 v8, s[40:43], s30 offen sc1 lds
    s_mov_b32 exec_hi, -1
    s_waitcnt lgkmcnt(10)
    v_mfma_f32_16x16x32_bf16 v[80:83], v[192:195], v[144:147], v[80:83]
    ds_read_b64_tr_b16 v[184:185], v11 offset:9376
    v_mfma_f32_16x16x32_bf16 v[84:87], v[192:195], v[148:151], v[84:87]
    ds_read_b64_tr_b16 v[186:187], v11 offset:13984
    s_waitcnt vmcnt(28) lgkmcnt(10)
    v_mfma_f32_16x16x32_bf16 v[16:19], v[196:199], v[152:155], v[16:19]
    ds_read_b64_tr_b16 v[188:189], v11 offset:9408
    v_mfma_f32_16x16x32_bf16 v[20:23], v[196:199], v[156:159], v[20:23]
    ds_read_b64_tr_b16 v[190:191], v11 offset:14016
    s_add_u32 s33, s28, 30720
    buffer_load_dwordx4 v[144:147], v1, s[16:19], s33 offen offset:0 sc1
    buffer_load_dwordx4 v[148:151], v1, s[16:19], s33 offen offset:1024 sc1
    s_waitcnt lgkmcnt(10)
    v_mfma_f32_16x16x32_bf16 v[24:27], v[168:171], v[152:155], v[24:27]
    ds_read_b64_tr_b16 v[192:193], v11 offset:9440
    v_mfma_f32_16x16x32_bf16 v[28:31], v[168:171], v[156:159], v[28:31]
    ds_read_b64_tr_b16 v[194:195], v11 offset:14048
    s_waitcnt lgkmcnt(10)
    v_mfma_f32_16x16x32_bf16 v[32:35], v[172:175], v[152:155], v[32:35]
    ds_read_b64_tr_b16 v[196:197], v11 offset:9472
    v_mfma_f32_16x16x32_bf16 v[36:39], v[172:175], v[156:159], v[36:39]
    ds_read_b64_tr_b16 v[198:199], v11 offset:14080
    s_waitcnt lgkmcnt(10)
    v_mfma_f32_16x16x32_bf16 v[40:43], v[176:179], v[152:155], v[40:43]
    ds_read_b64_tr_b16 v[168:169], v11 offset:18432
    v_mfma_f32_16x16x32_bf16 v[44:47], v[176:179], v[156:159], v[44:47]
    ds_read_b64_tr_b16 v[170:171], v11 offset:23040
    s_waitcnt lgkmcnt(10)
    v_mfma_f32_16x16x32_bf16 v[48:51], v[180:183], v[152:155], v[48:51]
    ds_read_b64_tr_b16 v[172:173], v11 offset:18464
    v_mfma_f32_16x16x32_bf16 v[52:55], v[180:183], v[156:159], v[52:55]
    ds_read_b64_tr_b16 v[174:175], v11 offset:23072
    s_waitcnt lgkmcnt(10)
    v_mfma_f32_16x16x32_bf16 v[56:59], v[184:187], v[152:155], v[56:59]
    ds_read_b64_tr_b16 v[176:177], v11 offset:18496
    v_mfma_f32_16x16x32_bf16 v[60:63], v[184:187], v[156:159], v[60:63]
    ds_read_b64_tr_b16 v[178:179], v11 offset:23104
    s_waitcnt lgkmcnt(10)
    v_mfma_f32_16x16x32_bf16 v[64:67], v[188:191], v[152:155], v[64:67]
    ds_read_b64_tr_b16 v[180:181], v11 offset:18528
    v_mfma_f32_16x16x32_bf16 v[68:71], v[188:191], v[156:159], v[68:71]
    ds_read_b64_tr_b16 v[182:183], v11 offset:23136
    s_waitcnt lgkmcnt(10)
    v_mfma_f32_16x16x32_bf16 v[72:75], v[192:195], v[152:155], v[72:75]
    ds_read_b64_tr_b16 v[184:185], v11 offset:18560
    v_mfma_f32_16x16x32_bf16 v[76:79], v[192:195], v[156:159], v[76:79]
    ds_read_b64_tr_b16 v[186:187], v11 offset:23168
    s_waitcnt lgkmcnt(10)
    v_mfma_f32_16x16x32_bf16 v[80:83], v[196:199], v[152:155], v[80:83]
    ds_read_b64_tr_b16 v[188:189], v11 offset:18592
    v_mfma_f32_16x16x32_bf16 v[84:87], v[196:199], v[156:159], v[84:87]
    ds_read_b64_tr_b16 v[190:191], v11 offset:23200
    s_waitcnt vmcnt(28) lgkmcnt(10)
    v_mfma_f32_16x16x32_bf16 v[16:19], v[168:171], v[160:163], v[16:19]
    ds_read_b64_tr_b16 v[192:193], v11 offset:18624
    v_mfma_f32_16x16x32_bf16 v[20:23], v[168:171], v[164:167], v[20:23]
    ds_read_b64_tr_b16 v[194:195], v11 offset:23232
    s_add_u32 s33, s28, 32768
    buffer_load_dwordx4 v[152:155], v1, s[16:19], s33 offen offset:0 sc1
    buffer_load_dwordx4 v[156:159], v1, s[16:19], s33 offen offset:1024 sc1
    s_waitcnt lgkmcnt(10)
    v_mfma_f32_16x16x32_bf16 v[24:27], v[172:175], v[160:163], v[24:27]
    ds_read_b64_tr_b16 v[196:197], v11 offset:18656
    v_mfma_f32_16x16x32_bf16 v[28:31], v[172:175], v[164:167], v[28:31]
    ds_read_b64_tr_b16 v[198:199], v11 offset:23264
    s_waitcnt lgkmcnt(10)
    v_mfma_f32_16x16x32_bf16 v[32:35], v[176:179], v[160:163], v[32:35]
    ds_read_b64_tr_b16 v[168:169], v11 offset:18688
    v_mfma_f32_16x16x32_bf16 v[36:39], v[176:179], v[164:167], v[36:39]
    ds_read_b64_tr_b16 v[170:171], v11 offset:23296
    s_barrier
    s_waitcnt lgkmcnt(10)
    v_mfma_f32_16x16x32_bf16 v[40:43], v[180:183], v[160:163], v[40:43]
    ds_read_b64_tr_b16 v[172:173], v12 offset:0
    v_mfma_f32_16x16x32_bf16 v[44:47], v[180:183], v[164:167], v[44:47]
    ds_read_b64_tr_b16 v[174:175], v12 offset:4608
    s_add_u32 s30, s29, 663552
    s_add_u32 m0, s27, 27648
    s_nop 0
    buffer_load_dwordx4 v2, s[40:43], s30 offen sc1 lds
    s_waitcnt lgkmcnt(10)
    v_mfma_f32_16x16x32_bf16 v[48:51], v[184:187], v[160:163], v[48:51]
    ds_read_b64_tr_b16 v[176:177], v12 offset:32
    v_mfma_f32_16x16x32_bf16 v[52:55], v[184:187], v[164:167], v[52:55]
    ds_read_b64_tr_b16 v[178:179], v12 offset:4640
    s_waitcnt lgkmcnt(10)
    v_mfma_f32_16x16x32_bf16 v[56:59], v[188:191], v[160:163], v[56:59]
    ds_read_b64_tr_b16 v[180:181], v12 offset:64
    v_mfma_f32_16x16x32_bf16 v[60:63], v[188:191], v[164:167], v[60:63]
    ds_read_b64_tr_b16 v[182:183], v12 offset:4672
    s_add_u32 m0, s27, 28672
    s_nop 0
    buffer_load_dwordx4 v3, s[40:43], s30 offen sc1 lds
    s_waitcnt lgkmcnt(10)
    v_mfma_f32_16x16x32_bf16 v[64:67], v[192:195], v[160:163], v[64:67]
    ds_read_b64_tr_b16 v[184:185], v12 offset:96
    v_mfma_f32_16x16x32_bf16 v[68:71], v[192:195], v[164:167], v[68:71]
    ds_read_b64_tr_b16 v[186:187], v12 offset:4704
    s_waitcnt lgkmcnt(10)
    v_mfma_f32_16x16x32_bf16 v[72:75], v[196:199], v[160:163], v[72:75]
    ds_read_b64_tr_b16 v[188:189], v12 offset:128
    v_mfma_f32_16x16x32_bf16 v[76:79], v[196:199], v[164:167], v[76:79]
    ds_read_b64_tr_b16 v[190:191], v12 offset:4736
    s_add_u32 m0, s27, 29696
    s_nop 0
    buffer_load_dwordx4 v4, s[40:43], s30 offen sc1 lds
    s_waitcnt lgkmcnt(10)
    v_mfma_f32_16x16x32_bf16 v[80:83], v[168:171], v[160:163], v[80:83]
    ds_read_b64_tr_b16 v[192:193], v12 offset:160
    v_mfma_f32_16x16x32_bf16 v[84:87], v[168:171], v[164:167], v[84:87]
    ds_read_b64_tr_b16 v[194:195], v12 offset:4768
    s_waitcnt vmcnt(31) lgkmcnt(10)
    v_mfma_f32_16x16x32_bf16 v[16:19], v[172:175], v[96:99], v[16:19]
    ds_read_b64_tr_b16 v[196:197], v12 offset:192
    v_mfma_f32_16x16x32_bf16 v[20:23], v[172:175], v[100:103], v[20:23]
    ds_read_b64_tr_b16 v[198:199], v12 offset:4800
    s_add_u32 s33, s28, 34816
    buffer_load_dwordx4 v[160:163], v1, s[16:19], s33 offen offset:0 sc1
    buffer_load_dwordx4 v[164:167], v1, s[16:19], s33 offen offset:1024 sc1
    s_waitcnt lgkmcnt(10)
    v_mfma_f32_16x16x32_bf16 v[24:27], v[176:179], v[96:99], v[24:27]
    ds_read_b64_tr_b16 v[168:169], v12 offset:224
    v_mfma_f32_16x16x32_bf16 v[28:31], v[176:179], v[100:103], v[28:31]
    ds_read_b64_tr_b16 v[170:171], v12 offset:4832
    s_add_u32 m0, s27, 30720
    s_nop 0
    buffer_load_dwordx4 v5, s[40:43], s30 offen sc1 lds
    s_waitcnt lgkmcnt(10)
    v_mfma_f32_16x16x32_bf16 v[32:35], v[180:183], v[96:99], v[32:35]
    ds_read_b64_tr_b16 v[172:173], v12 offset:256
    v_mfma_f32_16x16x32_bf16 v[36:39], v[180:183], v[100:103], v[36:39]
    ds_read_b64_tr_b16 v[174:175], v12 offset:4864
    s_waitcnt lgkmcnt(10)
    v_mfma_f32_16x16x32_bf16 v[40:43], v[184:187], v[96:99], v[40:43]
    ds_read_b64_tr_b16 v[176:177], v12 offset:9216
    v_mfma_f32_16x16x32_bf16 v[44:47], v[184:187], v[100:103], v[44:47]
    ds_read_b64_tr_b16 v[178:179], v12 offset:13824
    s_add_u32 m0, s27, 31744
    s_nop 0
    buffer_load_dwordx4 v6, s[40:43], s30 offen sc1 lds
    s_waitcnt lgkmcnt(10)
    v_mfma_f32_16x16x32_bf16 v[48:51], v[188:191], v[96:99], v[48:51]
    ds_read_b64_tr_b16 v[180:181], v12 offset:9248
    v_mfma_f32_16x16x32_bf16 v[52:55], v[188:191], v[100:103], v[52:55]
    ds_read_b64_tr_b16 v[182:183], v12 offset:13856
    s_waitcnt lgkmcnt(10)
    v_mfma_f32_16x16x32_bf16 v[56:59], v[192:195], v[96:99], v[56:59]
    ds_read_b64_tr_b16 v[184:185], v12 offset:9280
    v_mfma_f32_16x16x32_bf16 v[60:63], v[192:195], v[100:103], v[60:63]
    ds_read_b64_tr_b16 v[186:187], v12 offset:13888
    s_add_u32 m0, s27, 32768
    s_nop 0
    buffer_load_dwordx4 v7, s[40:43], s30 offen sc1 lds
    s_waitcnt lgkmcnt(10)
    v_mfma_f32_16x16x32_bf16 v[64:67], v[196:199], v[96:99], v[64:67]
    ds_read_b64_tr_b16 v[188:189], v12 offset:9312
    v_mfma_f32_16x16x32_bf16 v[68:71], v[196:199], v[100:103], v[68:71]
    ds_read_b64_tr_b16 v[190:191], v12 offset:13920
    s_waitcnt lgkmcnt(10)
    v_mfma_f32_16x16x32_bf16 v[72:75], v[168:171], v[96:99], v[72:75]
    ds_read_b64_tr_b16 v[192:193], v12 offset:9344
    v_mfma_f32_16x16x32_bf16 v[76:79], v[168:171], v[100:103], v[76:79]
    ds_read_b64_tr_b16 v[194:195], v12 offset:13952
    s_add_u32 m0, s27, 33792
    s_mov_b32 exec_hi, 0xffff
    buffer_load_dwordx4 v8, s[40:43], s30 offen sc1 lds
    s_mov_b32 exec_hi, -1
    s_waitcnt lgkmcnt(10)
    v_mfma_f32_16x16x32_bf16 v[80:83], v[172:175], v[96:99], v[80:83]
    ds_read_b64_tr_b16 v[196:197], v12 offset:9376
    v_mfma_f32_16x16x32_bf16 v[84:87], v[172:175], v[100:103], v[84:87]
    ds_read_b64_tr_b16 v[198:199], v12 offset:13984
    s_waitcnt vmcnt(35) lgkmcnt(10)
    v_mfma_f32_16x16x32_bf16 v[16:19], v[176:179], v[104:107], v[16:19]
    ds_read_b64_tr_b16 v[168:169], v12 offset:9408
    v_mfma_f32_16x16x32_bf16 v[20:23], v[176:179], v[108:111], v[20:23]
    ds_read_b64_tr_b16 v[170:171], v12 offset:14016
    s_add_u32 s33, s28, 36864
    buffer_load_dwordx4 v[96:99], v1, s[16:19], s33 offen offset:0 sc1
    buffer_load_dwordx4 v[100:103], v1, s[16:19], s33 offen offset:1024 sc1
    s_waitcnt lgkmcnt(10)
    v_mfma_f32_16x16x32_bf16 v[24:27], v[180:183], v[104:107], v[24:27]
    ds_read_b64_tr_b16 v[172:173], v12 offset:9440
    v_mfma_f32_16x16x32_bf16 v[28:31], v[180:183], v[108:111], v[28:31]
    ds_read_b64_tr_b16 v[174:175], v12 offset:14048
    s_waitcnt lgkmcnt(10)
    v_mfma_f32_16x16x32_bf16 v[32:35], v[184:187], v[104:107], v[32:35]
    ds_read_b64_tr_b16 v[176:177], v12 offset:9472
    v_mfma_f32_16x16x32_bf16 v[36:39], v[184:187], v[108:111], v[36:39]
    ds_read_b64_tr_b16 v[178:179], v12 offset:14080
    s_waitcnt lgkmcnt(10)
    v_mfma_f32_16x16x32_bf16 v[40:43], v[188:191], v[104:107], v[40:43]
    ds_read_b64_tr_b16 v[180:181], v12 offset:18432
    v_mfma_f32_16x16x32_bf16 v[44:47], v[188:191], v[108:111], v[44:47]
    ds_read_b64_tr_b16 v[182:183], v12 offset:23040
    s_waitcnt lgkmcnt(10)
    v_mfma_f32_16x16x32_bf16 v[48:51], v[192:195], v[104:107], v[48:51]
    ds_read_b64_tr_b16 v[184:185], v12 offset:18464
    v_mfma_f32_16x16x32_bf16 v[52:55], v[192:195], v[108:111], v[52:55]
    ds_read_b64_tr_b16 v[186:187], v12 offset:23072
    s_waitcnt lgkmcnt(10)
    v_mfma_f32_16x16x32_bf16 v[56:59], v[196:199], v[104:107], v[56:59]
    ds_read_b64_tr_b16 v[188:189], v12 offset:18496
    v_mfma_f32_16x16x32_bf16 v[60:63], v[196:199], v[108:111], v[60:63]
    ds_read_b64_tr_b16 v[190:191], v12 offset:23104
    s_waitcnt lgkmcnt(10)
    v_mfma_f32_16x16x32_bf16 v[64:67], v[168:171], v[104:107], v[64:67]
    ds_read_b64_tr_b16 v[192:193], v12 offset:18528
    v_mfma_f32_16x16x32_bf16 v[68:71], v[168:171], v[108:111], v[68:71]
    ds_read_b64_tr_b16 v[194:195], v12 offset:23136
    s_waitcnt lgkmcnt(10)
    v_mfma_f32_16x16x32_bf16 v[72:75], v[172:175], v[104:107], v[72:75]
    ds_read_b64_tr_b16 v[196:197], v12 offset:18560
    v_mfma_f32_16x16x32_bf16 v[76:79], v[172:175], v[108:111], v[76:79]
    ds_read_b64_tr_b16 v[198:199], v12 offset:23168
    s_waitcnt lgkmcnt(10)
    v_mfma_f32_16x16x32_bf16 v[80:83], v[176:179], v[104:107], v[80:83]
    ds_read_b64_tr_b16 v[168:169], v12 offset:18592
    v_mfma_f32_16x16x32_bf16 v[84:87], v[176:179], v[108:111], v[84:87]
    ds_read_b64_tr_b16 v[170:171], v12 offset:23200
    s_waitcnt vmcnt(32) lgkmcnt(10)
    v_mfma_f32_16x16x32_bf16 v[16:19], v[180:183], v[112:115], v[16:19]
    ds_read_b64_tr_b16 v[172:173], v12 offset:18624
    v_mfma_f32_16x16x32_bf16 v[20:23], v[180:183], v[116:119], v[20:23]
    ds_read_b64_tr_b16 v[174:175], v12 offset:23232
    s_add_u32 s33, s28, 38912
    buffer_load_dwordx4 v[104:107], v1, s[16:19], s33 offen offset:0 sc1
    buffer_load_dwordx4 v[108:111], v1, s[16:19], s33 offen offset:1024 sc1
    s_waitcnt lgkmcnt(10)
    v_mfma_f32_16x16x32_bf16 v[24:27], v[184:187], v[112:115], v[24:27]
    ds_read_b64_tr_b16 v[176:177], v12 offset:18656
    v_mfma_f32_16x16x32_bf16 v[28:31], v[184:187], v[116:119], v[28:31]
    ds_read_b64_tr_b16 v[178:179], v12 offset:23264
    s_waitcnt lgkmcnt(10)
    v_mfma_f32_16x16x32_bf16 v[32:35], v[188:191], v[112:115], v[32:35]
    ds_read_b64_tr_b16 v[180:181], v12 offset:18688
    v_mfma_f32_16x16x32_bf16 v[36:39], v[188:191], v[116:119], v[36:39]
    ds_read_b64_tr_b16 v[182:183], v12 offset:23296
    s_waitcnt vmcnt(30)
    s_barrier
    s_waitcnt lgkmcnt(10)
    v_mfma_f32_16x16x32_bf16 v[40:43], v[192:195], v[112:115], v[40:43]
    ds_read_b64_tr_b16 v[184:185], v13 offset:0
    v_mfma_f32_16x16x32_bf16 v[44:47], v[192:195], v[116:119], v[44:47]
    ds_read_b64_tr_b16 v[186:187], v13 offset:4608
    s_add_u32 s30, s29, 774144
    s_add_u32 m0, s27, 55296
    s_nop 0
    buffer_load_dwordx4 v2, s[40:43], s30 offen sc1 lds
    s_waitcnt lgkmcnt(10)
    v_mfma_f32_16x16x32_bf16 v[48:51], v[196:199], v[112:115], v[48:51]
    ds_read_b64_tr_b16 v[188:189], v13 offset:32
    v_mfma_f32_16x16x32_bf16 v[52:55], v[196:199], v[116:119], v[52:55]
    ds_read_b64_tr_b16 v[190:191], v13 offset:4640
    s_waitcnt lgkmcnt(10)
    v_mfma_f32_16x16x32_bf16 v[56:59], v[168:171], v[112:115], v[56:59]
    ds_read_b64_tr_b16 v[192:193], v13 offset:64
    v_mfma_f32_16x16x32_bf16 v[60:63], v[168:171], v[116:119], v[60:63]
    ds_read_b64_tr_b16 v[194:195], v13 offset:4672
    s_add_u32 m0, s27, 56320
    s_nop 0
    buffer_load_dwordx4 v3, s[40:43], s30 offen sc1 lds
    s_waitcnt lgkmcnt(10)
    v_mfma_f32_16x16x32_bf16 v[64:67], v[172:175], v[112:115], v[64:67]
    ds_read_b64_tr_b16 v[196:197], v13 offset:96
    v_mfma_f32_16x16x32_bf16 v[68:71], v[172:175], v[116:119], v[68:71]
    ds_read_b64_tr_b16 v[198:199], v13 offset:4704
    s_waitcnt lgkmcnt(10)
    v_mfma_f32_16x16x32_bf16 v[72:75], v[176:179], v[112:115], v[72:75]
    ds_read_b64_tr_b16 v[168:169], v13 offset:128
    v_mfma_f32_16x16x32_bf16 v[76:79], v[176:179], v[116:119], v[76:79]
    ds_read_b64_tr_b16 v[170:171], v13 offset:4736
    s_add_u32 m0, s27, 57344
    s_nop 0
    buffer_load_dwordx4 v4, s[40:43], s30 offen sc1 lds
    s_waitcnt lgkmcnt(10)
    v_mfma_f32_16x16x32_bf16 v[80:83], v[180:183], v[112:115], v[80:83]
    ds_read_b64_tr_b16 v[172:173], v13 offset:160
    v_mfma_f32_16x16x32_bf16 v[84:87], v[180:183], v[116:119], v[84:87]
    ds_read_b64_tr_b16 v[174:175], v13 offset:4768
    s_waitcnt vmcnt(31) lgkmcnt(10)
    v_mfma_f32_16x16x32_bf16 v[16:19], v[184:187], v[120:123], v[16:19]
    ds_read_b64_tr_b16 v[176:177], v13 offset:192
    v_mfma_f32_16x16x32_bf16 v[20:23], v[184:187], v[124:127], v[20:23]
    ds_read_b64_tr_b16 v[178:179], v13 offset:4800
    s_add_u32 s33, s28, 40960
    buffer_load_dwordx4 v[112:115], v1, s[16:19], s33 offen offset:0 sc1
    buffer_load_dwordx4 v[116:119], v1, s[16:19], s33 offen offset:1024 sc1
    s_waitcnt lgkmcnt(10)
    v_mfma_f32_16x16x32_bf16 v[24:27], v[188:191], v[120:123], v[24:27]
    ds_read_b64_tr_b16 v[180:181], v13 offset:224
    v_mfma_f32_16x16x32_bf16 v[28:31], v[188:191], v[124:127], v[28:31]
    ds_read_b64_tr_b16 v[182:183], v13 offset:4832
    s_add_u32 m0, s27, 58368
    s_nop 0
    buffer_load_dwordx4 v5, s[40:43], s30 offen sc1 lds
    s_waitcnt lgkmcnt(10)
    v_mfma_f32_16x16x32_bf16 v[32:35], v[192:195], v[120:123], v[32:35]
    ds_read_b64_tr_b16 v[184:185], v13 offset:256
    v_mfma_f32_16x16x32_bf16 v[36:39], v[192:195], v[124:127], v[36:39]
    ds_read_b64_tr_b16 v[186:187], v13 offset:4864
    s_waitcnt lgkmcnt(10)
    v_mfma_f32_16x16x32_bf16 v[40:43], v[196:199], v[120:123], v[40:43]
    ds_read_b64_tr_b16 v[188:189], v13 offset:9216
    v_mfma_f32_16x16x32_bf16 v[44:47], v[196:199], v[124:127], v[44:47]
    ds_read_b64_tr_b16 v[190:191], v13 offset:13824
    s_add_u32 m0, s27, 59392
    s_nop 0
    buffer_load_dwordx4 v6, s[40:43], s30 offen sc1 lds
    s_waitcnt lgkmcnt(10)
    v_mfma_f32_16x16x32_bf16 v[48:51], v[168:171], v[120:123], v[48:51]
    ds_read_b64_tr_b16 v[192:193], v13 offset:9248
    v_mfma_f32_16x16x32_bf16 v[52:55], v[168:171], v[124:127], v[52:55]
    ds_read_b64_tr_b16 v[194:195], v13 offset:13856
    s_waitcnt lgkmcnt(10)
    v_mfma_f32_16x16x32_bf16 v[56:59], v[172:175], v[120:123], v[56:59]
    ds_read_b64_tr_b16 v[196:197], v13 offset:9280
    v_mfma_f32_16x16x32_bf16 v[60:63], v[172:175], v[124:127], v[60:63]
    ds_read_b64_tr_b16 v[198:199], v13 offset:13888
    s_add_u32 m0, s27, 60416
    s_nop 0
    buffer_load_dwordx4 v7, s[40:43], s30 offen sc1 lds
    s_waitcnt lgkmcnt(10)
    v_mfma_f32_16x16x32_bf16 v[64:67], v[176:179], v[120:123], v[64:67]
    ds_read_b64_tr_b16 v[168:169], v13 offset:9312
    v_mfma_f32_16x16x32_bf16 v[68:71], v[176:179], v[124:127], v[68:71]
    ds_read_b64_tr_b16 v[170:171], v13 offset:13920
    s_waitcnt lgkmcnt(10)
    v_mfma_f32_16x16x32_bf16 v[72:75], v[180:183], v[120:123], v[72:75]
    ds_read_b64_tr_b16 v[172:173], v13 offset:9344
    v_mfma_f32_16x16x32_bf16 v[76:79], v[180:183], v[124:127], v[76:79]
    ds_read_b64_tr_b16 v[174:175], v13 offset:13952
    s_add_u32 m0, s27, 61440
    s_mov_b32 exec_hi, 0xffff
    buffer_load_dwordx4 v8, s[40:43], s30 offen sc1 lds
    s_mov_b32 exec_hi, -1
    s_waitcnt lgkmcnt(10)
    v_mfma_f32_16x16x32_bf16 v[80:83], v[184:187], v[120:123], v[80:83]
    ds_read_b64_tr_b16 v[176:177], v13 offset:9376
    v_mfma_f32_16x16x32_bf16 v[84:87], v[184:187], v[124:127], v[84:87]
    ds_read_b64_tr_b16 v[178:179], v13 offset:13984
    s_waitcnt vmcnt(35) lgkmcnt(10)
    v_mfma_f32_16x16x32_bf16 v[16:19], v[188:191], v[128:131], v[16:19]
    ds_read_b64_tr_b16 v[180:181], v13 offset:9408
    v_mfma_f32_16x16x32_bf16 v[20:23], v[188:191], v[132:135], v[20:23]
    ds_read_b64_tr_b16 v[182:183], v13 offset:14016
    s_add_u32 s33, s28, 43008
    buffer_load_dwordx4 v[120:123], v1, s[16:19], s33 offen offset:0 sc1
    buffer_load_dwordx4 v[124:127], v1, s[16:19], s33 offen offset:1024 sc1
    s_waitcnt lgkmcnt(10)
    v_mfma_f32_16x16x32_bf16 v[24:27], v[192:195], v[128:131], v[24:27]
    ds_read_b64_tr_b16 v[184:185], v13 offset:9440
    v_mfma_f32_16x16x32_bf16 v[28:31], v[192:195], v[132:135], v[28:31]
    ds_read_b64_tr_b16 v[186:187], v13 offset:14048
    s_waitcnt lgkmcnt(10)
    v_mfma_f32_16x16x32_bf16 v[32:35], v[196:199], v[128:131], v[32:35]
    ds_read_b64_tr_b16 v[188:189], v13 offset:9472
    v_mfma_f32_16x16x32_bf16 v[36:39], v[196:199], v[132:135], v[36:39]
    ds_read_b64_tr_b16 v[190:191], v13 offset:14080
    s_waitcnt lgkmcnt(10)
    v_mfma_f32_16x16x32_bf16 v[40:43], v[168:171], v[128:131], v[40:43]
    ds_read_b64_tr_b16 v[192:193], v13 offset:18432
    v_mfma_f32_16x16x32_bf16 v[44:47], v[168:171], v[132:135], v[44:47]
    ds_read_b64_tr_b16 v[194:195], v13 offset:23040
    s_waitcnt lgkmcnt(10)
    v_mfma_f32_16x16x32_bf16 v[48:51], v[172:175], v[128:131], v[48:51]
    ds_read_b64_tr_b16 v[196:197], v13 offset:18464
    v_mfma_f32_16x16x32_bf16 v[52:55], v[172:175], v[132:135], v[52:55]
    ds_read_b64_tr_b16 v[198:199], v13 offset:23072
    s_waitcnt lgkmcnt(10)
    v_mfma_f32_16x16x32_bf16 v[56:59], v[176:179], v[128:131], v[56:59]
    ds_read_b64_tr_b16 v[168:169], v13 offset:18496
    v_mfma_f32_16x16x32_bf16 v[60:63], v[176:179], v[132:135], v[60:63]
    ds_read_b64_tr_b16 v[170:171], v13 offset:23104
    s_waitcnt lgkmcnt(10)
    v_mfma_f32_16x16x32_bf16 v[64:67], v[180:183], v[128:131], v[64:67]
    ds_read_b64_tr_b16 v[172:173], v13 offset:18528
    v_mfma_f32_16x16x32_bf16 v[68:71], v[180:183], v[132:135], v[68:71]
    ds_read_b64_tr_b16 v[174:175], v13 offset:23136
    s_waitcnt lgkmcnt(10)
    v_mfma_f32_16x16x32_bf16 v[72:75], v[184:187], v[128:131], v[72:75]
    ds_read_b64_tr_b16 v[176:177], v13 offset:18560
    v_mfma_f32_16x16x32_bf16 v[76:79], v[184:187], v[132:135], v[76:79]
    ds_read_b64_tr_b16 v[178:179], v13 offset:23168
    s_waitcnt lgkmcnt(10)
    v_mfma_f32_16x16x32_bf16 v[80:83], v[188:191], v[128:131], v[80:83]
    ds_read_b64_tr_b16 v[180:181], v13 offset:18592
    v_mfma_f32_16x16x32_bf16 v[84:87], v[188:191], v[132:135], v[84:87]
    ds_read_b64_tr_b16 v[182:183], v13 offset:23200
    s_waitcnt vmcnt(32) lgkmcnt(10)
    v_mfma_f32_16x16x32_bf16 v[16:19], v[192:195], v[136:139], v[16:19]
    ds_read_b64_tr_b16 v[184:185], v13 offset:18624
    v_mfma_f32_16x16x32_bf16 v[20:23], v[192:195], v[140:143], v[20:23]
    ds_read_b64_tr_b16 v[186:187], v13 offset:23232
    s_add_u32 s33, s28, 45056
    buffer_load_dwordx4 v[128:131], v1, s[16:19], s33 offen offset:0 sc1
    buffer_load_dwordx4 v[132:135], v1, s[16:19], s33 offen offset:1024 sc1
    s_waitcnt lgkmcnt(10)
    v_mfma_f32_16x16x32_bf16 v[24:27], v[196:199], v[136:139], v[24:27]
    ds_read_b64_tr_b16 v[188:189], v13 offset:18656
    v_mfma_f32_16x16x32_bf16 v[28:31], v[196:199], v[140:143], v[28:31]
    ds_read_b64_tr_b16 v[190:191], v13 offset:23264
    s_waitcnt lgkmcnt(10)
    v_mfma_f32_16x16x32_bf16 v[32:35], v[168:171], v[136:139], v[32:35]
    ds_read_b64_tr_b16 v[192:193], v13 offset:18688
    v_mfma_f32_16x16x32_bf16 v[36:39], v[168:171], v[140:143], v[36:39]
    ds_read_b64_tr_b16 v[194:195], v13 offset:23296
    s_waitcnt vmcnt(30)
    s_barrier
    s_waitcnt lgkmcnt(10)
    v_mfma_f32_16x16x32_bf16 v[40:43], v[172:175], v[136:139], v[40:43]
    ds_read_b64_tr_b16 v[196:197], v9 offset:0
    v_mfma_f32_16x16x32_bf16 v[44:47], v[172:175], v[140:143], v[44:47]
    ds_read_b64_tr_b16 v[198:199], v9 offset:4608
    s_add_u32 s30, s29, 884736
    s_add_u32 m0, s27, 82944
    s_nop 0
    buffer_load_dwordx4 v2, s[40:43], s30 offen sc1 lds
    s_waitcnt lgkmcnt(10)
    v_mfma_f32_16x16x32_bf16 v[48:51], v[176:179], v[136:139], v[48:51]
    ds_read_b64_tr_b16 v[168:169], v9 offset:32
    v_mfma_f32_16x16x32_bf16 v[52:55], v[176:179], v[140:143], v[52:55]
    ds_read_b64_tr_b16 v[170:171], v9 offset:4640
    s_waitcnt lgkmcnt(10)
    v_mfma_f32_16x16x32_bf16 v[56:59], v[180:183], v[136:139], v[56:59]
    ds_read_b64_tr_b16 v[172:173], v9 offset:64
    v_mfma_f32_16x16x32_bf16 v[60:63], v[180:183], v[140:143], v[60:63]
    ds_read_b64_tr_b16 v[174:175], v9 offset:4672
    s_add_u32 m0, s27, 83968
    s_nop 0
    buffer_load_dwordx4 v3, s[40:43], s30 offen sc1 lds
    s_waitcnt lgkmcnt(10)
    v_mfma_f32_16x16x32_bf16 v[64:67], v[184:187], v[136:139], v[64:67]
    ds_read_b64_tr_b16 v[176:177], v9 offset:96
    v_mfma_f32_16x16x32_bf16 v[68:71], v[184:187], v[140:143], v[68:71]
    ds_read_b64_tr_b16 v[178:179], v9 offset:4704
    s_waitcnt lgkmcnt(10)
    v_mfma_f32_16x16x32_bf16 v[72:75], v[188:191], v[136:139], v[72:75]
    ds_read_b64_tr_b16 v[180:181], v9 offset:128
    v_mfma_f32_16x16x32_bf16 v[76:79], v[188:191], v[140:143], v[76:79]
    ds_read_b64_tr_b16 v[182:183], v9 offset:4736
    s_add_u32 m0, s27, 84992
    s_nop 0
    buffer_load_dwordx4 v4, s[40:43], s30 offen sc1 lds
    s_waitcnt lgkmcnt(10)
    v_mfma_f32_16x16x32_bf16 v[80:83], v[192:195], v[136:139], v[80:83]
    ds_read_b64_tr_b16 v[184:185], v9 offset:160
    v_mfma_f32_16x16x32_bf16 v[84:87], v[192:195], v[140:143], v[84:87]
    ds_read_b64_tr_b16 v[186:187], v9 offset:4768
    s_waitcnt vmcnt(31) lgkmcnt(10)
    v_mfma_f32_16x16x32_bf16 v[16:19], v[196:199], v[144:147], v[16:19]
    ds_read_b64_tr_b16 v[188:189], v9 offset:192
    v_mfma_f32_16x16x32_bf16 v[20:23], v[196:199], v[148:151], v[20:23]
    ds_read_b64_tr_b16 v[190:191], v9 offset:4800
    s_add_u32 s33, s28, 47104
    buffer_load_dwordx4 v[136:139], v1, s[16:19], s33 offen offset:0 sc1
    buffer_load_dwordx4 v[140:143], v1, s[16:19], s33 offen offset:1024 sc1
    s_waitcnt lgkmcnt(10)
    v_mfma_f32_16x16x32_bf16 v[24:27], v[168:171], v[144:147], v[24:27]
    ds_read_b64_tr_b16 v[192:193], v9 offset:224
    v_mfma_f32_16x16x32_bf16 v[28:31], v[168:171], v[148:151], v[28:31]
    ds_read_b64_tr_b16 v[194:195], v9 offset:4832
    s_add_u32 m0, s27, 86016
    s_nop 0
    buffer_load_dwordx4 v5, s[40:43], s30 offen sc1 lds
    s_waitcnt lgkmcnt(10)
    v_mfma_f32_16x16x32_bf16 v[32:35], v[172:175], v[144:147], v[32:35]
    ds_read_b64_tr_b16 v[196:197], v9 offset:256
    v_mfma_f32_16x16x32_bf16 v[36:39], v[172:175], v[148:151], v[36:39]
    ds_read_b64_tr_b16 v[198:199], v9 offset:4864
    s_waitcnt lgkmcnt(10)
    v_mfma_f32_16x16x32_bf16 v[40:43], v[176:179], v[144:147], v[40:43]
    ds_read_b64_tr_b16 v[168:169], v9 offset:9216
    v_mfma_f32_16x16x32_bf16 v[44:47], v[176:179], v[148:151], v[44:47]
    ds_read_b64_tr_b16 v[170:171], v9 offset:13824
    s_add_u32 m0, s27, 87040
    s_nop 0
    buffer_load_dwordx4 v6, s[40:43], s30 offen sc1 lds
    s_waitcnt lgkmcnt(10)
    v_mfma_f32_16x16x32_bf16 v[48:51], v[180:183], v[144:147], v[48:51]
    ds_read_b64_tr_b16 v[172:173], v9 offset:9248
    v_mfma_f32_16x16x32_bf16 v[52:55], v[180:183], v[148:151], v[52:55]
    ds_read_b64_tr_b16 v[174:175], v9 offset:13856
    s_waitcnt lgkmcnt(10)
    v_mfma_f32_16x16x32_bf16 v[56:59], v[184:187], v[144:147], v[56:59]
    ds_read_b64_tr_b16 v[176:177], v9 offset:9280
    v_mfma_f32_16x16x32_bf16 v[60:63], v[184:187], v[148:151], v[60:63]
    ds_read_b64_tr_b16 v[178:179], v9 offset:13888
    s_add_u32 m0, s27, 88064
    s_nop 0
    buffer_load_dwordx4 v7, s[40:43], s30 offen sc1 lds
    s_waitcnt lgkmcnt(10)
    v_mfma_f32_16x16x32_bf16 v[64:67], v[188:191], v[144:147], v[64:67]
    ds_read_b64_tr_b16 v[180:181], v9 offset:9312
    v_mfma_f32_16x16x32_bf16 v[68:71], v[188:191], v[148:151], v[68:71]
    ds_read_b64_tr_b16 v[182:183], v9 offset:13920
    s_waitcnt lgkmcnt(10)
    v_mfma_f32_16x16x32_bf16 v[72:75], v[192:195], v[144:147], v[72:75]
    ds_read_b64_tr_b16 v[184:185], v9 offset:9344
    v_mfma_f32_16x16x32_bf16 v[76:79], v[192:195], v[148:151], v[76:79]
    ds_read_b64_tr_b16 v[186:187], v9 offset:13952
    s_add_u32 m0, s27, 89088
    s_mov_b32 exec_hi, 0xffff
    buffer_load_dwordx4 v8, s[40:43], s30 offen sc1 lds
    s_mov_b32 exec_hi, -1
    s_waitcnt lgkmcnt(10)
    v_mfma_f32_16x16x32_bf16 v[80:83], v[196:199], v[144:147], v[80:83]
    ds_read_b64_tr_b16 v[188:189], v9 offset:9376
    v_mfma_f32_16x16x32_bf16 v[84:87], v[196:199], v[148:151], v[84:87]
    ds_read_b64_tr_b16 v[190:191], v9 offset:13984
    s_waitcnt vmcnt(35) lgkmcnt(10)
    v_mfma_f32_16x16x32_bf16 v[16:19], v[168:171], v[152:155], v[16:19]
    ds_read_b64_tr_b16 v[192:193], v9 offset:9408
    v_mfma_f32_16x16x32_bf16 v[20:23], v[168:171], v[156:159], v[20:23]
    ds_read_b64_tr_b16 v[194:195], v9 offset:14016
    s_add_u32 s33, s28, 49152
    buffer_load_dwordx4 v[144:147], v1, s[16:19], s33 offen offset:0 sc1
    buffer_load_dwordx4 v[148:151], v1, s[16:19], s33 offen offset:1024 sc1
    s_waitcnt lgkmcnt(10)
    v_mfma_f32_16x16x32_bf16 v[24:27], v[172:175], v[152:155], v[24:27]
    ds_read_b64_tr_b16 v[196:197], v9 offset:9440
    v_mfma_f32_16x16x32_bf16 v[28:31], v[172:175], v[156:159], v[28:31]
    ds_read_b64_tr_b16 v[198:199], v9 offset:14048
    s_waitcnt lgkmcnt(10)
    v_mfma_f32_16x16x32_bf16 v[32:35], v[176:179], v[152:155], v[32:35]
    ds_read_b64_tr_b16 v[168:169], v9 offset:9472
    v_mfma_f32_16x16x32_bf16 v[36:39], v[176:179], v[156:159], v[36:39]
    ds_read_b64_tr_b16 v[170:171], v9 offset:14080
    s_waitcnt lgkmcnt(10)
    v_mfma_f32_16x16x32_bf16 v[40:43], v[180:183], v[152:155], v[40:43]
    ds_read_b64_tr_b16 v[172:173], v9 offset:18432
    v_mfma_f32_16x16x32_bf16 v[44:47], v[180:183], v[156:159], v[44:47]
    ds_read_b64_tr_b16 v[174:175], v9 offset:23040
    s_waitcnt lgkmcnt(10)
    v_mfma_f32_16x16x32_bf16 v[48:51], v[184:187], v[152:155], v[48:51]
    ds_read_b64_tr_b16 v[176:177], v9 offset:18464
    v_mfma_f32_16x16x32_bf16 v[52:55], v[184:187], v[156:159], v[52:55]
    ds_read_b64_tr_b16 v[178:179], v9 offset:23072
    s_waitcnt lgkmcnt(10)
    v_mfma_f32_16x16x32_bf16 v[56:59], v[188:191], v[152:155], v[56:59]
    ds_read_b64_tr_b16 v[180:181], v9 offset:18496
    v_mfma_f32_16x16x32_bf16 v[60:63], v[188:191], v[156:159], v[60:63]
    ds_read_b64_tr_b16 v[182:183], v9 offset:23104
    s_waitcnt lgkmcnt(10)
    v_mfma_f32_16x16x32_bf16 v[64:67], v[192:195], v[152:155], v[64:67]
    ds_read_b64_tr_b16 v[184:185], v9 offset:18528
    v_mfma_f32_16x16x32_bf16 v[68:71], v[192:195], v[156:159], v[68:71]
    ds_read_b64_tr_b16 v[186:187], v9 offset:23136
    s_waitcnt lgkmcnt(10)
    v_mfma_f32_16x16x32_bf16 v[72:75], v[196:199], v[152:155], v[72:75]
    ds_read_b64_tr_b16 v[188:189], v9 offset:18560
    v_mfma_f32_16x16x32_bf16 v[76:79], v[196:199], v[156:159], v[76:79]
    ds_read_b64_tr_b16 v[190:191], v9 offset:23168
    s_waitcnt lgkmcnt(10)
    v_mfma_f32_16x16x32_bf16 v[80:83], v[168:171], v[152:155], v[80:83]
    ds_read_b64_tr_b16 v[192:193], v9 offset:18592
    v_mfma_f32_16x16x32_bf16 v[84:87], v[168:171], v[156:159], v[84:87]
    ds_read_b64_tr_b16 v[194:195], v9 offset:23200
    s_waitcnt vmcnt(32) lgkmcnt(10)
    v_mfma_f32_16x16x32_bf16 v[16:19], v[172:175], v[160:163], v[16:19]
    ds_read_b64_tr_b16 v[196:197], v9 offset:18624
    v_mfma_f32_16x16x32_bf16 v[20:23], v[172:175], v[164:167], v[20:23]
    ds_read_b64_tr_b16 v[198:199], v9 offset:23232
    s_add_u32 s33, s28, 51200
    buffer_load_dwordx4 v[152:155], v1, s[16:19], s33 offen offset:0 sc1
    buffer_load_dwordx4 v[156:159], v1, s[16:19], s33 offen offset:1024 sc1
    s_waitcnt lgkmcnt(10)
    v_mfma_f32_16x16x32_bf16 v[24:27], v[176:179], v[160:163], v[24:27]
    ds_read_b64_tr_b16 v[168:169], v9 offset:18656
    v_mfma_f32_16x16x32_bf16 v[28:31], v[176:179], v[164:167], v[28:31]
    ds_read_b64_tr_b16 v[170:171], v9 offset:23264
    s_waitcnt lgkmcnt(10)
    v_mfma_f32_16x16x32_bf16 v[32:35], v[180:183], v[160:163], v[32:35]
    ds_read_b64_tr_b16 v[172:173], v9 offset:18688
    v_mfma_f32_16x16x32_bf16 v[36:39], v[180:183], v[164:167], v[36:39]
    ds_read_b64_tr_b16 v[174:175], v9 offset:23296
    s_waitcnt vmcnt(30)
    s_barrier
    s_waitcnt lgkmcnt(10)
    v_mfma_f32_16x16x32_bf16 v[40:43], v[184:187], v[160:163], v[40:43]
    ds_read_b64_tr_b16 v[176:177], v10 offset:0
    v_mfma_f32_16x16x32_bf16 v[44:47], v[184:187], v[164:167], v[44:47]
    ds_read_b64_tr_b16 v[178:179], v10 offset:4608
    s_add_u32 s30, s29, 995328
    s_add_u32 m0, s27, 110592
    s_nop 0
    buffer_load_dwordx4 v2, s[40:43], s30 offen sc1 lds
    s_waitcnt lgkmcnt(10)
    v_mfma_f32_16x16x32_bf16 v[48:51], v[188:191], v[160:163], v[48:51]
    ds_read_b64_tr_b16 v[180:181], v10 offset:32
    v_mfma_f32_16x16x32_bf16 v[52:55], v[188:191], v[164:167], v[52:55]
    ds_read_b64_tr_b16 v[182:183], v10 offset:4640
    s_waitcnt lgkmcnt(10)
    v_mfma_f32_16x16x32_bf16 v[56:59], v[192:195], v[160:163], v[56:59]
    ds_read_b64_tr_b16 v[184:185], v10 offset:64
    v_mfma_f32_16x16x32_bf16 v[60:63], v[192:195], v[164:167], v[60:63]
    ds_read_b64_tr_b16 v[186:187], v10 offset:4672
    s_add_u32 m0, s27, 111616
    s_nop 0
    buffer_load_dwordx4 v3, s[40:43], s30 offen sc1 lds
    s_waitcnt lgkmcnt(10)
    v_mfma_f32_16x16x32_bf16 v[64:67], v[196:199], v[160:163], v[64:67]
    ds_read_b64_tr_b16 v[188:189], v10 offset:96
    v_mfma_f32_16x16x32_bf16 v[68:71], v[196:199], v[164:167], v[68:71]
    ds_read_b64_tr_b16 v[190:191], v10 offset:4704
    s_waitcnt lgkmcnt(10)
    v_mfma_f32_16x16x32_bf16 v[72:75], v[168:171], v[160:163], v[72:75]
    ds_read_b64_tr_b16 v[192:193], v10 offset:128
    v_mfma_f32_16x16x32_bf16 v[76:79], v[168:171], v[164:167], v[76:79]
    ds_read_b64_tr_b16 v[194:195], v10 offset:4736
    s_add_u32 m0, s27, 112640
    s_nop 0
    buffer_load_dwordx4 v4, s[40:43], s30 offen sc1 lds
    s_waitcnt lgkmcnt(10)
    v_mfma_f32_16x16x32_bf16 v[80:83], v[172:175], v[160:163], v[80:83]
    ds_read_b64_tr_b16 v[196:197], v10 offset:160
    v_mfma_f32_16x16x32_bf16 v[84:87], v[172:175], v[164:167], v[84:87]
    ds_read_b64_tr_b16 v[198:199], v10 offset:4768
    s_waitcnt vmcnt(31) lgkmcnt(10)
    v_mfma_f32_16x16x32_bf16 v[16:19], v[176:179], v[96:99], v[16:19]
    ds_read_b64_tr_b16 v[168:169], v10 offset:192
    v_mfma_f32_16x16x32_bf16 v[20:23], v[176:179], v[100:103], v[20:23]
    ds_read_b64_tr_b16 v[170:171], v10 offset:4800
    s_add_u32 s33, s28, 53248
    buffer_load_dwordx4 v[160:163], v1, s[16:19], s33 offen offset:0 sc1
    buffer_load_dwordx4 v[164:167], v1, s[16:19], s33 offen offset:1024 sc1
    s_waitcnt lgkmcnt(10)
    v_mfma_f32_16x16x32_bf16 v[24:27], v[180:183], v[96:99], v[24:27]
    ds_read_b64_tr_b16 v[172:173], v10 offset:224
    v_mfma_f32_16x16x32_bf16 v[28:31], v[180:183], v[100:103], v[28:31]
    ds_read_b64_tr_b16 v[174:175], v10 offset:4832
    s_add_u32 m0, s27, 113664
    s_nop 0
    buffer_load_dwordx4 v5, s[40:43], s30 offen sc1 lds
    s_waitcnt lgkmcnt(10)
    v_mfma_f32_16x16x32_bf16 v[32:35], v[184:187], v[96:99], v[32:35]
    ds_read_b64_tr_b16 v[176:177], v10 offset:256
    v_mfma_f32_16x16x32_bf16 v[36:39], v[184:187], v[100:103], v[36:39]
    ds_read_b64_tr_b16 v[178:179], v10 offset:4864
    s_waitcnt lgkmcnt(10)
    v_mfma_f32_16x16x32_bf16 v[40:43], v[188:191], v[96:99], v[40:43]
    ds_read_b64_tr_b16 v[180:181], v10 offset:9216
    v_mfma_f32_16x16x32_bf16 v[44:47], v[188:191], v[100:103], v[44:47]
    ds_read_b64_tr_b16 v[182:183], v10 offset:13824
    s_add_u32 m0, s27, 114688
    s_nop 0
    buffer_load_dwordx4 v6, s[40:43], s30 offen sc1 lds
    s_waitcnt lgkmcnt(10)
    v_mfma_f32_16x16x32_bf16 v[48:51], v[192:195], v[96:99], v[48:51]
    ds_read_b64_tr_b16 v[184:185], v10 offset:9248
    v_mfma_f32_16x16x32_bf16 v[52:55], v[192:195], v[100:103], v[52:55]
    ds_read_b64_tr_b16 v[186:187], v10 offset:13856
    s_waitcnt lgkmcnt(10)
    v_mfma_f32_16x16x32_bf16 v[56:59], v[196:199], v[96:99], v[56:59]
    ds_read_b64_tr_b16 v[188:189], v10 offset:9280
    v_mfma_f32_16x16x32_bf16 v[60:63], v[196:199], v[100:103], v[60:63]
    ds_read_b64_tr_b16 v[190:191], v10 offset:13888
    s_add_u32 m0, s27, 115712
    s_nop 0
    buffer_load_dwordx4 v7, s[40:43], s30 offen sc1 lds
    s_waitcnt lgkmcnt(10)
    v_mfma_f32_16x16x32_bf16 v[64:67], v[168:171], v[96:99], v[64:67]
    ds_read_b64_tr_b16 v[192:193], v10 offset:9312
    v_mfma_f32_16x16x32_bf16 v[68:71], v[168:171], v[100:103], v[68:71]
    ds_read_b64_tr_b16 v[194:195], v10 offset:13920
    s_waitcnt lgkmcnt(10)
    v_mfma_f32_16x16x32_bf16 v[72:75], v[172:175], v[96:99], v[72:75]
    ds_read_b64_tr_b16 v[196:197], v10 offset:9344
    v_mfma_f32_16x16x32_bf16 v[76:79], v[172:175], v[100:103], v[76:79]
    ds_read_b64_tr_b16 v[198:199], v10 offset:13952
    s_add_u32 m0, s27, 116736
    s_mov_b32 exec_hi, 0xffff
    buffer_load_dwordx4 v8, s[40:43], s30 offen sc1 lds
    s_mov_b32 exec_hi, -1
    s_waitcnt lgkmcnt(10)
    v_mfma_f32_16x16x32_bf16 v[80:83], v[176:179], v[96:99], v[80:83]
    ds_read_b64_tr_b16 v[168:169], v10 offset:9376
    v_mfma_f32_16x16x32_bf16 v[84:87], v[176:179], v[100:103], v[84:87]
    ds_read_b64_tr_b16 v[170:171], v10 offset:13984
    s_waitcnt vmcnt(35) lgkmcnt(10)
    v_mfma_f32_16x16x32_bf16 v[16:19], v[180:183], v[104:107], v[16:19]
    ds_read_b64_tr_b16 v[172:173], v10 offset:9408
    v_mfma_f32_16x16x32_bf16 v[20:23], v[180:183], v[108:111], v[20:23]
    ds_read_b64_tr_b16 v[174:175], v10 offset:14016
    s_add_u32 s33, s28, 55296
    buffer_load_dwordx4 v[96:99], v1, s[16:19], s33 offen offset:0 sc1
    buffer_load_dwordx4 v[100:103], v1, s[16:19], s33 offen offset:1024 sc1
    s_waitcnt lgkmcnt(10)
    v_mfma_f32_16x16x32_bf16 v[24:27], v[184:187], v[104:107], v[24:27]
    ds_read_b64_tr_b16 v[176:177], v10 offset:9440
    v_mfma_f32_16x16x32_bf16 v[28:31], v[184:187], v[108:111], v[28:31]
    ds_read_b64_tr_b16 v[178:179], v10 offset:14048
    s_waitcnt lgkmcnt(10)
    v_mfma_f32_16x16x32_bf16 v[32:35], v[188:191], v[104:107], v[32:35]
    ds_read_b64_tr_b16 v[180:181], v10 offset:9472
    v_mfma_f32_16x16x32_bf16 v[36:39], v[188:191], v[108:111], v[36:39]
    ds_read_b64_tr_b16 v[182:183], v10 offset:14080
    s_waitcnt lgkmcnt(10)
    v_mfma_f32_16x16x32_bf16 v[40:43], v[192:195], v[104:107], v[40:43]
    ds_read_b64_tr_b16 v[184:185], v10 offset:18432
    v_mfma_f32_16x16x32_bf16 v[44:47], v[192:195], v[108:111], v[44:47]
    ds_read_b64_tr_b16 v[186:187], v10 offset:23040
    s_waitcnt lgkmcnt(10)
    v_mfma_f32_16x16x32_bf16 v[48:51], v[196:199], v[104:107], v[48:51]
    ds_read_b64_tr_b16 v[188:189], v10 offset:18464
    v_mfma_f32_16x16x32_bf16 v[52:55], v[196:199], v[108:111], v[52:55]
    ds_read_b64_tr_b16 v[190:191], v10 offset:23072
    s_waitcnt lgkmcnt(10)
    v_mfma_f32_16x16x32_bf16 v[56:59], v[168:171], v[104:107], v[56:59]
    ds_read_b64_tr_b16 v[192:193], v10 offset:18496
    v_mfma_f32_16x16x32_bf16 v[60:63], v[168:171], v[108:111], v[60:63]
    ds_read_b64_tr_b16 v[194:195], v10 offset:23104
    s_waitcnt lgkmcnt(10)
    v_mfma_f32_16x16x32_bf16 v[64:67], v[172:175], v[104:107], v[64:67]
    ds_read_b64_tr_b16 v[196:197], v10 offset:18528
    v_mfma_f32_16x16x32_bf16 v[68:71], v[172:175], v[108:111], v[68:71]
    ds_read_b64_tr_b16 v[198:199], v10 offset:23136
    s_waitcnt lgkmcnt(10)
    v_mfma_f32_16x16x32_bf16 v[72:75], v[176:179], v[104:107], v[72:75]
    ds_read_b64_tr_b16 v[168:169], v10 offset:18560
    v_mfma_f32_16x16x32_bf16 v[76:79], v[176:179], v[108:111], v[76:79]
    ds_read_b64_tr_b16 v[170:171], v10 offset:23168
    s_waitcnt lgkmcnt(10)
    v_mfma_f32_16x16x32_bf16 v[80:83], v[180:183], v[104:107], v[80:83]
    ds_read_b64_tr_b16 v[172:173], v10 offset:18592
    v_mfma_f32_16x16x32_bf16 v[84:87], v[180:183], v[108:111], v[84:87]
    ds_read_b64_tr_b16 v[174:175], v10 offset:23200
    s_waitcnt vmcnt(32) lgkmcnt(10)
    v_mfma_f32_16x16x32_bf16 v[16:19], v[184:187], v[112:115], v[16:19]
    ds_read_b64_tr_b16 v[176:177], v10 offset:18624
    v_mfma_f32_16x16x32_bf16 v[20:23], v[184:187], v[116:119], v[20:23]
    ds_read_b64_tr_b16 v[178:179], v10 offset:23232
    s_add_u32 s33, s28, 57344
    buffer_load_dwordx4 v[104:107], v1, s[16:19], s33 offen offset:0 sc1
    buffer_load_dwordx4 v[108:111], v1, s[16:19], s33 offen offset:1024 sc1
    s_waitcnt lgkmcnt(10)
    v_mfma_f32_16x16x32_bf16 v[24:27], v[188:191], v[112:115], v[24:27]
    ds_read_b64_tr_b16 v[180:181], v10 offset:18656
    v_mfma_f32_16x16x32_bf16 v[28:31], v[188:191], v[116:119], v[28:31]
    ds_read_b64_tr_b16 v[182:183], v10 offset:23264
    s_waitcnt lgkmcnt(10)
    v_mfma_f32_16x16x32_bf16 v[32:35], v[192:195], v[112:115], v[32:35]
    ds_read_b64_tr_b16 v[184:185], v10 offset:18688
    v_mfma_f32_16x16x32_bf16 v[36:39], v[192:195], v[116:119], v[36:39]
    ds_read_b64_tr_b16 v[186:187], v10 offset:23296
    s_waitcnt vmcnt(30)
    s_barrier
    s_waitcnt lgkmcnt(10)
    v_mfma_f32_16x16x32_bf16 v[40:43], v[196:199], v[112:115], v[40:43]
    ds_read_b64_tr_b16 v[188:189], v11 offset:0
    v_mfma_f32_16x16x32_bf16 v[44:47], v[196:199], v[116:119], v[44:47]
    ds_read_b64_tr_b16 v[190:191], v11 offset:4608
    s_add_u32 s30, s29, 1105920
    s_add_u32 m0, s27, 0
    s_nop 0
    buffer_load_dwordx4 v2, s[40:43], s30 offen sc1 lds
    s_waitcnt lgkmcnt(10)
    v_mfma_f32_16x16x32_bf16 v[48:51], v[168:171], v[112:115], v[48:51]
    ds_read_b64_tr_b16 v[192:193], v11 offset:32
    v_mfma_f32_16x16x32_bf16 v[52:55], v[168:171], v[116:119], v[52:55]
    ds_read_b64_tr_b16 v[194:195], v11 offset:4640
    s_waitcnt lgkmcnt(10)
    v_mfma_f32_16x16x32_bf16 v[56:59], v[172:175], v[112:115], v[56:59]
    ds_read_b64_tr_b16 v[196:197], v11 offset:64
    v_mfma_f32_16x16x32_bf16 v[60:63], v[172:175], v[116:119], v[60:63]
    ds_read_b64_tr_b16 v[198:199], v11 offset:4672
    s_add_u32 m0, s27, 1024
    s_nop 0
    buffer_load_dwordx4 v3, s[40:43], s30 offen sc1 lds
    s_waitcnt lgkmcnt(10)
    v_mfma_f32_16x16x32_bf16 v[64:67], v[176:179], v[112:115], v[64:67]
    ds_read_b64_tr_b16 v[168:169], v11 offset:96
    v_mfma_f32_16x16x32_bf16 v[68:71], v[176:179], v[116:119], v[68:71]
    ds_read_b64_tr_b16 v[170:171], v11 offset:4704
    s_waitcnt lgkmcnt(10)
    v_mfma_f32_16x16x32_bf16 v[72:75], v[180:183], v[112:115], v[72:75]
    ds_read_b64_tr_b16 v[172:173], v11 offset:128
    v_mfma_f32_16x16x32_bf16 v[76:79], v[180:183], v[116:119], v[76:79]
    ds_read_b64_tr_b16 v[174:175], v11 offset:4736
    s_add_u32 m0, s27, 2048
    s_nop 0
    buffer_load_dwordx4 v4, s[40:43], s30 offen sc1 lds
    s_waitcnt lgkmcnt(10)
    v_mfma_f32_16x16x32_bf16 v[80:83], v[184:187], v[112:115], v[80:83]
    ds_read_b64_tr_b16 v[176:177], v11 offset:160
    v_mfma_f32_16x16x32_bf16 v[84:87], v[184:187], v[116:119], v[84:87]
    ds_read_b64_tr_b16 v[178:179], v11 offset:4768
    s_waitcnt vmcnt(31) lgkmcnt(10)
    v_mfma_f32_16x16x32_bf16 v[16:19], v[188:191], v[120:123], v[16:19]
    ds_read_b64_tr_b16 v[180:181], v11 offset:192
    v_mfma_f32_16x16x32_bf16 v[20:23], v[188:191], v[124:127], v[20:23]
    ds_read_b64_tr_b16 v[182:183], v11 offset:4800
    s_add_u32 s33, s28, 59392
    buffer_load_dwordx4 v[112:115], v1, s[16:19], s33 offen offset:0 sc1
    buffer_load_dwordx4 v[116:119], v1, s[16:19], s33 offen offset:1024 sc1
    s_waitcnt lgkmcnt(10)
    v_mfma_f32_16x16x32_bf16 v[24:27], v[192:195], v[120:123], v[24:27]
    ds_read_b64_tr_b16 v[184:185], v11 offset:224
    v_mfma_f32_16x16x32_bf16 v[28:31], v[192:195], v[124:127], v[28:31]
    ds_read_b64_tr_b16 v[186:187], v11 offset:4832
    s_add_u32 m0, s27, 3072
    s_nop 0
    buffer_load_dwordx4 v5, s[40:43], s30 offen sc1 lds
    s_waitcnt lgkmcnt(10)
    v_mfma_f32_16x16x32_bf16 v[32:35], v[196:199], v[120:123], v[32:35]
    ds_read_b64_tr_b16 v[188:189], v11 offset:256
    v_mfma_f32_16x16x32_bf16 v[36:39], v[196:199], v[124:127], v[36:39]
    ds_read_b64_tr_b16 v[190:191], v11 offset:4864
    s_waitcnt lgkmcnt(10)
    v_mfma_f32_16x16x32_bf16 v[40:43], v[168:171], v[120:123], v[40:43]
    ds_read_b64_tr_b16 v[192:193], v11 offset:9216
    v_mfma_f32_16x16x32_bf16 v[44:47], v[168:171], v[124:127], v[44:47]
    ds_read_b64_tr_b16 v[194:195], v11 offset:13824
    s_add_u32 m0, s27, 4096
    s_nop 0
    buffer_load_dwordx4 v6, s[40:43], s30 offen sc1 lds
    s_waitcnt lgkmcnt(10)
    v_mfma_f32_16x16x32_bf16 v[48:51], v[172:175], v[120:123], v[48:51]
    ds_read_b64_tr_b16 v[196:197], v11 offset:9248
    v_mfma_f32_16x16x32_bf16 v[52:55], v[172:175], v[124:127], v[52:55]
    ds_read_b64_tr_b16 v[198:199], v11 offset:13856
    s_waitcnt lgkmcnt(10)
    v_mfma_f32_16x16x32_bf16 v[56:59], v[176:179], v[120:123], v[56:59]
    ds_read_b64_tr_b16 v[168:169], v11 offset:9280
    v_mfma_f32_16x16x32_bf16 v[60:63], v[176:179], v[124:127], v[60:63]
    ds_read_b64_tr_b16 v[170:171], v11 offset:13888
    s_add_u32 m0, s27, 5120
    s_nop 0
    buffer_load_dwordx4 v7, s[40:43], s30 offen sc1 lds
    s_waitcnt lgkmcnt(10)
    v_mfma_f32_16x16x32_bf16 v[64:67], v[180:183], v[120:123], v[64:67]
    ds_read_b64_tr_b16 v[172:173], v11 offset:9312
    v_mfma_f32_16x16x32_bf16 v[68:71], v[180:183], v[124:127], v[68:71]
    ds_read_b64_tr_b16 v[174:175], v11 offset:13920
    s_waitcnt lgkmcnt(10)
    v_mfma_f32_16x16x32_bf16 v[72:75], v[184:187], v[120:123], v[72:75]
    ds_read_b64_tr_b16 v[176:177], v11 offset:9344
    v_mfma_f32_16x16x32_bf16 v[76:79], v[184:187], v[124:127], v[76:79]
    ds_read_b64_tr_b16 v[178:179], v11 offset:13952
    s_add_u32 m0, s27, 6144
    s_mov_b32 exec_hi, 0xffff
    buffer_load_dwordx4 v8, s[40:43], s30 offen sc1 lds
    s_mov_b32 exec_hi, -1
    s_waitcnt lgkmcnt(10)
    v_mfma_f32_16x16x32_bf16 v[80:83], v[188:191], v[120:123], v[80:83]
    ds_read_b64_tr_b16 v[180:181], v11 offset:9376
    v_mfma_f32_16x16x32_bf16 v[84:87], v[188:191], v[124:127], v[84:87]
    ds_read_b64_tr_b16 v[182:183], v11 offset:13984
    s_waitcnt vmcnt(35) lgkmcnt(10)
    v_mfma_f32_16x16x32_bf16 v[16:19], v[192:195], v[128:131], v[16:19]
    ds_read_b64_tr_b16 v[184:185], v11 offset:9408
    v_mfma_f32_16x16x32_bf16 v[20:23], v[192:195], v[132:135], v[20:23]
    ds_read_b64_tr_b16 v[186:187], v11 offset:14016
    s_add_u32 s33, s28, 61440
    buffer_load_dwordx4 v[120:123], v1, s[16:19], s33 offen offset:0 sc1
    buffer_load_dwordx4 v[124:127], v1, s[16:19], s33 offen offset:1024 sc1
    s_waitcnt lgkmcnt(10)
    v_mfma_f32_16x16x32_bf16 v[24:27], v[196:199], v[128:131], v[24:27]
    ds_read_b64_tr_b16 v[188:189], v11 offset:9440
    v_mfma_f32_16x16x32_bf16 v[28:31], v[196:199], v[132:135], v[28:31]
    ds_read_b64_tr_b16 v[190:191], v11 offset:14048
    s_waitcnt lgkmcnt(10)
    v_mfma_f32_16x16x32_bf16 v[32:35], v[168:171], v[128:131], v[32:35]
    ds_read_b64_tr_b16 v[192:193], v11 offset:9472
    v_mfma_f32_16x16x32_bf16 v[36:39], v[168:171], v[132:135], v[36:39]
    ds_read_b64_tr_b16 v[194:195], v11 offset:14080
    s_waitcnt lgkmcnt(10)
    v_mfma_f32_16x16x32_bf16 v[40:43], v[172:175], v[128:131], v[40:43]
    ds_read_b64_tr_b16 v[196:197], v11 offset:18432
    v_mfma_f32_16x16x32_bf16 v[44:47], v[172:175], v[132:135], v[44:47]
    ds_read_b64_tr_b16 v[198:199], v11 offset:23040
    s_waitcnt lgkmcnt(10)
    v_mfma_f32_16x16x32_bf16 v[48:51], v[176:179], v[128:131], v[48:51]
    ds_read_b64_tr_b16 v[168:169], v11 offset:18464
    v_mfma_f32_16x16x32_bf16 v[52:55], v[176:179], v[132:135], v[52:55]
    ds_read_b64_tr_b16 v[170:171], v11 offset:23072
    s_waitcnt lgkmcnt(10)
    v_mfma_f32_16x16x32_bf16 v[56:59], v[180:183], v[128:131], v[56:59]
    ds_read_b64_tr_b16 v[172:173], v11 offset:18496
    v_mfma_f32_16x16x32_bf16 v[60:63], v[180:183], v[132:135], v[60:63]
    ds_read_b64_tr_b16 v[174:175], v11 offset:23104
    s_waitcnt lgkmcnt(10)
    v_mfma_f32_16x16x32_bf16 v[64:67], v[184:187], v[128:131], v[64:67]
    ds_read_b64_tr_b16 v[176:177], v11 offset:18528
    v_mfma_f32_16x16x32_bf16 v[68:71], v[184:187], v[132:135], v[68:71]
    ds_read_b64_tr_b16 v[178:179], v11 offset:23136
    s_waitcnt lgkmcnt(10)
    v_mfma_f32_16x16x32_bf16 v[72:75], v[188:191], v[128:131], v[72:75]
    ds_read_b64_tr_b16 v[180:181], v11 offset:18560
    v_mfma_f32_16x16x32_bf16 v[76:79], v[188:191], v[132:135], v[76:79]
    ds_read_b64_tr_b16 v[182:183], v11 offset:23168
    s_waitcnt lgkmcnt(10)
    v_mfma_f32_16x16x32_bf16 v[80:83], v[192:195], v[128:131], v[80:83]
    ds_read_b64_tr_b16 v[184:185], v11 offset:18592
    v_mfma_f32_16x16x32_bf16 v[84:87], v[192:195], v[132:135], v[84:87]
    ds_read_b64_tr_b16 v[186:187], v11 offset:23200
    s_waitcnt vmcnt(32) lgkmcnt(10)
    v_mfma_f32_16x16x32_bf16 v[16:19], v[196:199], v[136:139], v[16:19]
    ds_read_b64_tr_b16 v[188:189], v11 offset:18624
    v_mfma_f32_16x16x32_bf16 v[20:23], v[196:199], v[140:143], v[20:23]
    ds_read_b64_tr_b16 v[190:191], v11 offset:23232
    s_add_u32 s33, s28, 63488
    buffer_load_dwordx4 v[128:131], v1, s[16:19], s33 offen offset:0 sc1
    buffer_load_dwordx4 v[132:135], v1, s[16:19], s33 offen offset:1024 sc1
    s_waitcnt lgkmcnt(10)
    v_mfma_f32_16x16x32_bf16 v[24:27], v[168:171], v[136:139], v[24:27]
    ds_read_b64_tr_b16 v[192:193], v11 offset:18656
    v_mfma_f32_16x16x32_bf16 v[28:31], v[168:171], v[140:143], v[28:31]
    ds_read_b64_tr_b16 v[194:195], v11 offset:23264
    s_waitcnt lgkmcnt(10)
    v_mfma_f32_16x16x32_bf16 v[32:35], v[172:175], v[136:139], v[32:35]
    ds_read_b64_tr_b16 v[196:197], v11 offset:18688
    v_mfma_f32_16x16x32_bf16 v[36:39], v[172:175], v[140:143], v[36:39]
    ds_read_b64_tr_b16 v[198:199], v11 offset:23296
    s_waitcnt vmcnt(30)
    s_barrier
    s_waitcnt lgkmcnt(10)
    v_mfma_f32_16x16x32_bf16 v[40:43], v[176:179], v[136:139], v[40:43]
    ds_read_b64_tr_b16 v[168:169], v12 offset:0
    v_mfma_f32_16x16x32_bf16 v[44:47], v[176:179], v[140:143], v[44:47]
    ds_read_b64_tr_b16 v[170:171], v12 offset:4608
    s_add_u32 s30, s29, 1216512
    s_add_u32 m0, s27, 27648
    s_nop 0
    buffer_load_dwordx4 v2, s[40:43], s30 offen sc1 lds
    s_waitcnt lgkmcnt(10)
    v_mfma_f32_16x16x32_bf16 v[48:51], v[180:183], v[136:139], v[48:51]
    ds_read_b64_tr_b16 v[172:173], v12 offset:32
    v_mfma_f32_16x16x32_bf16 v[52:55], v[180:183], v[140:143], v[52:55]
    ds_read_b64_tr_b16 v[174:175], v12 offset:4640
    s_waitcnt lgkmcnt(10)
    v_mfma_f32_16x16x32_bf16 v[56:59], v[184:187], v[136:139], v[56:59]
    ds_read_b64_tr_b16 v[176:177], v12 offset:64
    v_mfma_f32_16x16x32_bf16 v[60:63], v[184:187], v[140:143], v[60:63]
    ds_read_b64_tr_b16 v[178:179], v12 offset:4672
    s_add_u32 m0, s27, 28672
    s_nop 0
    buffer_load_dwordx4 v3, s[40:43], s30 offen sc1 lds
    s_waitcnt lgkmcnt(10)
    v_mfma_f32_16x16x32_bf16 v[64:67], v[188:191], v[136:139], v[64:67]
    ds_read_b64_tr_b16 v[180:181], v12 offset:96
    v_mfma_f32_16x16x32_bf16 v[68:71], v[188:191], v[140:143], v[68:71]
    ds_read_b64_tr_b16 v[182:183], v12 offset:4704
    s_waitcnt lgkmcnt(10)
    v_mfma_f32_16x16x32_bf16 v[72:75], v[192:195], v[136:139], v[72:75]
    ds_read_b64_tr_b16 v[184:185], v12 offset:128
    v_mfma_f32_16x16x32_bf16 v[76:79], v[192:195], v[140:143], v[76:79]
    ds_read_b64_tr_b16 v[186:187], v12 offset:4736
    s_add_u32 m0, s27, 29696
    s_nop 0
    buffer_load_dwordx4 v4, s[40:43], s30 offen sc1 lds
    s_waitcnt lgkmcnt(10)
    v_mfma_f32_16x16x32_bf16 v[80:83], v[196:199], v[136:139], v[80:83]
    ds_read_b64_tr_b16 v[188:189], v12 offset:160
    v_mfma_f32_16x16x32_bf16 v[84:87], v[196:199], v[140:143], v[84:87]
    ds_read_b64_tr_b16 v[190:191], v12 offset:4768
    s_waitcnt vmcnt(31) lgkmcnt(10)
    v_mfma_f32_16x16x32_bf16 v[16:19], v[168:171], v[144:147], v[16:19]
    ds_read_b64_tr_b16 v[192:193], v12 offset:192
    v_mfma_f32_16x16x32_bf16 v[20:23], v[168:171], v[148:151], v[20:23]
    ds_read_b64_tr_b16 v[194:195], v12 offset:4800
    s_add_u32 s33, s28, 65536
    buffer_load_dwordx4 v[136:139], v1, s[16:19], s33 offen offset:0 sc1
    buffer_load_dwordx4 v[140:143], v1, s[16:19], s33 offen offset:1024 sc1
    s_waitcnt lgkmcnt(10)
    v_mfma_f32_16x16x32_bf16 v[24:27], v[172:175], v[144:147], v[24:27]
    ds_read_b64_tr_b16 v[196:197], v12 offset:224
    v_mfma_f32_16x16x32_bf16 v[28:31], v[172:175], v[148:151], v[28:31]
    ds_read_b64_tr_b16 v[198:199], v12 offset:4832
    s_add_u32 m0, s27, 30720
    s_nop 0
    buffer_load_dwordx4 v5, s[40:43], s30 offen sc1 lds
    s_waitcnt lgkmcnt(10)
    v_mfma_f32_16x16x32_bf16 v[32:35], v[176:179], v[144:147], v[32:35]
    ds_read_b64_tr_b16 v[168:169], v12 offset:256
    v_mfma_f32_16x16x32_bf16 v[36:39], v[176:179], v[148:151], v[36:39]
    ds_read_b64_tr_b16 v[170:171], v12 offset:4864
    s_waitcnt lgkmcnt(10)
    v_mfma_f32_16x16x32_bf16 v[40:43], v[180:183], v[144:147], v[40:43]
    ds_read_b64_tr_b16 v[172:173], v12 offset:9216
    v_mfma_f32_16x16x32_bf16 v[44:47], v[180:183], v[148:151], v[44:47]
    ds_read_b64_tr_b16 v[174:175], v12 offset:13824
    s_add_u32 m0, s27, 31744
    s_nop 0
    buffer_load_dwordx4 v6, s[40:43], s30 offen sc1 lds
    s_waitcnt lgkmcnt(10)
    v_mfma_f32_16x16x32_bf16 v[48:51], v[184:187], v[144:147], v[48:51]
    ds_read_b64_tr_b16 v[176:177], v12 offset:9248
    v_mfma_f32_16x16x32_bf16 v[52:55], v[184:187], v[148:151], v[52:55]
    ds_read_b64_tr_b16 v[178:179], v12 offset:13856
    s_waitcnt lgkmcnt(10)
    v_mfma_f32_16x16x32_bf16 v[56:59], v[188:191], v[144:147], v[56:59]
    ds_read_b64_tr_b16 v[180:181], v12 offset:9280
    v_mfma_f32_16x16x32_bf16 v[60:63], v[188:191], v[148:151], v[60:63]
    ds_read_b64_tr_b16 v[182:183], v12 offset:13888
    s_add_u32 m0, s27, 32768
    s_nop 0
    buffer_load_dwordx4 v7, s[40:43], s30 offen sc1 lds
    s_waitcnt lgkmcnt(10)
    v_mfma_f32_16x16x32_bf16 v[64:67], v[192:195], v[144:147], v[64:67]
    ds_read_b64_tr_b16 v[184:185], v12 offset:9312
    v_mfma_f32_16x16x32_bf16 v[68:71], v[192:195], v[148:151], v[68:71]
    ds_read_b64_tr_b16 v[186:187], v12 offset:13920
    s_waitcnt lgkmcnt(10)
    v_mfma_f32_16x16x32_bf16 v[72:75], v[196:199], v[144:147], v[72:75]
    ds_read_b64_tr_b16 v[188:189], v12 offset:9344
    v_mfma_f32_16x16x32_bf16 v[76:79], v[196:199], v[148:151], v[76:79]
    ds_read_b64_tr_b16 v[190:191], v12 offset:13952
    s_add_u32 m0, s27, 33792
    s_mov_b32 exec_hi, 0xffff
    buffer_load_dwordx4 v8, s[40:43], s30 offen sc1 lds
    s_mov_b32 exec_hi, -1
    s_waitcnt lgkmcnt(10)
    v_mfma_f32_16x16x32_bf16 v[80:83], v[168:171], v[144:147], v[80:83]
    ds_read_b64_tr_b16 v[192:193], v12 offset:9376
    v_mfma_f32_16x16x32_bf16 v[84:87], v[168:171], v[148:151], v[84:87]
    ds_read_b64_tr_b16 v[194:195], v12 offset:13984
    s_waitcnt vmcnt(35) lgkmcnt(10)
    v_mfma_f32_16x16x32_bf16 v[16:19], v[172:175], v[152:155], v[16:19]
    ds_read_b64_tr_b16 v[196:197], v12 offset:9408
    v_mfma_f32_16x16x32_bf16 v[20:23], v[172:175], v[156:159], v[20:23]
    ds_read_b64_tr_b16 v[198:199], v12 offset:14016
    s_add_u32 s33, s28, 67584
    buffer_load_dwordx4 v[144:147], v1, s[16:19], s33 offen offset:0 sc1
    buffer_load_dwordx4 v[148:151], v1, s[16:19], s33 offen offset:1024 sc1
    s_waitcnt lgkmcnt(10)
    v_mfma_f32_16x16x32_bf16 v[24:27], v[176:179], v[152:155], v[24:27]
    ds_read_b64_tr_b16 v[168:169], v12 offset:9440
    v_mfma_f32_16x16x32_bf16 v[28:31], v[176:179], v[156:159], v[28:31]
    ds_read_b64_tr_b16 v[170:171], v12 offset:14048
    s_waitcnt lgkmcnt(10)
    v_mfma_f32_16x16x32_bf16 v[32:35], v[180:183], v[152:155], v[32:35]
    ds_read_b64_tr_b16 v[172:173], v12 offset:9472
    v_mfma_f32_16x16x32_bf16 v[36:39], v[180:183], v[156:159], v[36:39]
    ds_read_b64_tr_b16 v[174:175], v12 offset:14080
    s_waitcnt lgkmcnt(10)
    v_mfma_f32_16x16x32_bf16 v[40:43], v[184:187], v[152:155], v[40:43]
    ds_read_b64_tr_b16 v[176:177], v12 offset:18432
    v_mfma_f32_16x16x32_bf16 v[44:47], v[184:187], v[156:159], v[44:47]
    ds_read_b64_tr_b16 v[178:179], v12 offset:23040
    s_waitcnt lgkmcnt(10)
    v_mfma_f32_16x16x32_bf16 v[48:51], v[188:191], v[152:155], v[48:51]
    ds_read_b64_tr_b16 v[180:181], v12 offset:18464
    v_mfma_f32_16x16x32_bf16 v[52:55], v[188:191], v[156:159], v[52:55]
    ds_read_b64_tr_b16 v[182:183], v12 offset:23072
    s_waitcnt lgkmcnt(10)
    v_mfma_f32_16x16x32_bf16 v[56:59], v[192:195], v[152:155], v[56:59]
    ds_read_b64_tr_b16 v[184:185], v12 offset:18496
    v_mfma_f32_16x16x32_bf16 v[60:63], v[192:195], v[156:159], v[60:63]
    ds_read_b64_tr_b16 v[186:187], v12 offset:23104
    s_waitcnt lgkmcnt(10)
    v_mfma_f32_16x16x32_bf16 v[64:67], v[196:199], v[152:155], v[64:67]
    ds_read_b64_tr_b16 v[188:189], v12 offset:18528
    v_mfma_f32_16x16x32_bf16 v[68:71], v[196:199], v[156:159], v[68:71]
    ds_read_b64_tr_b16 v[190:191], v12 offset:23136
    s_waitcnt lgkmcnt(10)
    v_mfma_f32_16x16x32_bf16 v[72:75], v[168:171], v[152:155], v[72:75]
    ds_read_b64_tr_b16 v[192:193], v12 offset:18560
    v_mfma_f32_16x16x32_bf16 v[76:79], v[168:171], v[156:159], v[76:79]
    ds_read_b64_tr_b16 v[194:195], v12 offset:23168
    s_waitcnt lgkmcnt(10)
    v_mfma_f32_16x16x32_bf16 v[80:83], v[172:175], v[152:155], v[80:83]
    ds_read_b64_tr_b16 v[196:197], v12 offset:18592
    v_mfma_f32_16x16x32_bf16 v[84:87], v[172:175], v[156:159], v[84:87]
    ds_read_b64_tr_b16 v[198:199], v12 offset:23200
    s_waitcnt vmcnt(32) lgkmcnt(10)
    v_mfma_f32_16x16x32_bf16 v[16:19], v[176:179], v[160:163], v[16:19]
    ds_read_b64_tr_b16 v[168:169], v12 offset:18624
    v_mfma_f32_16x16x32_bf16 v[20:23], v[176:179], v[164:167], v[20:23]
    ds_read_b64_tr_b16 v[170:171], v12 offset:23232
    s_add_u32 s33, s28, 69632
    buffer_load_dwordx4 v[152:155], v1, s[16:19], s33 offen offset:0 sc1
    buffer_load_dwordx4 v[156:159], v1, s[16:19], s33 offen offset:1024 sc1
    s_waitcnt lgkmcnt(10)
    v_mfma_f32_16x16x32_bf16 v[24:27], v[180:183], v[160:163], v[24:27]
    ds_read_b64_tr_b16 v[172:173], v12 offset:18656
    v_mfma_f32_16x16x32_bf16 v[28:31], v[180:183], v[164:167], v[28:31]
    ds_read_b64_tr_b16 v[174:175], v12 offset:23264
    s_waitcnt lgkmcnt(10)
    v_mfma_f32_16x16x32_bf16 v[32:35], v[184:187], v[160:163], v[32:35]
    ds_read_b64_tr_b16 v[176:177], v12 offset:18688
    v_mfma_f32_16x16x32_bf16 v[36:39], v[184:187], v[164:167], v[36:39]
    ds_read_b64_tr_b16 v[178:179], v12 offset:23296
    s_waitcnt vmcnt(30)
    s_barrier
    s_waitcnt lgkmcnt(10)
    v_mfma_f32_16x16x32_bf16 v[40:43], v[188:191], v[160:163], v[40:43]
    ds_read_b64_tr_b16 v[180:181], v13 offset:0
    v_mfma_f32_16x16x32_bf16 v[44:47], v[188:191], v[164:167], v[44:47]
    ds_read_b64_tr_b16 v[182:183], v13 offset:4608
    s_waitcnt lgkmcnt(10)
    v_mfma_f32_16x16x32_bf16 v[48:51], v[192:195], v[160:163], v[48:51]
    ds_read_b64_tr_b16 v[184:185], v13 offset:32
    v_mfma_f32_16x16x32_bf16 v[52:55], v[192:195], v[164:167], v[52:55]
    ds_read_b64_tr_b16 v[186:187], v13 offset:4640
    s_waitcnt lgkmcnt(10)
    v_mfma_f32_16x16x32_bf16 v[56:59], v[196:199], v[160:163], v[56:59]
    ds_read_b64_tr_b16 v[188:189], v13 offset:64
    v_mfma_f32_16x16x32_bf16 v[60:63], v[196:199], v[164:167], v[60:63]
    ds_read_b64_tr_b16 v[190:191], v13 offset:4672
    s_waitcnt lgkmcnt(10)
    v_mfma_f32_16x16x32_bf16 v[64:67], v[168:171], v[160:163], v[64:67]
    ds_read_b64_tr_b16 v[192:193], v13 offset:96
    v_mfma_f32_16x16x32_bf16 v[68:71], v[168:171], v[164:167], v[68:71]
    ds_read_b64_tr_b16 v[194:195], v13 offset:4704
    s_waitcnt lgkmcnt(10)
    v_mfma_f32_16x16x32_bf16 v[72:75], v[172:175], v[160:163], v[72:75]
    ds_read_b64_tr_b16 v[196:197], v13 offset:128
    v_mfma_f32_16x16x32_bf16 v[76:79], v[172:175], v[164:167], v[76:79]
    ds_read_b64_tr_b16 v[198:199], v13 offset:4736
    s_waitcnt lgkmcnt(10)
    v_mfma_f32_16x16x32_bf16 v[80:83], v[176:179], v[160:163], v[80:83]
    ds_read_b64_tr_b16 v[168:169], v13 offset:160
    v_mfma_f32_16x16x32_bf16 v[84:87], v[176:179], v[164:167], v[84:87]
    ds_read_b64_tr_b16 v[170:171], v13 offset:4768
    s_waitcnt vmcnt(28) lgkmcnt(10)
    v_mfma_f32_16x16x32_bf16 v[16:19], v[180:183], v[96:99], v[16:19]
    ds_read_b64_tr_b16 v[172:173], v13 offset:192
    v_mfma_f32_16x16x32_bf16 v[20:23], v[180:183], v[100:103], v[20:23]
    ds_read_b64_tr_b16 v[174:175], v13 offset:4800
    s_add_u32 s33, s28, 71680
    buffer_load_dwordx4 v[160:163], v1, s[16:19], s33 offen offset:0 sc1
    buffer_load_dwordx4 v[164:167], v1, s[16:19], s33 offen offset:1024 sc1
    s_waitcnt lgkmcnt(10)
    v_mfma_f32_16x16x32_bf16 v[24:27], v[184:187], v[96:99], v[24:27]
    ds_read_b64_tr_b16 v[176:177], v13 offset:224
    v_mfma_f32_16x16x32_bf16 v[28:31], v[184:187], v[100:103], v[28:31]
    ds_read_b64_tr_b16 v[178:179], v13 offset:4832
    s_waitcnt lgkmcnt(10)
    v_mfma_f32_16x16x32_bf16 v[32:35], v[188:191], v[96:99], v[32:35]
    ds_read_b64_tr_b16 v[180:181], v13 offset:256
    v_mfma_f32_16x16x32_bf16 v[36:39], v[188:191], v[100:103], v[36:39]
    ds_read_b64_tr_b16 v[182:183], v13 offset:4864
    s_waitcnt lgkmcnt(10)
    v_mfma_f32_16x16x32_bf16 v[40:43], v[192:195], v[96:99], v[40:43]
    ds_read_b64_tr_b16 v[184:185], v13 offset:9216
    v_mfma_f32_16x16x32_bf16 v[44:47], v[192:195], v[100:103], v[44:47]
    ds_read_b64_tr_b16 v[186:187], v13 offset:13824
    s_waitcnt lgkmcnt(10)
    v_mfma_f32_16x16x32_bf16 v[48:51], v[196:199], v[96:99], v[48:51]
    ds_read_b64_tr_b16 v[188:189], v13 offset:9248
    v_mfma_f32_16x16x32_bf16 v[52:55], v[196:199], v[100:103], v[52:55]
    ds_read_b64_tr_b16 v[190:191], v13 offset:13856
    s_waitcnt lgkmcnt(10)
    v_mfma_f32_16x16x32_bf16 v[56:59], v[168:171], v[96:99], v[56:59]
    ds_read_b64_tr_b16 v[192:193], v13 offset:9280
    v_mfma_f32_16x16x32_bf16 v[60:63], v[168:171], v[100:103], v[60:63]
    ds_read_b64_tr_b16 v[194:195], v13 offset:13888
    s_waitcnt lgkmcnt(10)
    v_mfma_f32_16x16x32_bf16 v[64:67], v[172:175], v[96:99], v[64:67]
    ds_read_b64_tr_b16 v[196:197], v13 offset:9312
    v_mfma_f32_16x16x32_bf16 v[68:71], v[172:175], v[100:103], v[68:71]
    ds_read_b64_tr_b16 v[198:199], v13 offset:13920
    s_waitcnt lgkmcnt(10)
    v_mfma_f32_16x16x32_bf16 v[72:75], v[176:179], v[96:99], v[72:75]
    ds_read_b64_tr_b16 v[168:169], v13 offset:9344
    v_mfma_f32_16x16x32_bf16 v[76:79], v[176:179], v[100:103], v[76:79]
    ds_read_b64_tr_b16 v[170:171], v13 offset:13952
    s_waitcnt lgkmcnt(10)
    v_mfma_f32_16x16x32_bf16 v[80:83], v[180:183], v[96:99], v[80:83]
    ds_read_b64_tr_b16 v[172:173], v13 offset:9376
    v_mfma_f32_16x16x32_bf16 v[84:87], v[180:183], v[100:103], v[84:87]
    ds_read_b64_tr_b16 v[174:175], v13 offset:13984
    s_waitcnt vmcnt(28) lgkmcnt(10)
    v_mfma_f32_16x16x32_bf16 v[16:19], v[184:187], v[104:107], v[16:19]
    ds_read_b64_tr_b16 v[176:177], v13 offset:9408
    v_mfma_f32_16x16x32_bf16 v[20:23], v[184:187], v[108:111], v[20:23]
    ds_read_b64_tr_b16 v[178:179], v13 offset:14016
    s_waitcnt lgkmcnt(10)
    v_mfma_f32_16x16x32_bf16 v[24:27], v[188:191], v[104:107], v[24:27]
    ds_read_b64_tr_b16 v[180:181], v13 offset:9440
    v_mfma_f32_16x16x32_bf16 v[28:31], v[188:191], v[108:111], v[28:31]
    ds_read_b64_tr_b16 v[182:183], v13 offset:14048
    s_waitcnt lgkmcnt(10)
    v_mfma_f32_16x16x32_bf16 v[32:35], v[192:195], v[104:107], v[32:35]
    ds_read_b64_tr_b16 v[184:185], v13 offset:9472
    v_mfma_f32_16x16x32_bf16 v[36:39], v[192:195], v[108:111], v[36:39]
    ds_read_b64_tr_b16 v[186:187], v13 offset:14080
    s_waitcnt lgkmcnt(10)
    v_mfma_f32_16x16x32_bf16 v[40:43], v[196:199], v[104:107], v[40:43]
    ds_read_b64_tr_b16 v[188:189], v13 offset:18432
    v_mfma_f32_16x16x32_bf16 v[44:47], v[196:199], v[108:111], v[44:47]
    ds_read_b64_tr_b16 v[190:191], v13 offset:23040
    s_waitcnt lgkmcnt(10)
    v_mfma_f32_16x16x32_bf16 v[48:51], v[168:171], v[104:107], v[48:51]
    ds_read_b64_tr_b16 v[192:193], v13 offset:18464
    v_mfma_f32_16x16x32_bf16 v[52:55], v[168:171], v[108:111], v[52:55]
    ds_read_b64_tr_b16 v[194:195], v13 offset:23072
    s_waitcnt lgkmcnt(10)
    v_mfma_f32_16x16x32_bf16 v[56:59], v[172:175], v[104:107], v[56:59]
    ds_read_b64_tr_b16 v[196:197], v13 offset:18496
    v_mfma_f32_16x16x32_bf16 v[60:63], v[172:175], v[108:111], v[60:63]
    ds_read_b64_tr_b16 v[198:199], v13 offset:23104
    s_waitcnt lgkmcnt(10)
    v_mfma_f32_16x16x32_bf16 v[64:67], v[176:179], v[104:107], v[64:67]
    ds_read_b64_tr_b16 v[168:169], v13 offset:18528
    v_mfma_f32_16x16x32_bf16 v[68:71], v[176:179], v[108:111], v[68:71]
    ds_read_b64_tr_b16 v[170:171], v13 offset:23136
    s_waitcnt lgkmcnt(10)
    v_mfma_f32_16x16x32_bf16 v[72:75], v[180:183], v[104:107], v[72:75]
    ds_read_b64_tr_b16 v[172:173], v13 offset:18560
    v_mfma_f32_16x16x32_bf16 v[76:79], v[180:183], v[108:111], v[76:79]
    ds_read_b64_tr_b16 v[174:175], v13 offset:23168
    s_waitcnt lgkmcnt(10)
    v_mfma_f32_16x16x32_bf16 v[80:83], v[184:187], v[104:107], v[80:83]
    ds_read_b64_tr_b16 v[176:177], v13 offset:18592
    v_mfma_f32_16x16x32_bf16 v[84:87], v[184:187], v[108:111], v[84:87]
    ds_read_b64_tr_b16 v[178:179], v13 offset:23200
    s_waitcnt vmcnt(23) lgkmcnt(10)
    v_mfma_f32_16x16x32_bf16 v[16:19], v[188:191], v[112:115], v[16:19]
    ds_read_b64_tr_b16 v[180:181], v13 offset:18624
    v_mfma_f32_16x16x32_bf16 v[20:23], v[188:191], v[116:119], v[20:23]
    ds_read_b64_tr_b16 v[182:183], v13 offset:23232
    s_waitcnt lgkmcnt(10)
    v_mfma_f32_16x16x32_bf16 v[24:27], v[192:195], v[112:115], v[24:27]
    ds_read_b64_tr_b16 v[184:185], v13 offset:18656
    v_mfma_f32_16x16x32_bf16 v[28:31], v[192:195], v[116:119], v[28:31]
    ds_read_b64_tr_b16 v[186:187], v13 offset:23264
    s_waitcnt lgkmcnt(10)
    v_mfma_f32_16x16x32_bf16 v[32:35], v[196:199], v[112:115], v[32:35]
    ds_read_b64_tr_b16 v[188:189], v13 offset:18688
    v_mfma_f32_16x16x32_bf16 v[36:39], v[196:199], v[116:119], v[36:39]
    ds_read_b64_tr_b16 v[190:191], v13 offset:23296
    s_waitcnt vmcnt(19)
    s_barrier
    s_waitcnt lgkmcnt(10)
    v_mfma_f32_16x16x32_bf16 v[40:43], v[168:171], v[112:115], v[40:43]
    ds_read_b64_tr_b16 v[192:193], v9 offset:0
    v_mfma_f32_16x16x32_bf16 v[44:47], v[168:171], v[116:119], v[44:47]
    ds_read_b64_tr_b16 v[194:195], v9 offset:4608
    s_waitcnt lgkmcnt(10)
    v_mfma_f32_16x16x32_bf16 v[48:51], v[172:175], v[112:115], v[48:51]
    ds_read_b64_tr_b16 v[196:197], v9 offset:32
    v_mfma_f32_16x16x32_bf16 v[52:55], v[172:175], v[116:119], v[52:55]
    ds_read_b64_tr_b16 v[198:199], v9 offset:4640
    s_waitcnt lgkmcnt(10)
    v_mfma_f32_16x16x32_bf16 v[56:59], v[176:179], v[112:115], v[56:59]
    ds_read_b64_tr_b16 v[168:169], v9 offset:64
    v_mfma_f32_16x16x32_bf16 v[60:63], v[176:179], v[116:119], v[60:63]
    ds_read_b64_tr_b16 v[170:171], v9 offset:4672
    s_waitcnt lgkmcnt(10)
    v_mfma_f32_16x16x32_bf16 v[64:67], v[180:183], v[112:115], v[64:67]
    ds_read_b64_tr_b16 v[172:173], v9 offset:96
    v_mfma_f32_16x16x32_bf16 v[68:71], v[180:183], v[116:119], v[68:71]
    ds_read_b64_tr_b16 v[174:175], v9 offset:4704
    s_waitcnt lgkmcnt(10)
    v_mfma_f32_16x16x32_bf16 v[72:75], v[184:187], v[112:115], v[72:75]
    ds_read_b64_tr_b16 v[176:177], v9 offset:128
    v_mfma_f32_16x16x32_bf16 v[76:79], v[184:187], v[116:119], v[76:79]
    ds_read_b64_tr_b16 v[178:179], v9 offset:4736
    s_waitcnt lgkmcnt(10)
    v_mfma_f32_16x16x32_bf16 v[80:83], v[188:191], v[112:115], v[80:83]
    ds_read_b64_tr_b16 v[180:181], v9 offset:160
    v_mfma_f32_16x16x32_bf16 v[84:87], v[188:191], v[116:119], v[84:87]
    ds_read_b64_tr_b16 v[182:183], v9 offset:4768
    s_waitcnt vmcnt(17) lgkmcnt(10)
    v_mfma_f32_16x16x32_bf16 v[16:19], v[192:195], v[120:123], v[16:19]
    ds_read_b64_tr_b16 v[184:185], v9 offset:192
    v_mfma_f32_16x16x32_bf16 v[20:23], v[192:195], v[124:127], v[20:23]
    ds_read_b64_tr_b16 v[186:187], v9 offset:4800
    s_waitcnt lgkmcnt(10)
    v_mfma_f32_16x16x32_bf16 v[24:27], v[196:199], v[120:123], v[24:27]
    ds_read_b64_tr_b16 v[188:189], v9 offset:224
    v_mfma_f32_16x16x32_bf16 v[28:31], v[196:199], v[124:127], v[28:31]
    ds_read_b64_tr_b16 v[190:191], v9 offset:4832
    s_waitcnt lgkmcnt(10)
    v_mfma_f32_16x16x32_bf16 v[32:35], v[168:171], v[120:123], v[32:35]
    ds_read_b64_tr_b16 v[192:193], v9 offset:256
    v_mfma_f32_16x16x32_bf16 v[36:39], v[168:171], v[124:127], v[36:39]
    ds_read_b64_tr_b16 v[194:195], v9 offset:4864
    s_waitcnt lgkmcnt(10)
    v_mfma_f32_16x16x32_bf16 v[40:43], v[172:175], v[120:123], v[40:43]
    ds_read_b64_tr_b16 v[196:197], v9 offset:9216
    v_mfma_f32_16x16x32_bf16 v[44:47], v[172:175], v[124:127], v[44:47]
    ds_read_b64_tr_b16 v[198:199], v9 offset:13824
    s_waitcnt lgkmcnt(10)
    v_mfma_f32_16x16x32_bf16 v[48:51], v[176:179], v[120:123], v[48:51]
    ds_read_b64_tr_b16 v[168:169], v9 offset:9248
    v_mfma_f32_16x16x32_bf16 v[52:55], v[176:179], v[124:127], v[52:55]
    ds_read_b64_tr_b16 v[170:171], v9 offset:13856
    s_waitcnt lgkmcnt(10)
    v_mfma_f32_16x16x32_bf16 v[56:59], v[180:183], v[120:123], v[56:59]
    ds_read_b64_tr_b16 v[172:173], v9 offset:9280
    v_mfma_f32_16x16x32_bf16 v[60:63], v[180:183], v[124:127], v[60:63]
    ds_read_b64_tr_b16 v[174:175], v9 offset:13888
    s_waitcnt lgkmcnt(10)
    v_mfma_f32_16x16x32_bf16 v[64:67], v[184:187], v[120:123], v[64:67]
    ds_read_b64_tr_b16 v[176:177], v9 offset:9312
    v_mfma_f32_16x16x32_bf16 v[68:71], v[184:187], v[124:127], v[68:71]
    ds_read_b64_tr_b16 v[178:179], v9 offset:13920
    s_waitcnt lgkmcnt(10)
    v_mfma_f32_16x16x32_bf16 v[72:75], v[188:191], v[120:123], v[72:75]
    ds_read_b64_tr_b16 v[180:181], v9 offset:9344
    v_mfma_f32_16x16x32_bf16 v[76:79], v[188:191], v[124:127], v[76:79]
    ds_read_b64_tr_b16 v[182:183], v9 offset:13952
    s_waitcnt lgkmcnt(10)
    v_mfma_f32_16x16x32_bf16 v[80:83], v[192:195], v[120:123], v[80:83]
    ds_read_b64_tr_b16 v[184:185], v9 offset:9376
    v_mfma_f32_16x16x32_bf16 v[84:87], v[192:195], v[124:127], v[84:87]
    ds_read_b64_tr_b16 v[186:187], v9 offset:13984
    s_waitcnt vmcnt(15) lgkmcnt(10)
    v_mfma_f32_16x16x32_bf16 v[16:19], v[196:199], v[128:131], v[16:19]
    ds_read_b64_tr_b16 v[188:189], v9 offset:9408
    v_mfma_f32_16x16x32_bf16 v[20:23], v[196:199], v[132:135], v[20:23]
    ds_read_b64_tr_b16 v[190:191], v9 offset:14016
    s_waitcnt lgkmcnt(10)
    v_mfma_f32_16x16x32_bf16 v[24:27], v[168:171], v[128:131], v[24:27]
    ds_read_b64_tr_b16 v[192:193], v9 offset:9440
    v_mfma_f32_16x16x32_bf16 v[28:31], v[168:171], v[132:135], v[28:31]
    ds_read_b64_tr_b16 v[194:195], v9 offset:14048
    s_waitcnt lgkmcnt(10)
    v_mfma_f32_16x16x32_bf16 v[32:35], v[172:175], v[128:131], v[32:35]
    ds_read_b64_tr_b16 v[196:197], v9 offset:9472
    v_mfma_f32_16x16x32_bf16 v[36:39], v[172:175], v[132:135], v[36:39]
    ds_read_b64_tr_b16 v[198:199], v9 offset:14080
    s_waitcnt lgkmcnt(10)
    v_mfma_f32_16x16x32_bf16 v[40:43], v[176:179], v[128:131], v[40:43]
    ds_read_b64_tr_b16 v[168:169], v9 offset:18432
    v_mfma_f32_16x16x32_bf16 v[44:47], v[176:179], v[132:135], v[44:47]
    ds_read_b64_tr_b16 v[170:171], v9 offset:23040
    s_waitcnt lgkmcnt(10)
    v_mfma_f32_16x16x32_bf16 v[48:51], v[180:183], v[128:131], v[48:51]
    ds_read_b64_tr_b16 v[172:173], v9 offset:18464
    v_mfma_f32_16x16x32_bf16 v[52:55], v[180:183], v[132:135], v[52:55]
    ds_read_b64_tr_b16 v[174:175], v9 offset:23072
    s_waitcnt lgkmcnt(10)
    v_mfma_f32_16x16x32_bf16 v[56:59], v[184:187], v[128:131], v[56:59]
    ds_read_b64_tr_b16 v[176:177], v9 offset:18496
    v_mfma_f32_16x16x32_bf16 v[60:63], v[184:187], v[132:135], v[60:63]
    ds_read_b64_tr_b16 v[178:179], v9 offset:23104
    s_waitcnt lgkmcnt(10)
    v_mfma_f32_16x16x32_bf16 v[64:67], v[188:191], v[128:131], v[64:67]
    ds_read_b64_tr_b16 v[180:181], v9 offset:18528
    v_mfma_f32_16x16x32_bf16 v[68:71], v[188:191], v[132:135], v[68:71]
    ds_read_b64_tr_b16 v[182:183], v9 offset:23136
    s_waitcnt lgkmcnt(10)
    v_mfma_f32_16x16x32_bf16 v[72:75], v[192:195], v[128:131], v[72:75]
    ds_read_b64_tr_b16 v[184:185], v9 offset:18560
    v_mfma_f32_16x16x32_bf16 v[76:79], v[192:195], v[132:135], v[76:79]
    ds_read_b64_tr_b16 v[186:187], v9 offset:23168
    s_waitcnt lgkmcnt(10)
    v_mfma_f32_16x16x32_bf16 v[80:83], v[196:199], v[128:131], v[80:83]
    ds_read_b64_tr_b16 v[188:189], v9 offset:18592
    v_mfma_f32_16x16x32_bf16 v[84:87], v[196:199], v[132:135], v[84:87]
    ds_read_b64_tr_b16 v[190:191], v9 offset:23200
    s_waitcnt vmcnt(10) lgkmcnt(10)
    v_mfma_f32_16x16x32_bf16 v[16:19], v[168:171], v[136:139], v[16:19]
    ds_read_b64_tr_b16 v[192:193], v9 offset:18624
    v_mfma_f32_16x16x32_bf16 v[20:23], v[168:171], v[140:143], v[20:23]
    ds_read_b64_tr_b16 v[194:195], v9 offset:23232
    s_waitcnt lgkmcnt(10)
    v_mfma_f32_16x16x32_bf16 v[24:27], v[172:175], v[136:139], v[24:27]
    ds_read_b64_tr_b16 v[196:197], v9 offset:18656
    v_mfma_f32_16x16x32_bf16 v[28:31], v[172:175], v[140:143], v[28:31]
    ds_read_b64_tr_b16 v[198:199], v9 offset:23264
    s_waitcnt lgkmcnt(10)
    v_mfma_f32_16x16x32_bf16 v[32:35], v[176:179], v[136:139], v[32:35]
    ds_read_b64_tr_b16 v[168:169], v9 offset:18688
    v_mfma_f32_16x16x32_bf16 v[36:39], v[176:179], v[140:143], v[36:39]
    ds_read_b64_tr_b16 v[170:171], v9 offset:23296
    s_waitcnt vmcnt(6)
    s_barrier
    s_waitcnt lgkmcnt(10)
    v_mfma_f32_16x16x32_bf16 v[40:43], v[180:183], v[136:139], v[40:43]
    ds_read_b64_tr_b16 v[172:173], v10 offset:0
    v_mfma_f32_16x16x32_bf16 v[44:47], v[180:183], v[140:143], v[44:47]
    ds_read_b64_tr_b16 v[174:175], v10 offset:4608
    s_waitcnt lgkmcnt(10)
    v_mfma_f32_16x16x32_bf16 v[48:51], v[184:187], v[136:139], v[48:51]
    ds_read_b64_tr_b16 v[176:177], v10 offset:32
    v_mfma_f32_16x16x32_bf16 v[52:55], v[184:187], v[140:143], v[52:55]
    ds_read_b64_tr_b16 v[178:179], v10 offset:4640
    s_waitcnt lgkmcnt(10)
    v_mfma_f32_16x16x32_bf16 v[56:59], v[188:191], v[136:139], v[56:59]
    ds_read_b64_tr_b16 v[180:181], v10 offset:64
    v_mfma_f32_16x16x32_bf16 v[60:63], v[188:191], v[140:143], v[60:63]
    ds_read_b64_tr_b16 v[182:183], v10 offset:4672
    s_waitcnt lgkmcnt(10)
    v_mfma_f32_16x16x32_bf16 v[64:67], v[192:195], v[136:139], v[64:67]
    ds_read_b64_tr_b16 v[184:185], v10 offset:96
    v_mfma_f32_16x16x32_bf16 v[68:71], v[192:195], v[140:143], v[68:71]
    ds_read_b64_tr_b16 v[186:187], v10 offset:4704
    s_waitcnt lgkmcnt(10)
    v_mfma_f32_16x16x32_bf16 v[72:75], v[196:199], v[136:139], v[72:75]
    ds_read_b64_tr_b16 v[188:189], v10 offset:128
    v_mfma_f32_16x16x32_bf16 v[76:79], v[196:199], v[140:143], v[76:79]
    ds_read_b64_tr_b16 v[190:191], v10 offset:4736
    s_waitcnt lgkmcnt(10)
    v_mfma_f32_16x16x32_bf16 v[80:83], v[168:171], v[136:139], v[80:83]
    ds_read_b64_tr_b16 v[192:193], v10 offset:160
    v_mfma_f32_16x16x32_bf16 v[84:87], v[168:171], v[140:143], v[84:87]
    ds_read_b64_tr_b16 v[194:195], v10 offset:4768
    s_waitcnt vmcnt(4) lgkmcnt(10)
    v_mfma_f32_16x16x32_bf16 v[16:19], v[172:175], v[144:147], v[16:19]
    ds_read_b64_tr_b16 v[196:197], v10 offset:192
    v_mfma_f32_16x16x32_bf16 v[20:23], v[172:175], v[148:151], v[20:23]
    ds_read_b64_tr_b16 v[198:199], v10 offset:4800
    s_waitcnt lgkmcnt(10)
    v_mfma_f32_16x16x32_bf16 v[24:27], v[176:179], v[144:147], v[24:27]
    ds_read_b64_tr_b16 v[168:169], v10 offset:224
    v_mfma_f32_16x16x32_bf16 v[28:31], v[176:179], v[148:151], v[28:31]
    ds_read_b64_tr_b16 v[170:171], v10 offset:4832
    s_waitcnt lgkmcnt(10)
    v_mfma_f32_16x16x32_bf16 v[32:35], v[180:183], v[144:147], v[32:35]
    ds_read_b64_tr_b16 v[172:173], v10 offset:256
    v_mfma_f32_16x16x32_bf16 v[36:39], v[180:183], v[148:151], v[36:39]
    ds_read_b64_tr_b16 v[174:175], v10 offset:4864
    s_waitcnt lgkmcnt(10)
    v_mfma_f32_16x16x32_bf16 v[40:43], v[184:187], v[144:147], v[40:43]
    ds_read_b64_tr_b16 v[176:177], v10 offset:9216
    v_mfma_f32_16x16x32_bf16 v[44:47], v[184:187], v[148:151], v[44:47]
    ds_read_b64_tr_b16 v[178:179], v10 offset:13824
    s_waitcnt lgkmcnt(10)
    v_mfma_f32_16x16x32_bf16 v[48:51], v[188:191], v[144:147], v[48:51]
    ds_read_b64_tr_b16 v[180:181], v10 offset:9248
    v_mfma_f32_16x16x32_bf16 v[52:55], v[188:191], v[148:151], v[52:55]
    ds_read_b64_tr_b16 v[182:183], v10 offset:13856
    s_waitcnt lgkmcnt(10)
    v_mfma_f32_16x16x32_bf16 v[56:59], v[192:195], v[144:147], v[56:59]
    ds_read_b64_tr_b16 v[184:185], v10 offset:9280
    v_mfma_f32_16x16x32_bf16 v[60:63], v[192:195], v[148:151], v[60:63]
    ds_read_b64_tr_b16 v[186:187], v10 offset:13888
    s_waitcnt lgkmcnt(10)
    v_mfma_f32_16x16x32_bf16 v[64:67], v[196:199], v[144:147], v[64:67]
    ds_read_b64_tr_b16 v[188:189], v10 offset:9312
    v_mfma_f32_16x16x32_bf16 v[68:71], v[196:199], v[148:151], v[68:71]
    ds_read_b64_tr_b16 v[190:191], v10 offset:13920
    s_waitcnt lgkmcnt(10)
    v_mfma_f32_16x16x32_bf16 v[72:75], v[168:171], v[144:147], v[72:75]
    ds_read_b64_tr_b16 v[192:193], v10 offset:9344
    v_mfma_f32_16x16x32_bf16 v[76:79], v[168:171], v[148:151], v[76:79]
    ds_read_b64_tr_b16 v[194:195], v10 offset:13952
    s_waitcnt lgkmcnt(10)
    v_mfma_f32_16x16x32_bf16 v[80:83], v[172:175], v[144:147], v[80:83]
    ds_read_b64_tr_b16 v[196:197], v10 offset:9376
    v_mfma_f32_16x16x32_bf16 v[84:87], v[172:175], v[148:151], v[84:87]
    ds_read_b64_tr_b16 v[198:199], v10 offset:13984
    s_waitcnt vmcnt(2) lgkmcnt(10)
    v_mfma_f32_16x16x32_bf16 v[16:19], v[176:179], v[152:155], v[16:19]
    ds_read_b64_tr_b16 v[168:169], v10 offset:9408
    v_mfma_f32_16x16x32_bf16 v[20:23], v[176:179], v[156:159], v[20:23]
    ds_read_b64_tr_b16 v[170:171], v10 offset:14016
    s_waitcnt lgkmcnt(10)
    v_mfma_f32_16x16x32_bf16 v[24:27], v[180:183], v[152:155], v[24:27]
    ds_read_b64_tr_b16 v[172:173], v10 offset:9440
    v_mfma_f32_16x16x32_bf16 v[28:31], v[180:183], v[156:159], v[28:31]
    ds_read_b64_tr_b16 v[174:175], v10 offset:14048
    s_waitcnt lgkmcnt(10)
    v_mfma_f32_16x16x32_bf16 v[32:35], v[184:187], v[152:155], v[32:35]
    ds_read_b64_tr_b16 v[176:177], v10 offset:9472
    v_mfma_f32_16x16x32_bf16 v[36:39], v[184:187], v[156:159], v[36:39]
    ds_read_b64_tr_b16 v[178:179], v10 offset:14080
    s_waitcnt lgkmcnt(10)
    v_mfma_f32_16x16x32_bf16 v[40:43], v[188:191], v[152:155], v[40:43]
    ds_read_b64_tr_b16 v[180:181], v10 offset:18432
    v_mfma_f32_16x16x32_bf16 v[44:47], v[188:191], v[156:159], v[44:47]
    ds_read_b64_tr_b16 v[182:183], v10 offset:23040
    s_waitcnt lgkmcnt(10)
    v_mfma_f32_16x16x32_bf16 v[48:51], v[192:195], v[152:155], v[48:51]
    ds_read_b64_tr_b16 v[184:185], v10 offset:18464
    v_mfma_f32_16x16x32_bf16 v[52:55], v[192:195], v[156:159], v[52:55]
    ds_read_b64_tr_b16 v[186:187], v10 offset:23072
    s_waitcnt lgkmcnt(10)
    v_mfma_f32_16x16x32_bf16 v[56:59], v[196:199], v[152:155], v[56:59]
    ds_read_b64_tr_b16 v[188:189], v10 offset:18496
    v_mfma_f32_16x16x32_bf16 v[60:63], v[196:199], v[156:159], v[60:63]
    ds_read_b64_tr_b16 v[190:191], v10 offset:23104
    s_waitcnt lgkmcnt(10)
    v_mfma_f32_16x16x32_bf16 v[64:67], v[168:171], v[152:155], v[64:67]
    ds_read_b64_tr_b16 v[192:193], v10 offset:18528
    v_mfma_f32_16x16x32_bf16 v[68:71], v[168:171], v[156:159], v[68:71]
    ds_read_b64_tr_b16 v[194:195], v10 offset:23136
    s_waitcnt lgkmcnt(10)
    v_mfma_f32_16x16x32_bf16 v[72:75], v[172:175], v[152:155], v[72:75]
    ds_read_b64_tr_b16 v[196:197], v10 offset:18560
    v_mfma_f32_16x16x32_bf16 v[76:79], v[172:175], v[156:159], v[76:79]
    ds_read_b64_tr_b16 v[198:199], v10 offset:23168
    s_waitcnt lgkmcnt(10)
    v_mfma_f32_16x16x32_bf16 v[80:83], v[176:179], v[152:155], v[80:83]
    ds_read_b64_tr_b16 v[168:169], v10 offset:18592
    v_mfma_f32_16x16x32_bf16 v[84:87], v[176:179], v[156:159], v[84:87]
    ds_read_b64_tr_b16 v[170:171], v10 offset:23200
    s_waitcnt vmcnt(0) lgkmcnt(10)
    v_mfma_f32_16x16x32_bf16 v[16:19], v[180:183], v[160:163], v[16:19]
    ds_read_b64_tr_b16 v[172:173], v10 offset:18624
    v_mfma_f32_16x16x32_bf16 v[20:23], v[180:183], v[164:167], v[20:23]
    ds_read_b64_tr_b16 v[174:175], v10 offset:23232
    s_waitcnt lgkmcnt(10)
    v_mfma_f32_16x16x32_bf16 v[24:27], v[184:187], v[160:163], v[24:27]
    ds_read_b64_tr_b16 v[176:177], v10 offset:18656
    v_mfma_f32_16x16x32_bf16 v[28:31], v[184:187], v[164:167], v[28:31]
    ds_read_b64_tr_b16 v[178:179], v10 offset:23264
    s_waitcnt lgkmcnt(10)
    v_mfma_f32_16x16x32_bf16 v[32:35], v[188:191], v[160:163], v[32:35]
    ds_read_b64_tr_b16 v[180:181], v10 offset:18688
    v_mfma_f32_16x16x32_bf16 v[36:39], v[188:191], v[164:167], v[36:39]
    ds_read_b64_tr_b16 v[182:183], v10 offset:23296
    s_waitcnt lgkmcnt(10)
    v_mfma_f32_16x16x32_bf16 v[40:43], v[192:195], v[160:163], v[40:43]
    v_mfma_f32_16x16x32_bf16 v[44:47], v[192:195], v[164:167], v[44:47]
    s_waitcnt lgkmcnt(8)
    v_mfma_f32_16x16x32_bf16 v[48:51], v[196:199], v[160:163], v[48:51]
    v_mfma_f32_16x16x32_bf16 v[52:55], v[196:199], v[164:167], v[52:55]
    s_waitcnt lgkmcnt(6)
    v_mfma_f32_16x16x32_bf16 v[56:59], v[168:171], v[160:163], v[56:59]
    v_mfma_f32_16x16x32_bf16 v[60:63], v[168:171], v[164:167], v[60:63]
    s_waitcnt lgkmcnt(4)
    v_mfma_f32_16x16x32_bf16 v[64:67], v[172:175], v[160:163], v[64:67]
    v_mfma_f32_16x16x32_bf16 v[68:71], v[172:175], v[164:167], v[68:71]
    s_waitcnt lgkmcnt(2)
    v_mfma_f32_16x16x32_bf16 v[72:75], v[176:179], v[160:163], v[72:75]
    v_mfma_f32_16x16x32_bf16 v[76:79], v[176:179], v[164:167], v[76:79]
    s_waitcnt lgkmcnt(0)
    v_mfma_f32_16x16x32_bf16 v[80:83], v[180:183], v[160:163], v[80:83]
    v_mfma_f32_16x16x32_bf16 v[84:87], v[180:183], v[164:167], v[84:87]
K2_tail:
    s_nop 7
    s_load_dwordx2 s[10:11], s[0:1], 104
    s_lshl_b32 s26, s22, 2
    s_add_u32 s26, s26, s21
    s_lshl_b32 s27, s26, 2
    s_add_u32 s28, s27, s25
    s_lshl_b32 s28, s28, 2
    s_add_u32 s28, s28, s20
    s_mul_i32 s28, s28, 18432
    s_add_u32 s28, s28, 50331648
    v_and_b32 v2, 15, v0
    v_lshrrev_b32 v3, 4, v0
    v_mul_u32_u24 v4, 1152, v2
    v_lshl_add_u32 v4, v3, 3, v4
    v_lshlrev_b32 v5, 1, v4
    s_barrier
    s_cmp_eq_u32 s20, s25
    s_cbranch_scc1 K2_own
    s_add_u32 s35, s28, 0
    buffer_store_dwordx4 v[16:19], v1, s[16:19], s35 offen offset:0 sc1
    buffer_store_dwordx4 v[24:27], v1, s[16:19], s35 offen offset:1024 sc1
    buffer_store_dwordx4 v[32:35], v1, s[16:19], s35 offen offset:2048 sc1
    buffer_store_dwordx4 v[40:43], v1, s[16:19], s35 offen offset:3072 sc1
    s_add_u32 s35, s28, 4096
    buffer_store_dwordx4 v[48:51], v1, s[16:19], s35 offen offset:0 sc1
    buffer_store_dwordx4 v[56:59], v1, s[16:19], s35 offen offset:1024 sc1
    buffer_store_dwordx4 v[64:67], v1, s[16:19], s35 offen offset:2048 sc1
    buffer_store_dwordx4 v[72:75], v1, s[16:19], s35 offen offset:3072 sc1
    s_add_u32 s35, s28, 8192
    buffer_store_dwordx4 v[80:83], v1, s[16:19], s35 offen offset:0 sc1
    buffer_store_dwordx4 v[20:23], v1, s[16:19], s35 offen offset:1024 sc1
    buffer_store_dwordx4 v[28:31], v1, s[16:19], s35 offen offset:2048 sc1
    buffer_store_dwordx4 v[36:39], v1, s[16:19], s35 offen offset:3072 sc1
    s_add_u32 s35, s28, 12288
    buffer_store_dwordx4 v[44:47], v1, s[16:19], s35 offen offset:0 sc1
    buffer_store_dwordx4 v[52:55], v1, s[16:19], s35 offen offset:1024 sc1
    buffer_store_dwordx4 v[60:63], v1, s[16:19], s35 offen offset:2048 sc1
    buffer_store_dwordx4 v[68:71], v1, s[16:19], s35 offen offset:3072 sc1
    s_add_u32 s35, s28, 16384
    buffer_store_dwordx4 v[76:79], v1, s[16:19], s35 offen offset:0 sc1
    buffer_store_dwordx4 v[84:87], v1, s[16:19], s35 offen offset:1024 sc1
    s_branch K2_pub
K2_own:
    ds_write_b128 v1, v[16:19] offset:0
    ds_write_b128 v1, v[24:27] offset:1024
    ds_write_b128 v1, v[32:35] offset:2048
    ds_write_b128 v1, v[40:43] offset:3072
    ds_write_b128 v1, v[48:51] offset:4096
    ds_write_b128 v1, v[56:59] offset:5120
    ds_write_b128 v1, v[64:67] offset:6144
    ds_write_b128 v1, v[72:75] offset:7168
    ds_write_b128 v1, v[80:83] offset:8192
    ds_write_b128 v1, v[20:23] offset:9216
    ds_write_b128 v1, v[28:31] offset:10240
    ds_write_b128 v1, v[36:39] offset:11264
    ds_write_b128 v1, v[44:47] offset:12288
    ds_write_b128 v1, v[52:55] offset:13312
    ds_write_b128 v1, v[60:63] offset:14336
    ds_write_b128 v1, v[68:71] offset:15360
    ds_write_b128 v1, v[76:79] offset:16384
    ds_write_b128 v1, v[84:87] offset:17408
K2_pub:
    s_waitcnt vmcnt(0) lgkmcnt(0)
    s_mov_b32 s40, s10
    s_and_b32 s41, s11, 0xffff
    s_mov_b32 s42, 4718592
    s_mov_b32 s43, 0x00020000
    s_barrier
    s_cmp_lg_u32 s20, 0
    s_cbranch_scc1 K2_noflag
    s_mov_b64 exec, 1
    s_add_u32 s100, s3, 5
    v_mov_b32 v88, s100
    v_mov_b32 v89, 0
    buffer_store_dword v88, v89, s[16:19], s101 offen sc1
    s_mov_b64 exec, -1
K2_noflag:
    s_mov_b64 exec, 15
    v_lshlrev_b32 v88, 8, v0
    s_andn2_b32 s29, s2, 3
    s_lshl_b32 s29, s29, 8
    s_add_u32 s29, s29, 49283072
K2_poll:
    buffer_load_dword v89, v88, s[16:19], s29 offen sc1
    s_add_u32 s100, s3, 5
    s_waitcnt vmcnt(0)
    v_subrev_u32 v89, s100, v89
    v_cmp_le_u32 vcc, 3, v89
    s_nop 4
    s_cbranch_vccz K2_poll_ok
    s_sleep 2
    s_branch K2_poll
K2_poll_ok:
K2_polled:
    s_mov_b64 exec, -1
    s_lshl_b32 s44, s20, 10
    v_add_u32 v88, s44, v1
    s_cmp_eq_u32 s25, 0
    s_cbranch_scc1 K2_so_17
    s_add_u32 s44, s27, 0
    s_lshl_b32 s44, s44, 2
    s_add_u32 s44, s44, s25
    s_mul_i32 s44, s44, 18
    s_add_u32 s44, s44, s20
    s_lshl_b32 s44, s44, 10
    s_add_u32 s44, s44, 50331648
    buffer_load_dwordx4 v[96:99], v1, s[16:19], s44 offen sc1
    s_add_u32 s44, s44, 4096
    buffer_load_dwordx4 v[112:115], v1, s[16:19], s44 offen sc1
    s_add_u32 s44, s44, 4096
    buffer_load_dwordx4 v[128:131], v1, s[16:19], s44 offen sc1
    s_add_u32 s44, s44, 4096
    buffer_load_dwordx4 v[144:147], v1, s[16:19], s44 offen sc1
    s_add_u32 s44, s44, 4096
    s_cmp_gt_u32 s20, 1
    s_cbranch_scc1 K2_se_18
    buffer_load_dwordx4 v[160:163], v1, s[16:19], s44 offen sc1
    s_add_u32 s44, s44, 4096
    s_branch K2_se_18
K2_so_17:
    ds_read_b128 v[96:99], v88 offset:0
    ds_read_b128 v[112:115], v88 offset:4096
    ds_read_b128 v[128:131], v88 offset:8192
    ds_read_b128 v[144:147], v88 offset:12288
    ds_read_b128 v[160:163], v88 offset:16384
K2_se_18:
    s_cmp_eq_u32 s25, 1
    s_cbranch_scc1 K2_so_19
    s_add_u32 s44, s27, 1
    s_lshl_b32 s44, s44, 2
    s_add_u32 s44, s44, s25
    s_mul_i32 s44, s44, 18
    s_add_u32 s44, s44, s20
    s_lshl_b32 s44, s44, 10
    s_add_u32 s44, s44, 50331648
    buffer_load_dwordx4 v[100:103], v1, s[16:19], s44 offen sc1
    s_add_u32 s44, s44, 4096
    buffer_load_dwordx4 v[116:119], v1, s[16:19], s44 offen sc1
    s_add_u32 s44, s44, 4096
    buffer_load_dwordx4 v[132:135], v1, s[16:19], s44 offen sc1
    s_add_u32 s44, s44, 4096
    buffer_load_dwordx4 v[148:151], v1, s[16:19], s44 offen sc1
    s_add_u32 s44, s44, 4096
    s_cmp_gt_u32 s20, 1
    s_cbranch_scc1 K2_se_20
    buffer_load_dwordx4 v[164:167], v1, s[16:19], s44 offen sc1
    s_add_u32 s44, s44, 4096
    s_branch K2_se_20
K2_so_19:
    ds_read_b128 v[100:103], v88 offset:0
    ds_read_b128 v[116:119], v88 offset:4096
    ds_read_b128 v[132:135], v88 offset:8192
    ds_read_b128 v[148:151], v88 offset:12288
    ds_read_b128 v[164:167], v88 offset:16384
K2_se_20:
    s_cmp_eq_u32 s25, 2
    s_cbranch_scc1 K2_so_21
    s_add_u32 s44, s27, 2
    s_lshl_b32 s44, s44, 2
    s_add_u32 s44, s44, s25
    s_mul_i32 s44, s44, 18
    s_add_u32 s44, s44, s20
    s_lshl_b32 s44, s44, 10
    s_add_u32 s44, s44, 50331648
    buffer_load_dwordx4 v[104:107], v1, s[16:19], s44 offen sc1
    s_add_u32 s44, s44, 4096
    buffer_load_dwordx4 v[120:123], v1, s[16:19], s44 offen sc1
    s_add_u32 s44, s44, 4096
    buffer_load_dwordx4 v[136:139], v1, s[16:19], s44 offen sc1
    s_add_u32 s44, s44, 4096
    buffer_load_dwordx4 v[152:155], v1, s[16:19], s44 offen sc1
    s_add_u32 s44, s44, 4096
    s_cmp_gt_u32 s20, 1
    s_cbranch_scc1 K2_se_22
    buffer_load_dwordx4 v[168:171], v1, s[16:19], s44 offen sc1
    s_add_u32 s44, s44, 4096
    s_branch K2_se_22
K2_so_21:
    ds_read_b128 v[104:107], v88 offset:0
    ds_read_b128 v[120:123], v88 offset:4096
    ds_read_b128 v[136:139], v88 offset:8192
    ds_read_b128 v[152:155], v88 offset:12288
    ds_read_b128 v[168:171], v88 offset:16384
K2_se_22:
    s_cmp_eq_u32 s25, 3
    s_cbranch_scc1 K2_so_23
    s_add_u32 s44, s27, 3
    s_lshl_b32 s44, s44, 2
    s_add_u32 s44, s44, s25
    s_mul_i32 s44, s44, 18
    s_add_u32 s44, s44, s20
    s_lshl_b32 s44, s44, 10
    s_add_u32 s44, s44, 50331648
    buffer_load_dwordx4 v[108:111], v1, s[16:19], s44 offen sc1
    s_add_u32 s44, s44, 4096
    buffer_load_dwordx4 v[124:127], v1, s[16:19], s44 offen sc1
    s_add_u32 s44, s44, 4096
    buffer_load_dwordx4 v[140:143], v1, s[16:19], s44 offen sc1
    s_add_u32 s44, s44, 4096
    buffer_load_dwordx4 v[156:159], v1, s[16:19], s44 offen sc1
    s_add_u32 s44, s44, 4096
    s_cmp_gt_u32 s20, 1
    s_cbranch_scc1 K2_se_24
    buffer_load_dwordx4 v[172:175], v1, s[16:19], s44 offen sc1
    s_add_u32 s44, s44, 4096
    s_branch K2_se_24
K2_so_23:
    ds_read_b128 v[108:111], v88 offset:0
    ds_read_b128 v[124:127], v88 offset:4096
    ds_read_b128 v[140:143], v88 offset:8192
    ds_read_b128 v[156:159], v88 offset:12288
    ds_read_b128 v[172:175], v88 offset:16384
K2_se_24:
    s_waitcnt vmcnt(0) lgkmcnt(0)
    v_accvgpr_read_b32 v88, a0
    v_accvgpr_read_b32 v89, a1
    v_accvgpr_read_b32 v90, a2
    v_accvgpr_read_b32 v91, a3
    v_accvgpr_read_b32 v92, a4
    v_accvgpr_read_b32 v93, a5
    v_add_f32 v96, v96, v100
    v_add_f32 v97, v97, v101
    v_add_f32 v98, v98, v102
    v_add_f32 v99, v99, v103
    v_lshlrev_b32 v16, 16, v88
    v_and_b32 v17, 0xffff0000, v88
    v_lshlrev_b32 v18, 16, v89
    v_and_b32 v19, 0xffff0000, v89
    v_lshlrev_b32 v20, 16, v90
    v_and_b32 v21, 0xffff0000, v90
    v_lshlrev_b32 v22, 16, v91
    v_and_b32 v23, 0xffff0000, v91
    v_lshlrev_b32 v24, 16, v92
    v_and_b32 v25, 0xffff0000, v92
    v_lshlrev_b32 v26, 16, v93
    v_and_b32 v27, 0xffff0000, v93
    v_add_f32 v96, v96, v104
    v_add_f32 v97, v97, v105
    v_add_f32 v98, v98, v106
    v_add_f32 v99, v99, v107
    v_mul_f32 v20, v20, v24
    v_mul_f32 v21, v21, v25
    v_mul_f32 v22, v22, v26
    v_mul_f32 v23, v23, v27
    v_cvt_pk_bf16_f32 v96, 0, v96
    v_cvt_pk_bf16_f32 v97, 0, v97
    v_cvt_pk_bf16_f32 v98, 0, v98
    v_cvt_pk_bf16_f32 v99, 0, v99
    v_cvt_pk_bf16_f32 v20, 0, v20
    v_cvt_pk_bf16_f32 v21, 0, v21
    v_cvt_pk_bf16_f32 v22, 0, v22
    v_cvt_pk_bf16_f32 v23, 0, v23
    v_add_f32 v108, v108, v20
    v_add_f32 v109, v109, v21
    v_add_f32 v110, v110, v22
    v_add_f32 v111, v111, v23
    v_add_f32 v108, v16, v108
    v_add_f32 v109, v17, v109
    v_add_f32 v110, v18, v110
    v_add_f32 v111, v19, v111
    v_add_f32 v108, v108, v96
    v_add_f32 v109, v109, v97
    v_add_f32 v110, v110, v98
    v_add_f32 v111, v111, v99
    s_lshl_b32 s44, s52, 1
    buffer_store_dwordx4 v[108:111], v5, s[40:43], s44 offen
    v_accvgpr_read_b32 v88, a6
    v_accvgpr_read_b32 v89, a7
    v_accvgpr_read_b32 v90, a8
    v_accvgpr_read_b32 v91, a9
    v_accvgpr_read_b32 v92, a10
    v_accvgpr_read_b32 v93, a11
    v_add_f32 v112, v112, v116
    v_add_f32 v113, v113, v117
    v_add_f32 v114, v114, v118
    v_add_f32 v115, v115, v119
    v_lshlrev_b32 v28, 16, v88
    v_and_b32 v29, 0xffff0000, v88
    v_lshlrev_b32 v30, 16, v89
    v_and_b32 v31, 0xffff0000, v89
    v_lshlrev_b32 v32, 16, v90
    v_and_b32 v33, 0xffff0000, v90
    v_lshlrev_b32 v34, 16, v91
    v_and_b32 v35, 0xffff0000, v91
    v_lshlrev_b32 v36, 16, v92
    v_and_b32 v37, 0xffff0000, v92
    v_lshlrev_b32 v38, 16, v93
    v_and_b32 v39, 0xffff0000, v93
    v_add_f32 v112, v112, v120
    v_add_f32 v113, v113, v121
    v_add_f32 v114, v114, v122
    v_add_f32 v115, v115, v123
    v_mul_f32 v32, v32, v36
    v_mul_f32 v33, v33, v37
    v_mul_f32 v34, v34, v38
    v_mul_f32 v35, v35, v39
    v_cvt_pk_bf16_f32 v112, 0, v112
    v_cvt_pk_bf16_f32 v113, 0, v113
    v_cvt_pk_bf16_f32 v114, 0, v114
    v_cvt_pk_bf16_f32 v115, 0, v115
    v_cvt_pk_bf16_f32 v32, 0, v32
    v_cvt_pk_bf16_f32 v33, 0, v33
    v_cvt_pk_bf16_f32 v34, 0, v34
    v_cvt_pk_bf16_f32 v35, 0, v35
    v_add_f32 v124, v124, v32
    v_add_f32 v125, v125, v33
    v_add_f32 v126, v126, v34
    v_add_f32 v127, v127, v35
    v_add_f32 v124, v28, v124
    v_add_f32 v125, v29, v125
    v_add_f32 v126, v30, v126
    v_add_f32 v127, v31, v127
    v_add_f32 v124, v124, v112
    v_add_f32 v125, v125, v113
    v_add_f32 v126, v126, v114
    v_add_f32 v127, v127, v115
    s_lshl_b32 s44, s53, 1
    buffer_store_dwordx4 v[124:127], v5, s[40:43], s44 offen
    v_accvgpr_read_b32 v88, a12
    v_accvgpr_read_b32 v89, a13
    v_accvgpr_read_b32 v90, a14
    v_accvgpr_read_b32 v91, a15
    v_accvgpr_read_b32 v92, a16
    v_accvgpr_read_b32 v93, a17
    v_add_f32 v128, v128, v132
    v_add_f32 v129, v129, v133
    v_add_f32 v130, v130, v134
    v_add_f32 v131, v131, v135
    v_lshlrev_b32 v40, 16, v88
    v_and_b32 v41, 0xffff0000, v88
    v_lshlrev_b32 v42, 16, v89
    v_and_b32 v43, 0xffff0000, v89
    v_lshlrev_b32 v44, 16, v90
    v_and_b32 v45, 0xffff0000, v90
    v_lshlrev_b32 v46, 16, v91
    v_and_b32 v47, 0xffff0000, v91
    v_lshlrev_b32 v48, 16, v92
    v_and_b32 v49, 0xffff0000, v92
    v_lshlrev_b32 v50, 16, v93
    v_and_b32 v51, 0xffff0000, v93
    v_add_f32 v128, v128, v136
    v_add_f32 v129, v129, v137
    v_add_f32 v130, v130, v138
    v_add_f32 v131, v131, v139
    v_mul_f32 v44, v44, v48
    v_mul_f32 v45, v45, v49
    v_mul_f32 v46, v46, v50
    v_mul_f32 v47, v47, v51
    v_cvt_pk_bf16_f32 v128, 0, v128
    v_cvt_pk_bf16_f32 v129, 0, v129
    v_cvt_pk_bf16_f32 v130, 0, v130
    v_cvt_pk_bf16_f32 v131, 0, v131
    v_cvt_pk_bf16_f32 v44, 0, v44
    v_cvt_pk_bf16_f32 v45, 0, v45
    v_cvt_pk_bf16_f32 v46, 0, v46
    v_cvt_pk_bf16_f32 v47, 0, v47
    v_add_f32 v140, v140, v44
    v_add_f32 v141, v141, v45
    v_add_f32 v142, v142, v46
    v_add_f32 v143, v143, v47
    v_add_f32 v140, v40, v140
    v_add_f32 v141, v41, v141
    v_add_f32 v142, v42, v142
    v_add_f32 v143, v43, v143
    v_add_f32 v140, v140, v128
    v_add_f32 v141, v141, v129
    v_add_f32 v142, v142, v130
    v_add_f32 v143, v143, v131
    s_lshl_b32 s44, s54, 1
    buffer_store_dwordx4 v[140:143], v5, s[40:43], s44 offen
    v_accvgpr_read_b32 v88, a18
    v_accvgpr_read_b32 v89, a19
    v_accvgpr_read_b32 v90, a20
    v_accvgpr_read_b32 v91, a21
    v_accvgpr_read_b32 v92, a22
    v_accvgpr_read_b32 v93, a23
    v_add_f32 v144, v144, v148
    v_add_f32 v145, v145, v149
    v_add_f32 v146, v146, v150
    v_add_f32 v147, v147, v151
    v_lshlrev_b32 v52, 16, v88
    v_and_b32 v53, 0xffff0000, v88
    v_lshlrev_b32 v54, 16, v89
    v_and_b32 v55, 0xffff0000, v89
    v_lshlrev_b32 v56, 16, v90
    v_and_b32 v57, 0xffff0000, v90
    v_lshlrev_b32 v58, 16, v91
    v_and_b32 v59, 0xffff0000, v91
    v_lshlrev_b32 v60, 16, v92
    v_and_b32 v61, 0xffff0000, v92
    v_lshlrev_b32 v62, 16, v93
    v_and_b32 v63, 0xffff0000, v93
    v_add_f32 v144, v144, v152
    v_add_f32 v145, v145, v153
    v_add_f32 v146, v146, v154
    v_add_f32 v147, v147, v155
    v_mul_f32 v56, v56, v60
    v_mul_f32 v57, v57, v61
    v_mul_f32 v58, v58, v62
    v_mul_f32 v59, v59, v63
    v_cvt_pk_bf16_f32 v144, 0, v144
    v_cvt_pk_bf16_f32 v145, 0, v145
    v_cvt_pk_bf16_f32 v146, 0, v146
    v_cvt_pk_bf16_f32 v147, 0, v147
    v_cvt_pk_bf16_f32 v56, 0, v56
    v_cvt_pk_bf16_f32 v57, 0, v57
    v_cvt_pk_bf16_f32 v58, 0, v58
    v_cvt_pk_bf16_f32 v59, 0, v59
    v_add_f32 v156, v156, v56
    v_add_f32 v157, v157, v57
    v_add_f32 v158, v158, v58
    v_add_f32 v159, v159, v59
    v_add_f32 v156, v52, v156
    v_add_f32 v157, v53, v157
    v_add_f32 v158, v54, v158
    v_add_f32 v159, v55, v159
    v_add_f32 v156, v156, v144
    v_add_f32 v157, v157, v145
    v_add_f32 v158, v158, v146
    v_add_f32 v159, v159, v147
    s_lshl_b32 s44, s55, 1
    buffer_store_dwordx4 v[156:159], v5, s[40:43], s44 offen
    s_cmp_gt_u32 s20, 1
    s_cbranch_scc1 K2_l3
    v_accvgpr_read_b32 v88, a24
    v_accvgpr_read_b32 v89, a25
    v_accvgpr_read_b32 v90, a26
    v_accvgpr_read_b32 v91, a27
    v_accvgpr_read_b32 v92, a28
    v_accvgpr_read_b32 v93, a29
    v_add_f32 v160, v160, v164
    v_add_f32 v161, v161, v165
    v_add_f32 v162, v162, v166
    v_add_f32 v163, v163, v167
    v_lshlrev_b32 v64, 16, v88
    v_and_b32 v65, 0xffff0000, v88
    v_lshlrev_b32 v66, 16, v89
    v_and_b32 v67, 0xffff0000, v89
    v_lshlrev_b32 v68, 16, v90
    v_and_b32 v69, 0xffff0000, v90
    v_lshlrev_b32 v70, 16, v91
    v_and_b32 v71, 0xffff0000, v91
    v_lshlrev_b32 v72, 16, v92
    v_and_b32 v73, 0xffff0000, v92
    v_lshlrev_b32 v74, 16, v93
    v_and_b32 v75, 0xffff0000, v93
    v_add_f32 v160, v160, v168
    v_add_f32 v161, v161, v169
    v_add_f32 v162, v162, v170
    v_add_f32 v163, v163, v171
    v_mul_f32 v68, v68, v72
    v_mul_f32 v69, v69, v73
    v_mul_f32 v70, v70, v74
    v_mul_f32 v71, v71, v75
    v_cvt_pk_bf16_f32 v160, 0, v160
    v_cvt_pk_bf16_f32 v161, 0, v161
    v_cvt_pk_bf16_f32 v162, 0, v162
    v_cvt_pk_bf16_f32 v163, 0, v163
    v_cvt_pk_bf16_f32 v68, 0, v68
    v_cvt_pk_bf16_f32 v69, 0, v69
    v_cvt_pk_bf16_f32 v70, 0, v70
    v_cvt_pk_bf16_f32 v71, 0, v71
    v_add_f32 v172, v172, v68
    v_add_f32 v173, v173, v69
    v_add_f32 v174, v174, v70
    v_add_f32 v175, v175, v71
    v_add_f32 v172, v64, v172
    v_add_f32 v173, v65, v173
    v_add_f32 v174, v66, v174
    v_add_f32 v175, v67, v175
    v_add_f32 v172, v172, v160
    v_add_f32 v173, v173, v161
    v_add_f32 v174, v174, v162
    v_add_f32 v175, v175, v163
    s_lshl_b32 s44, s56, 1
    buffer_store_dwordx4 v[172:175], v5, s[40:43], s44 offen
K2_l3:
K1_done:
    s_endpgm
.section .rodata,"a"
.p2align 6
.amdhsa_kernel parallel_sum__ssm_conv_s5__swiglu_ffn__prompt_kernel
  .amdhsa_next_free_vgpr 256
  .amdhsa_next_free_sgpr 102
  .amdhsa_accum_offset 200
  .amdhsa_group_segment_fixed_size 0
  .amdhsa_kernarg_size 128
  .amdhsa_user_sgpr_count 2
  .amdhsa_user_sgpr_kernarg_segment_ptr 1
  .amdhsa_system_sgpr_workgroup_id_x 1
  .amdhsa_float_denorm_mode_32 3
.end_amdhsa_kernel
```
